```python
import torch

def _softmax(x, axis=-1):
    return torch.softmax(x, dim=axis)

def _gelu(x):
    return torch.nn.functional.gelu(x, approximate='tanh')

def _silu(x):
    return torch.nn.functional.silu(x)

def _sigmoid(x):
    return torch.sigmoid(x)

def _layernorm(x, axis=-1, eps=1e-05):
    m = x.mean(dim=axis, keepdim=True)
    v = x.var(dim=axis, keepdim=True, unbiased=False)
    return (x - m) / torch.sqrt(v + eps)

def _scatter_add(tgt, idx, src, axis=0):
    return tgt.clone().index_add_(axis, idx, src)

def _segment_sum(src, seg, n):
    out = torch.zeros((n,) + src.shape[1:], dtype=src.dtype)
    return out.index_add_(0, seg, src)

def _pad(x, pw):
    flat = tuple((v for pair in reversed(pw) for v in pair))
    return torch.nn.functional.pad(x, flat)
kernel_name = 'gated_mix__linear_attn_block__memory_aug_recurrent_mem_tr__prompt'

def setup_inputs():

    _w = lambda a: (lambda t: t.to(torch.bfloat16) if t.is_floating_point() else t)(torch.as_tensor(a))

    def _A_setup():
        B, S, D = (1, 2048, 640)
        return {'x': _w((lambda *s: torch.randn(*s, dtype=torch.bfloat16) * 0.05)(B, S, D)), 'wqkv': _w((lambda *s: torch.randn(*s, dtype=torch.bfloat16) * 1.6)(D, 3 * D)), 'wo': _w((lambda *s: torch.randn(*s, dtype=torch.bfloat16) * 0.1)(D, D))}
    _A_in = _A_setup()

    def _B_setup():
        B, S, Dm = (1, 2048, 640)
        H, Dh = (32, 192)
        M, seg = (8, 32)
        seg = min(seg, S)
        S = S // seg * seg
        return {'x': _w((lambda *s: torch.randn(*s, dtype=torch.bfloat16) * 0.05)(B, S, Dm)), 'mem0': _w((lambda *s: torch.randn(*s, dtype=torch.bfloat16) * 0.8)(B, M, Dm)), 'Wq': _w((lambda *s: torch.randn(*s, dtype=torch.bfloat16) * 3.2)(Dm, H, Dh) * Dm ** (-0.5)), 'Wk': _w((lambda *s: torch.randn(*s, dtype=torch.bfloat16) * 3.2)(Dm, H, Dh) * Dm ** (-0.5)), 'Wv': _w((lambda *s: torch.randn(*s, dtype=torch.bfloat16) * 0.8)(Dm, H, Dh) * Dm ** (-0.5)), 'Wo': _w((lambda *s: torch.randn(*s, dtype=torch.bfloat16) * 0.8)(H, Dh, Dm) * (H * Dh) ** (-0.5)), 'seg_len': seg}
    _B_in = _B_setup()
    return {'A_x': _A_in['x'], 'A_wqkv': _A_in['wqkv'], 'A_wo': _A_in['wo'], 'B_x': _B_in['x'], 'B_mem0': _B_in['mem0'], 'B_Wq': _B_in['Wq'], 'B_Wk': _B_in['Wk'], 'B_Wv': _B_in['Wv'], 'B_Wo': _B_in['Wo'], 'B_seg_len': _B_in['seg_len'], 'gate_w': _w((lambda *s: torch.randn(*s, dtype=torch.bfloat16) * 0.05)(640) * 16.0)}

def reference(A_x, A_wqkv, A_wo, B_x, B_mem0, B_Wq, B_Wk, B_Wv, B_Wo, B_seg_len, gate_w):

    def _A_ref(x, wqkv, wo):
        B, S, D = x.shape
        H = 32
        Dh = D // H
        qkv = (lambda x, *d: x.permute(*d))((x @ wqkv).reshape(B, S, 3, H, Dh), 2, 0, 3, 1, 4)
        q, k, v = (qkv[0], qkv[1], qkv[2])
        phi = lambda t: torch.where(t > 0, t + 1, torch.exp(t)) + 1e-06
        pq, pk = (phi(q), phi(k))
        kv = torch.einsum('bhsd,bhse->bhde', pk, v)
        z = torch.einsum('bhsd->bhd', pk)
        num = torch.einsum('bhqd,bhde->bhqe', pq, kv)
        den = torch.einsum('bhqd,bhd->bhq', pq, z)[..., None] + 1e-06
        o = num / den
        return (lambda x, *d: x.permute(*d))(o, 0, 2, 1, 3).reshape(B, S, D) @ wo

    def _B_ref(x, mem0, Wq, Wk, Wv, Wo, seg_len):
        B, S, Dm = x.shape
        H, Dh = (Wq.shape[1], Wq.shape[2])
        M = mem0.shape[1]
        scale = Dh ** (-0.5)
        n_seg = S // seg_len
        L = M + seg_len
        idx = torch.arange(L)
        mask = (idx[:, None] < M) | (idx[:, None] >= idx[None, :])
        mem = mem0
        outs = []
        for s in range(n_seg):
            xs = x[:, s * seg_len:(s + 1) * seg_len, :].clone()
            h = torch.concatenate([mem, xs], axis=1)
            q = torch.einsum('btd,dhe->bhte', h, Wq)
            k = torch.einsum('btd,dhe->bhte', h, Wk)
            v = torch.einsum('btd,dhe->bhte', h, Wv)
            scores = torch.einsum('bhqe,bhke->bhqk', q, k) * scale
            scores = torch.where(mask[None, None], scores, -1000000000.0)
            p = _softmax(scores, axis=-1)
            o = torch.einsum('bhqk,bhke->bhqe', p, v)
            o = torch.einsum('bhte,hed->btd', o, Wo)
            mem = o[:, :M, :].clone()
            outs.append(o[:, M:, :])
        return torch.concatenate(outs, axis=1)
    x = A_x
    g = _sigmoid((x * gate_w).sum(-1, keepdims=True))
    a = _A_ref(x, A_wqkv, A_wo)
    b = _B_ref(x, B_mem0, B_Wq, B_Wk, B_Wv, B_Wo, B_seg_len)
    return g * a + (1 - g) * b
```

```asm
; @launch grid=(256,1,1) block=(256,1,1) lds=163840
.amdgcn_target "amdgcn-amd-amdhsa--gfx950"
.text
.globl gated_mix__linear_attn_block__memory_aug_recurrent_mem_tr__prompt_kernel
.p2align 8
.type gated_mix__linear_attn_block__memory_aug_recurrent_mem_tr__prompt_kernel,@function
gated_mix__linear_attn_block__memory_aug_recurrent_mem_tr__prompt_kernel:
    s_load_dwordx16 s[8:23], s[0:1], 0
    s_load_dwordx8 s[24:31], s[0:1], 64
    s_load_dwordx4 s[32:35], s[0:1], 96
    s_getreg_b32 s4, hwreg(HW_REG_XCC_ID, 0, 3)
    v_lshrrev_b32 v1, 6, v0
    s_mov_b32 s7, 0
    v_readfirstlane_b32 s3, v1
    s_waitcnt lgkmcnt(0)
    s_add_u32 s34, s34, 0x1fffff
    s_addc_u32 s35, s35, 0
    s_and_b32 s34, s34, 0xffe00000
    s_mov_b32 s36, s34
    s_and_b32 s37, s35, 0xffff
    s_mov_b32 s38, 266338304
    s_mov_b32 s39, 0x20000
    s_mov_b32 s48, s32
    s_and_b32 s49, s33, 0xffff
    s_mov_b32 s50, 256
    s_mov_b32 s51, 0x20000
    v_mov_b32 v1, 0
    s_cmp_lg_u32 s3, 0
    s_cbranch_scc1 L_tk_1
    s_lshl_b32 s5, s4, 5
    v_mov_b32 v2, s5
    v_mov_b32 v3, 1
    s_mov_b64 exec, 1
    buffer_atomic_add v3, v2, s[48:51], 0 offen offset:0 sc0 sc1
    s_mov_b64 exec, -1
    s_mov_b32 s40, s24
    s_and_b32 s41, s25, 0xffff
    s_mov_b32 s42, 7864320
    s_mov_b32 s43, 0x20000
    s_lshr_b32 s52, s2, 3
    s_and_b32 s52, s52, 31
    s_lshl_b32 s53, s4, 5
    s_add_u32 s52, s52, s53
    s_mul_i32 s52, s52, 61440
    v_min_u32 v4, 59, v0
    v_lshlrev_b32 v4, 7, v4
    buffer_load_dword v255, v4, s[40:43], s52 offen
    s_add_u32 s52, s52, 7680
    buffer_load_dword v255, v4, s[40:43], s52 offen
    s_add_u32 s52, s52, 7680
    buffer_load_dword v255, v4, s[40:43], s52 offen
    s_add_u32 s52, s52, 7680
    buffer_load_dword v255, v4, s[40:43], s52 offen
    s_add_u32 s52, s52, 7680
    buffer_load_dword v255, v4, s[40:43], s52 offen
    s_add_u32 s52, s52, 7680
    buffer_load_dword v255, v4, s[40:43], s52 offen
    s_add_u32 s52, s52, 7680
    buffer_load_dword v255, v4, s[40:43], s52 offen
    s_add_u32 s52, s52, 7680
    buffer_load_dword v255, v4, s[40:43], s52 offen
    s_add_u32 s52, s52, 7680
    s_waitcnt vmcnt(8)
    s_mov_b64 exec, 1
    ds_write_b32 v1, v3
    s_mov_b64 exec, -1
    s_waitcnt lgkmcnt(0)
L_tk_1:
    s_barrier
    ds_read_b32 v2, v1
    s_waitcnt lgkmcnt(0)
    v_readfirstlane_b32 s5, v2
    s_barrier
    s_cmp_ge_u32 s5, 32
    s_cbranch_scc1 L_exit
    s_cmp_lt_u32 s4, 4
    s_cbranch_scc1 L_rec
    v_and_b32 v2, 63, v0
    v_lshrrev_b32 v1, 4, v2
    v_and_b32 v0, 15, v2
    v_lshlrev_b32 v3, 4, v2
    v_lshrrev_b32 v10, 3, v0
    v_lshlrev_b32 v10, 9, v10
    v_lshl_add_u32 v10, v1, 7, v10
    v_and_b32 v11, 7, v0
    v_lshl_add_u32 v4, v11, 4, v10
    v_mov_b32 v8, 0
    s_sub_u32 s52, s4, 4
    s_lshl_b32 s52, s52, 3
    s_lshr_b32 s55, s5, 2
    s_add_u32 s52, s52, s55
    s_lshl_b32 s65, s4, 5
    s_add_u32 s65, s65, s5
    s_lshl_b32 s65, s65, 7
    s_add_u32 s65, s65, 1441792
    s_cmp_lg_u32 s3, 0
    s_cbranch_scc1 L_ini_2
    v_lshlrev_b32 v10, 2, v2
    s_mov_b64 exec, 15
    buffer_store_dword v8, v10, s[36:39], s65 offen offset:0 sc1
    s_mov_b64 exec, -1
    s_and_b32 s55, s5, 3
    s_cmp_lg_u32 s55, 2
    s_cbranch_scc1 L_ini_2
    v_mbcnt_lo_u32_b32 v11, -1, 0
    v_and_b32 v12, 1, v11
    v_lshlrev_b32 v12, 7, v12
    v_bfe_u32 v13, v11, 1, 1
    v_lshl_add_u32 v12, v13, 13, v12
    s_lshl_b32 s86, s52, 8
    s_add_u32 s86, s86, 786432
    s_mov_b64 exec, 15
    buffer_store_dword v11, v12, s[36:39], s86 offen offset:0 sc1
    s_mov_b64 exec, -1
L_ini_2:
    s_and_b32 s58, s5, 3
    s_mov_b32 s40, s22
    s_and_b32 s41, s23, 0xffff
    s_mov_b32 s42, 7864320
    s_mov_b32 s43, 0x20000
    s_and_b32 s55, s52, 7
    s_mul_i32 s55, s55, 4
    s_add_u32 s55, s55, s58
    s_lshl_b32 s55, s55, 2
    s_add_u32 s55, s55, s3
    s_mul_i32 s55, s55, 61440
    s_lshr_b32 s56, s52, 3
    s_mul_i32 s56, s56, 3072
    s_add_u32 s55, s55, s56
    v_min_u32 v10, 59, v2
    v_add_u32 v10, 0, v10
    v_mul_u32_u24 v11, 0xaab, v10
    v_lshrrev_b32 v11, 16, v11
    v_mul_u32_u24 v12, 24, v11
    v_sub_u32 v10, v10, v12
    v_mul_u32_u24 v11, 12288, v11
    v_lshl_add_u32 v13, v10, 7, v11
    v_min_u32 v10, 59, v2
    v_add_u32 v10, 60, v10
    v_mul_u32_u24 v11, 0xaab, v10
    v_lshrrev_b32 v11, 16, v11
    v_mul_u32_u24 v12, 24, v11
    v_sub_u32 v10, v10, v12
    v_mul_u32_u24 v11, 12288, v11
    v_lshl_add_u32 v14, v10, 7, v11
    buffer_load_dword v255, v13, s[40:43], s55 offen
    buffer_load_dword v255, v14, s[40:43], s55 offen
    s_add_u32 s55, s55, 61440
    s_and_b32 s55, s5, 3
    s_cmp_eq_u32 s55, 0
    s_cbranch_scc1 L_k
    s_cmp_eq_u32 s55, 1
    s_cbranch_scc1 L_v
    s_cmp_eq_u32 s55, 2
    s_cbranch_scc1 L_y
    s_cmp_lg_u32 s3, 0
    s_cbranch_scc1 L_idn_3
    v_mov_b32 v10, 4
    v_mov_b32 v11, 1
    s_waitcnt vmcnt(0)
    s_mov_b64 exec, 1
    buffer_atomic_add v11, v10, s[48:51], 0 offen sc1
    s_mov_b64 exec, -1
L_idn_3:
    s_waitcnt vmcnt(0)
    s_barrier
    s_mov_b32 s40, s8
    s_and_b32 s41, s9, 0xffff
    s_mov_b32 s42, 2621440
    s_mov_b32 s43, 0x20000
    s_lshl_b32 s55, s52, 2
    s_add_u32 s55, s55, s3
    s_lshl_b32 s55, s55, 7
    v_lshlrev_b32 v10, 14, v2
    buffer_load_dword v255, v10, s[40:43], s55 offen
    s_add_u32 s55, s55, 1048576
    buffer_load_dword v255, v10, s[40:43], s55 offen
    s_add_u32 s55, s55, 1048576
    buffer_load_dword v255, v10, s[40:43], s55 offen
    s_add_u32 s55, s55, 1048576
    s_mov_b32 s6, 0
    s_mov_b32 s64, 58
    s_mov_b32 s95, 0
    s_mov_b32 s90, 1
    s_branch L_toq
L_k2q:
    s_mov_b32 s6, 58
    s_mov_b32 s64, 64
    s_mov_b32 s95, 128
    s_mov_b32 s90, 2
L_toq:
    s_mov_b32 s78, 0
    s_lshl_b32 s55, s52, 2
    v_add_u32 v9, s55, v2
    s_add_u32 s55, s55, 128
    v_mov_b32 v10, s55
    v_cmp_gt_u32 vcc, 4, v2
    s_nop 1
    v_cndmask_b32 v9, v10, v9, vcc
    v_lshlrev_b32 v9, 7, v9
    v_add_u32 v9, 1441792, v9
L_q:
    s_mov_b32 s40, s18
    s_and_b32 s41, s19, 0xffff
    s_mov_b32 s42, 7864320
    s_mov_b32 s43, 0x20000
    s_mul_i32 s54, s52, 384
    s_mul_i32 s53, s3, 3
    v_lshrrev_b32 v21, 3, v2
    v_mul_u32_u24 v16, 12288, v21
    v_bfe_u32 v21, v21, 1, 1
    s_and_b32 s55, s3, 1
    s_lshl_b32 s55, s55, 1
    v_add_u32 v21, s55, v21
    v_lshlrev_b32 v21, 1, v21
    v_and_b32 v22, 7, v2
    v_xor_b32 v21, v21, v22
    v_lshl_add_u32 v16, v21, 4, v16
    v_lshrrev_b32 v21, 2, v0
    v_lshl_add_u32 v17, v1, 3, v21
    v_lshlrev_b32 v17, 7, v17
    v_and_b32 v22, 3, v0
    v_lshl_add_u32 v17, v22, 3, v17
    v_lshrrev_b32 v21, 1, v21
    v_and_b32 v22, 1, v1
    v_lshl_add_u32 v21, v22, 1, v21
    s_lshl_b32 s58, s3, 10
    s_mul_i32 s57, s3, 98304
    s_add_u32 s57, s57, s54
    s_add_u32 s55, s53, 0
    s_and_b32 s56, s55, 3
    s_lshr_b32 s55, s55, 2
    s_mul_i32 s55, s55, 20480
    v_xor_b32 v22, s56, v21
    v_lshl_add_u32 v22, v22, 5, v17
    v_add_u32 v18, s55, v22
    s_add_u32 s55, s53, 1
    s_and_b32 s56, s55, 3
    s_lshr_b32 s55, s55, 2
    s_mul_i32 s55, s55, 20480
    v_xor_b32 v22, s56, v21
    v_lshl_add_u32 v22, v22, 5, v17
    v_add_u32 v19, s55, v22
    s_add_u32 s55, s53, 2
    s_and_b32 s56, s55, 3
    s_lshr_b32 s55, s55, 2
    s_mul_i32 s55, s55, 20480
    v_xor_b32 v22, s56, v21
    v_lshl_add_u32 v22, v22, 5, v17
    v_add_u32 v20, s55, v22
    s_add_u32 m0, s58, 0
    s_add_u32 s55, s57, 0
    buffer_load_dwordx4 v16, s[40:43], s55 offen lds
    s_add_u32 m0, s58, 20480
    s_add_u32 s55, s57, 128
    buffer_load_dwordx4 v16, s[40:43], s55 offen lds
    s_add_u32 m0, s58, 40960
    s_add_u32 s55, s57, 256
    buffer_load_dwordx4 v16, s[40:43], s55 offen lds
    s_add_u32 m0, s58, 4096
    s_add_u32 s55, s57, 393216
    buffer_load_dwordx4 v16, s[40:43], s55 offen lds
    s_add_u32 m0, s58, 24576
    s_add_u32 s55, s57, 393344
    buffer_load_dwordx4 v16, s[40:43], s55 offen lds
    s_add_u32 m0, s58, 45056
    s_add_u32 s55, s57, 393472
    buffer_load_dwordx4 v16, s[40:43], s55 offen lds
    s_add_u32 m0, s58, 8192
    s_add_u32 s55, s57, 786432
    buffer_load_dwordx4 v16, s[40:43], s55 offen lds
    s_add_u32 m0, s58, 28672
    s_add_u32 s55, s57, 786560
    buffer_load_dwordx4 v16, s[40:43], s55 offen lds
    s_add_u32 m0, s58, 49152
    s_add_u32 s55, s57, 786688
    buffer_load_dwordx4 v16, s[40:43], s55 offen lds
    s_add_u32 m0, s58, 12288
    s_add_u32 s55, s57, 1179648
    buffer_load_dwordx4 v16, s[40:43], s55 offen lds
    s_add_u32 m0, s58, 32768
    s_add_u32 s55, s57, 1179776
    buffer_load_dwordx4 v16, s[40:43], s55 offen lds
    s_add_u32 m0, s58, 53248
    s_add_u32 s55, s57, 1179904
    buffer_load_dwordx4 v16, s[40:43], s55 offen lds
    s_add_u32 m0, s58, 16384
    s_add_u32 s55, s57, 1572864
    buffer_load_dwordx4 v16, s[40:43], s55 offen lds
    s_add_u32 m0, s58, 36864
    s_add_u32 s55, s57, 1572992
    buffer_load_dwordx4 v16, s[40:43], s55 offen lds
    s_add_u32 m0, s58, 57344
    s_add_u32 s55, s57, 1573120
    buffer_load_dwordx4 v16, s[40:43], s55 offen lds
    s_add_u32 m0, s58, 61440
    s_add_u32 s55, s57, 1966080
    buffer_load_dwordx4 v16, s[40:43], s55 offen lds
    s_add_u32 m0, s58, 81920
    s_add_u32 s55, s57, 1966208
    buffer_load_dwordx4 v16, s[40:43], s55 offen lds
    s_add_u32 m0, s58, 102400
    s_add_u32 s55, s57, 1966336
    buffer_load_dwordx4 v16, s[40:43], s55 offen lds
    s_add_u32 m0, s58, 65536
    s_add_u32 s55, s57, 2359296
    buffer_load_dwordx4 v16, s[40:43], s55 offen lds
    s_add_u32 m0, s58, 86016
    s_add_u32 s55, s57, 2359424
    buffer_load_dwordx4 v16, s[40:43], s55 offen lds
    s_add_u32 m0, s58, 106496
    s_add_u32 s55, s57, 2359552
    buffer_load_dwordx4 v16, s[40:43], s55 offen lds
    s_add_u32 m0, s58, 69632
    s_add_u32 s55, s57, 2752512
    buffer_load_dwordx4 v16, s[40:43], s55 offen lds
    s_add_u32 m0, s58, 90112
    s_add_u32 s55, s57, 2752640
    buffer_load_dwordx4 v16, s[40:43], s55 offen lds
    s_add_u32 m0, s58, 110592
    s_add_u32 s55, s57, 2752768
    buffer_load_dwordx4 v16, s[40:43], s55 offen lds
    s_add_u32 m0, s58, 73728
    s_add_u32 s55, s57, 3145728
    buffer_load_dwordx4 v16, s[40:43], s55 offen lds
    s_add_u32 m0, s58, 94208
    s_add_u32 s55, s57, 3145856
    buffer_load_dwordx4 v16, s[40:43], s55 offen lds
    s_add_u32 m0, s58, 114688
    s_add_u32 s55, s57, 3145984
    buffer_load_dwordx4 v16, s[40:43], s55 offen lds
    s_add_u32 m0, s58, 77824
    s_add_u32 s55, s57, 3538944
    buffer_load_dwordx4 v16, s[40:43], s55 offen lds
    s_add_u32 m0, s58, 98304
    s_add_u32 s55, s57, 3539072
    buffer_load_dwordx4 v16, s[40:43], s55 offen lds
    s_add_u32 m0, s58, 118784
    s_add_u32 s55, s57, 3539200
    buffer_load_dwordx4 v16, s[40:43], s55 offen lds
    s_waitcnt vmcnt(15)
    s_barrier
    v_add_u32 v22, 0, v18
    ds_read_b64_tr_b16 a[0:1], v22 offset:0
    ds_read_b64_tr_b16 a[2:3], v22 offset:512
    ds_read_b64_tr_b16 a[4:5], v22 offset:4096
    ds_read_b64_tr_b16 a[6:7], v22 offset:4608
    ds_read_b64_tr_b16 a[8:9], v22 offset:8192
    ds_read_b64_tr_b16 a[10:11], v22 offset:8704
    ds_read_b64_tr_b16 a[12:13], v22 offset:12288
    ds_read_b64_tr_b16 a[14:15], v22 offset:12800
    s_waitcnt lgkmcnt(6)
    ds_read_b64_tr_b16 a[16:17], v22 offset:16384
    ds_read_b64_tr_b16 a[18:19], v22 offset:16896
    v_add_u32 v23, 0, v19
    ds_read_b64_tr_b16 a[80:81], v23 offset:0
    ds_read_b64_tr_b16 a[82:83], v23 offset:512
    ds_read_b64_tr_b16 a[84:85], v23 offset:4096
    ds_read_b64_tr_b16 a[86:87], v23 offset:4608
    ds_read_b64_tr_b16 a[88:89], v23 offset:8192
    ds_read_b64_tr_b16 a[90:91], v23 offset:8704
    s_waitcnt lgkmcnt(6)
    ds_read_b64_tr_b16 a[92:93], v23 offset:12288
    ds_read_b64_tr_b16 a[94:95], v23 offset:12800
    ds_read_b64_tr_b16 a[96:97], v23 offset:16384
    ds_read_b64_tr_b16 a[98:99], v23 offset:16896
    v_add_u32 v22, 0, v20
    ds_read_b64_tr_b16 a[160:161], v22 offset:0
    ds_read_b64_tr_b16 a[162:163], v22 offset:512
    ds_read_b64_tr_b16 a[164:165], v22 offset:4096
    ds_read_b64_tr_b16 a[166:167], v22 offset:4608
    s_waitcnt lgkmcnt(6)
    ds_read_b64_tr_b16 a[168:169], v22 offset:8192
    ds_read_b64_tr_b16 a[170:171], v22 offset:8704
    ds_read_b64_tr_b16 a[172:173], v22 offset:12288
    ds_read_b64_tr_b16 a[174:175], v22 offset:12800
    ds_read_b64_tr_b16 a[176:177], v22 offset:16384
    ds_read_b64_tr_b16 a[178:179], v22 offset:16896
    s_waitcnt lgkmcnt(0)
    s_barrier
    s_add_u32 m0, s58, 0
    s_add_u32 s55, s57, 3932160
    buffer_load_dwordx4 v16, s[40:43], s55 offen lds
    s_add_u32 m0, s58, 20480
    s_add_u32 s55, s57, 3932288
    buffer_load_dwordx4 v16, s[40:43], s55 offen lds
    s_add_u32 m0, s58, 40960
    s_add_u32 s55, s57, 3932416
    buffer_load_dwordx4 v16, s[40:43], s55 offen lds
    s_add_u32 m0, s58, 4096
    s_add_u32 s55, s57, 4325376
    buffer_load_dwordx4 v16, s[40:43], s55 offen lds
    s_add_u32 m0, s58, 24576
    s_add_u32 s55, s57, 4325504
    buffer_load_dwordx4 v16, s[40:43], s55 offen lds
    s_add_u32 m0, s58, 45056
    s_add_u32 s55, s57, 4325632
    buffer_load_dwordx4 v16, s[40:43], s55 offen lds
    s_add_u32 m0, s58, 8192
    s_add_u32 s55, s57, 4718592
    buffer_load_dwordx4 v16, s[40:43], s55 offen lds
    s_add_u32 m0, s58, 28672
    s_add_u32 s55, s57, 4718720
    buffer_load_dwordx4 v16, s[40:43], s55 offen lds
    s_add_u32 m0, s58, 49152
    s_add_u32 s55, s57, 4718848
    buffer_load_dwordx4 v16, s[40:43], s55 offen lds
    s_add_u32 m0, s58, 12288
    s_add_u32 s55, s57, 5111808
    buffer_load_dwordx4 v16, s[40:43], s55 offen lds
    s_add_u32 m0, s58, 32768
    s_add_u32 s55, s57, 5111936
    buffer_load_dwordx4 v16, s[40:43], s55 offen lds
    s_add_u32 m0, s58, 53248
    s_add_u32 s55, s57, 5112064
    buffer_load_dwordx4 v16, s[40:43], s55 offen lds
    s_add_u32 m0, s58, 16384
    s_add_u32 s55, s57, 5505024
    buffer_load_dwordx4 v16, s[40:43], s55 offen lds
    s_add_u32 m0, s58, 36864
    s_add_u32 s55, s57, 5505152
    buffer_load_dwordx4 v16, s[40:43], s55 offen lds
    s_add_u32 m0, s58, 57344
    s_add_u32 s55, s57, 5505280
    buffer_load_dwordx4 v16, s[40:43], s55 offen lds
    s_waitcnt vmcnt(15)
    s_barrier
    v_add_u32 v22, 61440, v18
    ds_read_b64_tr_b16 a[20:21], v22 offset:0
    ds_read_b64_tr_b16 a[22:23], v22 offset:512
    ds_read_b64_tr_b16 a[24:25], v22 offset:4096
    ds_read_b64_tr_b16 a[26:27], v22 offset:4608
    ds_read_b64_tr_b16 a[28:29], v22 offset:8192
    ds_read_b64_tr_b16 a[30:31], v22 offset:8704
    ds_read_b64_tr_b16 a[32:33], v22 offset:12288
    ds_read_b64_tr_b16 a[34:35], v22 offset:12800
    s_waitcnt lgkmcnt(6)
    ds_read_b64_tr_b16 a[36:37], v22 offset:16384
    ds_read_b64_tr_b16 a[38:39], v22 offset:16896
    v_add_u32 v23, 61440, v19
    ds_read_b64_tr_b16 a[100:101], v23 offset:0
    ds_read_b64_tr_b16 a[102:103], v23 offset:512
    ds_read_b64_tr_b16 a[104:105], v23 offset:4096
    ds_read_b64_tr_b16 a[106:107], v23 offset:4608
    ds_read_b64_tr_b16 a[108:109], v23 offset:8192
    ds_read_b64_tr_b16 a[110:111], v23 offset:8704
    s_waitcnt lgkmcnt(6)
    ds_read_b64_tr_b16 a[112:113], v23 offset:12288
    ds_read_b64_tr_b16 a[114:115], v23 offset:12800
    ds_read_b64_tr_b16 a[116:117], v23 offset:16384
    ds_read_b64_tr_b16 a[118:119], v23 offset:16896
    v_add_u32 v22, 61440, v20
    ds_read_b64_tr_b16 a[180:181], v22 offset:0
    ds_read_b64_tr_b16 a[182:183], v22 offset:512
    ds_read_b64_tr_b16 a[184:185], v22 offset:4096
    ds_read_b64_tr_b16 a[186:187], v22 offset:4608
    s_waitcnt lgkmcnt(6)
    ds_read_b64_tr_b16 a[188:189], v22 offset:8192
    ds_read_b64_tr_b16 a[190:191], v22 offset:8704
    ds_read_b64_tr_b16 a[192:193], v22 offset:12288
    ds_read_b64_tr_b16 a[194:195], v22 offset:12800
    ds_read_b64_tr_b16 a[196:197], v22 offset:16384
    ds_read_b64_tr_b16 a[198:199], v22 offset:16896
    s_waitcnt lgkmcnt(0)
    s_barrier
    s_add_u32 m0, s58, 61440
    s_add_u32 s55, s57, 5898240
    buffer_load_dwordx4 v16, s[40:43], s55 offen lds
    s_add_u32 m0, s58, 81920
    s_add_u32 s55, s57, 5898368
    buffer_load_dwordx4 v16, s[40:43], s55 offen lds
    s_add_u32 m0, s58, 102400
    s_add_u32 s55, s57, 5898496
    buffer_load_dwordx4 v16, s[40:43], s55 offen lds
    s_add_u32 m0, s58, 65536
    s_add_u32 s55, s57, 6291456
    buffer_load_dwordx4 v16, s[40:43], s55 offen lds
    s_add_u32 m0, s58, 86016
    s_add_u32 s55, s57, 6291584
    buffer_load_dwordx4 v16, s[40:43], s55 offen lds
    s_add_u32 m0, s58, 106496
    s_add_u32 s55, s57, 6291712
    buffer_load_dwordx4 v16, s[40:43], s55 offen lds
    s_add_u32 m0, s58, 69632
    s_add_u32 s55, s57, 6684672
    buffer_load_dwordx4 v16, s[40:43], s55 offen lds
    s_add_u32 m0, s58, 90112
    s_add_u32 s55, s57, 6684800
    buffer_load_dwordx4 v16, s[40:43], s55 offen lds
    s_add_u32 m0, s58, 110592
    s_add_u32 s55, s57, 6684928
    buffer_load_dwordx4 v16, s[40:43], s55 offen lds
    s_add_u32 m0, s58, 73728
    s_add_u32 s55, s57, 7077888
    buffer_load_dwordx4 v16, s[40:43], s55 offen lds
    s_add_u32 m0, s58, 94208
    s_add_u32 s55, s57, 7078016
    buffer_load_dwordx4 v16, s[40:43], s55 offen lds
    s_add_u32 m0, s58, 114688
    s_add_u32 s55, s57, 7078144
    buffer_load_dwordx4 v16, s[40:43], s55 offen lds
    s_add_u32 m0, s58, 77824
    s_add_u32 s55, s57, 7471104
    buffer_load_dwordx4 v16, s[40:43], s55 offen lds
    s_add_u32 m0, s58, 98304
    s_add_u32 s55, s57, 7471232
    buffer_load_dwordx4 v16, s[40:43], s55 offen lds
    s_add_u32 m0, s58, 118784
    s_add_u32 s55, s57, 7471360
    buffer_load_dwordx4 v16, s[40:43], s55 offen lds
    s_waitcnt vmcnt(15)
    s_barrier
    v_add_u32 v22, 0, v18
    ds_read_b64_tr_b16 a[40:41], v22 offset:0
    ds_read_b64_tr_b16 a[42:43], v22 offset:512
    ds_read_b64_tr_b16 a[44:45], v22 offset:4096
    ds_read_b64_tr_b16 a[46:47], v22 offset:4608
    ds_read_b64_tr_b16 a[48:49], v22 offset:8192
    ds_read_b64_tr_b16 a[50:51], v22 offset:8704
    ds_read_b64_tr_b16 a[52:53], v22 offset:12288
    ds_read_b64_tr_b16 a[54:55], v22 offset:12800
    s_waitcnt lgkmcnt(6)
    ds_read_b64_tr_b16 a[56:57], v22 offset:16384
    ds_read_b64_tr_b16 a[58:59], v22 offset:16896
    v_add_u32 v23, 0, v19
    ds_read_b64_tr_b16 a[120:121], v23 offset:0
    ds_read_b64_tr_b16 a[122:123], v23 offset:512
    ds_read_b64_tr_b16 a[124:125], v23 offset:4096
    ds_read_b64_tr_b16 a[126:127], v23 offset:4608
    ds_read_b64_tr_b16 a[128:129], v23 offset:8192
    ds_read_b64_tr_b16 a[130:131], v23 offset:8704
    s_waitcnt lgkmcnt(6)
    ds_read_b64_tr_b16 a[132:133], v23 offset:12288
    ds_read_b64_tr_b16 a[134:135], v23 offset:12800
    ds_read_b64_tr_b16 a[136:137], v23 offset:16384
    ds_read_b64_tr_b16 a[138:139], v23 offset:16896
    v_add_u32 v22, 0, v20
    ds_read_b64_tr_b16 a[200:201], v22 offset:0
    ds_read_b64_tr_b16 a[202:203], v22 offset:512
    ds_read_b64_tr_b16 a[204:205], v22 offset:4096
    ds_read_b64_tr_b16 a[206:207], v22 offset:4608
    s_waitcnt lgkmcnt(6)
    ds_read_b64_tr_b16 a[208:209], v22 offset:8192
    ds_read_b64_tr_b16 a[210:211], v22 offset:8704
    ds_read_b64_tr_b16 a[212:213], v22 offset:12288
    ds_read_b64_tr_b16 a[214:215], v22 offset:12800
    ds_read_b64_tr_b16 a[216:217], v22 offset:16384
    ds_read_b64_tr_b16 a[218:219], v22 offset:16896
    s_waitcnt lgkmcnt(0)
    s_barrier
    s_waitcnt vmcnt(0)
    s_barrier
    v_add_u32 v22, 61440, v18
    ds_read_b64_tr_b16 a[60:61], v22 offset:0
    ds_read_b64_tr_b16 a[62:63], v22 offset:512
    ds_read_b64_tr_b16 a[64:65], v22 offset:4096
    ds_read_b64_tr_b16 a[66:67], v22 offset:4608
    ds_read_b64_tr_b16 a[68:69], v22 offset:8192
    ds_read_b64_tr_b16 a[70:71], v22 offset:8704
    ds_read_b64_tr_b16 a[72:73], v22 offset:12288
    ds_read_b64_tr_b16 a[74:75], v22 offset:12800
    s_waitcnt lgkmcnt(6)
    ds_read_b64_tr_b16 a[76:77], v22 offset:16384
    ds_read_b64_tr_b16 a[78:79], v22 offset:16896
    v_add_u32 v23, 61440, v19
    ds_read_b64_tr_b16 a[140:141], v23 offset:0
    ds_read_b64_tr_b16 a[142:143], v23 offset:512
    ds_read_b64_tr_b16 a[144:145], v23 offset:4096
    ds_read_b64_tr_b16 a[146:147], v23 offset:4608
    ds_read_b64_tr_b16 a[148:149], v23 offset:8192
    ds_read_b64_tr_b16 a[150:151], v23 offset:8704
    s_waitcnt lgkmcnt(6)
    ds_read_b64_tr_b16 a[152:153], v23 offset:12288
    ds_read_b64_tr_b16 a[154:155], v23 offset:12800
    ds_read_b64_tr_b16 a[156:157], v23 offset:16384
    ds_read_b64_tr_b16 a[158:159], v23 offset:16896
    v_add_u32 v22, 61440, v20
    ds_read_b64_tr_b16 a[220:221], v22 offset:0
    ds_read_b64_tr_b16 a[222:223], v22 offset:512
    ds_read_b64_tr_b16 a[224:225], v22 offset:4096
    ds_read_b64_tr_b16 a[226:227], v22 offset:4608
    s_waitcnt lgkmcnt(6)
    ds_read_b64_tr_b16 a[228:229], v22 offset:8192
    ds_read_b64_tr_b16 a[230:231], v22 offset:8704
    ds_read_b64_tr_b16 a[232:233], v22 offset:12288
    ds_read_b64_tr_b16 a[234:235], v22 offset:12800
    ds_read_b64_tr_b16 a[236:237], v22 offset:16384
    ds_read_b64_tr_b16 a[238:239], v22 offset:16896
    s_waitcnt lgkmcnt(0)
    s_barrier
    s_cmp_lg_u32 s95, 0
    s_cbranch_scc1 L_pq_4
    s_mov_b32 s40, s10
    s_and_b32 s41, s11, 0xffff
    s_mov_b32 s42, 2457600
    s_mov_b32 s43, 0x20000
    s_lshl_b32 s55, s52, 2
    s_add_u32 s55, s55, s3
    s_lshl_b32 s55, s55, 13
    v_lshlrev_b32 v10, 7, v2
    buffer_load_dword v255, v10, s[40:43], s55 offen
    s_add_u32 s55, s55, 1048576
    buffer_load_dword v255, v10, s[40:43], s55 offen
    s_add_u32 s55, s55, 1048576
    buffer_load_dword v255, v10, s[40:43], s55 offen
    s_add_u32 s55, s55, 1048576
    s_mov_b32 s40, s12
    s_and_b32 s41, s13, 0xffff
    s_mov_b32 s42, 819200
    s_mov_b32 s43, 0x20000
    s_lshl_b32 s55, s52, 2
    s_add_u32 s55, s55, s3
    s_lshl_b32 s55, s55, 13
    v_lshlrev_b32 v10, 7, v2
    buffer_load_dword v255, v10, s[40:43], s55 offen
    s_add_u32 s55, s55, 1048576
L_pq_4:
    v_mov_b32 v11, 4
    s_branch L_wi_5_go
L_wi_5:
    s_sleep 4
    s_add_u32 s7, s7, 1
    s_cmp_gt_u32 s7, 400000
    s_cbranch_scc1 L_exit
L_wi_5_go:
    buffer_load_dword v10, v11, s[48:51], 0 offen sc1
    s_waitcnt vmcnt(0)
    v_cmp_gt_u32 vcc, 128, v10
    s_cbranch_vccnz L_wi_5
    s_mov_b32 s88, 0x3dd53b95
    s_mov_b32 s89, 0x3dd53b95
    s_mov_b32 s67, 0
    s_mov_b32 s75, 0
    v_lshrrev_b32 v12, 2, v2
    v_and_b32 v16, 1, v2
    v_lshl_add_u32 v12, v12, 1, v16
    v_lshlrev_b32 v205, 4, v12
    v_lshlrev_b32 v12, 3, v12
    s_lshl_b32 s55, s3, 12
    s_add_u32 s55, s55, 122880
    v_add_u32 v14, s55, v3
    s_lshl_b32 s55, s3, 2
    v_and_b32 v16, 3, v0
    v_add_u32 v16, s55, v16
    v_bfe_u32 v17, v0, 2, 1
    v_lshrrev_b32 v18, 3, v0
    v_lshl_add_u32 v19, v1, 4, v16
    v_lshlrev_b32 v19, 4, v19
    v_add_u32 v20, v17, v18
    v_lshl_add_u32 v171, v20, 10, v19
    v_add_u32 v171, 122880, v171
    v_lshl_add_u32 v20, v17, 1, v18
    v_lshl_add_u32 v172, v20, 2, v19
    v_add_u32 v172, 125952, v172
    v_lshl_add_u32 v173, v17, 10, v19
    v_lshl_add_u32 v173, v18, 3, v173
    v_lshl_add_u32 v16, v17, 4, v16
    v_lshlrev_b32 v20, 2, v1
    v_lshl_add_u32 v20, v18, 4, v20
    v_mov_b32 v174, 0xceabfb8f
    v_min_u32 v15, 1, v2
    v_mul_u32_u24 v15, 0xf00000, v15
    v_lshlrev_b32 v15, 8, v15
    v_add_u32 v15, s55, v15
    v_add_u32 v11, 0, v20
    v_cmp_le_u32 s[80:81], v11, v16
    v_add_u32 v11, 1, v20
    v_cmp_le_u32 s[82:83], v11, v16
    v_add_u32 v11, 2, v20
    v_cmp_le_u32 s[84:85], v11, v16
    v_add_u32 v11, 3, v20
    v_cmp_le_u32 s[86:87], v11, v16
    v_mov_b32 v114, 0
    v_mov_b32 v115, 0
    v_mov_b32 v122, 0
    v_mov_b32 v123, 0
    v_mov_b32 v130, 0
    v_mov_b32 v131, 0
    v_mov_b32 v138, 0
    v_mov_b32 v139, 0
    v_mov_b32 v146, 0
    v_mov_b32 v147, 0
L_q_again:
    s_mul_i32 s59, s6, 40960
    s_mul_i32 s91, s90, 40960
    s_mov_b32 s44, s8
    s_and_b32 s45, s9, 0xffff
    s_mov_b32 s46, 2621440
    s_mov_b32 s47, 0x20000
    v_lshrrev_b32 v10, 3, v2
    v_mul_u32_u24 v5, 1280, v10
    v_lshrrev_b32 v10, 1, v10
    s_and_b32 s55, s3, 1
    s_lshl_b32 s55, s55, 2
    v_add_u32 v10, s55, v10
    v_and_b32 v11, 7, v2
    v_xor_b32 v10, v10, v11
    v_lshl_add_u32 v5, v10, 4, v5
    s_mul_i32 s55, s3, 10240
    s_add_u32 s59, s59, s55
    s_mul_i32 s60, s3, 10240
    v_lshrrev_b32 v10, 3, v0
    v_mul_u32_u24 v10, 10240, v10
    v_and_b32 v11, 7, v0
    v_lshl_add_u32 v10, v11, 7, v10
    v_lshrrev_b32 v11, 1, v0
    v_xor_b32 v11, v11, v1
    v_lshl_add_u32 v6, v11, 4, v10
    v_xor_b32 v11, 4, v11
    v_lshl_add_u32 v7, v11, 4, v10
    s_mov_b32 s61, 0
    s_mov_b32 s74, 4026531840
    s_mov_b32 s79, s78
    s_add_u32 m0, s60, 0
    s_nop 0
    buffer_load_dwordx4 v5, s[44:47], s59 offen offset:0 lds
    s_add_u32 m0, s60, 896
    s_nop 0
    buffer_load_dwordx4 v5, s[44:47], s59 offen offset:128 lds
    s_add_u32 m0, s60, 1792
    s_nop 0
    buffer_load_dwordx4 v5, s[44:47], s59 offen offset:256 lds
    s_add_u32 m0, s60, 2688
    s_nop 0
    buffer_load_dwordx4 v5, s[44:47], s59 offen offset:384 lds
    s_add_u32 m0, s60, 3584
    s_nop 0
    buffer_load_dwordx4 v5, s[44:47], s59 offen offset:512 lds
    s_add_u32 m0, s60, 4480
    s_nop 0
    buffer_load_dwordx4 v5, s[44:47], s59 offen offset:640 lds
    s_add_u32 m0, s60, 5376
    s_nop 0
    buffer_load_dwordx4 v5, s[44:47], s59 offen offset:768 lds
    s_add_u32 m0, s60, 6272
    s_nop 0
    buffer_load_dwordx4 v5, s[44:47], s59 offen offset:896 lds
    s_add_u32 m0, s60, 7168
    s_nop 0
    buffer_load_dwordx4 v5, s[44:47], s59 offen offset:1024 lds
    s_add_u32 m0, s60, 8064
    s_nop 0
    buffer_load_dwordx4 v5, s[44:47], s59 offen offset:1152 lds
    s_add_u32 s59, s59, s91
    s_add_u32 s60, s60, 40960
    s_cmp_ge_u32 s60, 122880
    s_cselect_b32 s55, 122880, 0
    s_sub_u32 s60, s60, s55
    s_add_u32 m0, s60, 0
    s_nop 0
    buffer_load_dwordx4 v5, s[44:47], s59 offen offset:0 lds
    s_add_u32 m0, s60, 896
    s_nop 0
    buffer_load_dwordx4 v5, s[44:47], s59 offen offset:128 lds
    s_add_u32 m0, s60, 1792
    s_nop 0
    buffer_load_dwordx4 v5, s[44:47], s59 offen offset:256 lds
    s_add_u32 m0, s60, 2688
    s_nop 0
    buffer_load_dwordx4 v5, s[44:47], s59 offen offset:384 lds
    s_add_u32 m0, s60, 3584
    s_nop 0
    buffer_load_dwordx4 v5, s[44:47], s59 offen offset:512 lds
    s_add_u32 m0, s60, 4480
    s_nop 0
    buffer_load_dwordx4 v5, s[44:47], s59 offen offset:640 lds
    s_add_u32 m0, s60, 5376
    s_nop 0
    buffer_load_dwordx4 v5, s[44:47], s59 offen offset:768 lds
    s_add_u32 m0, s60, 6272
    s_nop 0
    buffer_load_dwordx4 v5, s[44:47], s59 offen offset:896 lds
    s_add_u32 m0, s60, 7168
    s_nop 0
    buffer_load_dwordx4 v5, s[44:47], s59 offen offset:1024 lds
    s_add_u32 m0, s60, 8064
    s_nop 0
    buffer_load_dwordx4 v5, s[44:47], s59 offen offset:1152 lds
    s_add_u32 s59, s59, s91
    s_add_u32 s60, s60, 40960
    s_cmp_ge_u32 s60, 122880
    s_cselect_b32 s55, 122880, 0
    s_sub_u32 s60, s60, s55
    s_waitcnt vmcnt(10)
    s_barrier
    ds_read_b128 v[16:19], v6 offset:0
    ds_read_b128 v[20:23], v6 offset:20480
    ds_read_b128 v[24:27], v7 offset:0
    ds_read_b128 v[28:31], v7 offset:20480
    s_mov_b32 s62, 4026531840
    s_waitcnt lgkmcnt(2)
    .p2align 6
L_q_loop:
    v_mfma_f32_16x16x32_bf16 v[48:51], a[0:3], v[16:19], 0
    ds_read_b128 v[32:35], v6 offset:1024
    s_lshl_b32 s76, s6, 5
    s_add_u32 s76, s76, s52
    v_mfma_f32_16x16x32_bf16 v[52:55], a[0:3], v[20:23], 0
    ds_read_b128 v[36:39], v6 offset:21504
    s_lshl_b32 s69, s76, 2
    s_add_u32 s69, s69, s3
    v_mfma_f32_16x16x32_bf16 v[56:59], a[80:83], v[16:19], 0
    s_mul_i32 s70, s69, 768
    s_lshl_b32 s69, s70, 2
    v_mfma_f32_16x16x32_bf16 v[60:63], a[80:83], v[20:23], 0
    s_add_u32 s69, s69, 48234496
    s_add_u32 s70, s70, 2228224
    v_mfma_f32_16x16x32_bf16 v[64:67], a[160:163], v[16:19], 0
    s_lshl_b32 s76, s76, 11
    s_add_u32 s76, s76, 8519680
    v_mfma_f32_16x16x32_bf16 v[68:71], a[160:163], v[20:23], 0
    s_waitcnt lgkmcnt(2)
    s_cmp_gt_u32 s75, s6
    s_cbranch_scc0 L_qe_6_k
L_qe_6_b:
    v_mfma_f32_16x16x32_bf16 v[48:51], a[4:7], v[24:27], v[48:51]
    ds_read_b128 v[40:43], v7 offset:1024
    buffer_load_dwordx4 v[96:99], v3, s[36:39], s69 offen offset:0 sc1
    buffer_load_dwordx4 v[100:103], v3, s[36:39], s69 offen offset:1024 sc1
    v_mfma_f32_16x16x32_bf16 v[52:55], a[4:7], v[28:31], v[52:55]
    ds_read_b128 v[44:47], v7 offset:21504
    buffer_load_dwordx4 v[104:107], v3, s[36:39], s69 offen offset:2048 sc1
    s_cmp_gt_u32 s67, s6
    s_cselect_b32 s68, 1, 0
    s_cbranch_scc0 L_qe_6
    buffer_load_dwordx4 v[124:127], v205, s[36:39], s70 offen offset:0 sc1
    buffer_load_dwordx2 v[128:129], v12, s[36:39], s70 offen offset:512 sc1
L_qe_6:
    v_mfma_f32_16x16x32_bf16 v[56:59], a[84:87], v[24:27], v[56:59]
    s_add_u32 s61, s61, 40960
    s_cmp_ge_u32 s61, 122880
    s_cselect_b32 s94, 122880, 0
    v_mfma_f32_16x16x32_bf16 v[60:63], a[84:87], v[28:31], v[60:63]
    s_sub_u32 s61, s61, s94
    s_sub_u32 s94, 40960, s94
    ds_write_b128 v14, v[148:151]
    v_mfma_f32_16x16x32_bf16 v[64:67], a[164:167], v[24:27], v[64:67]
    s_add_u32 m0, s60, 0
    v_mfma_f32_16x16x32_bf16 v[68:71], a[164:167], v[28:31], v[68:71]
    s_waitcnt lgkmcnt(2)
    v_mov_b32 v162, v164
    ds_write_b128 v14, v[152:155] offset:1024
    v_mfma_f32_16x16x32_bf16 v[48:51], a[8:11], v[32:35], v[48:51]
    ds_read_b128 v[16:19], v6 offset:2048
    v_mfma_f32_16x16x32_bf16 v[52:55], a[8:11], v[36:39], v[52:55]
    ds_read_b128 v[20:23], v6 offset:22528
    v_mov_b32 v163, v165
    ds_write_b128 v14, v[156:159] offset:2048
    v_mfma_f32_16x16x32_bf16 v[56:59], a[88:91], v[32:35], v[56:59]
    buffer_load_dwordx4 v5, s[44:47], s59 offen offset:0 lds
    v_mfma_f32_16x16x32_bf16 v[60:63], a[88:91], v[36:39], v[60:63]
    ds_write_b128 v14, v[160:163] offset:3072
    v_mfma_f32_16x16x32_bf16 v[64:67], a[168:171], v[32:35], v[64:67]
    v_mfma_f32_16x16x32_bf16 v[68:71], a[168:171], v[36:39], v[68:71]
    s_waitcnt lgkmcnt(2)
    v_mfma_f32_16x16x32_bf16 v[48:51], a[12:15], v[40:43], v[48:51]
    ds_read_b128 v[24:27], v7 offset:2048
    v_mfma_f32_16x16x32_bf16 v[52:55], a[12:15], v[44:47], v[52:55]
    ds_read_b128 v[28:31], v7 offset:22528
    v_mfma_f32_16x16x32_bf16 v[56:59], a[92:95], v[40:43], v[56:59]
    s_add_u32 m0, s60, 896
    v_mfma_f32_16x16x32_bf16 v[60:63], a[92:95], v[44:47], v[60:63]
    buffer_load_dwordx4 v5, s[44:47], s59 offen offset:128 lds
    v_mfma_f32_16x16x32_bf16 v[64:67], a[172:175], v[40:43], v[64:67]
    v_mfma_f32_16x16x32_bf16 v[68:71], a[172:175], v[44:47], v[68:71]
    s_waitcnt lgkmcnt(2)
    s_waitcnt lgkmcnt(2)
    s_barrier
    v_mfma_f32_16x16x32_bf16 v[48:51], a[16:19], v[16:19], v[48:51]
    ds_read_b128 v[32:35], v6 offset:3072
    ds_read_b128 v[176:179], v171 offset:0
    ds_read_b128 v[180:183], v171 offset:4096
    v_mfma_f32_16x16x32_bf16 v[52:55], a[16:19], v[20:23], v[52:55]
    ds_read_b128 v[36:39], v6 offset:23552
    ds_read_b128 v[184:187], v171 offset:8192
    ds_read_b128 v[188:191], v171 offset:12288
    v_mfma_f32_16x16x32_bf16 v[56:59], a[96:99], v[16:19], v[56:59]
    s_add_u32 m0, s60, 1792
    ds_read_b32 v192, v172 offset:0
    ds_read_b32 v193, v172 offset:4096
    v_mfma_f32_16x16x32_bf16 v[60:63], a[96:99], v[20:23], v[60:63]
    ds_read_b32 v194, v172 offset:8192
    ds_read_b32 v195, v172 offset:12288
    v_mfma_f32_16x16x32_bf16 v[64:67], a[176:179], v[16:19], v[64:67]
    v_mfma_f32_16x16x32_bf16 v[68:71], a[176:179], v[20:23], v[68:71]
    s_waitcnt lgkmcnt(2)
    v_mfma_f32_16x16x32_bf16 v[48:51], a[20:23], v[24:27], v[48:51]
    ds_read_b128 v[40:43], v7 offset:3072
    v_mfma_f32_16x16x32_bf16 v[52:55], a[20:23], v[28:31], v[52:55]
    ds_read_b128 v[44:47], v7 offset:23552
    v_mfma_f32_16x16x32_bf16 v[56:59], a[100:103], v[24:27], v[56:59]
    buffer_load_dwordx4 v5, s[44:47], s59 offen offset:256 lds
    v_mfma_f32_16x16x32_bf16 v[60:63], a[100:103], v[28:31], v[60:63]
    s_add_u32 m0, s60, 2688
    s_waitcnt lgkmcnt(2)
    v_add_f32 v176, v176, v180
    v_mfma_f32_16x16x32_bf16 v[64:67], a[180:183], v[24:27], v[64:67]
    v_add_f32 v177, v177, v181
    v_add_f32 v178, v178, v182
    v_mfma_f32_16x16x32_bf16 v[68:71], a[180:183], v[28:31], v[68:71]
    s_waitcnt lgkmcnt(2)
    v_add_f32 v179, v179, v183
    v_add_f32 v184, v184, v188
    v_mfma_f32_16x16x32_bf16 v[48:51], a[24:27], v[32:35], v[48:51]
    ds_read_b128 v[16:19], v6 offset:4096
    v_add_f32 v185, v185, v189
    v_add_f32 v186, v186, v190
    v_mfma_f32_16x16x32_bf16 v[52:55], a[24:27], v[36:39], v[52:55]
    ds_read_b128 v[20:23], v6 offset:24576
    v_add_f32 v187, v187, v191
    v_add_f32 v176, v176, v184
    v_mfma_f32_16x16x32_bf16 v[56:59], a[104:107], v[32:35], v[56:59]
    buffer_load_dwordx4 v5, s[44:47], s59 offen offset:384 lds
    v_add_f32 v177, v177, v185
    v_add_f32 v178, v178, v186
    v_mfma_f32_16x16x32_bf16 v[60:63], a[104:107], v[36:39], v[60:63]
    v_add_f32 v179, v179, v187
    v_add_f32 v192, v192, v193
    v_mfma_f32_16x16x32_bf16 v[64:67], a[184:187], v[32:35], v[64:67]
    s_add_u32 m0, s60, 3584
    v_add_f32 v194, v194, v195
    v_add_f32 v192, v192, v194
    v_mfma_f32_16x16x32_bf16 v[68:71], a[184:187], v[36:39], v[68:71]
    s_waitcnt lgkmcnt(2)
    v_cndmask_b32 v176, v174, v176, s[80:81]
    v_cndmask_b32 v177, v174, v177, s[82:83]
    v_mfma_f32_16x16x32_bf16 v[48:51], a[28:31], v[40:43], v[48:51]
    ds_read_b128 v[24:27], v7 offset:4096
    v_cndmask_b32 v178, v174, v178, s[84:85]
    v_cndmask_b32 v179, v174, v179, s[86:87]
    v_mfma_f32_16x16x32_bf16 v[52:55], a[28:31], v[44:47], v[52:55]
    ds_read_b128 v[28:31], v7 offset:24576
    v_max3_f32 v196, v176, v177, v178
    v_max3_f32 v196, v196, v179, v192
    v_mfma_f32_16x16x32_bf16 v[56:59], a[108:111], v[40:43], v[56:59]
    buffer_load_dwordx4 v5, s[44:47], s59 offen offset:512 lds
    v_max_f32_dpp v197, v196, v196 row_ror:8 row_mask:0xf bank_mask:0xf
    v_max_f32_dpp v198, v196, v196 row_ror:8 row_mask:0xf bank_mask:0xf
    v_mfma_f32_16x16x32_bf16 v[60:63], a[108:111], v[44:47], v[60:63]
    v_mfma_f32_16x16x32_bf16 v[64:67], a[188:191], v[40:43], v[64:67]
    v_permlane16_swap_b32 v197, v198
    v_mfma_f32_16x16x32_bf16 v[68:71], a[188:191], v[44:47], v[68:71]
    s_waitcnt lgkmcnt(2)
    v_max_f32 v196, v197, v198
    v_max_f32 v197, v197, v198
    v_mfma_f32_16x16x32_bf16 v[48:51], a[32:35], v[16:19], v[48:51]
    ds_read_b128 v[32:35], v6 offset:5120
    v_permlane32_swap_b32 v196, v197
    v_mfma_f32_16x16x32_bf16 v[52:55], a[32:35], v[20:23], v[52:55]
    ds_read_b128 v[36:39], v6 offset:25600
    v_max_f32 v196, v196, v197
    v_sub_f32 v176, v176, v196
    v_mfma_f32_16x16x32_bf16 v[56:59], a[112:115], v[16:19], v[56:59]
    buffer_load_dword v170, v9, s[36:39], 0 offen offset:0 sc1
    v_sub_f32 v177, v177, v196
    v_sub_f32 v178, v178, v196
    v_mfma_f32_16x16x32_bf16 v[60:63], a[112:115], v[20:23], v[60:63]
    v_sub_f32 v179, v179, v196
    v_sub_f32 v192, v192, v196
    v_mfma_f32_16x16x32_bf16 v[64:67], a[192:195], v[16:19], v[64:67]
    s_add_u32 m0, s60, 4480
    v_exp_f32 v176, v176
    v_mfma_f32_16x16x32_bf16 v[68:71], a[192:195], v[20:23], v[68:71]
    s_waitcnt lgkmcnt(2)
    v_exp_f32 v177, v177
    v_mfma_f32_16x16x32_bf16 v[48:51], a[36:39], v[24:27], v[48:51]
    ds_read_b128 v[40:43], v7 offset:5120
    v_exp_f32 v178, v178
    v_mfma_f32_16x16x32_bf16 v[52:55], a[36:39], v[28:31], v[52:55]
    ds_read_b128 v[44:47], v7 offset:25600
    v_exp_f32 v179, v179
    v_mfma_f32_16x16x32_bf16 v[56:59], a[116:119], v[24:27], v[56:59]
    buffer_load_dwordx4 v5, s[44:47], s59 offen offset:640 lds
    v_exp_f32 v192, v192
    v_mfma_f32_16x16x32_bf16 v[60:63], a[116:119], v[28:31], v[60:63]
    v_add_f32 v196, v176, v177
    v_add_f32 v197, v178, v179
    v_mfma_f32_16x16x32_bf16 v[64:67], a[196:199], v[24:27], v[64:67]
    v_add_f32 v196, v196, v192
    v_add_f32 v196, v196, v197
    v_mfma_f32_16x16x32_bf16 v[68:71], a[196:199], v[28:31], v[68:71]
    s_waitcnt lgkmcnt(2)
    v_add_f32_dpp v197, v196, v196 row_ror:8 row_mask:0xf bank_mask:0xf
    v_add_f32_dpp v198, v196, v196 row_ror:8 row_mask:0xf bank_mask:0xf
    v_mfma_f32_16x16x32_bf16 v[48:51], a[40:43], v[32:35], v[48:51]
    ds_read_b128 v[16:19], v6 offset:6144
    v_permlane16_swap_b32 v197, v198
    v_mfma_f32_16x16x32_bf16 v[52:55], a[40:43], v[36:39], v[52:55]
    ds_read_b128 v[20:23], v6 offset:26624
    v_add_f32 v196, v197, v198
    v_add_f32 v197, v197, v198
    v_mfma_f32_16x16x32_bf16 v[56:59], a[120:123], v[32:35], v[56:59]
    s_add_u32 m0, s60, 5376
    v_permlane32_swap_b32 v196, v197
    v_mfma_f32_16x16x32_bf16 v[60:63], a[120:123], v[36:39], v[60:63]
    buffer_load_dwordx4 v5, s[44:47], s59 offen offset:768 lds
    v_add_f32 v196, v196, v197
    v_mfma_f32_16x16x32_bf16 v[64:67], a[200:203], v[32:35], v[64:67]
    v_rcp_f32 v196, v196
    v_mfma_f32_16x16x32_bf16 v[68:71], a[200:203], v[36:39], v[68:71]
    s_waitcnt lgkmcnt(2)
    v_mul_f32 v192, v192, v196
    v_mul_f32 v176, v176, v196
    v_mfma_f32_16x16x32_bf16 v[48:51], a[44:47], v[40:43], v[48:51]
    ds_read_b128 v[24:27], v7 offset:6144
    v_mul_f32 v177, v177, v196
    v_mul_f32 v178, v178, v196
    v_mfma_f32_16x16x32_bf16 v[52:55], a[44:47], v[44:47], v[52:55]
    ds_read_b128 v[28:31], v7 offset:26624
    v_mul_f32 v179, v179, v196
    v_mov_b32_dpp v193, v192 row_ror:8 row_mask:0xf bank_mask:0xf
    v_mfma_f32_16x16x32_bf16 v[56:59], a[124:127], v[40:43], v[56:59]
    s_add_u32 m0, s60, 6272
    v_cvt_pk_bf16_f32 v192, v193, v192
    v_cvt_pk_bf16_f32 v180, v176, v177
    v_mfma_f32_16x16x32_bf16 v[60:63], a[124:127], v[44:47], v[60:63]
    v_cvt_pk_bf16_f32 v181, v178, v179
    v_mov_b32_dpp v180, v192 quad_perm:[0,1,2,3] row_mask:0xf bank_mask:0x4
    v_mfma_f32_16x16x32_bf16 v[64:67], a[204:207], v[40:43], v[64:67]
    v_mov_b32_dpp v181, v192 row_shl:4 row_mask:0xf bank_mask:0x4
    buffer_store_dwordx2 v[180:181], v173, s[36:39], s74 offen offset:0 sc1
    v_mfma_f32_16x16x32_bf16 v[68:71], a[204:207], v[44:47], v[68:71]
    s_waitcnt lgkmcnt(2)
    buffer_load_dwordx4 v5, s[44:47], s59 offen offset:896 lds
    v_mfma_f32_16x16x32_bf16 v[48:51], a[48:51], v[16:19], v[48:51]
    ds_read_b128 v[32:35], v6 offset:7168
    v_mfma_f32_16x16x32_bf16 v[52:55], a[48:51], v[20:23], v[52:55]
    ds_read_b128 v[36:39], v6 offset:27648
    v_mfma_f32_16x16x32_bf16 v[56:59], a[128:131], v[16:19], v[56:59]
    v_mfma_f32_16x16x32_bf16 v[60:63], a[128:131], v[20:23], v[60:63]
    s_add_u32 m0, s60, 7168
    v_mfma_f32_16x16x32_bf16 v[64:67], a[208:211], v[16:19], v[64:67]
    v_mfma_f32_16x16x32_bf16 v[68:71], a[208:211], v[20:23], v[68:71]
    s_waitcnt lgkmcnt(2)
    v_mfma_f32_16x16x32_bf16 v[48:51], a[52:55], v[24:27], v[48:51]
    ds_read_b128 v[40:43], v7 offset:7168
    v_mfma_f32_16x16x32_bf16 v[52:55], a[52:55], v[28:31], v[52:55]
    ds_read_b128 v[44:47], v7 offset:27648
    buffer_load_dwordx4 v5, s[44:47], s59 offen offset:1024 lds
    v_mfma_f32_16x16x32_bf16 v[56:59], a[132:135], v[24:27], v[56:59]
    v_mfma_f32_16x16x32_bf16 v[60:63], a[132:135], v[28:31], v[60:63]
    v_mfma_f32_16x16x32_bf16 v[64:67], a[212:215], v[24:27], v[64:67]
    s_add_u32 m0, s60, 8064
    v_mfma_f32_16x16x32_bf16 v[68:71], a[212:215], v[28:31], v[68:71]
    s_waitcnt lgkmcnt(2)
    v_mfma_f32_16x16x32_bf16 v[48:51], a[56:59], v[32:35], v[48:51]
    ds_read_b128 v[16:19], v6 offset:8192
    v_mfma_f32_16x16x32_bf16 v[52:55], a[56:59], v[36:39], v[52:55]
    ds_read_b128 v[20:23], v6 offset:28672
    v_mfma_f32_16x16x32_bf16 v[56:59], a[136:139], v[32:35], v[56:59]
    buffer_load_dwordx4 v5, s[44:47], s59 offen offset:1152 lds
    v_mfma_f32_16x16x32_bf16 v[60:63], a[136:139], v[36:39], v[60:63]
    v_mfma_f32_16x16x32_bf16 v[64:67], a[216:219], v[32:35], v[64:67]
    v_mfma_f32_16x16x32_bf16 v[68:71], a[216:219], v[36:39], v[68:71]
    s_waitcnt lgkmcnt(2)
    v_mfma_f32_16x16x32_bf16 v[48:51], a[60:63], v[40:43], v[48:51]
    ds_read_b128 v[24:27], v7 offset:8192
    s_add_u32 s59, s59, s91
    v_mfma_f32_16x16x32_bf16 v[52:55], a[60:63], v[44:47], v[52:55]
    ds_read_b128 v[28:31], v7 offset:28672
    v_mfma_f32_16x16x32_bf16 v[56:59], a[140:143], v[40:43], v[56:59]
    v_mfma_f32_16x16x32_bf16 v[60:63], a[140:143], v[44:47], v[60:63]
    v_mfma_f32_16x16x32_bf16 v[64:67], a[220:223], v[40:43], v[64:67]
    s_add_u32 s60, s60, 40960
    v_mfma_f32_16x16x32_bf16 v[68:71], a[220:223], v[44:47], v[68:71]
    s_waitcnt lgkmcnt(2)
    v_mfma_f32_16x16x32_bf16 v[48:51], a[64:67], v[16:19], v[48:51]
    ds_read_b128 v[32:35], v6 offset:9216
    v_mfma_f32_16x16x32_bf16 v[52:55], a[64:67], v[20:23], v[52:55]
    ds_read_b128 v[36:39], v6 offset:29696
    v_mfma_f32_16x16x32_bf16 v[56:59], a[144:147], v[16:19], v[56:59]
    s_cmp_ge_u32 s60, 122880
    s_cselect_b32 s55, 122880, 0
    v_mfma_f32_16x16x32_bf16 v[60:63], a[144:147], v[20:23], v[60:63]
    v_mfma_f32_16x16x32_bf16 v[64:67], a[224:227], v[16:19], v[64:67]
    v_mfma_f32_16x16x32_bf16 v[68:71], a[224:227], v[20:23], v[68:71]
    s_waitcnt lgkmcnt(2)
    v_mfma_f32_16x16x32_bf16 v[48:51], a[68:71], v[24:27], v[48:51]
    ds_read_b128 v[40:43], v7 offset:9216
    v_add_u32 v6, s94, v6
    s_sub_u32 s60, s60, s55
    v_mfma_f32_16x16x32_bf16 v[52:55], a[68:71], v[28:31], v[52:55]
    ds_read_b128 v[44:47], v7 offset:29696
    v_add_u32 v7, s94, v7
    v_mfma_f32_16x16x32_bf16 v[56:59], a[148:151], v[24:27], v[56:59]
    v_mfma_f32_16x16x32_bf16 v[60:63], a[148:151], v[28:31], v[60:63]
    v_mfma_f32_16x16x32_bf16 v[64:67], a[228:231], v[24:27], v[64:67]
    v_mfma_f32_16x16x32_bf16 v[68:71], a[228:231], v[28:31], v[68:71]
    s_waitcnt vmcnt(6) lgkmcnt(0)
    s_barrier
    v_mfma_f32_16x16x32_bf16 v[48:51], a[72:75], v[32:35], v[48:51]
    ds_read_b128 v[16:19], v6 offset:0
    v_readlane_b32 s55, v170, 0
    v_readlane_b32 s56, v170, 1
    v_mfma_f32_16x16x32_bf16 v[52:55], a[72:75], v[36:39], v[52:55]
    ds_read_b128 v[20:23], v6 offset:20480
    v_readlane_b32 s57, v170, 2
    v_readlane_b32 s58, v170, 3
    v_mfma_f32_16x16x32_bf16 v[56:59], a[152:155], v[32:35], v[56:59]
    v_readlane_b32 s75, v170, 4
    s_min_u32 s55, s55, s56
    v_mfma_f32_16x16x32_bf16 v[60:63], a[152:155], v[36:39], v[60:63]
    s_min_u32 s57, s57, s58
    s_min_u32 s67, s55, s57
    s_cmp_lg_u32 s68, 0
    s_cbranch_scc1 L_qm_7
    s_cmp_gt_u32 s67, s6
    s_cselect_b32 s68, 1, 0
    s_cbranch_scc0 L_qm_7
    buffer_load_dwordx4 v[124:127], v205, s[36:39], s70 offen offset:0 sc1
    buffer_load_dwordx2 v[128:129], v12, s[36:39], s70 offen offset:512 sc1
L_qm_7:
    v_mfma_f32_16x16x32_bf16 v[64:67], a[232:235], v[32:35], v[64:67]
    v_mov_b32 v108, v96
    v_mov_b32 v109, v97
    v_mfma_f32_16x16x32_bf16 v[68:71], a[232:235], v[36:39], v[68:71]
    v_mov_b32 v116, v98
    v_mov_b32 v117, v99
    v_mfma_f32_16x16x32_bf16 v[48:51], a[76:79], v[40:43], v[48:51]
    ds_read_b128 v[24:27], v7 offset:0
    v_mov_b32 v110, v100
    v_mov_b32 v111, v101
    v_mfma_f32_16x16x32_bf16 v[52:55], a[76:79], v[44:47], v[52:55]
    ds_read_b128 v[28:31], v7 offset:20480
    v_mov_b32 v118, v102
    v_mov_b32 v119, v103
    v_mfma_f32_16x16x32_bf16 v[56:59], a[156:159], v[40:43], v[56:59]
    v_mov_b32 v112, v104
    v_mov_b32 v113, v105
    v_mfma_f32_16x16x32_bf16 v[60:63], a[156:159], v[44:47], v[60:63]
    v_mov_b32 v120, v106
    v_mov_b32 v121, v107
    v_mfma_f32_16x16x32_bf16 v[64:67], a[236:239], v[40:43], v[64:67]
    v_mfma_f32_16x16x32_bf16 v[68:71], a[236:239], v[44:47], v[68:71]
    s_waitcnt lgkmcnt(2)
    s_mov_b32 s78, s79
    s_add_u32 s79, s6, 1
    s_mov_b32 s74, s76
    s_nop 0
    s_cmp_lg_u32 s68, 0
    s_cbranch_scc1 L_qh_8
    buffer_load_dword v170, v9, s[36:39], 0 offen offset:0 sc1
    s_waitcnt vmcnt(0)
    s_add_u32 s56, s78, s95
    v_mov_b32 v175, s56
    buffer_store_dword v175, v15, s[36:39], s65 offen offset:0 sc1
    v_cmp_ge_u32 vcc, s6, v170
    s_cbranch_vccz L_qw_9_ok
    s_branch L_qw_9_go
L_qw_9:
    s_sleep 1
    s_add_u32 s7, s7, 1
    s_cmp_gt_u32 s7, 400000
    s_cbranch_scc1 L_exit
L_qw_9_go:
    buffer_load_dword v170, v9, s[36:39], 0 offen offset:0 sc1
    s_waitcnt vmcnt(0)
    v_cmp_ge_u32 vcc, s6, v170
    s_cbranch_vccnz L_qw_9
L_qw_9_ok:
    buffer_load_dwordx4 v[124:127], v205, s[36:39], s70 offen offset:0 sc1
    buffer_load_dwordx2 v[128:129], v12, s[36:39], s70 offen offset:512 sc1
L_qh_8:
    s_nop 1
    v_pk_mul_f32 v[48:49], v[48:49], s[88:89]
    v_pk_mul_f32 v[50:51], v[50:51], s[88:89]
    v_cvt_pk_bf16_f32 v132, v48, v49
    v_cvt_pk_bf16_f32 v133, v50, v51
    v_pk_mul_f32 v[52:53], v[52:53], s[88:89]
    v_pk_mul_f32 v[54:55], v[54:55], s[88:89]
    v_cvt_pk_bf16_f32 v140, v52, v53
    v_cvt_pk_bf16_f32 v141, v54, v55
    v_pk_mul_f32 v[56:57], v[56:57], s[88:89]
    v_pk_mul_f32 v[58:59], v[58:59], s[88:89]
    v_cvt_pk_bf16_f32 v134, v56, v57
    v_cvt_pk_bf16_f32 v135, v58, v59
    v_pk_mul_f32 v[60:61], v[60:61], s[88:89]
    v_pk_mul_f32 v[62:63], v[62:63], s[88:89]
    v_cvt_pk_bf16_f32 v142, v60, v61
    v_cvt_pk_bf16_f32 v143, v62, v63
    v_pk_mul_f32 v[64:65], v[64:65], s[88:89]
    v_pk_mul_f32 v[66:67], v[66:67], s[88:89]
    v_cvt_pk_bf16_f32 v136, v64, v65
    v_cvt_pk_bf16_f32 v137, v66, v67
    v_pk_mul_f32 v[68:69], v[68:69], s[88:89]
    v_pk_mul_f32 v[70:71], v[70:71], s[88:89]
    v_cvt_pk_bf16_f32 v144, v68, v69
    v_cvt_pk_bf16_f32 v145, v70, v71
    s_nop 1
    v_mfma_f32_16x16x32_bf16 v[148:151], v[108:111], v[132:135], 0
    v_mfma_f32_16x16x32_bf16 v[148:151], v[112:115], v[136:139], v[148:151]
    v_mfma_f32_16x16x32_bf16 v[152:155], v[108:111], v[140:143], 0
    v_mfma_f32_16x16x32_bf16 v[152:155], v[112:115], v[144:147], v[152:155]
    v_mfma_f32_16x16x32_bf16 v[156:159], v[116:119], v[140:143], 0
    v_mfma_f32_16x16x32_bf16 v[156:159], v[120:123], v[144:147], v[156:159]
    s_waitcnt vmcnt(0)
    v_mfma_f32_16x16x32_bf16 v[160:163], v[124:127], v[132:135], 0
    s_add_u32 s56, s78, s95
    v_mfma_f32_16x16x32_bf16 v[160:163], v[128:131], v[136:139], v[160:163]
    v_mov_b32 v175, s56
    v_mfma_f32_16x16x32_bf16 v[164:167], v[124:127], v[140:143], 0
    s_cmp_eq_u32 s68, 0
    s_cbranch_scc1 L_qh_8_p
    buffer_store_dword v175, v15, s[36:39], s65 offen offset:0 sc1
L_qh_8_p:
    v_mfma_f32_16x16x32_bf16 v[164:167], v[128:131], v[144:147], v[164:167]
    s_mov_b32 s62, s63
    s_add_u32 s6, s6, s90
    s_cmp_lt_u32 s6, s64
    s_cbranch_scc1 L_q_loop
    s_nop 7
    ds_write_b128 v14, v[148:151]
    v_mov_b32 v162, v164
    ds_write_b128 v14, v[152:155] offset:1024
    v_mov_b32 v163, v165
    ds_write_b128 v14, v[156:159] offset:2048
    ds_write_b128 v14, v[160:163] offset:3072
    s_waitcnt lgkmcnt(0)
    s_barrier
    ds_read_b128 v[176:179], v171 offset:0
    ds_read_b128 v[180:183], v171 offset:4096
    ds_read_b128 v[184:187], v171 offset:8192
    ds_read_b128 v[188:191], v171 offset:12288
    ds_read_b32 v192, v172 offset:0
    ds_read_b32 v193, v172 offset:4096
    ds_read_b32 v194, v172 offset:8192
    ds_read_b32 v195, v172 offset:12288
    s_waitcnt lgkmcnt(0)
    v_add_f32 v176, v176, v180
    v_add_f32 v177, v177, v181
    v_add_f32 v178, v178, v182
    v_add_f32 v179, v179, v183
    v_add_f32 v184, v184, v188
    v_add_f32 v185, v185, v189
    v_add_f32 v186, v186, v190
    v_add_f32 v187, v187, v191
    v_add_f32 v176, v176, v184
    v_add_f32 v177, v177, v185
    v_add_f32 v178, v178, v186
    v_add_f32 v179, v179, v187
    v_add_f32 v192, v192, v193
    v_add_f32 v194, v194, v195
    v_add_f32 v192, v192, v194
    v_cndmask_b32 v176, v174, v176, s[80:81]
    v_cndmask_b32 v177, v174, v177, s[82:83]
    v_cndmask_b32 v178, v174, v178, s[84:85]
    v_cndmask_b32 v179, v174, v179, s[86:87]
    v_max3_f32 v196, v176, v177, v178
    v_max3_f32 v196, v196, v179, v192
    s_nop 1
    v_max_f32_dpp v197, v196, v196 row_ror:8 row_mask:0xf bank_mask:0xf
    v_max_f32_dpp v198, v196, v196 row_ror:8 row_mask:0xf bank_mask:0xf
    s_nop 1
    v_permlane16_swap_b32 v197, v198
    v_max_f32 v196, v197, v198
    v_max_f32 v197, v197, v198
    s_nop 1
    v_permlane32_swap_b32 v196, v197
    v_max_f32 v196, v196, v197
    v_sub_f32 v176, v176, v196
    v_sub_f32 v177, v177, v196
    v_sub_f32 v178, v178, v196
    v_sub_f32 v179, v179, v196
    v_sub_f32 v192, v192, v196
    v_exp_f32 v176, v176
    v_exp_f32 v177, v177
    v_exp_f32 v178, v178
    v_exp_f32 v179, v179
    v_exp_f32 v192, v192
    v_add_f32 v196, v176, v177
    v_add_f32 v197, v178, v179
    v_add_f32 v196, v196, v192
    v_add_f32 v196, v196, v197
    s_nop 1
    v_add_f32_dpp v197, v196, v196 row_ror:8 row_mask:0xf bank_mask:0xf
    v_add_f32_dpp v198, v196, v196 row_ror:8 row_mask:0xf bank_mask:0xf
    s_nop 1
    v_permlane16_swap_b32 v197, v198
    v_add_f32 v196, v197, v198
    v_add_f32 v197, v197, v198
    s_nop 1
    v_permlane32_swap_b32 v196, v197
    v_add_f32 v196, v196, v197
    v_rcp_f32 v196, v196
    s_nop 0
    v_mul_f32 v192, v192, v196
    v_mul_f32 v176, v176, v196
    v_mul_f32 v177, v177, v196
    v_mul_f32 v178, v178, v196
    v_mul_f32 v179, v179, v196
    v_mov_b32_dpp v193, v192 row_ror:8 row_mask:0xf bank_mask:0xf
    v_cvt_pk_bf16_f32 v192, v193, v192
    v_cvt_pk_bf16_f32 v180, v176, v177
    v_cvt_pk_bf16_f32 v181, v178, v179
    v_mov_b32_dpp v180, v192 quad_perm:[0,1,2,3] row_mask:0xf bank_mask:0x4
    v_mov_b32_dpp v181, v192 row_shl:4 row_mask:0xf bank_mask:0x4
    buffer_store_dwordx2 v[180:181], v173, s[36:39], s74 offen offset:0 sc1
    s_mov_b32 s78, s79
    s_waitcnt vmcnt(0)
    s_add_u32 s56, s78, s95
    v_mov_b32 v175, s56
    buffer_store_dword v175, v15, s[36:39], s65 offen offset:0 sc1
    s_sub_u32 s6, s6, s90
    s_barrier
    s_branch L_q_end
L_qe_6_k:
    s_branch L_qk_50001_go
L_qk_50001:
    s_sleep 2
    s_add_u32 s7, s7, 1
    s_cmp_gt_u32 s7, 400000
    s_cbranch_scc1 L_exit
L_qk_50001_go:
    buffer_load_dword v170, v9, s[36:39], 0 offen offset:0 sc1
    s_waitcnt vmcnt(0)
    v_readlane_b32 s75, v170, 4
    s_nop 3
    s_cmp_gt_u32 s75, s6
    s_cbranch_scc0 L_qk_50001
    s_branch L_qe_6_b
L_q_end:
    s_cmp_eq_u32 s90, 2
    s_cbranch_scc1 L_exit
    s_mov_b32 s6, 59
    s_mov_b32 s64, 64
    s_mov_b32 s90, 2
    s_branch L_q_again
L_k:
    s_waitcnt vmcnt(0)
    s_barrier
    s_cmp_lg_u32 s3, 0
    s_cbranch_scc1 L_idn_10
    v_mov_b32 v10, 4
    v_mov_b32 v11, 1
    s_waitcnt vmcnt(0)
    s_mov_b64 exec, 1
    buffer_atomic_add v11, v10, s[48:51], 0 offen sc1
    s_mov_b64 exec, -1
L_idn_10:
    s_mov_b32 s40, s20
    s_and_b32 s41, s21, 0xffff
    s_mov_b32 s42, 7864320
    s_mov_b32 s43, 0x20000
    s_mul_i32 s54, s52, 384
    s_mul_i32 s53, s3, 3
    v_lshrrev_b32 v21, 3, v2
    v_mul_u32_u24 v16, 12288, v21
    v_bfe_u32 v21, v21, 1, 1
    s_and_b32 s55, s3, 1
    s_lshl_b32 s55, s55, 1
    v_add_u32 v21, s55, v21
    v_lshlrev_b32 v21, 1, v21
    v_and_b32 v22, 7, v2
    v_xor_b32 v21, v21, v22
    v_lshl_add_u32 v16, v21, 4, v16
    v_lshrrev_b32 v21, 2, v0
    v_lshl_add_u32 v17, v1, 3, v21
    v_lshlrev_b32 v17, 7, v17
    v_and_b32 v22, 3, v0
    v_lshl_add_u32 v17, v22, 3, v17
    v_lshrrev_b32 v21, 1, v21
    v_and_b32 v22, 1, v1
    v_lshl_add_u32 v21, v22, 1, v21
    s_lshl_b32 s58, s3, 10
    s_mul_i32 s57, s3, 98304
    s_add_u32 s57, s57, s54
    s_add_u32 s55, s53, 0
    s_and_b32 s56, s55, 3
    s_lshr_b32 s55, s55, 2
    s_mul_i32 s55, s55, 20480
    v_xor_b32 v22, s56, v21
    v_lshl_add_u32 v22, v22, 5, v17
    v_add_u32 v18, s55, v22
    s_add_u32 s55, s53, 1
    s_and_b32 s56, s55, 3
    s_lshr_b32 s55, s55, 2
    s_mul_i32 s55, s55, 20480
    v_xor_b32 v22, s56, v21
    v_lshl_add_u32 v22, v22, 5, v17
    v_add_u32 v19, s55, v22
    s_add_u32 s55, s53, 2
    s_and_b32 s56, s55, 3
    s_lshr_b32 s55, s55, 2
    s_mul_i32 s55, s55, 20480
    v_xor_b32 v22, s56, v21
    v_lshl_add_u32 v22, v22, 5, v17
    v_add_u32 v20, s55, v22
    s_add_u32 m0, s58, 0
    s_add_u32 s55, s57, 0
    buffer_load_dwordx4 v16, s[40:43], s55 offen lds
    s_add_u32 m0, s58, 20480
    s_add_u32 s55, s57, 128
    buffer_load_dwordx4 v16, s[40:43], s55 offen lds
    s_add_u32 m0, s58, 40960
    s_add_u32 s55, s57, 256
    buffer_load_dwordx4 v16, s[40:43], s55 offen lds
    s_add_u32 m0, s58, 4096
    s_add_u32 s55, s57, 393216
    buffer_load_dwordx4 v16, s[40:43], s55 offen lds
    s_add_u32 m0, s58, 24576
    s_add_u32 s55, s57, 393344
    buffer_load_dwordx4 v16, s[40:43], s55 offen lds
    s_add_u32 m0, s58, 45056
    s_add_u32 s55, s57, 393472
    buffer_load_dwordx4 v16, s[40:43], s55 offen lds
    s_add_u32 m0, s58, 8192
    s_add_u32 s55, s57, 786432
    buffer_load_dwordx4 v16, s[40:43], s55 offen lds
    s_add_u32 m0, s58, 28672
    s_add_u32 s55, s57, 786560
    buffer_load_dwordx4 v16, s[40:43], s55 offen lds
    s_add_u32 m0, s58, 49152
    s_add_u32 s55, s57, 786688
    buffer_load_dwordx4 v16, s[40:43], s55 offen lds
    s_add_u32 m0, s58, 12288
    s_add_u32 s55, s57, 1179648
    buffer_load_dwordx4 v16, s[40:43], s55 offen lds
    s_add_u32 m0, s58, 32768
    s_add_u32 s55, s57, 1179776
    buffer_load_dwordx4 v16, s[40:43], s55 offen lds
    s_add_u32 m0, s58, 53248
    s_add_u32 s55, s57, 1179904
    buffer_load_dwordx4 v16, s[40:43], s55 offen lds
    s_add_u32 m0, s58, 16384
    s_add_u32 s55, s57, 1572864
    buffer_load_dwordx4 v16, s[40:43], s55 offen lds
    s_add_u32 m0, s58, 36864
    s_add_u32 s55, s57, 1572992
    buffer_load_dwordx4 v16, s[40:43], s55 offen lds
    s_add_u32 m0, s58, 57344
    s_add_u32 s55, s57, 1573120
    buffer_load_dwordx4 v16, s[40:43], s55 offen lds
    s_add_u32 m0, s58, 61440
    s_add_u32 s55, s57, 1966080
    buffer_load_dwordx4 v16, s[40:43], s55 offen lds
    s_add_u32 m0, s58, 81920
    s_add_u32 s55, s57, 1966208
    buffer_load_dwordx4 v16, s[40:43], s55 offen lds
    s_add_u32 m0, s58, 102400
    s_add_u32 s55, s57, 1966336
    buffer_load_dwordx4 v16, s[40:43], s55 offen lds
    s_add_u32 m0, s58, 65536
    s_add_u32 s55, s57, 2359296
    buffer_load_dwordx4 v16, s[40:43], s55 offen lds
    s_add_u32 m0, s58, 86016
    s_add_u32 s55, s57, 2359424
    buffer_load_dwordx4 v16, s[40:43], s55 offen lds
    s_add_u32 m0, s58, 106496
    s_add_u32 s55, s57, 2359552
    buffer_load_dwordx4 v16, s[40:43], s55 offen lds
    s_add_u32 m0, s58, 69632
    s_add_u32 s55, s57, 2752512
    buffer_load_dwordx4 v16, s[40:43], s55 offen lds
    s_add_u32 m0, s58, 90112
    s_add_u32 s55, s57, 2752640
    buffer_load_dwordx4 v16, s[40:43], s55 offen lds
    s_add_u32 m0, s58, 110592
    s_add_u32 s55, s57, 2752768
    buffer_load_dwordx4 v16, s[40:43], s55 offen lds
    s_add_u32 m0, s58, 73728
    s_add_u32 s55, s57, 3145728
    buffer_load_dwordx4 v16, s[40:43], s55 offen lds
    s_add_u32 m0, s58, 94208
    s_add_u32 s55, s57, 3145856
    buffer_load_dwordx4 v16, s[40:43], s55 offen lds
    s_add_u32 m0, s58, 114688
    s_add_u32 s55, s57, 3145984
    buffer_load_dwordx4 v16, s[40:43], s55 offen lds
    s_add_u32 m0, s58, 77824
    s_add_u32 s55, s57, 3538944
    buffer_load_dwordx4 v16, s[40:43], s55 offen lds
    s_add_u32 m0, s58, 98304
    s_add_u32 s55, s57, 3539072
    buffer_load_dwordx4 v16, s[40:43], s55 offen lds
    s_add_u32 m0, s58, 118784
    s_add_u32 s55, s57, 3539200
    buffer_load_dwordx4 v16, s[40:43], s55 offen lds
    s_waitcnt vmcnt(15)
    s_barrier
    v_add_u32 v22, 0, v18
    ds_read_b64_tr_b16 a[0:1], v22 offset:0
    ds_read_b64_tr_b16 a[2:3], v22 offset:512
    ds_read_b64_tr_b16 a[4:5], v22 offset:4096
    ds_read_b64_tr_b16 a[6:7], v22 offset:4608
    ds_read_b64_tr_b16 a[8:9], v22 offset:8192
    ds_read_b64_tr_b16 a[10:11], v22 offset:8704
    ds_read_b64_tr_b16 a[12:13], v22 offset:12288
    ds_read_b64_tr_b16 a[14:15], v22 offset:12800
    s_waitcnt lgkmcnt(6)
    ds_read_b64_tr_b16 a[16:17], v22 offset:16384
    ds_read_b64_tr_b16 a[18:19], v22 offset:16896
    v_add_u32 v23, 0, v19
    ds_read_b64_tr_b16 a[80:81], v23 offset:0
    ds_read_b64_tr_b16 a[82:83], v23 offset:512
    ds_read_b64_tr_b16 a[84:85], v23 offset:4096
    ds_read_b64_tr_b16 a[86:87], v23 offset:4608
    ds_read_b64_tr_b16 a[88:89], v23 offset:8192
    ds_read_b64_tr_b16 a[90:91], v23 offset:8704
    s_waitcnt lgkmcnt(6)
    ds_read_b64_tr_b16 a[92:93], v23 offset:12288
    ds_read_b64_tr_b16 a[94:95], v23 offset:12800
    ds_read_b64_tr_b16 a[96:97], v23 offset:16384
    ds_read_b64_tr_b16 a[98:99], v23 offset:16896
    v_add_u32 v22, 0, v20
    ds_read_b64_tr_b16 a[160:161], v22 offset:0
    ds_read_b64_tr_b16 a[162:163], v22 offset:512
    ds_read_b64_tr_b16 a[164:165], v22 offset:4096
    ds_read_b64_tr_b16 a[166:167], v22 offset:4608
    s_waitcnt lgkmcnt(6)
    ds_read_b64_tr_b16 a[168:169], v22 offset:8192
    ds_read_b64_tr_b16 a[170:171], v22 offset:8704
    ds_read_b64_tr_b16 a[172:173], v22 offset:12288
    ds_read_b64_tr_b16 a[174:175], v22 offset:12800
    ds_read_b64_tr_b16 a[176:177], v22 offset:16384
    ds_read_b64_tr_b16 a[178:179], v22 offset:16896
    s_waitcnt lgkmcnt(0)
    s_barrier
    s_add_u32 m0, s58, 0
    s_add_u32 s55, s57, 3932160
    buffer_load_dwordx4 v16, s[40:43], s55 offen lds
    s_add_u32 m0, s58, 20480
    s_add_u32 s55, s57, 3932288
    buffer_load_dwordx4 v16, s[40:43], s55 offen lds
    s_add_u32 m0, s58, 40960
    s_add_u32 s55, s57, 3932416
    buffer_load_dwordx4 v16, s[40:43], s55 offen lds
    s_add_u32 m0, s58, 4096
    s_add_u32 s55, s57, 4325376
    buffer_load_dwordx4 v16, s[40:43], s55 offen lds
    s_add_u32 m0, s58, 24576
    s_add_u32 s55, s57, 4325504
    buffer_load_dwordx4 v16, s[40:43], s55 offen lds
    s_add_u32 m0, s58, 45056
    s_add_u32 s55, s57, 4325632
    buffer_load_dwordx4 v16, s[40:43], s55 offen lds
    s_add_u32 m0, s58, 8192
    s_add_u32 s55, s57, 4718592
    buffer_load_dwordx4 v16, s[40:43], s55 offen lds
    s_add_u32 m0, s58, 28672
    s_add_u32 s55, s57, 4718720
    buffer_load_dwordx4 v16, s[40:43], s55 offen lds
    s_add_u32 m0, s58, 49152
    s_add_u32 s55, s57, 4718848
    buffer_load_dwordx4 v16, s[40:43], s55 offen lds
    s_add_u32 m0, s58, 12288
    s_add_u32 s55, s57, 5111808
    buffer_load_dwordx4 v16, s[40:43], s55 offen lds
    s_add_u32 m0, s58, 32768
    s_add_u32 s55, s57, 5111936
    buffer_load_dwordx4 v16, s[40:43], s55 offen lds
    s_add_u32 m0, s58, 53248
    s_add_u32 s55, s57, 5112064
    buffer_load_dwordx4 v16, s[40:43], s55 offen lds
    s_add_u32 m0, s58, 16384
    s_add_u32 s55, s57, 5505024
    buffer_load_dwordx4 v16, s[40:43], s55 offen lds
    s_add_u32 m0, s58, 36864
    s_add_u32 s55, s57, 5505152
    buffer_load_dwordx4 v16, s[40:43], s55 offen lds
    s_add_u32 m0, s58, 57344
    s_add_u32 s55, s57, 5505280
    buffer_load_dwordx4 v16, s[40:43], s55 offen lds
    s_waitcnt vmcnt(15)
    s_barrier
    v_add_u32 v22, 61440, v18
    ds_read_b64_tr_b16 a[20:21], v22 offset:0
    ds_read_b64_tr_b16 a[22:23], v22 offset:512
    ds_read_b64_tr_b16 a[24:25], v22 offset:4096
    ds_read_b64_tr_b16 a[26:27], v22 offset:4608
    ds_read_b64_tr_b16 a[28:29], v22 offset:8192
    ds_read_b64_tr_b16 a[30:31], v22 offset:8704
    ds_read_b64_tr_b16 a[32:33], v22 offset:12288
    ds_read_b64_tr_b16 a[34:35], v22 offset:12800
    s_waitcnt lgkmcnt(6)
    ds_read_b64_tr_b16 a[36:37], v22 offset:16384
    ds_read_b64_tr_b16 a[38:39], v22 offset:16896
    v_add_u32 v23, 61440, v19
    ds_read_b64_tr_b16 a[100:101], v23 offset:0
    ds_read_b64_tr_b16 a[102:103], v23 offset:512
    ds_read_b64_tr_b16 a[104:105], v23 offset:4096
    ds_read_b64_tr_b16 a[106:107], v23 offset:4608
    ds_read_b64_tr_b16 a[108:109], v23 offset:8192
    ds_read_b64_tr_b16 a[110:111], v23 offset:8704
    s_waitcnt lgkmcnt(6)
    ds_read_b64_tr_b16 a[112:113], v23 offset:12288
    ds_read_b64_tr_b16 a[114:115], v23 offset:12800
    ds_read_b64_tr_b16 a[116:117], v23 offset:16384
    ds_read_b64_tr_b16 a[118:119], v23 offset:16896
    v_add_u32 v22, 61440, v20
    ds_read_b64_tr_b16 a[180:181], v22 offset:0
    ds_read_b64_tr_b16 a[182:183], v22 offset:512
    ds_read_b64_tr_b16 a[184:185], v22 offset:4096
    ds_read_b64_tr_b16 a[186:187], v22 offset:4608
    s_waitcnt lgkmcnt(6)
    ds_read_b64_tr_b16 a[188:189], v22 offset:8192
    ds_read_b64_tr_b16 a[190:191], v22 offset:8704
    ds_read_b64_tr_b16 a[192:193], v22 offset:12288
    ds_read_b64_tr_b16 a[194:195], v22 offset:12800
    ds_read_b64_tr_b16 a[196:197], v22 offset:16384
    ds_read_b64_tr_b16 a[198:199], v22 offset:16896
    s_waitcnt lgkmcnt(0)
    s_barrier
    s_add_u32 m0, s58, 61440
    s_add_u32 s55, s57, 5898240
    buffer_load_dwordx4 v16, s[40:43], s55 offen lds
    s_add_u32 m0, s58, 81920
    s_add_u32 s55, s57, 5898368
    buffer_load_dwordx4 v16, s[40:43], s55 offen lds
    s_add_u32 m0, s58, 102400
    s_add_u32 s55, s57, 5898496
    buffer_load_dwordx4 v16, s[40:43], s55 offen lds
    s_add_u32 m0, s58, 65536
    s_add_u32 s55, s57, 6291456
    buffer_load_dwordx4 v16, s[40:43], s55 offen lds
    s_add_u32 m0, s58, 86016
    s_add_u32 s55, s57, 6291584
    buffer_load_dwordx4 v16, s[40:43], s55 offen lds
    s_add_u32 m0, s58, 106496
    s_add_u32 s55, s57, 6291712
    buffer_load_dwordx4 v16, s[40:43], s55 offen lds
    s_add_u32 m0, s58, 69632
    s_add_u32 s55, s57, 6684672
    buffer_load_dwordx4 v16, s[40:43], s55 offen lds
    s_add_u32 m0, s58, 90112
    s_add_u32 s55, s57, 6684800
    buffer_load_dwordx4 v16, s[40:43], s55 offen lds
    s_add_u32 m0, s58, 110592
    s_add_u32 s55, s57, 6684928
    buffer_load_dwordx4 v16, s[40:43], s55 offen lds
    s_add_u32 m0, s58, 73728
    s_add_u32 s55, s57, 7077888
    buffer_load_dwordx4 v16, s[40:43], s55 offen lds
    s_add_u32 m0, s58, 94208
    s_add_u32 s55, s57, 7078016
    buffer_load_dwordx4 v16, s[40:43], s55 offen lds
    s_add_u32 m0, s58, 114688
    s_add_u32 s55, s57, 7078144
    buffer_load_dwordx4 v16, s[40:43], s55 offen lds
    s_add_u32 m0, s58, 77824
    s_add_u32 s55, s57, 7471104
    buffer_load_dwordx4 v16, s[40:43], s55 offen lds
    s_add_u32 m0, s58, 98304
    s_add_u32 s55, s57, 7471232
    buffer_load_dwordx4 v16, s[40:43], s55 offen lds
    s_add_u32 m0, s58, 118784
    s_add_u32 s55, s57, 7471360
    buffer_load_dwordx4 v16, s[40:43], s55 offen lds
    s_waitcnt vmcnt(15)
    s_barrier
    v_add_u32 v22, 0, v18
    ds_read_b64_tr_b16 a[40:41], v22 offset:0
    ds_read_b64_tr_b16 a[42:43], v22 offset:512
    ds_read_b64_tr_b16 a[44:45], v22 offset:4096
    ds_read_b64_tr_b16 a[46:47], v22 offset:4608
    ds_read_b64_tr_b16 a[48:49], v22 offset:8192
    ds_read_b64_tr_b16 a[50:51], v22 offset:8704
    ds_read_b64_tr_b16 a[52:53], v22 offset:12288
    ds_read_b64_tr_b16 a[54:55], v22 offset:12800
    s_waitcnt lgkmcnt(6)
    ds_read_b64_tr_b16 a[56:57], v22 offset:16384
    ds_read_b64_tr_b16 a[58:59], v22 offset:16896
    v_add_u32 v23, 0, v19
    ds_read_b64_tr_b16 a[120:121], v23 offset:0
    ds_read_b64_tr_b16 a[122:123], v23 offset:512
    ds_read_b64_tr_b16 a[124:125], v23 offset:4096
    ds_read_b64_tr_b16 a[126:127], v23 offset:4608
    ds_read_b64_tr_b16 a[128:129], v23 offset:8192
    ds_read_b64_tr_b16 a[130:131], v23 offset:8704
    s_waitcnt lgkmcnt(6)
    ds_read_b64_tr_b16 a[132:133], v23 offset:12288
    ds_read_b64_tr_b16 a[134:135], v23 offset:12800
    ds_read_b64_tr_b16 a[136:137], v23 offset:16384
    ds_read_b64_tr_b16 a[138:139], v23 offset:16896
    v_add_u32 v22, 0, v20
    ds_read_b64_tr_b16 a[200:201], v22 offset:0
    ds_read_b64_tr_b16 a[202:203], v22 offset:512
    ds_read_b64_tr_b16 a[204:205], v22 offset:4096
    ds_read_b64_tr_b16 a[206:207], v22 offset:4608
    s_waitcnt lgkmcnt(6)
    ds_read_b64_tr_b16 a[208:209], v22 offset:8192
    ds_read_b64_tr_b16 a[210:211], v22 offset:8704
    ds_read_b64_tr_b16 a[212:213], v22 offset:12288
    ds_read_b64_tr_b16 a[214:215], v22 offset:12800
    ds_read_b64_tr_b16 a[216:217], v22 offset:16384
    ds_read_b64_tr_b16 a[218:219], v22 offset:16896
    s_waitcnt lgkmcnt(0)
    s_barrier
    s_waitcnt vmcnt(0)
    s_barrier
    v_add_u32 v22, 61440, v18
    ds_read_b64_tr_b16 a[60:61], v22 offset:0
    ds_read_b64_tr_b16 a[62:63], v22 offset:512
    ds_read_b64_tr_b16 a[64:65], v22 offset:4096
    ds_read_b64_tr_b16 a[66:67], v22 offset:4608
    ds_read_b64_tr_b16 a[68:69], v22 offset:8192
    ds_read_b64_tr_b16 a[70:71], v22 offset:8704
    ds_read_b64_tr_b16 a[72:73], v22 offset:12288
    ds_read_b64_tr_b16 a[74:75], v22 offset:12800
    s_waitcnt lgkmcnt(6)
    ds_read_b64_tr_b16 a[76:77], v22 offset:16384
    ds_read_b64_tr_b16 a[78:79], v22 offset:16896
    v_add_u32 v23, 61440, v19
    ds_read_b64_tr_b16 a[140:141], v23 offset:0
    ds_read_b64_tr_b16 a[142:143], v23 offset:512
    ds_read_b64_tr_b16 a[144:145], v23 offset:4096
    ds_read_b64_tr_b16 a[146:147], v23 offset:4608
    ds_read_b64_tr_b16 a[148:149], v23 offset:8192
    ds_read_b64_tr_b16 a[150:151], v23 offset:8704
    s_waitcnt lgkmcnt(6)
    ds_read_b64_tr_b16 a[152:153], v23 offset:12288
    ds_read_b64_tr_b16 a[154:155], v23 offset:12800
    ds_read_b64_tr_b16 a[156:157], v23 offset:16384
    ds_read_b64_tr_b16 a[158:159], v23 offset:16896
    v_add_u32 v22, 61440, v20
    ds_read_b64_tr_b16 a[220:221], v22 offset:0
    ds_read_b64_tr_b16 a[222:223], v22 offset:512
    ds_read_b64_tr_b16 a[224:225], v22 offset:4096
    ds_read_b64_tr_b16 a[226:227], v22 offset:4608
    s_waitcnt lgkmcnt(6)
    ds_read_b64_tr_b16 a[228:229], v22 offset:8192
    ds_read_b64_tr_b16 a[230:231], v22 offset:8704
    ds_read_b64_tr_b16 a[232:233], v22 offset:12288
    ds_read_b64_tr_b16 a[234:235], v22 offset:12800
    ds_read_b64_tr_b16 a[236:237], v22 offset:16384
    ds_read_b64_tr_b16 a[238:239], v22 offset:16896
    s_waitcnt lgkmcnt(0)
    s_barrier
    s_mov_b32 s6, 0
    s_mov_b32 s64, 64
    s_mov_b32 s59, 0
    s_mul_i32 s63, s52, 12288
    s_mul_i32 s55, s3, 3072
    s_add_u32 s63, s63, s55
    s_add_u32 s63, s63, 47841280
    s_mov_b32 s44, s8
    s_and_b32 s45, s9, 0xffff
    s_mov_b32 s46, 2621440
    s_mov_b32 s47, 0x20000
    v_lshrrev_b32 v10, 3, v2
    v_mul_u32_u24 v5, 1280, v10
    v_lshrrev_b32 v10, 1, v10
    s_and_b32 s55, s3, 1
    s_lshl_b32 s55, s55, 2
    v_add_u32 v10, s55, v10
    v_and_b32 v11, 7, v2
    v_xor_b32 v10, v10, v11
    v_lshl_add_u32 v5, v10, 4, v5
    s_mul_i32 s55, s3, 10240
    s_add_u32 s59, s59, s55
    s_mul_i32 s60, s3, 10240
    v_lshrrev_b32 v10, 3, v0
    v_mul_u32_u24 v10, 10240, v10
    v_and_b32 v11, 7, v0
    v_lshl_add_u32 v10, v11, 7, v10
    v_lshrrev_b32 v11, 1, v0
    v_xor_b32 v11, v11, v1
    v_lshl_add_u32 v6, v11, 4, v10
    v_xor_b32 v11, 4, v11
    v_lshl_add_u32 v7, v11, 4, v10
    s_mov_b32 s61, 0
    s_add_u32 m0, s60, 0
    s_nop 0
    buffer_load_dwordx4 v5, s[44:47], s59 offen offset:0 lds
    s_add_u32 m0, s60, 896
    s_nop 0
    buffer_load_dwordx4 v5, s[44:47], s59 offen offset:128 lds
    s_add_u32 m0, s60, 1792
    s_nop 0
    buffer_load_dwordx4 v5, s[44:47], s59 offen offset:256 lds
    s_add_u32 m0, s60, 2688
    s_nop 0
    buffer_load_dwordx4 v5, s[44:47], s59 offen offset:384 lds
    s_add_u32 m0, s60, 3584
    s_nop 0
    buffer_load_dwordx4 v5, s[44:47], s59 offen offset:512 lds
    s_add_u32 m0, s60, 4480
    s_nop 0
    buffer_load_dwordx4 v5, s[44:47], s59 offen offset:640 lds
    s_add_u32 m0, s60, 5376
    s_nop 0
    buffer_load_dwordx4 v5, s[44:47], s59 offen offset:768 lds
    s_add_u32 m0, s60, 6272
    s_nop 0
    buffer_load_dwordx4 v5, s[44:47], s59 offen offset:896 lds
    s_add_u32 m0, s60, 7168
    s_nop 0
    buffer_load_dwordx4 v5, s[44:47], s59 offen offset:1024 lds
    s_add_u32 m0, s60, 8064
    s_nop 0
    buffer_load_dwordx4 v5, s[44:47], s59 offen offset:1152 lds
    s_add_u32 s59, s59, 40960
    s_add_u32 s60, s60, 40960
    s_cmp_ge_u32 s60, 122880
    s_cselect_b32 s55, 122880, 0
    s_sub_u32 s60, s60, s55
    s_add_u32 m0, s60, 0
    s_nop 0
    buffer_load_dwordx4 v5, s[44:47], s59 offen offset:0 lds
    s_add_u32 m0, s60, 896
    s_nop 0
    buffer_load_dwordx4 v5, s[44:47], s59 offen offset:128 lds
    s_add_u32 m0, s60, 1792
    s_nop 0
    buffer_load_dwordx4 v5, s[44:47], s59 offen offset:256 lds
    s_add_u32 m0, s60, 2688
    s_nop 0
    buffer_load_dwordx4 v5, s[44:47], s59 offen offset:384 lds
    s_add_u32 m0, s60, 3584
    s_nop 0
    buffer_load_dwordx4 v5, s[44:47], s59 offen offset:512 lds
    s_add_u32 m0, s60, 4480
    s_nop 0
    buffer_load_dwordx4 v5, s[44:47], s59 offen offset:640 lds
    s_add_u32 m0, s60, 5376
    s_nop 0
    buffer_load_dwordx4 v5, s[44:47], s59 offen offset:768 lds
    s_add_u32 m0, s60, 6272
    s_nop 0
    buffer_load_dwordx4 v5, s[44:47], s59 offen offset:896 lds
    s_add_u32 m0, s60, 7168
    s_nop 0
    buffer_load_dwordx4 v5, s[44:47], s59 offen offset:1024 lds
    s_add_u32 m0, s60, 8064
    s_nop 0
    buffer_load_dwordx4 v5, s[44:47], s59 offen offset:1152 lds
    s_add_u32 s59, s59, 40960
    s_add_u32 s60, s60, 40960
    s_cmp_ge_u32 s60, 122880
    s_cselect_b32 s55, 122880, 0
    s_sub_u32 s60, s60, s55
    s_waitcnt vmcnt(10)
    s_barrier
    ds_read_b128 v[16:19], v6 offset:0
    ds_read_b128 v[20:23], v6 offset:20480
    ds_read_b128 v[24:27], v7 offset:0
    ds_read_b128 v[28:31], v7 offset:20480
    s_mov_b32 s62, 4026531840
    s_waitcnt lgkmcnt(2)
    .p2align 6
L_k_loop:
    v_mfma_f32_16x16x32_bf16 v[48:51], a[0:3], v[16:19], 0
    ds_read_b128 v[32:35], v6 offset:1024
    s_add_u32 s61, s61, 40960
    s_cmp_ge_u32 s61, 122880
    s_cselect_b32 s94, 122880, 0
    v_mfma_f32_16x16x32_bf16 v[52:55], a[0:3], v[20:23], 0
    ds_read_b128 v[36:39], v6 offset:21504
    s_sub_u32 s61, s61, s94
    s_sub_u32 s94, 40960, s94
    v_mfma_f32_16x16x32_bf16 v[56:59], a[80:83], v[16:19], 0
    v_mfma_f32_16x16x32_bf16 v[60:63], a[80:83], v[20:23], 0
    v_mfma_f32_16x16x32_bf16 v[64:67], a[160:163], v[16:19], 0
    v_mfma_f32_16x16x32_bf16 v[68:71], a[160:163], v[20:23], 0
    s_waitcnt lgkmcnt(2)
    v_mfma_f32_16x16x32_bf16 v[48:51], a[4:7], v[24:27], v[48:51]
    ds_read_b128 v[40:43], v7 offset:1024
    v_mfma_f32_16x16x32_bf16 v[52:55], a[4:7], v[28:31], v[52:55]
    ds_read_b128 v[44:47], v7 offset:21504
    v_cvt_pk_bf16_f32 v96, v72, v73
    v_cvt_pk_bf16_f32 v97, v74, v75
    v_mfma_f32_16x16x32_bf16 v[56:59], a[84:87], v[24:27], v[56:59]
    v_cvt_pk_bf16_f32 v98, v76, v77
    v_cvt_pk_bf16_f32 v99, v78, v79
    v_mfma_f32_16x16x32_bf16 v[60:63], a[84:87], v[28:31], v[60:63]
    buffer_store_dwordx4 v[96:99], v3, s[36:39], s62 offen offset:0 sc1
    v_cvt_pk_bf16_f32 v100, v80, v81
    v_cvt_pk_bf16_f32 v101, v82, v83
    v_mfma_f32_16x16x32_bf16 v[64:67], a[164:167], v[24:27], v[64:67]
    v_cvt_pk_bf16_f32 v102, v84, v85
    v_cvt_pk_bf16_f32 v103, v86, v87
    v_mfma_f32_16x16x32_bf16 v[68:71], a[164:167], v[28:31], v[68:71]
    s_waitcnt lgkmcnt(2)
    buffer_store_dwordx4 v[100:103], v3, s[36:39], s62 offen offset:1024 sc1
    v_cvt_pk_bf16_f32 v104, v88, v89
    v_mfma_f32_16x16x32_bf16 v[48:51], a[8:11], v[32:35], v[48:51]
    ds_read_b128 v[16:19], v6 offset:2048
    v_cvt_pk_bf16_f32 v105, v90, v91
    v_cvt_pk_bf16_f32 v106, v92, v93
    v_mfma_f32_16x16x32_bf16 v[52:55], a[8:11], v[36:39], v[52:55]
    ds_read_b128 v[20:23], v6 offset:22528
    v_cvt_pk_bf16_f32 v107, v94, v95
    buffer_store_dwordx4 v[104:107], v3, s[36:39], s62 offen offset:2048 sc1
    v_mfma_f32_16x16x32_bf16 v[56:59], a[88:91], v[32:35], v[56:59]
    s_add_u32 m0, s60, 0
    s_add_u32 s63, s63, 393216
    v_mfma_f32_16x16x32_bf16 v[60:63], a[88:91], v[36:39], v[60:63]
    v_mfma_f32_16x16x32_bf16 v[64:67], a[168:171], v[32:35], v[64:67]
    v_mfma_f32_16x16x32_bf16 v[68:71], a[168:171], v[36:39], v[68:71]
    s_waitcnt lgkmcnt(2)
    buffer_load_dwordx4 v5, s[44:47], s59 offen offset:0 lds
    v_mfma_f32_16x16x32_bf16 v[48:51], a[12:15], v[40:43], v[48:51]
    ds_read_b128 v[24:27], v7 offset:2048
    v_mfma_f32_16x16x32_bf16 v[52:55], a[12:15], v[44:47], v[52:55]
    ds_read_b128 v[28:31], v7 offset:22528
    v_mfma_f32_16x16x32_bf16 v[56:59], a[92:95], v[40:43], v[56:59]
    v_mfma_f32_16x16x32_bf16 v[60:63], a[92:95], v[44:47], v[60:63]
    s_add_u32 m0, s60, 896
    v_mfma_f32_16x16x32_bf16 v[64:67], a[172:175], v[40:43], v[64:67]
    v_mfma_f32_16x16x32_bf16 v[68:71], a[172:175], v[44:47], v[68:71]
    s_waitcnt lgkmcnt(2)
    v_mfma_f32_16x16x32_bf16 v[48:51], a[16:19], v[16:19], v[48:51]
    ds_read_b128 v[32:35], v6 offset:3072
    v_mfma_f32_16x16x32_bf16 v[52:55], a[16:19], v[20:23], v[52:55]
    ds_read_b128 v[36:39], v6 offset:23552
    buffer_load_dwordx4 v5, s[44:47], s59 offen offset:128 lds
    v_mfma_f32_16x16x32_bf16 v[56:59], a[96:99], v[16:19], v[56:59]
    v_mfma_f32_16x16x32_bf16 v[60:63], a[96:99], v[20:23], v[60:63]
    v_mfma_f32_16x16x32_bf16 v[64:67], a[176:179], v[16:19], v[64:67]
    v_mfma_f32_16x16x32_bf16 v[68:71], a[176:179], v[20:23], v[68:71]
    s_waitcnt lgkmcnt(2)
    s_add_u32 m0, s60, 1792
    v_mfma_f32_16x16x32_bf16 v[48:51], a[20:23], v[24:27], v[48:51]
    ds_read_b128 v[40:43], v7 offset:3072
    v_mfma_f32_16x16x32_bf16 v[52:55], a[20:23], v[28:31], v[52:55]
    ds_read_b128 v[44:47], v7 offset:23552
    v_mfma_f32_16x16x32_bf16 v[56:59], a[100:103], v[24:27], v[56:59]
    v_mfma_f32_16x16x32_bf16 v[60:63], a[100:103], v[28:31], v[60:63]
    buffer_load_dwordx4 v5, s[44:47], s59 offen offset:256 lds
    v_mfma_f32_16x16x32_bf16 v[64:67], a[180:183], v[24:27], v[64:67]
    v_mfma_f32_16x16x32_bf16 v[68:71], a[180:183], v[28:31], v[68:71]
    s_waitcnt lgkmcnt(2)
    v_mfma_f32_16x16x32_bf16 v[48:51], a[24:27], v[32:35], v[48:51]
    ds_read_b128 v[16:19], v6 offset:4096
    s_add_u32 m0, s60, 2688
    v_mfma_f32_16x16x32_bf16 v[52:55], a[24:27], v[36:39], v[52:55]
    ds_read_b128 v[20:23], v6 offset:24576
    v_mfma_f32_16x16x32_bf16 v[56:59], a[104:107], v[32:35], v[56:59]
    v_mfma_f32_16x16x32_bf16 v[60:63], a[104:107], v[36:39], v[60:63]
    v_mfma_f32_16x16x32_bf16 v[64:67], a[184:187], v[32:35], v[64:67]
    buffer_load_dwordx4 v5, s[44:47], s59 offen offset:384 lds
    v_mfma_f32_16x16x32_bf16 v[68:71], a[184:187], v[36:39], v[68:71]
    s_waitcnt lgkmcnt(2)
    v_mfma_f32_16x16x32_bf16 v[48:51], a[28:31], v[40:43], v[48:51]
    ds_read_b128 v[24:27], v7 offset:4096
    v_mfma_f32_16x16x32_bf16 v[52:55], a[28:31], v[44:47], v[52:55]
    ds_read_b128 v[28:31], v7 offset:24576
    v_mfma_f32_16x16x32_bf16 v[56:59], a[108:111], v[40:43], v[56:59]
    s_add_u32 m0, s60, 3584
    v_mfma_f32_16x16x32_bf16 v[60:63], a[108:111], v[44:47], v[60:63]
    v_mfma_f32_16x16x32_bf16 v[64:67], a[188:191], v[40:43], v[64:67]
    v_mfma_f32_16x16x32_bf16 v[68:71], a[188:191], v[44:47], v[68:71]
    s_waitcnt lgkmcnt(2)
    v_mfma_f32_16x16x32_bf16 v[48:51], a[32:35], v[16:19], v[48:51]
    ds_read_b128 v[32:35], v6 offset:5120
    buffer_load_dwordx4 v5, s[44:47], s59 offen offset:512 lds
    v_mfma_f32_16x16x32_bf16 v[52:55], a[32:35], v[20:23], v[52:55]
    ds_read_b128 v[36:39], v6 offset:25600
    v_mfma_f32_16x16x32_bf16 v[56:59], a[112:115], v[16:19], v[56:59]
    v_mfma_f32_16x16x32_bf16 v[60:63], a[112:115], v[20:23], v[60:63]
    v_mfma_f32_16x16x32_bf16 v[64:67], a[192:195], v[16:19], v[64:67]
    s_add_u32 m0, s60, 4480
    v_mfma_f32_16x16x32_bf16 v[68:71], a[192:195], v[20:23], v[68:71]
    s_waitcnt lgkmcnt(2)
    v_mfma_f32_16x16x32_bf16 v[48:51], a[36:39], v[24:27], v[48:51]
    ds_read_b128 v[40:43], v7 offset:5120
    v_mfma_f32_16x16x32_bf16 v[52:55], a[36:39], v[28:31], v[52:55]
    ds_read_b128 v[44:47], v7 offset:25600
    v_mfma_f32_16x16x32_bf16 v[56:59], a[116:119], v[24:27], v[56:59]
    buffer_load_dwordx4 v5, s[44:47], s59 offen offset:640 lds
    v_mfma_f32_16x16x32_bf16 v[60:63], a[116:119], v[28:31], v[60:63]
    v_mfma_f32_16x16x32_bf16 v[64:67], a[196:199], v[24:27], v[64:67]
    v_mfma_f32_16x16x32_bf16 v[68:71], a[196:199], v[28:31], v[68:71]
    s_waitcnt lgkmcnt(2)
    s_add_u32 m0, s60, 5376
    v_mfma_f32_16x16x32_bf16 v[48:51], a[40:43], v[32:35], v[48:51]
    ds_read_b128 v[16:19], v6 offset:6144
    v_mfma_f32_16x16x32_bf16 v[52:55], a[40:43], v[36:39], v[52:55]
    ds_read_b128 v[20:23], v6 offset:26624
    v_mfma_f32_16x16x32_bf16 v[56:59], a[120:123], v[32:35], v[56:59]
    v_mfma_f32_16x16x32_bf16 v[60:63], a[120:123], v[36:39], v[60:63]
    buffer_load_dwordx4 v5, s[44:47], s59 offen offset:768 lds
    v_mfma_f32_16x16x32_bf16 v[64:67], a[200:203], v[32:35], v[64:67]
    v_mfma_f32_16x16x32_bf16 v[68:71], a[200:203], v[36:39], v[68:71]
    s_waitcnt lgkmcnt(2)
    v_mfma_f32_16x16x32_bf16 v[48:51], a[44:47], v[40:43], v[48:51]
    ds_read_b128 v[24:27], v7 offset:6144
    v_mfma_f32_16x16x32_bf16 v[52:55], a[44:47], v[44:47], v[52:55]
    ds_read_b128 v[28:31], v7 offset:26624
    s_add_u32 m0, s60, 6272
    v_mfma_f32_16x16x32_bf16 v[56:59], a[124:127], v[40:43], v[56:59]
    v_mfma_f32_16x16x32_bf16 v[60:63], a[124:127], v[44:47], v[60:63]
    v_mfma_f32_16x16x32_bf16 v[64:67], a[204:207], v[40:43], v[64:67]
    v_mfma_f32_16x16x32_bf16 v[68:71], a[204:207], v[44:47], v[68:71]
    s_waitcnt lgkmcnt(2)
    buffer_load_dwordx4 v5, s[44:47], s59 offen offset:896 lds
    v_mfma_f32_16x16x32_bf16 v[48:51], a[48:51], v[16:19], v[48:51]
    ds_read_b128 v[32:35], v6 offset:7168
    v_mfma_f32_16x16x32_bf16 v[52:55], a[48:51], v[20:23], v[52:55]
    ds_read_b128 v[36:39], v6 offset:27648
    v_mfma_f32_16x16x32_bf16 v[56:59], a[128:131], v[16:19], v[56:59]
    v_mfma_f32_16x16x32_bf16 v[60:63], a[128:131], v[20:23], v[60:63]
    s_add_u32 m0, s60, 7168
    v_mfma_f32_16x16x32_bf16 v[64:67], a[208:211], v[16:19], v[64:67]
    v_mfma_f32_16x16x32_bf16 v[68:71], a[208:211], v[20:23], v[68:71]
    s_waitcnt lgkmcnt(2)
    v_mfma_f32_16x16x32_bf16 v[48:51], a[52:55], v[24:27], v[48:51]
    ds_read_b128 v[40:43], v7 offset:7168
    v_mfma_f32_16x16x32_bf16 v[52:55], a[52:55], v[28:31], v[52:55]
    ds_read_b128 v[44:47], v7 offset:27648
    buffer_load_dwordx4 v5, s[44:47], s59 offen offset:1024 lds
    v_mfma_f32_16x16x32_bf16 v[56:59], a[132:135], v[24:27], v[56:59]
    v_mfma_f32_16x16x32_bf16 v[60:63], a[132:135], v[28:31], v[60:63]
    v_mfma_f32_16x16x32_bf16 v[64:67], a[212:215], v[24:27], v[64:67]
    s_add_u32 m0, s60, 8064
    v_mfma_f32_16x16x32_bf16 v[68:71], a[212:215], v[28:31], v[68:71]
    s_waitcnt lgkmcnt(2)
    v_mfma_f32_16x16x32_bf16 v[48:51], a[56:59], v[32:35], v[48:51]
    ds_read_b128 v[16:19], v6 offset:8192
    v_mfma_f32_16x16x32_bf16 v[52:55], a[56:59], v[36:39], v[52:55]
    ds_read_b128 v[20:23], v6 offset:28672
    v_mfma_f32_16x16x32_bf16 v[56:59], a[136:139], v[32:35], v[56:59]
    buffer_load_dwordx4 v5, s[44:47], s59 offen offset:1152 lds
    v_mfma_f32_16x16x32_bf16 v[60:63], a[136:139], v[36:39], v[60:63]
    v_mfma_f32_16x16x32_bf16 v[64:67], a[216:219], v[32:35], v[64:67]
    v_mfma_f32_16x16x32_bf16 v[68:71], a[216:219], v[36:39], v[68:71]
    s_waitcnt lgkmcnt(2)
    v_mfma_f32_16x16x32_bf16 v[48:51], a[60:63], v[40:43], v[48:51]
    ds_read_b128 v[24:27], v7 offset:8192
    s_add_u32 s59, s59, 40960
    v_mfma_f32_16x16x32_bf16 v[52:55], a[60:63], v[44:47], v[52:55]
    ds_read_b128 v[28:31], v7 offset:28672
    v_mfma_f32_16x16x32_bf16 v[56:59], a[140:143], v[40:43], v[56:59]
    v_mfma_f32_16x16x32_bf16 v[60:63], a[140:143], v[44:47], v[60:63]
    v_mfma_f32_16x16x32_bf16 v[64:67], a[220:223], v[40:43], v[64:67]
    s_add_u32 s60, s60, 40960
    v_mfma_f32_16x16x32_bf16 v[68:71], a[220:223], v[44:47], v[68:71]
    s_waitcnt lgkmcnt(2)
    v_mfma_f32_16x16x32_bf16 v[48:51], a[64:67], v[16:19], v[48:51]
    ds_read_b128 v[32:35], v6 offset:9216
    v_mfma_f32_16x16x32_bf16 v[52:55], a[64:67], v[20:23], v[52:55]
    ds_read_b128 v[36:39], v6 offset:29696
    v_mfma_f32_16x16x32_bf16 v[56:59], a[144:147], v[16:19], v[56:59]
    s_cmp_ge_u32 s60, 122880
    s_cselect_b32 s55, 122880, 0
    v_mfma_f32_16x16x32_bf16 v[60:63], a[144:147], v[20:23], v[60:63]
    v_mfma_f32_16x16x32_bf16 v[64:67], a[224:227], v[16:19], v[64:67]
    v_mfma_f32_16x16x32_bf16 v[68:71], a[224:227], v[20:23], v[68:71]
    s_waitcnt lgkmcnt(2)
    v_mfma_f32_16x16x32_bf16 v[48:51], a[68:71], v[24:27], v[48:51]
    ds_read_b128 v[40:43], v7 offset:9216
    v_add_u32 v6, s94, v6
    s_sub_u32 s60, s60, s55
    v_mfma_f32_16x16x32_bf16 v[52:55], a[68:71], v[28:31], v[52:55]
    ds_read_b128 v[44:47], v7 offset:29696
    v_add_u32 v7, s94, v7
    v_mfma_f32_16x16x32_bf16 v[56:59], a[148:151], v[24:27], v[56:59]
    v_mfma_f32_16x16x32_bf16 v[60:63], a[148:151], v[28:31], v[60:63]
    v_mfma_f32_16x16x32_bf16 v[64:67], a[228:231], v[24:27], v[64:67]
    v_mfma_f32_16x16x32_bf16 v[68:71], a[228:231], v[28:31], v[68:71]
    s_waitcnt vmcnt(10) lgkmcnt(0)
    s_barrier
    v_mfma_f32_16x16x32_bf16 v[48:51], a[72:75], v[32:35], v[48:51]
    ds_read_b128 v[16:19], v6 offset:0
    v_mfma_f32_16x16x32_bf16 v[52:55], a[72:75], v[36:39], v[52:55]
    ds_read_b128 v[20:23], v6 offset:20480
    v_mfma_f32_16x16x32_bf16 v[56:59], a[152:155], v[32:35], v[56:59]
    v_mfma_f32_16x16x32_bf16 v[60:63], a[152:155], v[36:39], v[60:63]
    v_mfma_f32_16x16x32_bf16 v[64:67], a[232:235], v[32:35], v[64:67]
    v_mfma_f32_16x16x32_bf16 v[68:71], a[232:235], v[36:39], v[68:71]
    v_mfma_f32_16x16x32_bf16 v[48:51], a[76:79], v[40:43], v[48:51]
    ds_read_b128 v[24:27], v7 offset:0
    v_mfma_f32_16x16x32_bf16 v[52:55], a[76:79], v[44:47], v[52:55]
    ds_read_b128 v[28:31], v7 offset:20480
    v_mfma_f32_16x16x32_bf16 v[56:59], a[156:159], v[40:43], v[56:59]
    s_cmp_lg_u32 s3, 0
    s_cbranch_scc1 L_sf_11
    v_mov_b32 v10, s6
    s_mov_b64 exec, 1
    buffer_store_dword v10, v8, s[36:39], s65 offen offset:0 sc1
    s_mov_b64 exec, -1
L_sf_11:
    v_mfma_f32_16x16x32_bf16 v[60:63], a[156:159], v[44:47], v[60:63]
    v_mfma_f32_16x16x32_bf16 v[64:67], a[236:239], v[40:43], v[64:67]
    v_mfma_f32_16x16x32_bf16 v[68:71], a[236:239], v[44:47], v[68:71]
    s_waitcnt lgkmcnt(2)
    s_mov_b32 s62, s63
    s_add_u32 s6, s6, 1
    v_mfma_f32_16x16x32_bf16 v[72:75], a[0:3], v[16:19], 0
    ds_read_b128 v[32:35], v6 offset:1024
    s_add_u32 s61, s61, 40960
    s_cmp_ge_u32 s61, 122880
    s_cselect_b32 s94, 122880, 0
    v_mfma_f32_16x16x32_bf16 v[76:79], a[0:3], v[20:23], 0
    ds_read_b128 v[36:39], v6 offset:21504
    s_sub_u32 s61, s61, s94
    s_sub_u32 s94, 40960, s94
    v_mfma_f32_16x16x32_bf16 v[80:83], a[80:83], v[16:19], 0
    v_mfma_f32_16x16x32_bf16 v[84:87], a[80:83], v[20:23], 0
    v_mfma_f32_16x16x32_bf16 v[88:91], a[160:163], v[16:19], 0
    v_mfma_f32_16x16x32_bf16 v[92:95], a[160:163], v[20:23], 0
    s_waitcnt lgkmcnt(2)
    v_mfma_f32_16x16x32_bf16 v[72:75], a[4:7], v[24:27], v[72:75]
    ds_read_b128 v[40:43], v7 offset:1024
    v_mfma_f32_16x16x32_bf16 v[76:79], a[4:7], v[28:31], v[76:79]
    ds_read_b128 v[44:47], v7 offset:21504
    v_cvt_pk_bf16_f32 v96, v48, v49
    v_cvt_pk_bf16_f32 v97, v50, v51
    v_mfma_f32_16x16x32_bf16 v[80:83], a[84:87], v[24:27], v[80:83]
    v_cvt_pk_bf16_f32 v98, v52, v53
    v_cvt_pk_bf16_f32 v99, v54, v55
    v_mfma_f32_16x16x32_bf16 v[84:87], a[84:87], v[28:31], v[84:87]
    buffer_store_dwordx4 v[96:99], v3, s[36:39], s62 offen offset:0 sc1
    v_cvt_pk_bf16_f32 v100, v56, v57
    v_cvt_pk_bf16_f32 v101, v58, v59
    v_mfma_f32_16x16x32_bf16 v[88:91], a[164:167], v[24:27], v[88:91]
    v_cvt_pk_bf16_f32 v102, v60, v61
    v_cvt_pk_bf16_f32 v103, v62, v63
    v_mfma_f32_16x16x32_bf16 v[92:95], a[164:167], v[28:31], v[92:95]
    s_waitcnt lgkmcnt(2)
    buffer_store_dwordx4 v[100:103], v3, s[36:39], s62 offen offset:1024 sc1
    v_cvt_pk_bf16_f32 v104, v64, v65
    v_mfma_f32_16x16x32_bf16 v[72:75], a[8:11], v[32:35], v[72:75]
    ds_read_b128 v[16:19], v6 offset:2048
    v_cvt_pk_bf16_f32 v105, v66, v67
    v_cvt_pk_bf16_f32 v106, v68, v69
    v_mfma_f32_16x16x32_bf16 v[76:79], a[8:11], v[36:39], v[76:79]
    ds_read_b128 v[20:23], v6 offset:22528
    v_cvt_pk_bf16_f32 v107, v70, v71
    buffer_store_dwordx4 v[104:107], v3, s[36:39], s62 offen offset:2048 sc1
    v_mfma_f32_16x16x32_bf16 v[80:83], a[88:91], v[32:35], v[80:83]
    s_add_u32 m0, s60, 0
    s_add_u32 s63, s63, 393216
    v_mfma_f32_16x16x32_bf16 v[84:87], a[88:91], v[36:39], v[84:87]
    v_mfma_f32_16x16x32_bf16 v[88:91], a[168:171], v[32:35], v[88:91]
    v_mfma_f32_16x16x32_bf16 v[92:95], a[168:171], v[36:39], v[92:95]
    s_waitcnt lgkmcnt(2)
    buffer_load_dwordx4 v5, s[44:47], s59 offen offset:0 lds
    v_mfma_f32_16x16x32_bf16 v[72:75], a[12:15], v[40:43], v[72:75]
    ds_read_b128 v[24:27], v7 offset:2048
    v_mfma_f32_16x16x32_bf16 v[76:79], a[12:15], v[44:47], v[76:79]
    ds_read_b128 v[28:31], v7 offset:22528
    v_mfma_f32_16x16x32_bf16 v[80:83], a[92:95], v[40:43], v[80:83]
    v_mfma_f32_16x16x32_bf16 v[84:87], a[92:95], v[44:47], v[84:87]
    s_add_u32 m0, s60, 896
    v_mfma_f32_16x16x32_bf16 v[88:91], a[172:175], v[40:43], v[88:91]
    v_mfma_f32_16x16x32_bf16 v[92:95], a[172:175], v[44:47], v[92:95]
    s_waitcnt lgkmcnt(2)
    v_mfma_f32_16x16x32_bf16 v[72:75], a[16:19], v[16:19], v[72:75]
    ds_read_b128 v[32:35], v6 offset:3072
    v_mfma_f32_16x16x32_bf16 v[76:79], a[16:19], v[20:23], v[76:79]
    ds_read_b128 v[36:39], v6 offset:23552
    buffer_load_dwordx4 v5, s[44:47], s59 offen offset:128 lds
    v_mfma_f32_16x16x32_bf16 v[80:83], a[96:99], v[16:19], v[80:83]
    v_mfma_f32_16x16x32_bf16 v[84:87], a[96:99], v[20:23], v[84:87]
    v_mfma_f32_16x16x32_bf16 v[88:91], a[176:179], v[16:19], v[88:91]
    v_mfma_f32_16x16x32_bf16 v[92:95], a[176:179], v[20:23], v[92:95]
    s_waitcnt lgkmcnt(2)
    s_add_u32 m0, s60, 1792
    v_mfma_f32_16x16x32_bf16 v[72:75], a[20:23], v[24:27], v[72:75]
    ds_read_b128 v[40:43], v7 offset:3072
    v_mfma_f32_16x16x32_bf16 v[76:79], a[20:23], v[28:31], v[76:79]
    ds_read_b128 v[44:47], v7 offset:23552
    v_mfma_f32_16x16x32_bf16 v[80:83], a[100:103], v[24:27], v[80:83]
    v_mfma_f32_16x16x32_bf16 v[84:87], a[100:103], v[28:31], v[84:87]
    buffer_load_dwordx4 v5, s[44:47], s59 offen offset:256 lds
    v_mfma_f32_16x16x32_bf16 v[88:91], a[180:183], v[24:27], v[88:91]
    v_mfma_f32_16x16x32_bf16 v[92:95], a[180:183], v[28:31], v[92:95]
    s_waitcnt lgkmcnt(2)
    v_mfma_f32_16x16x32_bf16 v[72:75], a[24:27], v[32:35], v[72:75]
    ds_read_b128 v[16:19], v6 offset:4096
    s_add_u32 m0, s60, 2688
    v_mfma_f32_16x16x32_bf16 v[76:79], a[24:27], v[36:39], v[76:79]
    ds_read_b128 v[20:23], v6 offset:24576
    v_mfma_f32_16x16x32_bf16 v[80:83], a[104:107], v[32:35], v[80:83]
    v_mfma_f32_16x16x32_bf16 v[84:87], a[104:107], v[36:39], v[84:87]
    v_mfma_f32_16x16x32_bf16 v[88:91], a[184:187], v[32:35], v[88:91]
    buffer_load_dwordx4 v5, s[44:47], s59 offen offset:384 lds
    v_mfma_f32_16x16x32_bf16 v[92:95], a[184:187], v[36:39], v[92:95]
    s_waitcnt lgkmcnt(2)
    v_mfma_f32_16x16x32_bf16 v[72:75], a[28:31], v[40:43], v[72:75]
    ds_read_b128 v[24:27], v7 offset:4096
    v_mfma_f32_16x16x32_bf16 v[76:79], a[28:31], v[44:47], v[76:79]
    ds_read_b128 v[28:31], v7 offset:24576
    v_mfma_f32_16x16x32_bf16 v[80:83], a[108:111], v[40:43], v[80:83]
    s_add_u32 m0, s60, 3584
    v_mfma_f32_16x16x32_bf16 v[84:87], a[108:111], v[44:47], v[84:87]
    v_mfma_f32_16x16x32_bf16 v[88:91], a[188:191], v[40:43], v[88:91]
    v_mfma_f32_16x16x32_bf16 v[92:95], a[188:191], v[44:47], v[92:95]
    s_waitcnt lgkmcnt(2)
    v_mfma_f32_16x16x32_bf16 v[72:75], a[32:35], v[16:19], v[72:75]
    ds_read_b128 v[32:35], v6 offset:5120
    buffer_load_dwordx4 v5, s[44:47], s59 offen offset:512 lds
    v_mfma_f32_16x16x32_bf16 v[76:79], a[32:35], v[20:23], v[76:79]
    ds_read_b128 v[36:39], v6 offset:25600
    v_mfma_f32_16x16x32_bf16 v[80:83], a[112:115], v[16:19], v[80:83]
    v_mfma_f32_16x16x32_bf16 v[84:87], a[112:115], v[20:23], v[84:87]
    v_mfma_f32_16x16x32_bf16 v[88:91], a[192:195], v[16:19], v[88:91]
    s_add_u32 m0, s60, 4480
    v_mfma_f32_16x16x32_bf16 v[92:95], a[192:195], v[20:23], v[92:95]
    s_waitcnt lgkmcnt(2)
    v_mfma_f32_16x16x32_bf16 v[72:75], a[36:39], v[24:27], v[72:75]
    ds_read_b128 v[40:43], v7 offset:5120
    v_mfma_f32_16x16x32_bf16 v[76:79], a[36:39], v[28:31], v[76:79]
    ds_read_b128 v[44:47], v7 offset:25600
    v_mfma_f32_16x16x32_bf16 v[80:83], a[116:119], v[24:27], v[80:83]
    buffer_load_dwordx4 v5, s[44:47], s59 offen offset:640 lds
    v_mfma_f32_16x16x32_bf16 v[84:87], a[116:119], v[28:31], v[84:87]
    v_mfma_f32_16x16x32_bf16 v[88:91], a[196:199], v[24:27], v[88:91]
    v_mfma_f32_16x16x32_bf16 v[92:95], a[196:199], v[28:31], v[92:95]
    s_waitcnt lgkmcnt(2)
    s_add_u32 m0, s60, 5376
    v_mfma_f32_16x16x32_bf16 v[72:75], a[40:43], v[32:35], v[72:75]
    ds_read_b128 v[16:19], v6 offset:6144
    v_mfma_f32_16x16x32_bf16 v[76:79], a[40:43], v[36:39], v[76:79]
    ds_read_b128 v[20:23], v6 offset:26624
    v_mfma_f32_16x16x32_bf16 v[80:83], a[120:123], v[32:35], v[80:83]
    v_mfma_f32_16x16x32_bf16 v[84:87], a[120:123], v[36:39], v[84:87]
    buffer_load_dwordx4 v5, s[44:47], s59 offen offset:768 lds
    v_mfma_f32_16x16x32_bf16 v[88:91], a[200:203], v[32:35], v[88:91]
    v_mfma_f32_16x16x32_bf16 v[92:95], a[200:203], v[36:39], v[92:95]
    s_waitcnt lgkmcnt(2)
    v_mfma_f32_16x16x32_bf16 v[72:75], a[44:47], v[40:43], v[72:75]
    ds_read_b128 v[24:27], v7 offset:6144
    v_mfma_f32_16x16x32_bf16 v[76:79], a[44:47], v[44:47], v[76:79]
    ds_read_b128 v[28:31], v7 offset:26624
    s_add_u32 m0, s60, 6272
    v_mfma_f32_16x16x32_bf16 v[80:83], a[124:127], v[40:43], v[80:83]
    v_mfma_f32_16x16x32_bf16 v[84:87], a[124:127], v[44:47], v[84:87]
    v_mfma_f32_16x16x32_bf16 v[88:91], a[204:207], v[40:43], v[88:91]
    v_mfma_f32_16x16x32_bf16 v[92:95], a[204:207], v[44:47], v[92:95]
    s_waitcnt lgkmcnt(2)
    buffer_load_dwordx4 v5, s[44:47], s59 offen offset:896 lds
    v_mfma_f32_16x16x32_bf16 v[72:75], a[48:51], v[16:19], v[72:75]
    ds_read_b128 v[32:35], v6 offset:7168
    v_mfma_f32_16x16x32_bf16 v[76:79], a[48:51], v[20:23], v[76:79]
    ds_read_b128 v[36:39], v6 offset:27648
    v_mfma_f32_16x16x32_bf16 v[80:83], a[128:131], v[16:19], v[80:83]
    v_mfma_f32_16x16x32_bf16 v[84:87], a[128:131], v[20:23], v[84:87]
    s_add_u32 m0, s60, 7168
    v_mfma_f32_16x16x32_bf16 v[88:91], a[208:211], v[16:19], v[88:91]
    v_mfma_f32_16x16x32_bf16 v[92:95], a[208:211], v[20:23], v[92:95]
    s_waitcnt lgkmcnt(2)
    v_mfma_f32_16x16x32_bf16 v[72:75], a[52:55], v[24:27], v[72:75]
    ds_read_b128 v[40:43], v7 offset:7168
    v_mfma_f32_16x16x32_bf16 v[76:79], a[52:55], v[28:31], v[76:79]
    ds_read_b128 v[44:47], v7 offset:27648
    buffer_load_dwordx4 v5, s[44:47], s59 offen offset:1024 lds
    v_mfma_f32_16x16x32_bf16 v[80:83], a[132:135], v[24:27], v[80:83]
    v_mfma_f32_16x16x32_bf16 v[84:87], a[132:135], v[28:31], v[84:87]
    v_mfma_f32_16x16x32_bf16 v[88:91], a[212:215], v[24:27], v[88:91]
    s_add_u32 m0, s60, 8064
    v_mfma_f32_16x16x32_bf16 v[92:95], a[212:215], v[28:31], v[92:95]
    s_waitcnt lgkmcnt(2)
    v_mfma_f32_16x16x32_bf16 v[72:75], a[56:59], v[32:35], v[72:75]
    ds_read_b128 v[16:19], v6 offset:8192
    v_mfma_f32_16x16x32_bf16 v[76:79], a[56:59], v[36:39], v[76:79]
    ds_read_b128 v[20:23], v6 offset:28672
    v_mfma_f32_16x16x32_bf16 v[80:83], a[136:139], v[32:35], v[80:83]
    buffer_load_dwordx4 v5, s[44:47], s59 offen offset:1152 lds
    v_mfma_f32_16x16x32_bf16 v[84:87], a[136:139], v[36:39], v[84:87]
    v_mfma_f32_16x16x32_bf16 v[88:91], a[216:219], v[32:35], v[88:91]
    v_mfma_f32_16x16x32_bf16 v[92:95], a[216:219], v[36:39], v[92:95]
    s_waitcnt lgkmcnt(2)
    v_mfma_f32_16x16x32_bf16 v[72:75], a[60:63], v[40:43], v[72:75]
    ds_read_b128 v[24:27], v7 offset:8192
    s_add_u32 s59, s59, 40960
    v_mfma_f32_16x16x32_bf16 v[76:79], a[60:63], v[44:47], v[76:79]
    ds_read_b128 v[28:31], v7 offset:28672
    v_mfma_f32_16x16x32_bf16 v[80:83], a[140:143], v[40:43], v[80:83]
    v_mfma_f32_16x16x32_bf16 v[84:87], a[140:143], v[44:47], v[84:87]
    v_mfma_f32_16x16x32_bf16 v[88:91], a[220:223], v[40:43], v[88:91]
    s_add_u32 s60, s60, 40960
    v_mfma_f32_16x16x32_bf16 v[92:95], a[220:223], v[44:47], v[92:95]
    s_waitcnt lgkmcnt(2)
    v_mfma_f32_16x16x32_bf16 v[72:75], a[64:67], v[16:19], v[72:75]
    ds_read_b128 v[32:35], v6 offset:9216
    v_mfma_f32_16x16x32_bf16 v[76:79], a[64:67], v[20:23], v[76:79]
    ds_read_b128 v[36:39], v6 offset:29696
    v_mfma_f32_16x16x32_bf16 v[80:83], a[144:147], v[16:19], v[80:83]
    s_cmp_ge_u32 s60, 122880
    s_cselect_b32 s55, 122880, 0
    v_mfma_f32_16x16x32_bf16 v[84:87], a[144:147], v[20:23], v[84:87]
    v_mfma_f32_16x16x32_bf16 v[88:91], a[224:227], v[16:19], v[88:91]
    v_mfma_f32_16x16x32_bf16 v[92:95], a[224:227], v[20:23], v[92:95]
    s_waitcnt lgkmcnt(2)
    v_mfma_f32_16x16x32_bf16 v[72:75], a[68:71], v[24:27], v[72:75]
    ds_read_b128 v[40:43], v7 offset:9216
    v_add_u32 v6, s94, v6
    s_sub_u32 s60, s60, s55
    v_mfma_f32_16x16x32_bf16 v[76:79], a[68:71], v[28:31], v[76:79]
    ds_read_b128 v[44:47], v7 offset:29696
    v_add_u32 v7, s94, v7
    v_mfma_f32_16x16x32_bf16 v[80:83], a[148:151], v[24:27], v[80:83]
    v_mfma_f32_16x16x32_bf16 v[84:87], a[148:151], v[28:31], v[84:87]
    v_mfma_f32_16x16x32_bf16 v[88:91], a[228:231], v[24:27], v[88:91]
    v_mfma_f32_16x16x32_bf16 v[92:95], a[228:231], v[28:31], v[92:95]
    s_waitcnt vmcnt(10) lgkmcnt(0)
    s_barrier
    v_mfma_f32_16x16x32_bf16 v[72:75], a[72:75], v[32:35], v[72:75]
    ds_read_b128 v[16:19], v6 offset:0
    v_mfma_f32_16x16x32_bf16 v[76:79], a[72:75], v[36:39], v[76:79]
    ds_read_b128 v[20:23], v6 offset:20480
    v_mfma_f32_16x16x32_bf16 v[80:83], a[152:155], v[32:35], v[80:83]
    v_mfma_f32_16x16x32_bf16 v[84:87], a[152:155], v[36:39], v[84:87]
    v_mfma_f32_16x16x32_bf16 v[88:91], a[232:235], v[32:35], v[88:91]
    v_mfma_f32_16x16x32_bf16 v[92:95], a[232:235], v[36:39], v[92:95]
    v_mfma_f32_16x16x32_bf16 v[72:75], a[76:79], v[40:43], v[72:75]
    ds_read_b128 v[24:27], v7 offset:0
    v_mfma_f32_16x16x32_bf16 v[76:79], a[76:79], v[44:47], v[76:79]
    ds_read_b128 v[28:31], v7 offset:20480
    v_mfma_f32_16x16x32_bf16 v[80:83], a[156:159], v[40:43], v[80:83]
    s_cmp_lg_u32 s3, 0
    s_cbranch_scc1 L_sf_12
    v_mov_b32 v10, s6
    s_mov_b64 exec, 1
    buffer_store_dword v10, v8, s[36:39], s65 offen offset:0 sc1
    s_mov_b64 exec, -1
L_sf_12:
    v_mfma_f32_16x16x32_bf16 v[84:87], a[156:159], v[44:47], v[84:87]
    v_mfma_f32_16x16x32_bf16 v[88:91], a[236:239], v[40:43], v[88:91]
    v_mfma_f32_16x16x32_bf16 v[92:95], a[236:239], v[44:47], v[92:95]
    s_waitcnt lgkmcnt(2)
    s_mov_b32 s62, s63
    s_add_u32 s6, s6, 1
    s_cmp_lt_u32 s6, s64
    s_cbranch_scc1 L_k_loop
    s_nop 7
    v_cvt_pk_bf16_f32 v96, v72, v73
    v_cvt_pk_bf16_f32 v97, v74, v75
    v_cvt_pk_bf16_f32 v98, v76, v77
    v_cvt_pk_bf16_f32 v99, v78, v79
    buffer_store_dwordx4 v[96:99], v3, s[36:39], s62 offen offset:0 sc1
    v_cvt_pk_bf16_f32 v100, v80, v81
    v_cvt_pk_bf16_f32 v101, v82, v83
    v_cvt_pk_bf16_f32 v102, v84, v85
    v_cvt_pk_bf16_f32 v103, v86, v87
    buffer_store_dwordx4 v[100:103], v3, s[36:39], s62 offen offset:1024 sc1
    v_cvt_pk_bf16_f32 v104, v88, v89
    v_cvt_pk_bf16_f32 v105, v90, v91
    v_cvt_pk_bf16_f32 v106, v92, v93
    v_cvt_pk_bf16_f32 v107, v94, v95
    buffer_store_dwordx4 v[104:107], v3, s[36:39], s62 offen offset:2048 sc1
    s_add_u32 s63, s63, 393216
    s_waitcnt vmcnt(0) lgkmcnt(0)
    s_barrier
    s_cmp_lg_u32 s3, 0
    s_cbranch_scc1 L_sf_13
    v_mov_b32 v10, 64
    s_mov_b64 exec, 1
    buffer_store_dword v10, v8, s[36:39], s65 offen offset:0 sc1
    s_mov_b64 exec, -1
L_sf_13:
    s_branch L_alpha
L_v:
    s_mov_b32 s40, s22
    s_and_b32 s41, s23, 0xffff
    s_mov_b32 s42, 7864320
    s_mov_b32 s43, 0x20000
    s_mul_i32 s54, s52, 384
    s_mul_i32 s53, s3, 3
    v_lshrrev_b32 v21, 3, v2
    v_mul_u32_u24 v16, 12288, v21
    v_bfe_u32 v21, v21, 1, 1
    s_and_b32 s55, s3, 1
    s_lshl_b32 s55, s55, 1
    v_add_u32 v21, s55, v21
    v_lshlrev_b32 v21, 1, v21
    v_and_b32 v22, 7, v2
    v_xor_b32 v21, v21, v22
    v_lshl_add_u32 v16, v21, 4, v16
    v_lshrrev_b32 v21, 2, v0
    v_lshl_add_u32 v17, v1, 3, v21
    v_lshlrev_b32 v17, 7, v17
    v_and_b32 v22, 3, v0
    v_lshl_add_u32 v17, v22, 3, v17
    v_lshrrev_b32 v21, 1, v21
    v_and_b32 v22, 1, v1
    v_lshl_add_u32 v21, v22, 1, v21
    s_lshl_b32 s58, s3, 10
    s_mul_i32 s57, s3, 98304
    s_add_u32 s57, s57, s54
    s_add_u32 s55, s53, 0
    s_and_b32 s56, s55, 3
    s_lshr_b32 s55, s55, 2
    s_mul_i32 s55, s55, 20480
    v_xor_b32 v22, s56, v21
    v_lshl_add_u32 v22, v22, 5, v17
    v_add_u32 v18, s55, v22
    s_add_u32 s55, s53, 1
    s_and_b32 s56, s55, 3
    s_lshr_b32 s55, s55, 2
    s_mul_i32 s55, s55, 20480
    v_xor_b32 v22, s56, v21
    v_lshl_add_u32 v22, v22, 5, v17
    v_add_u32 v19, s55, v22
    s_add_u32 s55, s53, 2
    s_and_b32 s56, s55, 3
    s_lshr_b32 s55, s55, 2
    s_mul_i32 s55, s55, 20480
    v_xor_b32 v22, s56, v21
    v_lshl_add_u32 v22, v22, 5, v17
    v_add_u32 v20, s55, v22
    s_add_u32 m0, s58, 0
    s_add_u32 s55, s57, 0
    buffer_load_dwordx4 v16, s[40:43], s55 offen lds
    s_add_u32 m0, s58, 20480
    s_add_u32 s55, s57, 128
    buffer_load_dwordx4 v16, s[40:43], s55 offen lds
    s_add_u32 m0, s58, 40960
    s_add_u32 s55, s57, 256
    buffer_load_dwordx4 v16, s[40:43], s55 offen lds
    s_add_u32 m0, s58, 4096
    s_add_u32 s55, s57, 393216
    buffer_load_dwordx4 v16, s[40:43], s55 offen lds
    s_add_u32 m0, s58, 24576
    s_add_u32 s55, s57, 393344
    buffer_load_dwordx4 v16, s[40:43], s55 offen lds
    s_add_u32 m0, s58, 45056
    s_add_u32 s55, s57, 393472
    buffer_load_dwordx4 v16, s[40:43], s55 offen lds
    s_add_u32 m0, s58, 8192
    s_add_u32 s55, s57, 786432
    buffer_load_dwordx4 v16, s[40:43], s55 offen lds
    s_add_u32 m0, s58, 28672
    s_add_u32 s55, s57, 786560
    buffer_load_dwordx4 v16, s[40:43], s55 offen lds
    s_add_u32 m0, s58, 49152
    s_add_u32 s55, s57, 786688
    buffer_load_dwordx4 v16, s[40:43], s55 offen lds
    s_add_u32 m0, s58, 12288
    s_add_u32 s55, s57, 1179648
    buffer_load_dwordx4 v16, s[40:43], s55 offen lds
    s_add_u32 m0, s58, 32768
    s_add_u32 s55, s57, 1179776
    buffer_load_dwordx4 v16, s[40:43], s55 offen lds
    s_add_u32 m0, s58, 53248
    s_add_u32 s55, s57, 1179904
    buffer_load_dwordx4 v16, s[40:43], s55 offen lds
    s_add_u32 m0, s58, 16384
    s_add_u32 s55, s57, 1572864
    buffer_load_dwordx4 v16, s[40:43], s55 offen lds
    s_add_u32 m0, s58, 36864
    s_add_u32 s55, s57, 1572992
    buffer_load_dwordx4 v16, s[40:43], s55 offen lds
    s_add_u32 m0, s58, 57344
    s_add_u32 s55, s57, 1573120
    buffer_load_dwordx4 v16, s[40:43], s55 offen lds
    s_add_u32 m0, s58, 61440
    s_add_u32 s55, s57, 1966080
    buffer_load_dwordx4 v16, s[40:43], s55 offen lds
    s_add_u32 m0, s58, 81920
    s_add_u32 s55, s57, 1966208
    buffer_load_dwordx4 v16, s[40:43], s55 offen lds
    s_add_u32 m0, s58, 102400
    s_add_u32 s55, s57, 1966336
    buffer_load_dwordx4 v16, s[40:43], s55 offen lds
    s_add_u32 m0, s58, 65536
    s_add_u32 s55, s57, 2359296
    buffer_load_dwordx4 v16, s[40:43], s55 offen lds
    s_add_u32 m0, s58, 86016
    s_add_u32 s55, s57, 2359424
    buffer_load_dwordx4 v16, s[40:43], s55 offen lds
    s_add_u32 m0, s58, 106496
    s_add_u32 s55, s57, 2359552
    buffer_load_dwordx4 v16, s[40:43], s55 offen lds
    s_add_u32 m0, s58, 69632
    s_add_u32 s55, s57, 2752512
    buffer_load_dwordx4 v16, s[40:43], s55 offen lds
    s_add_u32 m0, s58, 90112
    s_add_u32 s55, s57, 2752640
    buffer_load_dwordx4 v16, s[40:43], s55 offen lds
    s_add_u32 m0, s58, 110592
    s_add_u32 s55, s57, 2752768
    buffer_load_dwordx4 v16, s[40:43], s55 offen lds
    s_add_u32 m0, s58, 73728
    s_add_u32 s55, s57, 3145728
    buffer_load_dwordx4 v16, s[40:43], s55 offen lds
    s_add_u32 m0, s58, 94208
    s_add_u32 s55, s57, 3145856
    buffer_load_dwordx4 v16, s[40:43], s55 offen lds
    s_add_u32 m0, s58, 114688
    s_add_u32 s55, s57, 3145984
    buffer_load_dwordx4 v16, s[40:43], s55 offen lds
    s_add_u32 m0, s58, 77824
    s_add_u32 s55, s57, 3538944
    buffer_load_dwordx4 v16, s[40:43], s55 offen lds
    s_add_u32 m0, s58, 98304
    s_add_u32 s55, s57, 3539072
    buffer_load_dwordx4 v16, s[40:43], s55 offen lds
    s_add_u32 m0, s58, 118784
    s_add_u32 s55, s57, 3539200
    buffer_load_dwordx4 v16, s[40:43], s55 offen lds
    s_waitcnt vmcnt(15)
    s_barrier
    v_add_u32 v22, 0, v18
    ds_read_b64_tr_b16 a[0:1], v22 offset:0
    ds_read_b64_tr_b16 a[2:3], v22 offset:512
    ds_read_b64_tr_b16 a[4:5], v22 offset:4096
    ds_read_b64_tr_b16 a[6:7], v22 offset:4608
    ds_read_b64_tr_b16 a[8:9], v22 offset:8192
    ds_read_b64_tr_b16 a[10:11], v22 offset:8704
    ds_read_b64_tr_b16 a[12:13], v22 offset:12288
    ds_read_b64_tr_b16 a[14:15], v22 offset:12800
    s_waitcnt lgkmcnt(6)
    ds_read_b64_tr_b16 a[16:17], v22 offset:16384
    ds_read_b64_tr_b16 a[18:19], v22 offset:16896
    v_add_u32 v23, 0, v19
    ds_read_b64_tr_b16 a[80:81], v23 offset:0
    ds_read_b64_tr_b16 a[82:83], v23 offset:512
    ds_read_b64_tr_b16 a[84:85], v23 offset:4096
    ds_read_b64_tr_b16 a[86:87], v23 offset:4608
    ds_read_b64_tr_b16 a[88:89], v23 offset:8192
    ds_read_b64_tr_b16 a[90:91], v23 offset:8704
    s_waitcnt lgkmcnt(6)
    ds_read_b64_tr_b16 a[92:93], v23 offset:12288
    ds_read_b64_tr_b16 a[94:95], v23 offset:12800
    ds_read_b64_tr_b16 a[96:97], v23 offset:16384
    ds_read_b64_tr_b16 a[98:99], v23 offset:16896
    v_add_u32 v22, 0, v20
    ds_read_b64_tr_b16 a[160:161], v22 offset:0
    ds_read_b64_tr_b16 a[162:163], v22 offset:512
    ds_read_b64_tr_b16 a[164:165], v22 offset:4096
    ds_read_b64_tr_b16 a[166:167], v22 offset:4608
    s_waitcnt lgkmcnt(6)
    ds_read_b64_tr_b16 a[168:169], v22 offset:8192
    ds_read_b64_tr_b16 a[170:171], v22 offset:8704
    ds_read_b64_tr_b16 a[172:173], v22 offset:12288
    ds_read_b64_tr_b16 a[174:175], v22 offset:12800
    ds_read_b64_tr_b16 a[176:177], v22 offset:16384
    ds_read_b64_tr_b16 a[178:179], v22 offset:16896
    s_waitcnt lgkmcnt(0)
    s_barrier
    s_add_u32 m0, s58, 0
    s_add_u32 s55, s57, 3932160
    buffer_load_dwordx4 v16, s[40:43], s55 offen lds
    s_add_u32 m0, s58, 20480
    s_add_u32 s55, s57, 3932288
    buffer_load_dwordx4 v16, s[40:43], s55 offen lds
    s_add_u32 m0, s58, 40960
    s_add_u32 s55, s57, 3932416
    buffer_load_dwordx4 v16, s[40:43], s55 offen lds
    s_add_u32 m0, s58, 4096
    s_add_u32 s55, s57, 4325376
    buffer_load_dwordx4 v16, s[40:43], s55 offen lds
    s_add_u32 m0, s58, 24576
    s_add_u32 s55, s57, 4325504
    buffer_load_dwordx4 v16, s[40:43], s55 offen lds
    s_add_u32 m0, s58, 45056
    s_add_u32 s55, s57, 4325632
    buffer_load_dwordx4 v16, s[40:43], s55 offen lds
    s_add_u32 m0, s58, 8192
    s_add_u32 s55, s57, 4718592
    buffer_load_dwordx4 v16, s[40:43], s55 offen lds
    s_add_u32 m0, s58, 28672
    s_add_u32 s55, s57, 4718720
    buffer_load_dwordx4 v16, s[40:43], s55 offen lds
    s_add_u32 m0, s58, 49152
    s_add_u32 s55, s57, 4718848
    buffer_load_dwordx4 v16, s[40:43], s55 offen lds
    s_add_u32 m0, s58, 12288
    s_add_u32 s55, s57, 5111808
    buffer_load_dwordx4 v16, s[40:43], s55 offen lds
    s_add_u32 m0, s58, 32768
    s_add_u32 s55, s57, 5111936
    buffer_load_dwordx4 v16, s[40:43], s55 offen lds
    s_add_u32 m0, s58, 53248
    s_add_u32 s55, s57, 5112064
    buffer_load_dwordx4 v16, s[40:43], s55 offen lds
    s_add_u32 m0, s58, 16384
    s_add_u32 s55, s57, 5505024
    buffer_load_dwordx4 v16, s[40:43], s55 offen lds
    s_add_u32 m0, s58, 36864
    s_add_u32 s55, s57, 5505152
    buffer_load_dwordx4 v16, s[40:43], s55 offen lds
    s_add_u32 m0, s58, 57344
    s_add_u32 s55, s57, 5505280
    buffer_load_dwordx4 v16, s[40:43], s55 offen lds
    s_waitcnt vmcnt(15)
    s_barrier
    v_add_u32 v22, 61440, v18
    ds_read_b64_tr_b16 a[20:21], v22 offset:0
    ds_read_b64_tr_b16 a[22:23], v22 offset:512
    ds_read_b64_tr_b16 a[24:25], v22 offset:4096
    ds_read_b64_tr_b16 a[26:27], v22 offset:4608
    ds_read_b64_tr_b16 a[28:29], v22 offset:8192
    ds_read_b64_tr_b16 a[30:31], v22 offset:8704
    ds_read_b64_tr_b16 a[32:33], v22 offset:12288
    ds_read_b64_tr_b16 a[34:35], v22 offset:12800
    s_waitcnt lgkmcnt(6)
    ds_read_b64_tr_b16 a[36:37], v22 offset:16384
    ds_read_b64_tr_b16 a[38:39], v22 offset:16896
    v_add_u32 v23, 61440, v19
    ds_read_b64_tr_b16 a[100:101], v23 offset:0
    ds_read_b64_tr_b16 a[102:103], v23 offset:512
    ds_read_b64_tr_b16 a[104:105], v23 offset:4096
    ds_read_b64_tr_b16 a[106:107], v23 offset:4608
    ds_read_b64_tr_b16 a[108:109], v23 offset:8192
    ds_read_b64_tr_b16 a[110:111], v23 offset:8704
    s_waitcnt lgkmcnt(6)
    ds_read_b64_tr_b16 a[112:113], v23 offset:12288
    ds_read_b64_tr_b16 a[114:115], v23 offset:12800
    ds_read_b64_tr_b16 a[116:117], v23 offset:16384
    ds_read_b64_tr_b16 a[118:119], v23 offset:16896
    v_add_u32 v22, 61440, v20
    ds_read_b64_tr_b16 a[180:181], v22 offset:0
    ds_read_b64_tr_b16 a[182:183], v22 offset:512
    ds_read_b64_tr_b16 a[184:185], v22 offset:4096
    ds_read_b64_tr_b16 a[186:187], v22 offset:4608
    s_waitcnt lgkmcnt(6)
    ds_read_b64_tr_b16 a[188:189], v22 offset:8192
    ds_read_b64_tr_b16 a[190:191], v22 offset:8704
    ds_read_b64_tr_b16 a[192:193], v22 offset:12288
    ds_read_b64_tr_b16 a[194:195], v22 offset:12800
    ds_read_b64_tr_b16 a[196:197], v22 offset:16384
    ds_read_b64_tr_b16 a[198:199], v22 offset:16896
    s_waitcnt lgkmcnt(0)
    s_barrier
    s_add_u32 m0, s58, 61440
    s_add_u32 s55, s57, 5898240
    buffer_load_dwordx4 v16, s[40:43], s55 offen lds
    s_add_u32 m0, s58, 81920
    s_add_u32 s55, s57, 5898368
    buffer_load_dwordx4 v16, s[40:43], s55 offen lds
    s_add_u32 m0, s58, 102400
    s_add_u32 s55, s57, 5898496
    buffer_load_dwordx4 v16, s[40:43], s55 offen lds
    s_add_u32 m0, s58, 65536
    s_add_u32 s55, s57, 6291456
    buffer_load_dwordx4 v16, s[40:43], s55 offen lds
    s_add_u32 m0, s58, 86016
    s_add_u32 s55, s57, 6291584
    buffer_load_dwordx4 v16, s[40:43], s55 offen lds
    s_add_u32 m0, s58, 106496
    s_add_u32 s55, s57, 6291712
    buffer_load_dwordx4 v16, s[40:43], s55 offen lds
    s_add_u32 m0, s58, 69632
    s_add_u32 s55, s57, 6684672
    buffer_load_dwordx4 v16, s[40:43], s55 offen lds
    s_add_u32 m0, s58, 90112
    s_add_u32 s55, s57, 6684800
    buffer_load_dwordx4 v16, s[40:43], s55 offen lds
    s_add_u32 m0, s58, 110592
    s_add_u32 s55, s57, 6684928
    buffer_load_dwordx4 v16, s[40:43], s55 offen lds
    s_add_u32 m0, s58, 73728
    s_add_u32 s55, s57, 7077888
    buffer_load_dwordx4 v16, s[40:43], s55 offen lds
    s_add_u32 m0, s58, 94208
    s_add_u32 s55, s57, 7078016
    buffer_load_dwordx4 v16, s[40:43], s55 offen lds
    s_add_u32 m0, s58, 114688
    s_add_u32 s55, s57, 7078144
    buffer_load_dwordx4 v16, s[40:43], s55 offen lds
    s_add_u32 m0, s58, 77824
    s_add_u32 s55, s57, 7471104
    buffer_load_dwordx4 v16, s[40:43], s55 offen lds
    s_add_u32 m0, s58, 98304
    s_add_u32 s55, s57, 7471232
    buffer_load_dwordx4 v16, s[40:43], s55 offen lds
    s_add_u32 m0, s58, 118784
    s_add_u32 s55, s57, 7471360
    buffer_load_dwordx4 v16, s[40:43], s55 offen lds
    s_waitcnt vmcnt(15)
    s_barrier
    v_add_u32 v22, 0, v18
    ds_read_b64_tr_b16 a[40:41], v22 offset:0
    ds_read_b64_tr_b16 a[42:43], v22 offset:512
    ds_read_b64_tr_b16 a[44:45], v22 offset:4096
    ds_read_b64_tr_b16 a[46:47], v22 offset:4608
    ds_read_b64_tr_b16 a[48:49], v22 offset:8192
    ds_read_b64_tr_b16 a[50:51], v22 offset:8704
    ds_read_b64_tr_b16 a[52:53], v22 offset:12288
    ds_read_b64_tr_b16 a[54:55], v22 offset:12800
    s_waitcnt lgkmcnt(6)
    ds_read_b64_tr_b16 a[56:57], v22 offset:16384
    ds_read_b64_tr_b16 a[58:59], v22 offset:16896
    v_add_u32 v23, 0, v19
    ds_read_b64_tr_b16 a[120:121], v23 offset:0
    ds_read_b64_tr_b16 a[122:123], v23 offset:512
    ds_read_b64_tr_b16 a[124:125], v23 offset:4096
    ds_read_b64_tr_b16 a[126:127], v23 offset:4608
    ds_read_b64_tr_b16 a[128:129], v23 offset:8192
    ds_read_b64_tr_b16 a[130:131], v23 offset:8704
    s_waitcnt lgkmcnt(6)
    ds_read_b64_tr_b16 a[132:133], v23 offset:12288
    ds_read_b64_tr_b16 a[134:135], v23 offset:12800
    ds_read_b64_tr_b16 a[136:137], v23 offset:16384
    ds_read_b64_tr_b16 a[138:139], v23 offset:16896
    v_add_u32 v22, 0, v20
    ds_read_b64_tr_b16 a[200:201], v22 offset:0
    ds_read_b64_tr_b16 a[202:203], v22 offset:512
    ds_read_b64_tr_b16 a[204:205], v22 offset:4096
    ds_read_b64_tr_b16 a[206:207], v22 offset:4608
    s_waitcnt lgkmcnt(6)
    ds_read_b64_tr_b16 a[208:209], v22 offset:8192
    ds_read_b64_tr_b16 a[210:211], v22 offset:8704
    ds_read_b64_tr_b16 a[212:213], v22 offset:12288
    ds_read_b64_tr_b16 a[214:215], v22 offset:12800
    ds_read_b64_tr_b16 a[216:217], v22 offset:16384
    ds_read_b64_tr_b16 a[218:219], v22 offset:16896
    s_waitcnt lgkmcnt(0)
    s_barrier
    s_waitcnt vmcnt(0)
    s_barrier
    v_add_u32 v22, 61440, v18
    ds_read_b64_tr_b16 a[60:61], v22 offset:0
    ds_read_b64_tr_b16 a[62:63], v22 offset:512
    ds_read_b64_tr_b16 a[64:65], v22 offset:4096
    ds_read_b64_tr_b16 a[66:67], v22 offset:4608
    ds_read_b64_tr_b16 a[68:69], v22 offset:8192
    ds_read_b64_tr_b16 a[70:71], v22 offset:8704
    ds_read_b64_tr_b16 a[72:73], v22 offset:12288
    ds_read_b64_tr_b16 a[74:75], v22 offset:12800
    s_waitcnt lgkmcnt(6)
    ds_read_b64_tr_b16 a[76:77], v22 offset:16384
    ds_read_b64_tr_b16 a[78:79], v22 offset:16896
    v_add_u32 v23, 61440, v19
    ds_read_b64_tr_b16 a[140:141], v23 offset:0
    ds_read_b64_tr_b16 a[142:143], v23 offset:512
    ds_read_b64_tr_b16 a[144:145], v23 offset:4096
    ds_read_b64_tr_b16 a[146:147], v23 offset:4608
    ds_read_b64_tr_b16 a[148:149], v23 offset:8192
    ds_read_b64_tr_b16 a[150:151], v23 offset:8704
    s_waitcnt lgkmcnt(6)
    ds_read_b64_tr_b16 a[152:153], v23 offset:12288
    ds_read_b64_tr_b16 a[154:155], v23 offset:12800
    ds_read_b64_tr_b16 a[156:157], v23 offset:16384
    ds_read_b64_tr_b16 a[158:159], v23 offset:16896
    v_add_u32 v22, 61440, v20
    ds_read_b64_tr_b16 a[220:221], v22 offset:0
    ds_read_b64_tr_b16 a[222:223], v22 offset:512
    ds_read_b64_tr_b16 a[224:225], v22 offset:4096
    ds_read_b64_tr_b16 a[226:227], v22 offset:4608
    s_waitcnt lgkmcnt(6)
    ds_read_b64_tr_b16 a[228:229], v22 offset:8192
    ds_read_b64_tr_b16 a[230:231], v22 offset:8704
    ds_read_b64_tr_b16 a[232:233], v22 offset:12288
    ds_read_b64_tr_b16 a[234:235], v22 offset:12800
    ds_read_b64_tr_b16 a[236:237], v22 offset:16384
    ds_read_b64_tr_b16 a[238:239], v22 offset:16896
    s_waitcnt lgkmcnt(0)
    s_barrier
    s_cmp_lg_u32 s3, 0
    s_cbranch_scc1 L_idn_14
    v_mov_b32 v10, 4
    v_mov_b32 v11, 1
    s_waitcnt vmcnt(0)
    s_mov_b64 exec, 1
    buffer_atomic_add v11, v10, s[48:51], 0 offen sc1
    s_mov_b64 exec, -1
L_idn_14:
    s_mov_b32 s6, 0
    s_mov_b32 s64, 64
    s_mov_b32 s59, 0
    s_mul_i32 s63, s52, 12288
    s_mul_i32 s55, s3, 3072
    s_add_u32 s63, s63, s55
    s_add_u32 s63, s63, 73007104
    s_mov_b32 s44, s8
    s_and_b32 s45, s9, 0xffff
    s_mov_b32 s46, 2621440
    s_mov_b32 s47, 0x20000
    v_lshrrev_b32 v10, 3, v2
    v_mul_u32_u24 v5, 1280, v10
    v_lshrrev_b32 v10, 1, v10
    s_and_b32 s55, s3, 1
    s_lshl_b32 s55, s55, 2
    v_add_u32 v10, s55, v10
    v_and_b32 v11, 7, v2
    v_xor_b32 v10, v10, v11
    v_lshl_add_u32 v5, v10, 4, v5
    s_mul_i32 s55, s3, 10240
    s_add_u32 s59, s59, s55
    s_mul_i32 s60, s3, 10240
    v_lshrrev_b32 v10, 3, v0
    v_mul_u32_u24 v10, 10240, v10
    v_and_b32 v11, 7, v0
    v_lshl_add_u32 v10, v11, 7, v10
    v_lshrrev_b32 v11, 1, v0
    v_xor_b32 v11, v11, v1
    v_lshl_add_u32 v6, v11, 4, v10
    v_xor_b32 v11, 4, v11
    v_lshl_add_u32 v7, v11, 4, v10
    s_mov_b32 s61, 0
    s_add_u32 m0, s60, 0
    s_nop 0
    buffer_load_dwordx4 v5, s[44:47], s59 offen offset:0 lds
    s_add_u32 m0, s60, 896
    s_nop 0
    buffer_load_dwordx4 v5, s[44:47], s59 offen offset:128 lds
    s_add_u32 m0, s60, 1792
    s_nop 0
    buffer_load_dwordx4 v5, s[44:47], s59 offen offset:256 lds
    s_add_u32 m0, s60, 2688
    s_nop 0
    buffer_load_dwordx4 v5, s[44:47], s59 offen offset:384 lds
    s_add_u32 m0, s60, 3584
    s_nop 0
    buffer_load_dwordx4 v5, s[44:47], s59 offen offset:512 lds
    s_add_u32 m0, s60, 4480
    s_nop 0
    buffer_load_dwordx4 v5, s[44:47], s59 offen offset:640 lds
    s_add_u32 m0, s60, 5376
    s_nop 0
    buffer_load_dwordx4 v5, s[44:47], s59 offen offset:768 lds
    s_add_u32 m0, s60, 6272
    s_nop 0
    buffer_load_dwordx4 v5, s[44:47], s59 offen offset:896 lds
    s_add_u32 m0, s60, 7168
    s_nop 0
    buffer_load_dwordx4 v5, s[44:47], s59 offen offset:1024 lds
    s_add_u32 m0, s60, 8064
    s_nop 0
    buffer_load_dwordx4 v5, s[44:47], s59 offen offset:1152 lds
    s_add_u32 s59, s59, 40960
    s_add_u32 s60, s60, 40960
    s_cmp_ge_u32 s60, 122880
    s_cselect_b32 s55, 122880, 0
    s_sub_u32 s60, s60, s55
    s_add_u32 m0, s60, 0
    s_nop 0
    buffer_load_dwordx4 v5, s[44:47], s59 offen offset:0 lds
    s_add_u32 m0, s60, 896
    s_nop 0
    buffer_load_dwordx4 v5, s[44:47], s59 offen offset:128 lds
    s_add_u32 m0, s60, 1792
    s_nop 0
    buffer_load_dwordx4 v5, s[44:47], s59 offen offset:256 lds
    s_add_u32 m0, s60, 2688
    s_nop 0
    buffer_load_dwordx4 v5, s[44:47], s59 offen offset:384 lds
    s_add_u32 m0, s60, 3584
    s_nop 0
    buffer_load_dwordx4 v5, s[44:47], s59 offen offset:512 lds
    s_add_u32 m0, s60, 4480
    s_nop 0
    buffer_load_dwordx4 v5, s[44:47], s59 offen offset:640 lds
    s_add_u32 m0, s60, 5376
    s_nop 0
    buffer_load_dwordx4 v5, s[44:47], s59 offen offset:768 lds
    s_add_u32 m0, s60, 6272
    s_nop 0
    buffer_load_dwordx4 v5, s[44:47], s59 offen offset:896 lds
    s_add_u32 m0, s60, 7168
    s_nop 0
    buffer_load_dwordx4 v5, s[44:47], s59 offen offset:1024 lds
    s_add_u32 m0, s60, 8064
    s_nop 0
    buffer_load_dwordx4 v5, s[44:47], s59 offen offset:1152 lds
    s_add_u32 s59, s59, 40960
    s_add_u32 s60, s60, 40960
    s_cmp_ge_u32 s60, 122880
    s_cselect_b32 s55, 122880, 0
    s_sub_u32 s60, s60, s55
    s_waitcnt vmcnt(10)
    s_barrier
    ds_read_b128 v[16:19], v6 offset:0
    ds_read_b128 v[20:23], v6 offset:20480
    ds_read_b128 v[24:27], v7 offset:0
    ds_read_b128 v[28:31], v7 offset:20480
    s_mov_b32 s62, 4026531840
    s_waitcnt lgkmcnt(2)
    .p2align 6
L_v_loop:
    v_mfma_f32_16x16x32_bf16 v[48:51], a[0:3], v[16:19], 0
    ds_read_b128 v[32:35], v6 offset:1024
    s_add_u32 s61, s61, 40960
    s_cmp_ge_u32 s61, 122880
    s_cselect_b32 s94, 122880, 0
    v_mfma_f32_16x16x32_bf16 v[52:55], a[0:3], v[20:23], 0
    ds_read_b128 v[36:39], v6 offset:21504
    s_sub_u32 s61, s61, s94
    s_sub_u32 s94, 40960, s94
    v_mfma_f32_16x16x32_bf16 v[56:59], a[80:83], v[16:19], 0
    v_mfma_f32_16x16x32_bf16 v[60:63], a[80:83], v[20:23], 0
    v_mfma_f32_16x16x32_bf16 v[64:67], a[160:163], v[16:19], 0
    v_mfma_f32_16x16x32_bf16 v[68:71], a[160:163], v[20:23], 0
    s_waitcnt lgkmcnt(2)
    v_mfma_f32_16x16x32_bf16 v[48:51], a[4:7], v[24:27], v[48:51]
    ds_read_b128 v[40:43], v7 offset:1024
    v_mfma_f32_16x16x32_bf16 v[52:55], a[4:7], v[28:31], v[52:55]
    ds_read_b128 v[44:47], v7 offset:21504
    v_cvt_pk_bf16_f32 v96, v72, v73
    v_cvt_pk_bf16_f32 v97, v74, v75
    v_mfma_f32_16x16x32_bf16 v[56:59], a[84:87], v[24:27], v[56:59]
    v_cvt_pk_bf16_f32 v98, v76, v77
    v_cvt_pk_bf16_f32 v99, v78, v79
    v_mfma_f32_16x16x32_bf16 v[60:63], a[84:87], v[28:31], v[60:63]
    buffer_store_dwordx4 v[96:99], v3, s[36:39], s62 offen offset:0
    v_cvt_pk_bf16_f32 v100, v80, v81
    v_cvt_pk_bf16_f32 v101, v82, v83
    v_mfma_f32_16x16x32_bf16 v[64:67], a[164:167], v[24:27], v[64:67]
    v_cvt_pk_bf16_f32 v102, v84, v85
    v_cvt_pk_bf16_f32 v103, v86, v87
    v_mfma_f32_16x16x32_bf16 v[68:71], a[164:167], v[28:31], v[68:71]
    s_waitcnt lgkmcnt(2)
    buffer_store_dwordx4 v[100:103], v3, s[36:39], s62 offen offset:1024
    v_cvt_pk_bf16_f32 v104, v88, v89
    v_mfma_f32_16x16x32_bf16 v[48:51], a[8:11], v[32:35], v[48:51]
    ds_read_b128 v[16:19], v6 offset:2048
    v_cvt_pk_bf16_f32 v105, v90, v91
    v_cvt_pk_bf16_f32 v106, v92, v93
    v_mfma_f32_16x16x32_bf16 v[52:55], a[8:11], v[36:39], v[52:55]
    ds_read_b128 v[20:23], v6 offset:22528
    v_cvt_pk_bf16_f32 v107, v94, v95
    buffer_store_dwordx4 v[104:107], v3, s[36:39], s62 offen offset:2048
    v_mfma_f32_16x16x32_bf16 v[56:59], a[88:91], v[32:35], v[56:59]
    s_add_u32 m0, s60, 0
    s_add_u32 s63, s63, 393216
    v_mfma_f32_16x16x32_bf16 v[60:63], a[88:91], v[36:39], v[60:63]
    v_mfma_f32_16x16x32_bf16 v[64:67], a[168:171], v[32:35], v[64:67]
    v_mfma_f32_16x16x32_bf16 v[68:71], a[168:171], v[36:39], v[68:71]
    s_waitcnt lgkmcnt(2)
    buffer_load_dwordx4 v5, s[44:47], s59 offen offset:0 lds
    v_mfma_f32_16x16x32_bf16 v[48:51], a[12:15], v[40:43], v[48:51]
    ds_read_b128 v[24:27], v7 offset:2048
    v_mfma_f32_16x16x32_bf16 v[52:55], a[12:15], v[44:47], v[52:55]
    ds_read_b128 v[28:31], v7 offset:22528
    v_mfma_f32_16x16x32_bf16 v[56:59], a[92:95], v[40:43], v[56:59]
    v_mfma_f32_16x16x32_bf16 v[60:63], a[92:95], v[44:47], v[60:63]
    s_add_u32 m0, s60, 896
    v_mfma_f32_16x16x32_bf16 v[64:67], a[172:175], v[40:43], v[64:67]
    v_mfma_f32_16x16x32_bf16 v[68:71], a[172:175], v[44:47], v[68:71]
    s_waitcnt lgkmcnt(2)
    v_mfma_f32_16x16x32_bf16 v[48:51], a[16:19], v[16:19], v[48:51]
    ds_read_b128 v[32:35], v6 offset:3072
    v_mfma_f32_16x16x32_bf16 v[52:55], a[16:19], v[20:23], v[52:55]
    ds_read_b128 v[36:39], v6 offset:23552
    buffer_load_dwordx4 v5, s[44:47], s59 offen offset:128 lds
    v_mfma_f32_16x16x32_bf16 v[56:59], a[96:99], v[16:19], v[56:59]
    v_mfma_f32_16x16x32_bf16 v[60:63], a[96:99], v[20:23], v[60:63]
    v_mfma_f32_16x16x32_bf16 v[64:67], a[176:179], v[16:19], v[64:67]
    v_mfma_f32_16x16x32_bf16 v[68:71], a[176:179], v[20:23], v[68:71]
    s_waitcnt lgkmcnt(2)
    s_add_u32 m0, s60, 1792
    v_mfma_f32_16x16x32_bf16 v[48:51], a[20:23], v[24:27], v[48:51]
    ds_read_b128 v[40:43], v7 offset:3072
    v_mfma_f32_16x16x32_bf16 v[52:55], a[20:23], v[28:31], v[52:55]
    ds_read_b128 v[44:47], v7 offset:23552
    v_mfma_f32_16x16x32_bf16 v[56:59], a[100:103], v[24:27], v[56:59]
    v_mfma_f32_16x16x32_bf16 v[60:63], a[100:103], v[28:31], v[60:63]
    buffer_load_dwordx4 v5, s[44:47], s59 offen offset:256 lds
    v_mfma_f32_16x16x32_bf16 v[64:67], a[180:183], v[24:27], v[64:67]
    v_mfma_f32_16x16x32_bf16 v[68:71], a[180:183], v[28:31], v[68:71]
    s_waitcnt lgkmcnt(2)
    v_mfma_f32_16x16x32_bf16 v[48:51], a[24:27], v[32:35], v[48:51]
    ds_read_b128 v[16:19], v6 offset:4096
    s_add_u32 m0, s60, 2688
    v_mfma_f32_16x16x32_bf16 v[52:55], a[24:27], v[36:39], v[52:55]
    ds_read_b128 v[20:23], v6 offset:24576
    v_mfma_f32_16x16x32_bf16 v[56:59], a[104:107], v[32:35], v[56:59]
    v_mfma_f32_16x16x32_bf16 v[60:63], a[104:107], v[36:39], v[60:63]
    v_mfma_f32_16x16x32_bf16 v[64:67], a[184:187], v[32:35], v[64:67]
    buffer_load_dwordx4 v5, s[44:47], s59 offen offset:384 lds
    v_mfma_f32_16x16x32_bf16 v[68:71], a[184:187], v[36:39], v[68:71]
    s_waitcnt lgkmcnt(2)
    v_mfma_f32_16x16x32_bf16 v[48:51], a[28:31], v[40:43], v[48:51]
    ds_read_b128 v[24:27], v7 offset:4096
    v_mfma_f32_16x16x32_bf16 v[52:55], a[28:31], v[44:47], v[52:55]
    ds_read_b128 v[28:31], v7 offset:24576
    v_mfma_f32_16x16x32_bf16 v[56:59], a[108:111], v[40:43], v[56:59]
    s_add_u32 m0, s60, 3584
    v_mfma_f32_16x16x32_bf16 v[60:63], a[108:111], v[44:47], v[60:63]
    v_mfma_f32_16x16x32_bf16 v[64:67], a[188:191], v[40:43], v[64:67]
    v_mfma_f32_16x16x32_bf16 v[68:71], a[188:191], v[44:47], v[68:71]
    s_waitcnt lgkmcnt(2)
    v_mfma_f32_16x16x32_bf16 v[48:51], a[32:35], v[16:19], v[48:51]
    ds_read_b128 v[32:35], v6 offset:5120
    buffer_load_dwordx4 v5, s[44:47], s59 offen offset:512 lds
    v_mfma_f32_16x16x32_bf16 v[52:55], a[32:35], v[20:23], v[52:55]
    ds_read_b128 v[36:39], v6 offset:25600
    v_mfma_f32_16x16x32_bf16 v[56:59], a[112:115], v[16:19], v[56:59]
    v_mfma_f32_16x16x32_bf16 v[60:63], a[112:115], v[20:23], v[60:63]
    v_mfma_f32_16x16x32_bf16 v[64:67], a[192:195], v[16:19], v[64:67]
    s_add_u32 m0, s60, 4480
    v_mfma_f32_16x16x32_bf16 v[68:71], a[192:195], v[20:23], v[68:71]
    s_waitcnt lgkmcnt(2)
    v_mfma_f32_16x16x32_bf16 v[48:51], a[36:39], v[24:27], v[48:51]
    ds_read_b128 v[40:43], v7 offset:5120
    v_mfma_f32_16x16x32_bf16 v[52:55], a[36:39], v[28:31], v[52:55]
    ds_read_b128 v[44:47], v7 offset:25600
    v_mfma_f32_16x16x32_bf16 v[56:59], a[116:119], v[24:27], v[56:59]
    buffer_load_dwordx4 v5, s[44:47], s59 offen offset:640 lds
    v_mfma_f32_16x16x32_bf16 v[60:63], a[116:119], v[28:31], v[60:63]
    v_mfma_f32_16x16x32_bf16 v[64:67], a[196:199], v[24:27], v[64:67]
    v_mfma_f32_16x16x32_bf16 v[68:71], a[196:199], v[28:31], v[68:71]
    s_waitcnt lgkmcnt(2)
    s_add_u32 m0, s60, 5376
    v_mfma_f32_16x16x32_bf16 v[48:51], a[40:43], v[32:35], v[48:51]
    ds_read_b128 v[16:19], v6 offset:6144
    v_mfma_f32_16x16x32_bf16 v[52:55], a[40:43], v[36:39], v[52:55]
    ds_read_b128 v[20:23], v6 offset:26624
    v_mfma_f32_16x16x32_bf16 v[56:59], a[120:123], v[32:35], v[56:59]
    v_mfma_f32_16x16x32_bf16 v[60:63], a[120:123], v[36:39], v[60:63]
    buffer_load_dwordx4 v5, s[44:47], s59 offen offset:768 lds
    v_mfma_f32_16x16x32_bf16 v[64:67], a[200:203], v[32:35], v[64:67]
    v_mfma_f32_16x16x32_bf16 v[68:71], a[200:203], v[36:39], v[68:71]
    s_waitcnt lgkmcnt(2)
    v_mfma_f32_16x16x32_bf16 v[48:51], a[44:47], v[40:43], v[48:51]
    ds_read_b128 v[24:27], v7 offset:6144
    v_mfma_f32_16x16x32_bf16 v[52:55], a[44:47], v[44:47], v[52:55]
    ds_read_b128 v[28:31], v7 offset:26624
    s_add_u32 m0, s60, 6272
    v_mfma_f32_16x16x32_bf16 v[56:59], a[124:127], v[40:43], v[56:59]
    v_mfma_f32_16x16x32_bf16 v[60:63], a[124:127], v[44:47], v[60:63]
    v_mfma_f32_16x16x32_bf16 v[64:67], a[204:207], v[40:43], v[64:67]
    v_mfma_f32_16x16x32_bf16 v[68:71], a[204:207], v[44:47], v[68:71]
    s_waitcnt lgkmcnt(2)
    buffer_load_dwordx4 v5, s[44:47], s59 offen offset:896 lds
    v_mfma_f32_16x16x32_bf16 v[48:51], a[48:51], v[16:19], v[48:51]
    ds_read_b128 v[32:35], v6 offset:7168
    v_mfma_f32_16x16x32_bf16 v[52:55], a[48:51], v[20:23], v[52:55]
    ds_read_b128 v[36:39], v6 offset:27648
    v_mfma_f32_16x16x32_bf16 v[56:59], a[128:131], v[16:19], v[56:59]
    v_mfma_f32_16x16x32_bf16 v[60:63], a[128:131], v[20:23], v[60:63]
    s_add_u32 m0, s60, 7168
    v_mfma_f32_16x16x32_bf16 v[64:67], a[208:211], v[16:19], v[64:67]
    v_mfma_f32_16x16x32_bf16 v[68:71], a[208:211], v[20:23], v[68:71]
    s_waitcnt lgkmcnt(2)
    v_mfma_f32_16x16x32_bf16 v[48:51], a[52:55], v[24:27], v[48:51]
    ds_read_b128 v[40:43], v7 offset:7168
    v_mfma_f32_16x16x32_bf16 v[52:55], a[52:55], v[28:31], v[52:55]
    ds_read_b128 v[44:47], v7 offset:27648
    buffer_load_dwordx4 v5, s[44:47], s59 offen offset:1024 lds
    v_mfma_f32_16x16x32_bf16 v[56:59], a[132:135], v[24:27], v[56:59]
    v_mfma_f32_16x16x32_bf16 v[60:63], a[132:135], v[28:31], v[60:63]
    v_mfma_f32_16x16x32_bf16 v[64:67], a[212:215], v[24:27], v[64:67]
    s_add_u32 m0, s60, 8064
    v_mfma_f32_16x16x32_bf16 v[68:71], a[212:215], v[28:31], v[68:71]
    s_waitcnt lgkmcnt(2)
    v_mfma_f32_16x16x32_bf16 v[48:51], a[56:59], v[32:35], v[48:51]
    ds_read_b128 v[16:19], v6 offset:8192
    v_mfma_f32_16x16x32_bf16 v[52:55], a[56:59], v[36:39], v[52:55]
    ds_read_b128 v[20:23], v6 offset:28672
    v_mfma_f32_16x16x32_bf16 v[56:59], a[136:139], v[32:35], v[56:59]
    buffer_load_dwordx4 v5, s[44:47], s59 offen offset:1152 lds
    v_mfma_f32_16x16x32_bf16 v[60:63], a[136:139], v[36:39], v[60:63]
    v_mfma_f32_16x16x32_bf16 v[64:67], a[216:219], v[32:35], v[64:67]
    v_mfma_f32_16x16x32_bf16 v[68:71], a[216:219], v[36:39], v[68:71]
    s_waitcnt lgkmcnt(2)
    v_mfma_f32_16x16x32_bf16 v[48:51], a[60:63], v[40:43], v[48:51]
    ds_read_b128 v[24:27], v7 offset:8192
    s_add_u32 s59, s59, 40960
    v_mfma_f32_16x16x32_bf16 v[52:55], a[60:63], v[44:47], v[52:55]
    ds_read_b128 v[28:31], v7 offset:28672
    v_mfma_f32_16x16x32_bf16 v[56:59], a[140:143], v[40:43], v[56:59]
    v_mfma_f32_16x16x32_bf16 v[60:63], a[140:143], v[44:47], v[60:63]
    v_mfma_f32_16x16x32_bf16 v[64:67], a[220:223], v[40:43], v[64:67]
    s_add_u32 s60, s60, 40960
    v_mfma_f32_16x16x32_bf16 v[68:71], a[220:223], v[44:47], v[68:71]
    s_waitcnt lgkmcnt(2)
    v_mfma_f32_16x16x32_bf16 v[48:51], a[64:67], v[16:19], v[48:51]
    ds_read_b128 v[32:35], v6 offset:9216
    v_mfma_f32_16x16x32_bf16 v[52:55], a[64:67], v[20:23], v[52:55]
    ds_read_b128 v[36:39], v6 offset:29696
    v_mfma_f32_16x16x32_bf16 v[56:59], a[144:147], v[16:19], v[56:59]
    s_cmp_ge_u32 s60, 122880
    s_cselect_b32 s55, 122880, 0
    v_mfma_f32_16x16x32_bf16 v[60:63], a[144:147], v[20:23], v[60:63]
    v_mfma_f32_16x16x32_bf16 v[64:67], a[224:227], v[16:19], v[64:67]
    v_mfma_f32_16x16x32_bf16 v[68:71], a[224:227], v[20:23], v[68:71]
    s_waitcnt lgkmcnt(2)
    v_mfma_f32_16x16x32_bf16 v[48:51], a[68:71], v[24:27], v[48:51]
    ds_read_b128 v[40:43], v7 offset:9216
    v_add_u32 v6, s94, v6
    s_sub_u32 s60, s60, s55
    v_mfma_f32_16x16x32_bf16 v[52:55], a[68:71], v[28:31], v[52:55]
    ds_read_b128 v[44:47], v7 offset:29696
    v_add_u32 v7, s94, v7
    v_mfma_f32_16x16x32_bf16 v[56:59], a[148:151], v[24:27], v[56:59]
    v_mfma_f32_16x16x32_bf16 v[60:63], a[148:151], v[28:31], v[60:63]
    v_mfma_f32_16x16x32_bf16 v[64:67], a[228:231], v[24:27], v[64:67]
    v_mfma_f32_16x16x32_bf16 v[68:71], a[228:231], v[28:31], v[68:71]
    s_waitcnt vmcnt(10) lgkmcnt(0)
    s_barrier
    v_mfma_f32_16x16x32_bf16 v[48:51], a[72:75], v[32:35], v[48:51]
    ds_read_b128 v[16:19], v6 offset:0
    v_mfma_f32_16x16x32_bf16 v[52:55], a[72:75], v[36:39], v[52:55]
    ds_read_b128 v[20:23], v6 offset:20480
    v_mfma_f32_16x16x32_bf16 v[56:59], a[152:155], v[32:35], v[56:59]
    v_mfma_f32_16x16x32_bf16 v[60:63], a[152:155], v[36:39], v[60:63]
    v_mfma_f32_16x16x32_bf16 v[64:67], a[232:235], v[32:35], v[64:67]
    v_mfma_f32_16x16x32_bf16 v[68:71], a[232:235], v[36:39], v[68:71]
    v_mfma_f32_16x16x32_bf16 v[48:51], a[76:79], v[40:43], v[48:51]
    ds_read_b128 v[24:27], v7 offset:0
    v_mfma_f32_16x16x32_bf16 v[52:55], a[76:79], v[44:47], v[52:55]
    ds_read_b128 v[28:31], v7 offset:20480
    v_mfma_f32_16x16x32_bf16 v[56:59], a[156:159], v[40:43], v[56:59]
    s_cmp_lg_u32 s3, 0
    s_cbranch_scc1 L_sf_15
    v_mov_b32 v10, s6
    s_mov_b64 exec, 1
    buffer_store_dword v10, v8, s[36:39], s65 offen offset:0
    s_mov_b64 exec, -1
L_sf_15:
    v_mfma_f32_16x16x32_bf16 v[60:63], a[156:159], v[44:47], v[60:63]
    v_mfma_f32_16x16x32_bf16 v[64:67], a[236:239], v[40:43], v[64:67]
    v_mfma_f32_16x16x32_bf16 v[68:71], a[236:239], v[44:47], v[68:71]
    s_waitcnt lgkmcnt(2)
    s_mov_b32 s62, s63
    s_add_u32 s6, s6, 1
    v_mfma_f32_16x16x32_bf16 v[72:75], a[0:3], v[16:19], 0
    ds_read_b128 v[32:35], v6 offset:1024
    s_add_u32 s61, s61, 40960
    s_cmp_ge_u32 s61, 122880
    s_cselect_b32 s94, 122880, 0
    v_mfma_f32_16x16x32_bf16 v[76:79], a[0:3], v[20:23], 0
    ds_read_b128 v[36:39], v6 offset:21504
    s_sub_u32 s61, s61, s94
    s_sub_u32 s94, 40960, s94
    v_mfma_f32_16x16x32_bf16 v[80:83], a[80:83], v[16:19], 0
    v_mfma_f32_16x16x32_bf16 v[84:87], a[80:83], v[20:23], 0
    v_mfma_f32_16x16x32_bf16 v[88:91], a[160:163], v[16:19], 0
    v_mfma_f32_16x16x32_bf16 v[92:95], a[160:163], v[20:23], 0
    s_waitcnt lgkmcnt(2)
    v_mfma_f32_16x16x32_bf16 v[72:75], a[4:7], v[24:27], v[72:75]
    ds_read_b128 v[40:43], v7 offset:1024
    v_mfma_f32_16x16x32_bf16 v[76:79], a[4:7], v[28:31], v[76:79]
    ds_read_b128 v[44:47], v7 offset:21504
    v_cvt_pk_bf16_f32 v96, v48, v49
    v_cvt_pk_bf16_f32 v97, v50, v51
    v_mfma_f32_16x16x32_bf16 v[80:83], a[84:87], v[24:27], v[80:83]
    v_cvt_pk_bf16_f32 v98, v52, v53
    v_cvt_pk_bf16_f32 v99, v54, v55
    v_mfma_f32_16x16x32_bf16 v[84:87], a[84:87], v[28:31], v[84:87]
    buffer_store_dwordx4 v[96:99], v3, s[36:39], s62 offen offset:0
    v_cvt_pk_bf16_f32 v100, v56, v57
    v_cvt_pk_bf16_f32 v101, v58, v59
    v_mfma_f32_16x16x32_bf16 v[88:91], a[164:167], v[24:27], v[88:91]
    v_cvt_pk_bf16_f32 v102, v60, v61
    v_cvt_pk_bf16_f32 v103, v62, v63
    v_mfma_f32_16x16x32_bf16 v[92:95], a[164:167], v[28:31], v[92:95]
    s_waitcnt lgkmcnt(2)
    buffer_store_dwordx4 v[100:103], v3, s[36:39], s62 offen offset:1024
    v_cvt_pk_bf16_f32 v104, v64, v65
    v_mfma_f32_16x16x32_bf16 v[72:75], a[8:11], v[32:35], v[72:75]
    ds_read_b128 v[16:19], v6 offset:2048
    v_cvt_pk_bf16_f32 v105, v66, v67
    v_cvt_pk_bf16_f32 v106, v68, v69
    v_mfma_f32_16x16x32_bf16 v[76:79], a[8:11], v[36:39], v[76:79]
    ds_read_b128 v[20:23], v6 offset:22528
    v_cvt_pk_bf16_f32 v107, v70, v71
    buffer_store_dwordx4 v[104:107], v3, s[36:39], s62 offen offset:2048
    v_mfma_f32_16x16x32_bf16 v[80:83], a[88:91], v[32:35], v[80:83]
    s_add_u32 m0, s60, 0
    s_add_u32 s63, s63, 393216
    v_mfma_f32_16x16x32_bf16 v[84:87], a[88:91], v[36:39], v[84:87]
    v_mfma_f32_16x16x32_bf16 v[88:91], a[168:171], v[32:35], v[88:91]
    v_mfma_f32_16x16x32_bf16 v[92:95], a[168:171], v[36:39], v[92:95]
    s_waitcnt lgkmcnt(2)
    buffer_load_dwordx4 v5, s[44:47], s59 offen offset:0 lds
    v_mfma_f32_16x16x32_bf16 v[72:75], a[12:15], v[40:43], v[72:75]
    ds_read_b128 v[24:27], v7 offset:2048
    v_mfma_f32_16x16x32_bf16 v[76:79], a[12:15], v[44:47], v[76:79]
    ds_read_b128 v[28:31], v7 offset:22528
    v_mfma_f32_16x16x32_bf16 v[80:83], a[92:95], v[40:43], v[80:83]
    v_mfma_f32_16x16x32_bf16 v[84:87], a[92:95], v[44:47], v[84:87]
    s_add_u32 m0, s60, 896
    v_mfma_f32_16x16x32_bf16 v[88:91], a[172:175], v[40:43], v[88:91]
    v_mfma_f32_16x16x32_bf16 v[92:95], a[172:175], v[44:47], v[92:95]
    s_waitcnt lgkmcnt(2)
    v_mfma_f32_16x16x32_bf16 v[72:75], a[16:19], v[16:19], v[72:75]
    ds_read_b128 v[32:35], v6 offset:3072
    v_mfma_f32_16x16x32_bf16 v[76:79], a[16:19], v[20:23], v[76:79]
    ds_read_b128 v[36:39], v6 offset:23552
    buffer_load_dwordx4 v5, s[44:47], s59 offen offset:128 lds
    v_mfma_f32_16x16x32_bf16 v[80:83], a[96:99], v[16:19], v[80:83]
    v_mfma_f32_16x16x32_bf16 v[84:87], a[96:99], v[20:23], v[84:87]
    v_mfma_f32_16x16x32_bf16 v[88:91], a[176:179], v[16:19], v[88:91]
    v_mfma_f32_16x16x32_bf16 v[92:95], a[176:179], v[20:23], v[92:95]
    s_waitcnt lgkmcnt(2)
    s_add_u32 m0, s60, 1792
    v_mfma_f32_16x16x32_bf16 v[72:75], a[20:23], v[24:27], v[72:75]
    ds_read_b128 v[40:43], v7 offset:3072
    v_mfma_f32_16x16x32_bf16 v[76:79], a[20:23], v[28:31], v[76:79]
    ds_read_b128 v[44:47], v7 offset:23552
    v_mfma_f32_16x16x32_bf16 v[80:83], a[100:103], v[24:27], v[80:83]
    v_mfma_f32_16x16x32_bf16 v[84:87], a[100:103], v[28:31], v[84:87]
    buffer_load_dwordx4 v5, s[44:47], s59 offen offset:256 lds
    v_mfma_f32_16x16x32_bf16 v[88:91], a[180:183], v[24:27], v[88:91]
    v_mfma_f32_16x16x32_bf16 v[92:95], a[180:183], v[28:31], v[92:95]
    s_waitcnt lgkmcnt(2)
    v_mfma_f32_16x16x32_bf16 v[72:75], a[24:27], v[32:35], v[72:75]
    ds_read_b128 v[16:19], v6 offset:4096
    s_add_u32 m0, s60, 2688
    v_mfma_f32_16x16x32_bf16 v[76:79], a[24:27], v[36:39], v[76:79]
    ds_read_b128 v[20:23], v6 offset:24576
    v_mfma_f32_16x16x32_bf16 v[80:83], a[104:107], v[32:35], v[80:83]
    v_mfma_f32_16x16x32_bf16 v[84:87], a[104:107], v[36:39], v[84:87]
    v_mfma_f32_16x16x32_bf16 v[88:91], a[184:187], v[32:35], v[88:91]
    buffer_load_dwordx4 v5, s[44:47], s59 offen offset:384 lds
    v_mfma_f32_16x16x32_bf16 v[92:95], a[184:187], v[36:39], v[92:95]
    s_waitcnt lgkmcnt(2)
    v_mfma_f32_16x16x32_bf16 v[72:75], a[28:31], v[40:43], v[72:75]
    ds_read_b128 v[24:27], v7 offset:4096
    v_mfma_f32_16x16x32_bf16 v[76:79], a[28:31], v[44:47], v[76:79]
    ds_read_b128 v[28:31], v7 offset:24576
    v_mfma_f32_16x16x32_bf16 v[80:83], a[108:111], v[40:43], v[80:83]
    s_add_u32 m0, s60, 3584
    v_mfma_f32_16x16x32_bf16 v[84:87], a[108:111], v[44:47], v[84:87]
    v_mfma_f32_16x16x32_bf16 v[88:91], a[188:191], v[40:43], v[88:91]
    v_mfma_f32_16x16x32_bf16 v[92:95], a[188:191], v[44:47], v[92:95]
    s_waitcnt lgkmcnt(2)
    v_mfma_f32_16x16x32_bf16 v[72:75], a[32:35], v[16:19], v[72:75]
    ds_read_b128 v[32:35], v6 offset:5120
    buffer_load_dwordx4 v5, s[44:47], s59 offen offset:512 lds
    v_mfma_f32_16x16x32_bf16 v[76:79], a[32:35], v[20:23], v[76:79]
    ds_read_b128 v[36:39], v6 offset:25600
    v_mfma_f32_16x16x32_bf16 v[80:83], a[112:115], v[16:19], v[80:83]
    v_mfma_f32_16x16x32_bf16 v[84:87], a[112:115], v[20:23], v[84:87]
    v_mfma_f32_16x16x32_bf16 v[88:91], a[192:195], v[16:19], v[88:91]
    s_add_u32 m0, s60, 4480
    v_mfma_f32_16x16x32_bf16 v[92:95], a[192:195], v[20:23], v[92:95]
    s_waitcnt lgkmcnt(2)
    v_mfma_f32_16x16x32_bf16 v[72:75], a[36:39], v[24:27], v[72:75]
    ds_read_b128 v[40:43], v7 offset:5120
    v_mfma_f32_16x16x32_bf16 v[76:79], a[36:39], v[28:31], v[76:79]
    ds_read_b128 v[44:47], v7 offset:25600
    v_mfma_f32_16x16x32_bf16 v[80:83], a[116:119], v[24:27], v[80:83]
    buffer_load_dwordx4 v5, s[44:47], s59 offen offset:640 lds
    v_mfma_f32_16x16x32_bf16 v[84:87], a[116:119], v[28:31], v[84:87]
    v_mfma_f32_16x16x32_bf16 v[88:91], a[196:199], v[24:27], v[88:91]
    v_mfma_f32_16x16x32_bf16 v[92:95], a[196:199], v[28:31], v[92:95]
    s_waitcnt lgkmcnt(2)
    s_add_u32 m0, s60, 5376
    v_mfma_f32_16x16x32_bf16 v[72:75], a[40:43], v[32:35], v[72:75]
    ds_read_b128 v[16:19], v6 offset:6144
    v_mfma_f32_16x16x32_bf16 v[76:79], a[40:43], v[36:39], v[76:79]
    ds_read_b128 v[20:23], v6 offset:26624
    v_mfma_f32_16x16x32_bf16 v[80:83], a[120:123], v[32:35], v[80:83]
    v_mfma_f32_16x16x32_bf16 v[84:87], a[120:123], v[36:39], v[84:87]
    buffer_load_dwordx4 v5, s[44:47], s59 offen offset:768 lds
    v_mfma_f32_16x16x32_bf16 v[88:91], a[200:203], v[32:35], v[88:91]
    v_mfma_f32_16x16x32_bf16 v[92:95], a[200:203], v[36:39], v[92:95]
    s_waitcnt lgkmcnt(2)
    v_mfma_f32_16x16x32_bf16 v[72:75], a[44:47], v[40:43], v[72:75]
    ds_read_b128 v[24:27], v7 offset:6144
    v_mfma_f32_16x16x32_bf16 v[76:79], a[44:47], v[44:47], v[76:79]
    ds_read_b128 v[28:31], v7 offset:26624
    s_add_u32 m0, s60, 6272
    v_mfma_f32_16x16x32_bf16 v[80:83], a[124:127], v[40:43], v[80:83]
    v_mfma_f32_16x16x32_bf16 v[84:87], a[124:127], v[44:47], v[84:87]
    v_mfma_f32_16x16x32_bf16 v[88:91], a[204:207], v[40:43], v[88:91]
    v_mfma_f32_16x16x32_bf16 v[92:95], a[204:207], v[44:47], v[92:95]
    s_waitcnt lgkmcnt(2)
    buffer_load_dwordx4 v5, s[44:47], s59 offen offset:896 lds
    v_mfma_f32_16x16x32_bf16 v[72:75], a[48:51], v[16:19], v[72:75]
    ds_read_b128 v[32:35], v6 offset:7168
    v_mfma_f32_16x16x32_bf16 v[76:79], a[48:51], v[20:23], v[76:79]
    ds_read_b128 v[36:39], v6 offset:27648
    v_mfma_f32_16x16x32_bf16 v[80:83], a[128:131], v[16:19], v[80:83]
    v_mfma_f32_16x16x32_bf16 v[84:87], a[128:131], v[20:23], v[84:87]
    s_add_u32 m0, s60, 7168
    v_mfma_f32_16x16x32_bf16 v[88:91], a[208:211], v[16:19], v[88:91]
    v_mfma_f32_16x16x32_bf16 v[92:95], a[208:211], v[20:23], v[92:95]
    s_waitcnt lgkmcnt(2)
    v_mfma_f32_16x16x32_bf16 v[72:75], a[52:55], v[24:27], v[72:75]
    ds_read_b128 v[40:43], v7 offset:7168
    v_mfma_f32_16x16x32_bf16 v[76:79], a[52:55], v[28:31], v[76:79]
    ds_read_b128 v[44:47], v7 offset:27648
    buffer_load_dwordx4 v5, s[44:47], s59 offen offset:1024 lds
    v_mfma_f32_16x16x32_bf16 v[80:83], a[132:135], v[24:27], v[80:83]
    v_mfma_f32_16x16x32_bf16 v[84:87], a[132:135], v[28:31], v[84:87]
    v_mfma_f32_16x16x32_bf16 v[88:91], a[212:215], v[24:27], v[88:91]
    s_add_u32 m0, s60, 8064
    v_mfma_f32_16x16x32_bf16 v[92:95], a[212:215], v[28:31], v[92:95]
    s_waitcnt lgkmcnt(2)
    v_mfma_f32_16x16x32_bf16 v[72:75], a[56:59], v[32:35], v[72:75]
    ds_read_b128 v[16:19], v6 offset:8192
    v_mfma_f32_16x16x32_bf16 v[76:79], a[56:59], v[36:39], v[76:79]
    ds_read_b128 v[20:23], v6 offset:28672
    v_mfma_f32_16x16x32_bf16 v[80:83], a[136:139], v[32:35], v[80:83]
    buffer_load_dwordx4 v5, s[44:47], s59 offen offset:1152 lds
    v_mfma_f32_16x16x32_bf16 v[84:87], a[136:139], v[36:39], v[84:87]
    v_mfma_f32_16x16x32_bf16 v[88:91], a[216:219], v[32:35], v[88:91]
    v_mfma_f32_16x16x32_bf16 v[92:95], a[216:219], v[36:39], v[92:95]
    s_waitcnt lgkmcnt(2)
    v_mfma_f32_16x16x32_bf16 v[72:75], a[60:63], v[40:43], v[72:75]
    ds_read_b128 v[24:27], v7 offset:8192
    s_add_u32 s59, s59, 40960
    v_mfma_f32_16x16x32_bf16 v[76:79], a[60:63], v[44:47], v[76:79]
    ds_read_b128 v[28:31], v7 offset:28672
    v_mfma_f32_16x16x32_bf16 v[80:83], a[140:143], v[40:43], v[80:83]
    v_mfma_f32_16x16x32_bf16 v[84:87], a[140:143], v[44:47], v[84:87]
    v_mfma_f32_16x16x32_bf16 v[88:91], a[220:223], v[40:43], v[88:91]
    s_add_u32 s60, s60, 40960
    v_mfma_f32_16x16x32_bf16 v[92:95], a[220:223], v[44:47], v[92:95]
    s_waitcnt lgkmcnt(2)
    v_mfma_f32_16x16x32_bf16 v[72:75], a[64:67], v[16:19], v[72:75]
    ds_read_b128 v[32:35], v6 offset:9216
    v_mfma_f32_16x16x32_bf16 v[76:79], a[64:67], v[20:23], v[76:79]
    ds_read_b128 v[36:39], v6 offset:29696
    v_mfma_f32_16x16x32_bf16 v[80:83], a[144:147], v[16:19], v[80:83]
    s_cmp_ge_u32 s60, 122880
    s_cselect_b32 s55, 122880, 0
    v_mfma_f32_16x16x32_bf16 v[84:87], a[144:147], v[20:23], v[84:87]
    v_mfma_f32_16x16x32_bf16 v[88:91], a[224:227], v[16:19], v[88:91]
    v_mfma_f32_16x16x32_bf16 v[92:95], a[224:227], v[20:23], v[92:95]
    s_waitcnt lgkmcnt(2)
    v_mfma_f32_16x16x32_bf16 v[72:75], a[68:71], v[24:27], v[72:75]
    ds_read_b128 v[40:43], v7 offset:9216
    v_add_u32 v6, s94, v6
    s_sub_u32 s60, s60, s55
    v_mfma_f32_16x16x32_bf16 v[76:79], a[68:71], v[28:31], v[76:79]
    ds_read_b128 v[44:47], v7 offset:29696
    v_add_u32 v7, s94, v7
    v_mfma_f32_16x16x32_bf16 v[80:83], a[148:151], v[24:27], v[80:83]
    v_mfma_f32_16x16x32_bf16 v[84:87], a[148:151], v[28:31], v[84:87]
    v_mfma_f32_16x16x32_bf16 v[88:91], a[228:231], v[24:27], v[88:91]
    v_mfma_f32_16x16x32_bf16 v[92:95], a[228:231], v[28:31], v[92:95]
    s_waitcnt vmcnt(10) lgkmcnt(0)
    s_barrier
    v_mfma_f32_16x16x32_bf16 v[72:75], a[72:75], v[32:35], v[72:75]
    ds_read_b128 v[16:19], v6 offset:0
    v_mfma_f32_16x16x32_bf16 v[76:79], a[72:75], v[36:39], v[76:79]
    ds_read_b128 v[20:23], v6 offset:20480
    v_mfma_f32_16x16x32_bf16 v[80:83], a[152:155], v[32:35], v[80:83]
    v_mfma_f32_16x16x32_bf16 v[84:87], a[152:155], v[36:39], v[84:87]
    v_mfma_f32_16x16x32_bf16 v[88:91], a[232:235], v[32:35], v[88:91]
    v_mfma_f32_16x16x32_bf16 v[92:95], a[232:235], v[36:39], v[92:95]
    v_mfma_f32_16x16x32_bf16 v[72:75], a[76:79], v[40:43], v[72:75]
    ds_read_b128 v[24:27], v7 offset:0
    v_mfma_f32_16x16x32_bf16 v[76:79], a[76:79], v[44:47], v[76:79]
    ds_read_b128 v[28:31], v7 offset:20480
    v_mfma_f32_16x16x32_bf16 v[80:83], a[156:159], v[40:43], v[80:83]
    s_cmp_lg_u32 s3, 0
    s_cbranch_scc1 L_sf_16
    v_mov_b32 v10, s6
    s_mov_b64 exec, 1
    buffer_store_dword v10, v8, s[36:39], s65 offen offset:0
    s_mov_b64 exec, -1
L_sf_16:
    v_mfma_f32_16x16x32_bf16 v[84:87], a[156:159], v[44:47], v[84:87]
    v_mfma_f32_16x16x32_bf16 v[88:91], a[236:239], v[40:43], v[88:91]
    v_mfma_f32_16x16x32_bf16 v[92:95], a[236:239], v[44:47], v[92:95]
    s_waitcnt lgkmcnt(2)
    s_mov_b32 s62, s63
    s_add_u32 s6, s6, 1
    s_cmp_lt_u32 s6, s64
    s_cbranch_scc1 L_v_loop
    s_nop 7
    v_cvt_pk_bf16_f32 v96, v72, v73
    v_cvt_pk_bf16_f32 v97, v74, v75
    v_cvt_pk_bf16_f32 v98, v76, v77
    v_cvt_pk_bf16_f32 v99, v78, v79
    buffer_store_dwordx4 v[96:99], v3, s[36:39], s62 offen offset:0
    v_cvt_pk_bf16_f32 v100, v80, v81
    v_cvt_pk_bf16_f32 v101, v82, v83
    v_cvt_pk_bf16_f32 v102, v84, v85
    v_cvt_pk_bf16_f32 v103, v86, v87
    buffer_store_dwordx4 v[100:103], v3, s[36:39], s62 offen offset:1024
    v_cvt_pk_bf16_f32 v104, v88, v89
    v_cvt_pk_bf16_f32 v105, v90, v91
    v_cvt_pk_bf16_f32 v106, v92, v93
    v_cvt_pk_bf16_f32 v107, v94, v95
    buffer_store_dwordx4 v[104:107], v3, s[36:39], s62 offen offset:2048
    s_add_u32 s63, s63, 393216
    s_waitcnt vmcnt(0) lgkmcnt(0)
    s_barrier
    s_cmp_lg_u32 s3, 0
    s_cbranch_scc1 L_sf_17
    v_mov_b32 v10, 64
    s_mov_b64 exec, 1
    buffer_store_dword v10, v8, s[36:39], s65 offen offset:0
    s_mov_b64 exec, -1
L_sf_17:
    s_branch L_alpha
L_y:
    s_mov_b32 s40, s24
    s_and_b32 s41, s25, 0xffff
    s_mov_b32 s42, 7864320
    s_mov_b32 s43, 0x20000
    s_mul_i32 s54, s52, 245760
    s_mul_i32 s53, s3, 10
    v_lshrrev_b32 v28, 3, v2
    v_mul_u32_u24 v16, 1280, v28
    v_lshrrev_b32 v28, 1, v28
    v_lshlrev_b32 v28, 1, v28
    v_and_b32 v29, 7, v2
    v_xor_b32 v28, v28, v29
    v_lshl_add_u32 v16, v28, 4, v16
    v_lshrrev_b32 v28, 2, v0
    v_lshl_add_u32 v17, v1, 2, v28
    v_lshlrev_b32 v17, 7, v17
    v_and_b32 v29, 3, v0
    v_lshl_add_u32 v17, v29, 3, v17
    v_lshrrev_b32 v28, 1, v28
    v_and_b32 v29, 1, v1
    v_lshl_add_u32 v28, v29, 1, v28
    s_lshl_b32 s58, s3, 10
    s_mul_i32 s57, s3, 10240
    s_add_u32 s57, s57, s54
    s_add_u32 s55, s53, 0
    s_and_b32 s56, s55, 3
    s_lshr_b32 s55, s55, 2
    s_mul_i32 s55, s55, 4096
    v_xor_b32 v29, s56, v28
    v_lshl_add_u32 v29, v29, 5, v17
    v_add_u32 v18, s55, v29
    s_add_u32 s55, s53, 1
    s_and_b32 s56, s55, 3
    s_lshr_b32 s55, s55, 2
    s_mul_i32 s55, s55, 4096
    v_xor_b32 v29, s56, v28
    v_lshl_add_u32 v29, v29, 5, v17
    v_add_u32 v19, s55, v29
    s_add_u32 s55, s53, 2
    s_and_b32 s56, s55, 3
    s_lshr_b32 s55, s55, 2
    s_mul_i32 s55, s55, 4096
    v_xor_b32 v29, s56, v28
    v_lshl_add_u32 v29, v29, 5, v17
    v_add_u32 v20, s55, v29
    s_add_u32 s55, s53, 3
    s_and_b32 s56, s55, 3
    s_lshr_b32 s55, s55, 2
    s_mul_i32 s55, s55, 4096
    v_xor_b32 v29, s56, v28
    v_lshl_add_u32 v29, v29, 5, v17
    v_add_u32 v21, s55, v29
    s_add_u32 s55, s53, 4
    s_and_b32 s56, s55, 3
    s_lshr_b32 s55, s55, 2
    s_mul_i32 s55, s55, 4096
    v_xor_b32 v29, s56, v28
    v_lshl_add_u32 v29, v29, 5, v17
    v_add_u32 v22, s55, v29
    s_add_u32 s55, s53, 5
    s_and_b32 s56, s55, 3
    s_lshr_b32 s55, s55, 2
    s_mul_i32 s55, s55, 4096
    v_xor_b32 v29, s56, v28
    v_lshl_add_u32 v29, v29, 5, v17
    v_add_u32 v23, s55, v29
    s_add_u32 s55, s53, 6
    s_and_b32 s56, s55, 3
    s_lshr_b32 s55, s55, 2
    s_mul_i32 s55, s55, 4096
    v_xor_b32 v29, s56, v28
    v_lshl_add_u32 v29, v29, 5, v17
    v_add_u32 v24, s55, v29
    s_add_u32 s55, s53, 7
    s_and_b32 s56, s55, 3
    s_lshr_b32 s55, s55, 2
    s_mul_i32 s55, s55, 4096
    v_xor_b32 v29, s56, v28
    v_lshl_add_u32 v29, v29, 5, v17
    v_add_u32 v25, s55, v29
    s_add_u32 s55, s53, 8
    s_and_b32 s56, s55, 3
    s_lshr_b32 s55, s55, 2
    s_mul_i32 s55, s55, 4096
    v_xor_b32 v29, s56, v28
    v_lshl_add_u32 v29, v29, 5, v17
    v_add_u32 v26, s55, v29
    s_add_u32 s55, s53, 9
    s_and_b32 s56, s55, 3
    s_lshr_b32 s55, s55, 2
    s_mul_i32 s55, s55, 4096
    v_xor_b32 v29, s56, v28
    v_lshl_add_u32 v29, v29, 5, v17
    v_add_u32 v27, s55, v29
    s_add_u32 m0, s58, 0
    s_add_u32 s55, s57, 0
    buffer_load_dwordx4 v16, s[40:43], s55 offen lds
    s_add_u32 m0, s58, 4096
    s_add_u32 s55, s57, 128
    buffer_load_dwordx4 v16, s[40:43], s55 offen lds
    s_add_u32 m0, s58, 8192
    s_add_u32 s55, s57, 256
    buffer_load_dwordx4 v16, s[40:43], s55 offen lds
    s_add_u32 m0, s58, 12288
    s_add_u32 s55, s57, 384
    buffer_load_dwordx4 v16, s[40:43], s55 offen lds
    s_add_u32 m0, s58, 16384
    s_add_u32 s55, s57, 512
    buffer_load_dwordx4 v16, s[40:43], s55 offen lds
    s_add_u32 m0, s58, 20480
    s_add_u32 s55, s57, 640
    buffer_load_dwordx4 v16, s[40:43], s55 offen lds
    s_add_u32 m0, s58, 24576
    s_add_u32 s55, s57, 768
    buffer_load_dwordx4 v16, s[40:43], s55 offen lds
    s_add_u32 m0, s58, 28672
    s_add_u32 s55, s57, 896
    buffer_load_dwordx4 v16, s[40:43], s55 offen lds
    s_add_u32 m0, s58, 32768
    s_add_u32 s55, s57, 1024
    buffer_load_dwordx4 v16, s[40:43], s55 offen lds
    s_add_u32 m0, s58, 36864
    s_add_u32 s55, s57, 1152
    buffer_load_dwordx4 v16, s[40:43], s55 offen lds
    s_add_u32 m0, s58, 40960
    s_add_u32 s55, s57, 40960
    buffer_load_dwordx4 v16, s[40:43], s55 offen lds
    s_add_u32 m0, s58, 45056
    s_add_u32 s55, s57, 41088
    buffer_load_dwordx4 v16, s[40:43], s55 offen lds
    s_add_u32 m0, s58, 49152
    s_add_u32 s55, s57, 41216
    buffer_load_dwordx4 v16, s[40:43], s55 offen lds
    s_add_u32 m0, s58, 53248
    s_add_u32 s55, s57, 41344
    buffer_load_dwordx4 v16, s[40:43], s55 offen lds
    s_add_u32 m0, s58, 57344
    s_add_u32 s55, s57, 41472
    buffer_load_dwordx4 v16, s[40:43], s55 offen lds
    s_add_u32 m0, s58, 61440
    s_add_u32 s55, s57, 41600
    buffer_load_dwordx4 v16, s[40:43], s55 offen lds
    s_add_u32 m0, s58, 65536
    s_add_u32 s55, s57, 41728
    buffer_load_dwordx4 v16, s[40:43], s55 offen lds
    s_add_u32 m0, s58, 69632
    s_add_u32 s55, s57, 41856
    buffer_load_dwordx4 v16, s[40:43], s55 offen lds
    s_add_u32 m0, s58, 73728
    s_add_u32 s55, s57, 41984
    buffer_load_dwordx4 v16, s[40:43], s55 offen lds
    s_add_u32 m0, s58, 77824
    s_add_u32 s55, s57, 42112
    buffer_load_dwordx4 v16, s[40:43], s55 offen lds
    s_add_u32 m0, s58, 81920
    s_add_u32 s55, s57, 81920
    buffer_load_dwordx4 v16, s[40:43], s55 offen lds
    s_add_u32 m0, s58, 86016
    s_add_u32 s55, s57, 82048
    buffer_load_dwordx4 v16, s[40:43], s55 offen lds
    s_add_u32 m0, s58, 90112
    s_add_u32 s55, s57, 82176
    buffer_load_dwordx4 v16, s[40:43], s55 offen lds
    s_add_u32 m0, s58, 94208
    s_add_u32 s55, s57, 82304
    buffer_load_dwordx4 v16, s[40:43], s55 offen lds
    s_add_u32 m0, s58, 98304
    s_add_u32 s55, s57, 82432
    buffer_load_dwordx4 v16, s[40:43], s55 offen lds
    s_add_u32 m0, s58, 102400
    s_add_u32 s55, s57, 82560
    buffer_load_dwordx4 v16, s[40:43], s55 offen lds
    s_add_u32 m0, s58, 106496
    s_add_u32 s55, s57, 82688
    buffer_load_dwordx4 v16, s[40:43], s55 offen lds
    s_add_u32 m0, s58, 110592
    s_add_u32 s55, s57, 82816
    buffer_load_dwordx4 v16, s[40:43], s55 offen lds
    s_add_u32 m0, s58, 114688
    s_add_u32 s55, s57, 82944
    buffer_load_dwordx4 v16, s[40:43], s55 offen lds
    s_add_u32 m0, s58, 118784
    s_add_u32 s55, s57, 83072
    buffer_load_dwordx4 v16, s[40:43], s55 offen lds
    s_waitcnt vmcnt(20)
    s_barrier
    v_add_u32 v29, 0, v18
    ds_read_b64_tr_b16 a[0:1], v29 offset:0
    ds_read_b64_tr_b16 a[2:3], v29 offset:2048
    v_add_u32 v30, 0, v19
    ds_read_b64_tr_b16 a[24:25], v30 offset:0
    ds_read_b64_tr_b16 a[26:27], v30 offset:2048
    v_add_u32 v29, 0, v20
    ds_read_b64_tr_b16 a[48:49], v29 offset:0
    ds_read_b64_tr_b16 a[50:51], v29 offset:2048
    v_add_u32 v30, 0, v21
    ds_read_b64_tr_b16 a[72:73], v30 offset:0
    ds_read_b64_tr_b16 a[74:75], v30 offset:2048
    s_waitcnt lgkmcnt(6)
    v_add_u32 v29, 0, v22
    ds_read_b64_tr_b16 a[96:97], v29 offset:0
    ds_read_b64_tr_b16 a[98:99], v29 offset:2048
    v_add_u32 v30, 0, v23
    ds_read_b64_tr_b16 a[120:121], v30 offset:0
    ds_read_b64_tr_b16 a[122:123], v30 offset:2048
    v_add_u32 v29, 0, v24
    ds_read_b64_tr_b16 a[144:145], v29 offset:0
    ds_read_b64_tr_b16 a[146:147], v29 offset:2048
    v_add_u32 v30, 0, v25
    ds_read_b64_tr_b16 a[168:169], v30 offset:0
    ds_read_b64_tr_b16 a[170:171], v30 offset:2048
    s_waitcnt lgkmcnt(6)
    v_add_u32 v29, 0, v26
    ds_read_b64_tr_b16 a[192:193], v29 offset:0
    ds_read_b64_tr_b16 a[194:195], v29 offset:2048
    v_add_u32 v30, 0, v27
    ds_read_b64_tr_b16 a[216:217], v30 offset:0
    ds_read_b64_tr_b16 a[218:219], v30 offset:2048
    s_waitcnt lgkmcnt(0)
    s_barrier
    s_add_u32 m0, s58, 0
    s_add_u32 s55, s57, 122880
    buffer_load_dwordx4 v16, s[40:43], s55 offen lds
    s_add_u32 m0, s58, 4096
    s_add_u32 s55, s57, 123008
    buffer_load_dwordx4 v16, s[40:43], s55 offen lds
    s_add_u32 m0, s58, 8192
    s_add_u32 s55, s57, 123136
    buffer_load_dwordx4 v16, s[40:43], s55 offen lds
    s_add_u32 m0, s58, 12288
    s_add_u32 s55, s57, 123264
    buffer_load_dwordx4 v16, s[40:43], s55 offen lds
    s_add_u32 m0, s58, 16384
    s_add_u32 s55, s57, 123392
    buffer_load_dwordx4 v16, s[40:43], s55 offen lds
    s_add_u32 m0, s58, 20480
    s_add_u32 s55, s57, 123520
    buffer_load_dwordx4 v16, s[40:43], s55 offen lds
    s_add_u32 m0, s58, 24576
    s_add_u32 s55, s57, 123648
    buffer_load_dwordx4 v16, s[40:43], s55 offen lds
    s_add_u32 m0, s58, 28672
    s_add_u32 s55, s57, 123776
    buffer_load_dwordx4 v16, s[40:43], s55 offen lds
    s_add_u32 m0, s58, 32768
    s_add_u32 s55, s57, 123904
    buffer_load_dwordx4 v16, s[40:43], s55 offen lds
    s_add_u32 m0, s58, 36864
    s_add_u32 s55, s57, 124032
    buffer_load_dwordx4 v16, s[40:43], s55 offen lds
    s_waitcnt vmcnt(20)
    s_barrier
    v_add_u32 v29, 40960, v18
    ds_read_b64_tr_b16 a[4:5], v29 offset:0
    ds_read_b64_tr_b16 a[6:7], v29 offset:2048
    v_add_u32 v30, 40960, v19
    ds_read_b64_tr_b16 a[28:29], v30 offset:0
    ds_read_b64_tr_b16 a[30:31], v30 offset:2048
    v_add_u32 v29, 40960, v20
    ds_read_b64_tr_b16 a[52:53], v29 offset:0
    ds_read_b64_tr_b16 a[54:55], v29 offset:2048
    v_add_u32 v30, 40960, v21
    ds_read_b64_tr_b16 a[76:77], v30 offset:0
    ds_read_b64_tr_b16 a[78:79], v30 offset:2048
    s_waitcnt lgkmcnt(6)
    v_add_u32 v29, 40960, v22
    ds_read_b64_tr_b16 a[100:101], v29 offset:0
    ds_read_b64_tr_b16 a[102:103], v29 offset:2048
    v_add_u32 v30, 40960, v23
    ds_read_b64_tr_b16 a[124:125], v30 offset:0
    ds_read_b64_tr_b16 a[126:127], v30 offset:2048
    v_add_u32 v29, 40960, v24
    ds_read_b64_tr_b16 a[148:149], v29 offset:0
    ds_read_b64_tr_b16 a[150:151], v29 offset:2048
    v_add_u32 v30, 40960, v25
    ds_read_b64_tr_b16 a[172:173], v30 offset:0
    ds_read_b64_tr_b16 a[174:175], v30 offset:2048
    s_waitcnt lgkmcnt(6)
    v_add_u32 v29, 40960, v26
    ds_read_b64_tr_b16 a[196:197], v29 offset:0
    ds_read_b64_tr_b16 a[198:199], v29 offset:2048
    v_add_u32 v30, 40960, v27
    ds_read_b64_tr_b16 a[220:221], v30 offset:0
    ds_read_b64_tr_b16 a[222:223], v30 offset:2048
    s_waitcnt lgkmcnt(0)
    s_barrier
    s_add_u32 m0, s58, 40960
    s_add_u32 s55, s57, 163840
    buffer_load_dwordx4 v16, s[40:43], s55 offen lds
    s_add_u32 m0, s58, 45056
    s_add_u32 s55, s57, 163968
    buffer_load_dwordx4 v16, s[40:43], s55 offen lds
    s_add_u32 m0, s58, 49152
    s_add_u32 s55, s57, 164096
    buffer_load_dwordx4 v16, s[40:43], s55 offen lds
    s_add_u32 m0, s58, 53248
    s_add_u32 s55, s57, 164224
    buffer_load_dwordx4 v16, s[40:43], s55 offen lds
    s_add_u32 m0, s58, 57344
    s_add_u32 s55, s57, 164352
    buffer_load_dwordx4 v16, s[40:43], s55 offen lds
    s_add_u32 m0, s58, 61440
    s_add_u32 s55, s57, 164480
    buffer_load_dwordx4 v16, s[40:43], s55 offen lds
    s_add_u32 m0, s58, 65536
    s_add_u32 s55, s57, 164608
    buffer_load_dwordx4 v16, s[40:43], s55 offen lds
    s_add_u32 m0, s58, 69632
    s_add_u32 s55, s57, 164736
    buffer_load_dwordx4 v16, s[40:43], s55 offen lds
    s_add_u32 m0, s58, 73728
    s_add_u32 s55, s57, 164864
    buffer_load_dwordx4 v16, s[40:43], s55 offen lds
    s_add_u32 m0, s58, 77824
    s_add_u32 s55, s57, 164992
    buffer_load_dwordx4 v16, s[40:43], s55 offen lds
    s_waitcnt vmcnt(20)
    s_barrier
    v_add_u32 v29, 81920, v18
    ds_read_b64_tr_b16 a[8:9], v29 offset:0
    ds_read_b64_tr_b16 a[10:11], v29 offset:2048
    v_add_u32 v30, 81920, v19
    ds_read_b64_tr_b16 a[32:33], v30 offset:0
    ds_read_b64_tr_b16 a[34:35], v30 offset:2048
    v_add_u32 v29, 81920, v20
    ds_read_b64_tr_b16 a[56:57], v29 offset:0
    ds_read_b64_tr_b16 a[58:59], v29 offset:2048
    v_add_u32 v30, 81920, v21
    ds_read_b64_tr_b16 a[80:81], v30 offset:0
    ds_read_b64_tr_b16 a[82:83], v30 offset:2048
    s_waitcnt lgkmcnt(6)
    v_add_u32 v29, 81920, v22
    ds_read_b64_tr_b16 a[104:105], v29 offset:0
    ds_read_b64_tr_b16 a[106:107], v29 offset:2048
    v_add_u32 v30, 81920, v23
    ds_read_b64_tr_b16 a[128:129], v30 offset:0
    ds_read_b64_tr_b16 a[130:131], v30 offset:2048
    v_add_u32 v29, 81920, v24
    ds_read_b64_tr_b16 a[152:153], v29 offset:0
    ds_read_b64_tr_b16 a[154:155], v29 offset:2048
    v_add_u32 v30, 81920, v25
    ds_read_b64_tr_b16 a[176:177], v30 offset:0
    ds_read_b64_tr_b16 a[178:179], v30 offset:2048
    s_waitcnt lgkmcnt(6)
    v_add_u32 v29, 81920, v26
    ds_read_b64_tr_b16 a[200:201], v29 offset:0
    ds_read_b64_tr_b16 a[202:203], v29 offset:2048
    v_add_u32 v30, 81920, v27
    ds_read_b64_tr_b16 a[224:225], v30 offset:0
    ds_read_b64_tr_b16 a[226:227], v30 offset:2048
    s_waitcnt lgkmcnt(0)
    s_barrier
    s_add_u32 m0, s58, 81920
    s_add_u32 s55, s57, 204800
    buffer_load_dwordx4 v16, s[40:43], s55 offen lds
    s_add_u32 m0, s58, 86016
    s_add_u32 s55, s57, 204928
    buffer_load_dwordx4 v16, s[40:43], s55 offen lds
    s_add_u32 m0, s58, 90112
    s_add_u32 s55, s57, 205056
    buffer_load_dwordx4 v16, s[40:43], s55 offen lds
    s_add_u32 m0, s58, 94208
    s_add_u32 s55, s57, 205184
    buffer_load_dwordx4 v16, s[40:43], s55 offen lds
    s_add_u32 m0, s58, 98304
    s_add_u32 s55, s57, 205312
    buffer_load_dwordx4 v16, s[40:43], s55 offen lds
    s_add_u32 m0, s58, 102400
    s_add_u32 s55, s57, 205440
    buffer_load_dwordx4 v16, s[40:43], s55 offen lds
    s_add_u32 m0, s58, 106496
    s_add_u32 s55, s57, 205568
    buffer_load_dwordx4 v16, s[40:43], s55 offen lds
    s_add_u32 m0, s58, 110592
    s_add_u32 s55, s57, 205696
    buffer_load_dwordx4 v16, s[40:43], s55 offen lds
    s_add_u32 m0, s58, 114688
    s_add_u32 s55, s57, 205824
    buffer_load_dwordx4 v16, s[40:43], s55 offen lds
    s_add_u32 m0, s58, 118784
    s_add_u32 s55, s57, 205952
    buffer_load_dwordx4 v16, s[40:43], s55 offen lds
    s_waitcnt vmcnt(20)
    s_barrier
    v_add_u32 v29, 0, v18
    ds_read_b64_tr_b16 a[12:13], v29 offset:0
    ds_read_b64_tr_b16 a[14:15], v29 offset:2048
    v_add_u32 v30, 0, v19
    ds_read_b64_tr_b16 a[36:37], v30 offset:0
    ds_read_b64_tr_b16 a[38:39], v30 offset:2048
    v_add_u32 v29, 0, v20
    ds_read_b64_tr_b16 a[60:61], v29 offset:0
    ds_read_b64_tr_b16 a[62:63], v29 offset:2048
    v_add_u32 v30, 0, v21
    ds_read_b64_tr_b16 a[84:85], v30 offset:0
    ds_read_b64_tr_b16 a[86:87], v30 offset:2048
    s_waitcnt lgkmcnt(6)
    v_add_u32 v29, 0, v22
    ds_read_b64_tr_b16 a[108:109], v29 offset:0
    ds_read_b64_tr_b16 a[110:111], v29 offset:2048
    v_add_u32 v30, 0, v23
    ds_read_b64_tr_b16 a[132:133], v30 offset:0
    ds_read_b64_tr_b16 a[134:135], v30 offset:2048
    v_add_u32 v29, 0, v24
    ds_read_b64_tr_b16 a[156:157], v29 offset:0
    ds_read_b64_tr_b16 a[158:159], v29 offset:2048
    v_add_u32 v30, 0, v25
    ds_read_b64_tr_b16 a[180:181], v30 offset:0
    ds_read_b64_tr_b16 a[182:183], v30 offset:2048
    s_waitcnt lgkmcnt(6)
    v_add_u32 v29, 0, v26
    ds_read_b64_tr_b16 a[204:205], v29 offset:0
    ds_read_b64_tr_b16 a[206:207], v29 offset:2048
    v_add_u32 v30, 0, v27
    ds_read_b64_tr_b16 a[228:229], v30 offset:0
    ds_read_b64_tr_b16 a[230:231], v30 offset:2048
    s_waitcnt lgkmcnt(0)
    s_barrier
    s_waitcnt vmcnt(10)
    s_barrier
    v_add_u32 v29, 40960, v18
    ds_read_b64_tr_b16 a[16:17], v29 offset:0
    ds_read_b64_tr_b16 a[18:19], v29 offset:2048
    v_add_u32 v30, 40960, v19
    ds_read_b64_tr_b16 a[40:41], v30 offset:0
    ds_read_b64_tr_b16 a[42:43], v30 offset:2048
    v_add_u32 v29, 40960, v20
    ds_read_b64_tr_b16 a[64:65], v29 offset:0
    ds_read_b64_tr_b16 a[66:67], v29 offset:2048
    v_add_u32 v30, 40960, v21
    ds_read_b64_tr_b16 a[88:89], v30 offset:0
    ds_read_b64_tr_b16 a[90:91], v30 offset:2048
    s_waitcnt lgkmcnt(6)
    v_add_u32 v29, 40960, v22
    ds_read_b64_tr_b16 a[112:113], v29 offset:0
    ds_read_b64_tr_b16 a[114:115], v29 offset:2048
    v_add_u32 v30, 40960, v23
    ds_read_b64_tr_b16 a[136:137], v30 offset:0
    ds_read_b64_tr_b16 a[138:139], v30 offset:2048
    v_add_u32 v29, 40960, v24
    ds_read_b64_tr_b16 a[160:161], v29 offset:0
    ds_read_b64_tr_b16 a[162:163], v29 offset:2048
    v_add_u32 v30, 40960, v25
    ds_read_b64_tr_b16 a[184:185], v30 offset:0
    ds_read_b64_tr_b16 a[186:187], v30 offset:2048
    s_waitcnt lgkmcnt(6)
    v_add_u32 v29, 40960, v26
    ds_read_b64_tr_b16 a[208:209], v29 offset:0
    ds_read_b64_tr_b16 a[210:211], v29 offset:2048
    v_add_u32 v30, 40960, v27
    ds_read_b64_tr_b16 a[232:233], v30 offset:0
    ds_read_b64_tr_b16 a[234:235], v30 offset:2048
    s_waitcnt lgkmcnt(0)
    s_barrier
    s_waitcnt vmcnt(0)
    s_barrier
    v_add_u32 v29, 81920, v18
    ds_read_b64_tr_b16 a[20:21], v29 offset:0
    ds_read_b64_tr_b16 a[22:23], v29 offset:2048
    v_add_u32 v30, 81920, v19
    ds_read_b64_tr_b16 a[44:45], v30 offset:0
    ds_read_b64_tr_b16 a[46:47], v30 offset:2048
    v_add_u32 v29, 81920, v20
    ds_read_b64_tr_b16 a[68:69], v29 offset:0
    ds_read_b64_tr_b16 a[70:71], v29 offset:2048
    v_add_u32 v30, 81920, v21
    ds_read_b64_tr_b16 a[92:93], v30 offset:0
    ds_read_b64_tr_b16 a[94:95], v30 offset:2048
    s_waitcnt lgkmcnt(6)
    v_add_u32 v29, 81920, v22
    ds_read_b64_tr_b16 a[116:117], v29 offset:0
    ds_read_b64_tr_b16 a[118:119], v29 offset:2048
    v_add_u32 v30, 81920, v23
    ds_read_b64_tr_b16 a[140:141], v30 offset:0
    ds_read_b64_tr_b16 a[142:143], v30 offset:2048
    v_add_u32 v29, 81920, v24
    ds_read_b64_tr_b16 a[164:165], v29 offset:0
    ds_read_b64_tr_b16 a[166:167], v29 offset:2048
    v_add_u32 v30, 81920, v25
    ds_read_b64_tr_b16 a[188:189], v30 offset:0
    ds_read_b64_tr_b16 a[190:191], v30 offset:2048
    s_waitcnt lgkmcnt(6)
    v_add_u32 v29, 81920, v26
    ds_read_b64_tr_b16 a[212:213], v29 offset:0
    ds_read_b64_tr_b16 a[214:215], v29 offset:2048
    v_add_u32 v30, 81920, v27
    ds_read_b64_tr_b16 a[236:237], v30 offset:0
    ds_read_b64_tr_b16 a[238:239], v30 offset:2048
    s_waitcnt lgkmcnt(0)
    s_barrier
    v_mbcnt_lo_u32_b32 v11, -1, 0
    v_mbcnt_hi_u32_b32 v11, -1, v11
    v_lshlrev_b32 v11, 4, v11
    v_mov_b32 v12, -1
    v_mov_b32 v13, -1
    v_mov_b32 v14, -1
    v_mov_b32 v15, -1
    s_lshl_b32 s80, s52, 2
    s_add_u32 s80, s80, s3
    s_lshl_b32 s81, s80, 10
    s_add_u32 s82, s81, 0
    buffer_store_dwordx4 v[12:15], v11, s[36:39], s82 offen offset:0 sc1
    s_add_u32 s82, s81, 131072
    buffer_store_dwordx4 v[12:15], v11, s[36:39], s82 offen offset:0 sc1
    s_add_u32 s82, s81, 262144
    buffer_store_dwordx4 v[12:15], v11, s[36:39], s82 offen offset:0 sc1
    s_add_u32 s82, s81, 393216
    buffer_store_dwordx4 v[12:15], v11, s[36:39], s82 offen offset:0 sc1
    s_add_u32 s82, s81, 524288
    buffer_store_dwordx4 v[12:15], v11, s[36:39], s82 offen offset:0 sc1
    s_add_u32 s82, s81, 655360
    buffer_store_dwordx4 v[12:15], v11, s[36:39], s82 offen offset:0 sc1
    s_add_u32 s82, s81, 1048576
    buffer_store_dwordx4 v[12:15], v11, s[36:39], s82 offen offset:0 sc1
    s_add_u32 s82, s81, 1245184
    buffer_store_dwordx4 v[12:15], v11, s[36:39], s82 offen offset:0 sc1
    s_lshl_b32 s82, s80, 8
    s_add_u32 s82, s82, 1179648
    s_mov_b64 exec, 0xffff
    buffer_store_dwordx4 v[12:15], v11, s[36:39], s82 offen offset:0 sc1
    s_mov_b64 exec, 1
    s_lshl_b32 s81, s80, 7
    s_add_u32 s82, s81, 1441792
    buffer_store_dword v11, v11, s[36:39], s82 offen offset:0 sc1
    s_mov_b64 exec, -1
    s_waitcnt vmcnt(0)
    s_barrier
    s_cmp_lg_u32 s3, 0
    s_cbranch_scc1 L_idn_18
    v_mov_b32 v10, 4
    v_mov_b32 v11, 1
    s_waitcnt vmcnt(0)
    s_mov_b64 exec, 1
    buffer_atomic_add v11, v10, s[48:51], 0 offen sc1
    s_mov_b64 exec, -1
L_idn_18:
    s_waitcnt vmcnt(0)
    s_barrier
    s_cmp_lg_u32 s3, 0
    s_cbranch_scc1 L_cal_19
    s_waitcnt vmcnt(0)
    s_mov_b32 s80, 0xffff
    s_mov_b32 s81, 0xffff
    v_mov_b32 v12, 0
    s_add_u32 s87, s86, 0
    s_memtime s[82:83]
    s_waitcnt lgkmcnt(0)
    buffer_load_dword v13, v12, s[36:39], s87 offen offset:0 sc1
    s_waitcnt vmcnt(0)
    s_memtime s[84:85]
    s_waitcnt lgkmcnt(0)
    s_sub_u32 s82, s84, s82
    s_min_u32 s80, s80, s82
    s_add_u32 s87, s86, 8192
    s_memtime s[82:83]
    s_waitcnt lgkmcnt(0)
    buffer_load_dword v13, v12, s[36:39], s87 offen offset:0 sc1
    s_waitcnt vmcnt(0)
    s_memtime s[84:85]
    s_waitcnt lgkmcnt(0)
    s_sub_u32 s82, s84, s82
    s_min_u32 s81, s81, s82
    s_add_u32 s87, s86, 128
    s_memtime s[82:83]
    s_waitcnt lgkmcnt(0)
    buffer_load_dword v13, v12, s[36:39], s87 offen offset:0 sc1
    s_waitcnt vmcnt(0)
    s_memtime s[84:85]
    s_waitcnt lgkmcnt(0)
    s_sub_u32 s82, s84, s82
    s_min_u32 s80, s80, s82
    s_add_u32 s87, s86, 8320
    s_memtime s[82:83]
    s_waitcnt lgkmcnt(0)
    buffer_load_dword v13, v12, s[36:39], s87 offen offset:0 sc1
    s_waitcnt vmcnt(0)
    s_memtime s[84:85]
    s_waitcnt lgkmcnt(0)
    s_sub_u32 s82, s84, s82
    s_min_u32 s81, s81, s82
    s_sub_u32 s80, 0xffff, s80
    s_sub_u32 s81, 0xffff, s81
    v_mov_b32 v13, s80
    v_mov_b32 v14, s81
    v_mov_b32 v11, 1
    s_mov_b64 exec, 1
    buffer_atomic_umax v13, v12, s[48:51], 0 offen offset:148 sc1
    buffer_atomic_umax v14, v12, s[48:51], 0 offen offset:152 sc1
    s_waitcnt vmcnt(0)
    buffer_atomic_add v11, v12, s[48:51], 0 offen offset:144 sc1
    s_mov_b64 exec, -1
L_cal_19:
    s_barrier
    v_mov_b32 v11, 4
    s_branch L_wi_20_go
L_wi_20:
    s_sleep 4
    s_add_u32 s7, s7, 1
    s_cmp_gt_u32 s7, 400000
    s_cbranch_scc1 L_exit
L_wi_20_go:
    buffer_load_dword v10, v11, s[48:51], 0 offen sc1
    s_waitcnt vmcnt(0)
    v_cmp_gt_u32 vcc, 128, v10
    s_cbranch_vccnz L_wi_20
    s_mov_b32 s6, 0
    s_mov_b32 s67, 0
    s_sub_u32 s66, s65, 128
    s_mul_i32 s59, s52, 12288
    s_mul_i32 s55, s3, 3072
    s_add_u32 s59, s59, s55
    s_add_u32 s59, s59, 73400320
    s_mov_b32 s60, s55
    s_mul_i32 s62, s52, 40960
    s_mul_i32 s55, s3, 10240
    s_add_u32 s62, s62, s55
    s_add_u32 s62, s62, 98566144
    s_mov_b32 s63, 4026531840
    s_mov_b32 s64, 0
    v_mov_b32 v6, v3
    v_add_u32 v7, 8, v3
    v_add_u32 v12, 4096, v4
    v_add_u32 v13, 8192, v4
    s_lshl_b32 s55, s3, 6
    v_add_u32 v15, s55, v2
    v_min_u32 v15, 1, v15
    v_mul_u32_u24 v15, 0xf00000, v15
    v_lshlrev_b32 v15, 8, v15
    s_cmp_gt_u32 s67, s64
    s_cbranch_scc1 L_nv_21
    s_add_u32 s56, s64, 1
    s_min_u32 s56, s56, 64
    s_branch L_wf_22_go
L_wf_22:
    s_sleep 1
    s_add_u32 s7, s7, 1
    s_cmp_gt_u32 s7, 400000
    s_cbranch_scc1 L_exit
L_wf_22_go:
    buffer_load_dword v10, v8, s[36:39], s66 offen offset:0 sc1
    s_waitcnt vmcnt(0)
    v_cmp_gt_u32 vcc, s56, v10
    s_cbranch_vccnz L_wf_22
    v_readfirstlane_b32 s67, v10
L_nv_21:
    s_mov_b32 m0, s60
    s_nop 0
    buffer_load_dwordx4 v3, s[36:39], s59 offen offset:0 sc1 lds
    buffer_load_dwordx4 v3, s[36:39], s59 offen offset:1024 sc1 lds
    buffer_load_dwordx4 v3, s[36:39], s59 offen offset:2048 sc1 lds
    s_add_u32 s59, s59, 393216
    s_add_u32 s64, s64, 1
    s_add_u32 s60, s60, 12288
    s_cmp_ge_u32 s60, 24576
    s_cselect_b32 s55, 24576, 0
    s_sub_u32 s60, s60, s55
    s_waitcnt vmcnt(0)
    s_barrier
    ds_read2st64_b64 v[16:19], v6 offset0:0 offset1:2
    ds_read2st64_b64 v[20:23], v7 offset0:0 offset1:2
    ds_read2st64_b64 v[24:27], v6 offset0:4 offset1:6
    ds_read2st64_b64 v[28:31], v7 offset0:4 offset1:6
    ds_read2st64_b64 v[32:35], v6 offset0:8 offset1:10
    ds_read2st64_b64 v[36:39], v7 offset0:8 offset1:10
    ds_read2st64_b64 v[40:43], v6 offset0:12 offset1:14
    ds_read2st64_b64 v[44:47], v7 offset0:12 offset1:14
    ds_read2st64_b64 v[48:51], v6 offset0:16 offset1:18
    ds_read2st64_b64 v[52:55], v7 offset0:16 offset1:18
    ds_read2st64_b64 v[56:59], v6 offset0:20 offset1:22
    ds_read2st64_b64 v[60:63], v7 offset0:20 offset1:22
    .p2align 6
L_y_loop:
    s_cmp_gt_u32 s67, s64
    s_cbranch_scc1 L_nv_23
    s_add_u32 s56, s64, 1
    s_min_u32 s56, s56, 64
    s_branch L_wf_24_go
L_wf_24:
    s_sleep 1
    s_add_u32 s7, s7, 1
    s_cmp_gt_u32 s7, 400000
    s_cbranch_scc1 L_exit
L_wf_24_go:
    buffer_load_dword v10, v8, s[36:39], s66 offen offset:0 sc1
    s_waitcnt vmcnt(0)
    v_cmp_gt_u32 vcc, s56, v10
    s_cbranch_vccnz L_wf_24
    v_readfirstlane_b32 s67, v10
L_nv_23:
    s_waitcnt lgkmcnt(0)
    v_mfma_f32_16x16x32_bf16 v[112:115], v[16:19], a[0:3], 0
    s_mov_b32 m0, s60
    v_mfma_f32_16x16x32_bf16 v[116:119], v[20:23], a[0:3], 0
    buffer_load_dwordx4 v3, s[36:39], s59 offen offset:0 sc1 lds
    v_mfma_f32_16x16x32_bf16 v[112:115], v[24:27], a[4:7], v[112:115]
    v_mfma_f32_16x16x32_bf16 v[116:119], v[28:31], a[4:7], v[116:119]
    buffer_load_dwordx4 v3, s[36:39], s59 offen offset:1024 sc1 lds
    v_mfma_f32_16x16x32_bf16 v[112:115], v[32:35], a[8:11], v[112:115]
    v_mfma_f32_16x16x32_bf16 v[116:119], v[36:39], a[8:11], v[116:119]
    buffer_load_dwordx4 v3, s[36:39], s59 offen offset:2048 sc1 lds
    v_mfma_f32_16x16x32_bf16 v[112:115], v[40:43], a[12:15], v[112:115]
    buffer_load_dword v11, v8, s[36:39], s66 offen offset:0 sc1
    v_mfma_f32_16x16x32_bf16 v[116:119], v[44:47], a[12:15], v[116:119]
    v_cvt_pk_bf16_f32 v132, v120, v121
    v_mfma_f32_16x16x32_bf16 v[112:115], v[48:51], a[16:19], v[112:115]
    v_cvt_pk_bf16_f32 v133, v122, v123
    v_mfma_f32_16x16x32_bf16 v[116:119], v[52:55], a[16:19], v[116:119]
    v_cvt_pk_bf16_f32 v134, v124, v125
    v_mfma_f32_16x16x32_bf16 v[112:115], v[56:59], a[20:23], v[112:115]
    v_cvt_pk_bf16_f32 v135, v126, v127
    v_mfma_f32_16x16x32_bf16 v[116:119], v[60:63], a[20:23], v[116:119]
    buffer_store_dwordx4 v[132:135], v13, s[36:39], s63 offen offset:1024 sc1
    v_mfma_f32_16x16x32_bf16 v[120:123], v[16:19], a[24:27], 0
    s_add_u32 s59, s59, 393216
    v_mfma_f32_16x16x32_bf16 v[124:127], v[20:23], a[24:27], 0
    s_add_u32 s64, s64, 1
    v_mfma_f32_16x16x32_bf16 v[120:123], v[24:27], a[28:31], v[120:123]
    s_add_u32 s60, s60, 12288
    v_mfma_f32_16x16x32_bf16 v[124:127], v[28:31], a[28:31], v[124:127]
    s_cmp_ge_u32 s60, 24576
    s_cselect_b32 s55, 24576, 0
    v_mfma_f32_16x16x32_bf16 v[120:123], v[32:35], a[32:35], v[120:123]
    s_sub_u32 s60, s60, s55
    v_mfma_f32_16x16x32_bf16 v[124:127], v[36:39], a[32:35], v[124:127]
    v_mfma_f32_16x16x32_bf16 v[120:123], v[40:43], a[36:39], v[120:123]
    v_mfma_f32_16x16x32_bf16 v[124:127], v[44:47], a[36:39], v[124:127]
    v_cvt_pk_bf16_f32 v128, v112, v113
    v_mfma_f32_16x16x32_bf16 v[120:123], v[48:51], a[40:43], v[120:123]
    v_cvt_pk_bf16_f32 v129, v114, v115
    v_mfma_f32_16x16x32_bf16 v[124:127], v[52:55], a[40:43], v[124:127]
    v_cvt_pk_bf16_f32 v130, v116, v117
    v_mfma_f32_16x16x32_bf16 v[120:123], v[56:59], a[44:47], v[120:123]
    v_cvt_pk_bf16_f32 v131, v118, v119
    v_mfma_f32_16x16x32_bf16 v[124:127], v[60:63], a[44:47], v[124:127]
    buffer_store_dwordx4 v[128:131], v4, s[36:39], s62 offen offset:0 sc1
    v_mfma_f32_16x16x32_bf16 v[112:115], v[16:19], a[48:51], 0
    v_mfma_f32_16x16x32_bf16 v[116:119], v[20:23], a[48:51], 0
    v_mfma_f32_16x16x32_bf16 v[112:115], v[24:27], a[52:55], v[112:115]
    v_mfma_f32_16x16x32_bf16 v[116:119], v[28:31], a[52:55], v[116:119]
    v_mfma_f32_16x16x32_bf16 v[112:115], v[32:35], a[56:59], v[112:115]
    v_mfma_f32_16x16x32_bf16 v[116:119], v[36:39], a[56:59], v[116:119]
    v_mfma_f32_16x16x32_bf16 v[112:115], v[40:43], a[60:63], v[112:115]
    v_mfma_f32_16x16x32_bf16 v[116:119], v[44:47], a[60:63], v[116:119]
    v_cvt_pk_bf16_f32 v132, v120, v121
    v_mfma_f32_16x16x32_bf16 v[112:115], v[48:51], a[64:67], v[112:115]
    v_cvt_pk_bf16_f32 v133, v122, v123
    v_mfma_f32_16x16x32_bf16 v[116:119], v[52:55], a[64:67], v[116:119]
    v_cvt_pk_bf16_f32 v134, v124, v125
    v_mfma_f32_16x16x32_bf16 v[112:115], v[56:59], a[68:71], v[112:115]
    v_cvt_pk_bf16_f32 v135, v126, v127
    v_mfma_f32_16x16x32_bf16 v[116:119], v[60:63], a[68:71], v[116:119]
    buffer_store_dwordx4 v[132:135], v4, s[36:39], s62 offen offset:1024 sc1
    v_mfma_f32_16x16x32_bf16 v[120:123], v[16:19], a[72:75], 0
    v_mfma_f32_16x16x32_bf16 v[124:127], v[20:23], a[72:75], 0
    v_mfma_f32_16x16x32_bf16 v[120:123], v[24:27], a[76:79], v[120:123]
    v_mfma_f32_16x16x32_bf16 v[124:127], v[28:31], a[76:79], v[124:127]
    v_mfma_f32_16x16x32_bf16 v[120:123], v[32:35], a[80:83], v[120:123]
    v_mfma_f32_16x16x32_bf16 v[124:127], v[36:39], a[80:83], v[124:127]
    v_mfma_f32_16x16x32_bf16 v[120:123], v[40:43], a[84:87], v[120:123]
    v_mfma_f32_16x16x32_bf16 v[124:127], v[44:47], a[84:87], v[124:127]
    v_cvt_pk_bf16_f32 v128, v112, v113
    v_mfma_f32_16x16x32_bf16 v[120:123], v[48:51], a[88:91], v[120:123]
    v_cvt_pk_bf16_f32 v129, v114, v115
    v_mfma_f32_16x16x32_bf16 v[124:127], v[52:55], a[88:91], v[124:127]
    v_cvt_pk_bf16_f32 v130, v116, v117
    v_mfma_f32_16x16x32_bf16 v[120:123], v[56:59], a[92:95], v[120:123]
    v_cvt_pk_bf16_f32 v131, v118, v119
    v_mfma_f32_16x16x32_bf16 v[124:127], v[60:63], a[92:95], v[124:127]
    buffer_store_dwordx4 v[128:131], v4, s[36:39], s62 offen offset:2048 sc1
    v_mfma_f32_16x16x32_bf16 v[112:115], v[16:19], a[96:99], 0
    v_mfma_f32_16x16x32_bf16 v[116:119], v[20:23], a[96:99], 0
    v_mfma_f32_16x16x32_bf16 v[112:115], v[24:27], a[100:103], v[112:115]
    v_mfma_f32_16x16x32_bf16 v[116:119], v[28:31], a[100:103], v[116:119]
    v_mfma_f32_16x16x32_bf16 v[112:115], v[32:35], a[104:107], v[112:115]
    v_mfma_f32_16x16x32_bf16 v[116:119], v[36:39], a[104:107], v[116:119]
    v_mfma_f32_16x16x32_bf16 v[112:115], v[40:43], a[108:111], v[112:115]
    v_mfma_f32_16x16x32_bf16 v[116:119], v[44:47], a[108:111], v[116:119]
    v_cvt_pk_bf16_f32 v132, v120, v121
    v_mfma_f32_16x16x32_bf16 v[112:115], v[48:51], a[112:115], v[112:115]
    v_cvt_pk_bf16_f32 v133, v122, v123
    v_mfma_f32_16x16x32_bf16 v[116:119], v[52:55], a[112:115], v[116:119]
    v_cvt_pk_bf16_f32 v134, v124, v125
    v_mfma_f32_16x16x32_bf16 v[112:115], v[56:59], a[116:119], v[112:115]
    v_cvt_pk_bf16_f32 v135, v126, v127
    v_mfma_f32_16x16x32_bf16 v[116:119], v[60:63], a[116:119], v[116:119]
    buffer_store_dwordx4 v[132:135], v4, s[36:39], s62 offen offset:3072 sc1
    v_mfma_f32_16x16x32_bf16 v[120:123], v[16:19], a[120:123], 0
    v_mfma_f32_16x16x32_bf16 v[124:127], v[20:23], a[120:123], 0
    v_mfma_f32_16x16x32_bf16 v[120:123], v[24:27], a[124:127], v[120:123]
    v_mfma_f32_16x16x32_bf16 v[124:127], v[28:31], a[124:127], v[124:127]
    v_mfma_f32_16x16x32_bf16 v[120:123], v[32:35], a[128:131], v[120:123]
    v_mfma_f32_16x16x32_bf16 v[124:127], v[36:39], a[128:131], v[124:127]
    v_mfma_f32_16x16x32_bf16 v[120:123], v[40:43], a[132:135], v[120:123]
    v_mfma_f32_16x16x32_bf16 v[124:127], v[44:47], a[132:135], v[124:127]
    v_cvt_pk_bf16_f32 v128, v112, v113
    v_mfma_f32_16x16x32_bf16 v[120:123], v[48:51], a[136:139], v[120:123]
    v_cvt_pk_bf16_f32 v129, v114, v115
    v_mfma_f32_16x16x32_bf16 v[124:127], v[52:55], a[136:139], v[124:127]
    v_cvt_pk_bf16_f32 v130, v116, v117
    v_mfma_f32_16x16x32_bf16 v[120:123], v[56:59], a[140:143], v[120:123]
    v_cvt_pk_bf16_f32 v131, v118, v119
    v_mfma_f32_16x16x32_bf16 v[124:127], v[60:63], a[140:143], v[124:127]
    buffer_store_dwordx4 v[128:131], v12, s[36:39], s62 offen offset:0 sc1
    s_waitcnt vmcnt(5)
    s_barrier
    v_mfma_f32_16x16x32_bf16 v[112:115], v[16:19], a[144:147], 0
    ds_read2st64_b64 v[64:67], v6 offset0:24 offset1:26
    v_mfma_f32_16x16x32_bf16 v[116:119], v[20:23], a[144:147], 0
    v_mfma_f32_16x16x32_bf16 v[112:115], v[24:27], a[148:151], v[112:115]
    v_mfma_f32_16x16x32_bf16 v[116:119], v[28:31], a[148:151], v[116:119]
    ds_read2st64_b64 v[68:71], v7 offset0:24 offset1:26
    v_mfma_f32_16x16x32_bf16 v[112:115], v[32:35], a[152:155], v[112:115]
    v_mfma_f32_16x16x32_bf16 v[116:119], v[36:39], a[152:155], v[116:119]
    v_readfirstlane_b32 s67, v11
    v_mfma_f32_16x16x32_bf16 v[112:115], v[40:43], a[156:159], v[112:115]
    ds_read2st64_b64 v[72:75], v6 offset0:28 offset1:30
    v_mfma_f32_16x16x32_bf16 v[116:119], v[44:47], a[156:159], v[116:119]
    v_cvt_pk_bf16_f32 v132, v120, v121
    v_mfma_f32_16x16x32_bf16 v[112:115], v[48:51], a[160:163], v[112:115]
    v_cvt_pk_bf16_f32 v133, v122, v123
    v_mfma_f32_16x16x32_bf16 v[116:119], v[52:55], a[160:163], v[116:119]
    v_cvt_pk_bf16_f32 v134, v124, v125
    v_mfma_f32_16x16x32_bf16 v[112:115], v[56:59], a[164:167], v[112:115]
    v_cvt_pk_bf16_f32 v135, v126, v127
    v_mfma_f32_16x16x32_bf16 v[116:119], v[60:63], a[164:167], v[116:119]
    buffer_store_dwordx4 v[132:135], v12, s[36:39], s62 offen offset:1024 sc1
    v_mfma_f32_16x16x32_bf16 v[120:123], v[16:19], a[168:171], 0
    ds_read2st64_b64 v[76:79], v7 offset0:28 offset1:30
    v_mfma_f32_16x16x32_bf16 v[124:127], v[20:23], a[168:171], 0
    v_mov_b32 v14, s6
    v_mfma_f32_16x16x32_bf16 v[120:123], v[24:27], a[172:175], v[120:123]
    v_mfma_f32_16x16x32_bf16 v[124:127], v[28:31], a[172:175], v[124:127]
    ds_read2st64_b64 v[80:83], v6 offset0:32 offset1:34
    v_mfma_f32_16x16x32_bf16 v[120:123], v[32:35], a[176:179], v[120:123]
    buffer_store_dword v14, v15, s[36:39], s65 offen offset:0 sc1
    v_mfma_f32_16x16x32_bf16 v[124:127], v[36:39], a[176:179], v[124:127]
    v_mfma_f32_16x16x32_bf16 v[120:123], v[40:43], a[180:183], v[120:123]
    ds_read2st64_b64 v[84:87], v7 offset0:32 offset1:34
    v_mfma_f32_16x16x32_bf16 v[124:127], v[44:47], a[180:183], v[124:127]
    v_cvt_pk_bf16_f32 v128, v112, v113
    v_mfma_f32_16x16x32_bf16 v[120:123], v[48:51], a[184:187], v[120:123]
    v_cvt_pk_bf16_f32 v129, v114, v115
    v_mfma_f32_16x16x32_bf16 v[124:127], v[52:55], a[184:187], v[124:127]
    v_cvt_pk_bf16_f32 v130, v116, v117
    v_mfma_f32_16x16x32_bf16 v[120:123], v[56:59], a[188:191], v[120:123]
    v_cvt_pk_bf16_f32 v131, v118, v119
    v_mfma_f32_16x16x32_bf16 v[124:127], v[60:63], a[188:191], v[124:127]
    buffer_store_dwordx4 v[128:131], v12, s[36:39], s62 offen offset:2048 sc1
    v_mfma_f32_16x16x32_bf16 v[112:115], v[16:19], a[192:195], 0
    ds_read2st64_b64 v[88:91], v6 offset0:36 offset1:38
    v_mfma_f32_16x16x32_bf16 v[116:119], v[20:23], a[192:195], 0
    v_mfma_f32_16x16x32_bf16 v[112:115], v[24:27], a[196:199], v[112:115]
    v_mfma_f32_16x16x32_bf16 v[116:119], v[28:31], a[196:199], v[116:119]
    ds_read2st64_b64 v[92:95], v7 offset0:36 offset1:38
    v_mfma_f32_16x16x32_bf16 v[112:115], v[32:35], a[200:203], v[112:115]
    v_mfma_f32_16x16x32_bf16 v[116:119], v[36:39], a[200:203], v[116:119]
    v_mfma_f32_16x16x32_bf16 v[112:115], v[40:43], a[204:207], v[112:115]
    ds_read2st64_b64 v[96:99], v6 offset0:40 offset1:42
    v_mfma_f32_16x16x32_bf16 v[116:119], v[44:47], a[204:207], v[116:119]
    v_cvt_pk_bf16_f32 v132, v120, v121
    v_mfma_f32_16x16x32_bf16 v[112:115], v[48:51], a[208:211], v[112:115]
    v_cvt_pk_bf16_f32 v133, v122, v123
    v_mfma_f32_16x16x32_bf16 v[116:119], v[52:55], a[208:211], v[116:119]
    v_cvt_pk_bf16_f32 v134, v124, v125
    v_mfma_f32_16x16x32_bf16 v[112:115], v[56:59], a[212:215], v[112:115]
    v_cvt_pk_bf16_f32 v135, v126, v127
    v_mfma_f32_16x16x32_bf16 v[116:119], v[60:63], a[212:215], v[116:119]
    buffer_store_dwordx4 v[132:135], v12, s[36:39], s62 offen offset:3072 sc1
    v_mfma_f32_16x16x32_bf16 v[120:123], v[16:19], a[216:219], 0
    ds_read2st64_b64 v[100:103], v7 offset0:40 offset1:42
    v_mfma_f32_16x16x32_bf16 v[124:127], v[20:23], a[216:219], 0
    s_add_u32 s6, s6, 1
    v_mfma_f32_16x16x32_bf16 v[120:123], v[24:27], a[220:223], v[120:123]
    v_mfma_f32_16x16x32_bf16 v[124:127], v[28:31], a[220:223], v[124:127]
    ds_read2st64_b64 v[104:107], v6 offset0:44 offset1:46
    v_mfma_f32_16x16x32_bf16 v[120:123], v[32:35], a[224:227], v[120:123]
    v_mfma_f32_16x16x32_bf16 v[124:127], v[36:39], a[224:227], v[124:127]
    v_mfma_f32_16x16x32_bf16 v[120:123], v[40:43], a[228:231], v[120:123]
    ds_read2st64_b64 v[108:111], v7 offset0:44 offset1:46
    v_mfma_f32_16x16x32_bf16 v[124:127], v[44:47], a[228:231], v[124:127]
    v_cvt_pk_bf16_f32 v128, v112, v113
    v_mfma_f32_16x16x32_bf16 v[120:123], v[48:51], a[232:235], v[120:123]
    v_cvt_pk_bf16_f32 v129, v114, v115
    v_mfma_f32_16x16x32_bf16 v[124:127], v[52:55], a[232:235], v[124:127]
    v_cvt_pk_bf16_f32 v130, v116, v117
    v_mfma_f32_16x16x32_bf16 v[120:123], v[56:59], a[236:239], v[120:123]
    v_cvt_pk_bf16_f32 v131, v118, v119
    v_mfma_f32_16x16x32_bf16 v[124:127], v[60:63], a[236:239], v[124:127]
    buffer_store_dwordx4 v[128:131], v13, s[36:39], s62 offen offset:0 sc1
    s_mov_b32 s63, s62
    s_add_u32 s62, s62, 1310720
    s_cmp_gt_u32 s67, s64
    s_cbranch_scc1 L_nv_25
    s_add_u32 s56, s64, 1
    s_min_u32 s56, s56, 64
    s_branch L_wf_26_go
L_wf_26:
    s_sleep 1
    s_add_u32 s7, s7, 1
    s_cmp_gt_u32 s7, 400000
    s_cbranch_scc1 L_exit
L_wf_26_go:
    buffer_load_dword v10, v8, s[36:39], s66 offen offset:0 sc1
    s_waitcnt vmcnt(0)
    v_cmp_gt_u32 vcc, s56, v10
    s_cbranch_vccnz L_wf_26
    v_readfirstlane_b32 s67, v10
L_nv_25:
    s_waitcnt lgkmcnt(0)
    v_mfma_f32_16x16x32_bf16 v[112:115], v[64:67], a[0:3], 0
    s_mov_b32 m0, s60
    v_mfma_f32_16x16x32_bf16 v[116:119], v[68:71], a[0:3], 0
    buffer_load_dwordx4 v3, s[36:39], s59 offen offset:0 sc1 lds
    v_mfma_f32_16x16x32_bf16 v[112:115], v[72:75], a[4:7], v[112:115]
    v_mfma_f32_16x16x32_bf16 v[116:119], v[76:79], a[4:7], v[116:119]
    buffer_load_dwordx4 v3, s[36:39], s59 offen offset:1024 sc1 lds
    v_mfma_f32_16x16x32_bf16 v[112:115], v[80:83], a[8:11], v[112:115]
    v_mfma_f32_16x16x32_bf16 v[116:119], v[84:87], a[8:11], v[116:119]
    buffer_load_dwordx4 v3, s[36:39], s59 offen offset:2048 sc1 lds
    v_mfma_f32_16x16x32_bf16 v[112:115], v[88:91], a[12:15], v[112:115]
    buffer_load_dword v11, v8, s[36:39], s66 offen offset:0 sc1
    v_mfma_f32_16x16x32_bf16 v[116:119], v[92:95], a[12:15], v[116:119]
    v_cvt_pk_bf16_f32 v132, v120, v121
    v_mfma_f32_16x16x32_bf16 v[112:115], v[96:99], a[16:19], v[112:115]
    v_cvt_pk_bf16_f32 v133, v122, v123
    v_mfma_f32_16x16x32_bf16 v[116:119], v[100:103], a[16:19], v[116:119]
    v_cvt_pk_bf16_f32 v134, v124, v125
    v_mfma_f32_16x16x32_bf16 v[112:115], v[104:107], a[20:23], v[112:115]
    v_cvt_pk_bf16_f32 v135, v126, v127
    v_mfma_f32_16x16x32_bf16 v[116:119], v[108:111], a[20:23], v[116:119]
    buffer_store_dwordx4 v[132:135], v13, s[36:39], s63 offen offset:1024 sc1
    v_mfma_f32_16x16x32_bf16 v[120:123], v[64:67], a[24:27], 0
    s_add_u32 s59, s59, 393216
    v_mfma_f32_16x16x32_bf16 v[124:127], v[68:71], a[24:27], 0
    s_add_u32 s64, s64, 1
    v_mfma_f32_16x16x32_bf16 v[120:123], v[72:75], a[28:31], v[120:123]
    s_add_u32 s60, s60, 12288
    v_mfma_f32_16x16x32_bf16 v[124:127], v[76:79], a[28:31], v[124:127]
    s_cmp_ge_u32 s60, 24576
    s_cselect_b32 s55, 24576, 0
    v_mfma_f32_16x16x32_bf16 v[120:123], v[80:83], a[32:35], v[120:123]
    s_sub_u32 s60, s60, s55
    v_mfma_f32_16x16x32_bf16 v[124:127], v[84:87], a[32:35], v[124:127]
    v_mfma_f32_16x16x32_bf16 v[120:123], v[88:91], a[36:39], v[120:123]
    v_mfma_f32_16x16x32_bf16 v[124:127], v[92:95], a[36:39], v[124:127]
    v_cvt_pk_bf16_f32 v128, v112, v113
    v_mfma_f32_16x16x32_bf16 v[120:123], v[96:99], a[40:43], v[120:123]
    v_cvt_pk_bf16_f32 v129, v114, v115
    v_mfma_f32_16x16x32_bf16 v[124:127], v[100:103], a[40:43], v[124:127]
    v_cvt_pk_bf16_f32 v130, v116, v117
    v_mfma_f32_16x16x32_bf16 v[120:123], v[104:107], a[44:47], v[120:123]
    v_cvt_pk_bf16_f32 v131, v118, v119
    v_mfma_f32_16x16x32_bf16 v[124:127], v[108:111], a[44:47], v[124:127]
    buffer_store_dwordx4 v[128:131], v4, s[36:39], s62 offen offset:0 sc1
    v_mfma_f32_16x16x32_bf16 v[112:115], v[64:67], a[48:51], 0
    v_mfma_f32_16x16x32_bf16 v[116:119], v[68:71], a[48:51], 0
    v_mfma_f32_16x16x32_bf16 v[112:115], v[72:75], a[52:55], v[112:115]
    v_mfma_f32_16x16x32_bf16 v[116:119], v[76:79], a[52:55], v[116:119]
    v_mfma_f32_16x16x32_bf16 v[112:115], v[80:83], a[56:59], v[112:115]
    v_mfma_f32_16x16x32_bf16 v[116:119], v[84:87], a[56:59], v[116:119]
    v_mfma_f32_16x16x32_bf16 v[112:115], v[88:91], a[60:63], v[112:115]
    v_mfma_f32_16x16x32_bf16 v[116:119], v[92:95], a[60:63], v[116:119]
    v_cvt_pk_bf16_f32 v132, v120, v121
    v_mfma_f32_16x16x32_bf16 v[112:115], v[96:99], a[64:67], v[112:115]
    v_cvt_pk_bf16_f32 v133, v122, v123
    v_mfma_f32_16x16x32_bf16 v[116:119], v[100:103], a[64:67], v[116:119]
    v_cvt_pk_bf16_f32 v134, v124, v125
    v_mfma_f32_16x16x32_bf16 v[112:115], v[104:107], a[68:71], v[112:115]
    v_cvt_pk_bf16_f32 v135, v126, v127
    v_mfma_f32_16x16x32_bf16 v[116:119], v[108:111], a[68:71], v[116:119]
    buffer_store_dwordx4 v[132:135], v4, s[36:39], s62 offen offset:1024 sc1
    v_mfma_f32_16x16x32_bf16 v[120:123], v[64:67], a[72:75], 0
    v_mfma_f32_16x16x32_bf16 v[124:127], v[68:71], a[72:75], 0
    v_mfma_f32_16x16x32_bf16 v[120:123], v[72:75], a[76:79], v[120:123]
    v_mfma_f32_16x16x32_bf16 v[124:127], v[76:79], a[76:79], v[124:127]
    v_mfma_f32_16x16x32_bf16 v[120:123], v[80:83], a[80:83], v[120:123]
    v_mfma_f32_16x16x32_bf16 v[124:127], v[84:87], a[80:83], v[124:127]
    v_mfma_f32_16x16x32_bf16 v[120:123], v[88:91], a[84:87], v[120:123]
    v_mfma_f32_16x16x32_bf16 v[124:127], v[92:95], a[84:87], v[124:127]
    v_cvt_pk_bf16_f32 v128, v112, v113
    v_mfma_f32_16x16x32_bf16 v[120:123], v[96:99], a[88:91], v[120:123]
    v_cvt_pk_bf16_f32 v129, v114, v115
    v_mfma_f32_16x16x32_bf16 v[124:127], v[100:103], a[88:91], v[124:127]
    v_cvt_pk_bf16_f32 v130, v116, v117
    v_mfma_f32_16x16x32_bf16 v[120:123], v[104:107], a[92:95], v[120:123]
    v_cvt_pk_bf16_f32 v131, v118, v119
    v_mfma_f32_16x16x32_bf16 v[124:127], v[108:111], a[92:95], v[124:127]
    buffer_store_dwordx4 v[128:131], v4, s[36:39], s62 offen offset:2048 sc1
    v_mfma_f32_16x16x32_bf16 v[112:115], v[64:67], a[96:99], 0
    v_mfma_f32_16x16x32_bf16 v[116:119], v[68:71], a[96:99], 0
    v_mfma_f32_16x16x32_bf16 v[112:115], v[72:75], a[100:103], v[112:115]
    v_mfma_f32_16x16x32_bf16 v[116:119], v[76:79], a[100:103], v[116:119]
    v_mfma_f32_16x16x32_bf16 v[112:115], v[80:83], a[104:107], v[112:115]
    v_mfma_f32_16x16x32_bf16 v[116:119], v[84:87], a[104:107], v[116:119]
    v_mfma_f32_16x16x32_bf16 v[112:115], v[88:91], a[108:111], v[112:115]
    v_mfma_f32_16x16x32_bf16 v[116:119], v[92:95], a[108:111], v[116:119]
    v_cvt_pk_bf16_f32 v132, v120, v121
    v_mfma_f32_16x16x32_bf16 v[112:115], v[96:99], a[112:115], v[112:115]
    v_cvt_pk_bf16_f32 v133, v122, v123
    v_mfma_f32_16x16x32_bf16 v[116:119], v[100:103], a[112:115], v[116:119]
    v_cvt_pk_bf16_f32 v134, v124, v125
    v_mfma_f32_16x16x32_bf16 v[112:115], v[104:107], a[116:119], v[112:115]
    v_cvt_pk_bf16_f32 v135, v126, v127
    v_mfma_f32_16x16x32_bf16 v[116:119], v[108:111], a[116:119], v[116:119]
    buffer_store_dwordx4 v[132:135], v4, s[36:39], s62 offen offset:3072 sc1
    v_mfma_f32_16x16x32_bf16 v[120:123], v[64:67], a[120:123], 0
    v_mfma_f32_16x16x32_bf16 v[124:127], v[68:71], a[120:123], 0
    v_mfma_f32_16x16x32_bf16 v[120:123], v[72:75], a[124:127], v[120:123]
    v_mfma_f32_16x16x32_bf16 v[124:127], v[76:79], a[124:127], v[124:127]
    v_mfma_f32_16x16x32_bf16 v[120:123], v[80:83], a[128:131], v[120:123]
    v_mfma_f32_16x16x32_bf16 v[124:127], v[84:87], a[128:131], v[124:127]
    v_mfma_f32_16x16x32_bf16 v[120:123], v[88:91], a[132:135], v[120:123]
    v_mfma_f32_16x16x32_bf16 v[124:127], v[92:95], a[132:135], v[124:127]
    v_cvt_pk_bf16_f32 v128, v112, v113
    v_mfma_f32_16x16x32_bf16 v[120:123], v[96:99], a[136:139], v[120:123]
    v_cvt_pk_bf16_f32 v129, v114, v115
    v_mfma_f32_16x16x32_bf16 v[124:127], v[100:103], a[136:139], v[124:127]
    v_cvt_pk_bf16_f32 v130, v116, v117
    v_mfma_f32_16x16x32_bf16 v[120:123], v[104:107], a[140:143], v[120:123]
    v_cvt_pk_bf16_f32 v131, v118, v119
    v_mfma_f32_16x16x32_bf16 v[124:127], v[108:111], a[140:143], v[124:127]
    buffer_store_dwordx4 v[128:131], v12, s[36:39], s62 offen offset:0 sc1
    s_waitcnt vmcnt(5)
    s_barrier
    v_mfma_f32_16x16x32_bf16 v[112:115], v[64:67], a[144:147], 0
    ds_read2st64_b64 v[16:19], v6 offset0:0 offset1:2
    v_mfma_f32_16x16x32_bf16 v[116:119], v[68:71], a[144:147], 0
    v_mfma_f32_16x16x32_bf16 v[112:115], v[72:75], a[148:151], v[112:115]
    v_mfma_f32_16x16x32_bf16 v[116:119], v[76:79], a[148:151], v[116:119]
    ds_read2st64_b64 v[20:23], v7 offset0:0 offset1:2
    v_mfma_f32_16x16x32_bf16 v[112:115], v[80:83], a[152:155], v[112:115]
    v_mfma_f32_16x16x32_bf16 v[116:119], v[84:87], a[152:155], v[116:119]
    v_readfirstlane_b32 s67, v11
    v_mfma_f32_16x16x32_bf16 v[112:115], v[88:91], a[156:159], v[112:115]
    ds_read2st64_b64 v[24:27], v6 offset0:4 offset1:6
    v_mfma_f32_16x16x32_bf16 v[116:119], v[92:95], a[156:159], v[116:119]
    v_cvt_pk_bf16_f32 v132, v120, v121
    v_mfma_f32_16x16x32_bf16 v[112:115], v[96:99], a[160:163], v[112:115]
    v_cvt_pk_bf16_f32 v133, v122, v123
    v_mfma_f32_16x16x32_bf16 v[116:119], v[100:103], a[160:163], v[116:119]
    v_cvt_pk_bf16_f32 v134, v124, v125
    v_mfma_f32_16x16x32_bf16 v[112:115], v[104:107], a[164:167], v[112:115]
    v_cvt_pk_bf16_f32 v135, v126, v127
    v_mfma_f32_16x16x32_bf16 v[116:119], v[108:111], a[164:167], v[116:119]
    buffer_store_dwordx4 v[132:135], v12, s[36:39], s62 offen offset:1024 sc1
    v_mfma_f32_16x16x32_bf16 v[120:123], v[64:67], a[168:171], 0
    ds_read2st64_b64 v[28:31], v7 offset0:4 offset1:6
    v_mfma_f32_16x16x32_bf16 v[124:127], v[68:71], a[168:171], 0
    v_mov_b32 v14, s6
    v_mfma_f32_16x16x32_bf16 v[120:123], v[72:75], a[172:175], v[120:123]
    v_mfma_f32_16x16x32_bf16 v[124:127], v[76:79], a[172:175], v[124:127]
    ds_read2st64_b64 v[32:35], v6 offset0:8 offset1:10
    v_mfma_f32_16x16x32_bf16 v[120:123], v[80:83], a[176:179], v[120:123]
    buffer_store_dword v14, v15, s[36:39], s65 offen offset:0 sc1
    v_mfma_f32_16x16x32_bf16 v[124:127], v[84:87], a[176:179], v[124:127]
    v_mfma_f32_16x16x32_bf16 v[120:123], v[88:91], a[180:183], v[120:123]
    ds_read2st64_b64 v[36:39], v7 offset0:8 offset1:10
    v_mfma_f32_16x16x32_bf16 v[124:127], v[92:95], a[180:183], v[124:127]
    v_cvt_pk_bf16_f32 v128, v112, v113
    v_mfma_f32_16x16x32_bf16 v[120:123], v[96:99], a[184:187], v[120:123]
    v_cvt_pk_bf16_f32 v129, v114, v115
    v_mfma_f32_16x16x32_bf16 v[124:127], v[100:103], a[184:187], v[124:127]
    v_cvt_pk_bf16_f32 v130, v116, v117
    v_mfma_f32_16x16x32_bf16 v[120:123], v[104:107], a[188:191], v[120:123]
    v_cvt_pk_bf16_f32 v131, v118, v119
    v_mfma_f32_16x16x32_bf16 v[124:127], v[108:111], a[188:191], v[124:127]
    buffer_store_dwordx4 v[128:131], v12, s[36:39], s62 offen offset:2048 sc1
    v_mfma_f32_16x16x32_bf16 v[112:115], v[64:67], a[192:195], 0
    ds_read2st64_b64 v[40:43], v6 offset0:12 offset1:14
    v_mfma_f32_16x16x32_bf16 v[116:119], v[68:71], a[192:195], 0
    v_mfma_f32_16x16x32_bf16 v[112:115], v[72:75], a[196:199], v[112:115]
    v_mfma_f32_16x16x32_bf16 v[116:119], v[76:79], a[196:199], v[116:119]
    ds_read2st64_b64 v[44:47], v7 offset0:12 offset1:14
    v_mfma_f32_16x16x32_bf16 v[112:115], v[80:83], a[200:203], v[112:115]
    v_mfma_f32_16x16x32_bf16 v[116:119], v[84:87], a[200:203], v[116:119]
    v_mfma_f32_16x16x32_bf16 v[112:115], v[88:91], a[204:207], v[112:115]
    ds_read2st64_b64 v[48:51], v6 offset0:16 offset1:18
    v_mfma_f32_16x16x32_bf16 v[116:119], v[92:95], a[204:207], v[116:119]
    v_cvt_pk_bf16_f32 v132, v120, v121
    v_mfma_f32_16x16x32_bf16 v[112:115], v[96:99], a[208:211], v[112:115]
    v_cvt_pk_bf16_f32 v133, v122, v123
    v_mfma_f32_16x16x32_bf16 v[116:119], v[100:103], a[208:211], v[116:119]
    v_cvt_pk_bf16_f32 v134, v124, v125
    v_mfma_f32_16x16x32_bf16 v[112:115], v[104:107], a[212:215], v[112:115]
    v_cvt_pk_bf16_f32 v135, v126, v127
    v_mfma_f32_16x16x32_bf16 v[116:119], v[108:111], a[212:215], v[116:119]
    buffer_store_dwordx4 v[132:135], v12, s[36:39], s62 offen offset:3072 sc1
    v_mfma_f32_16x16x32_bf16 v[120:123], v[64:67], a[216:219], 0
    ds_read2st64_b64 v[52:55], v7 offset0:16 offset1:18
    v_mfma_f32_16x16x32_bf16 v[124:127], v[68:71], a[216:219], 0
    s_add_u32 s6, s6, 1
    v_mfma_f32_16x16x32_bf16 v[120:123], v[72:75], a[220:223], v[120:123]
    v_mfma_f32_16x16x32_bf16 v[124:127], v[76:79], a[220:223], v[124:127]
    ds_read2st64_b64 v[56:59], v6 offset0:20 offset1:22
    v_mfma_f32_16x16x32_bf16 v[120:123], v[80:83], a[224:227], v[120:123]
    v_mfma_f32_16x16x32_bf16 v[124:127], v[84:87], a[224:227], v[124:127]
    v_mfma_f32_16x16x32_bf16 v[120:123], v[88:91], a[228:231], v[120:123]
    ds_read2st64_b64 v[60:63], v7 offset0:20 offset1:22
    v_mfma_f32_16x16x32_bf16 v[124:127], v[92:95], a[228:231], v[124:127]
    v_cvt_pk_bf16_f32 v128, v112, v113
    v_mfma_f32_16x16x32_bf16 v[120:123], v[96:99], a[232:235], v[120:123]
    v_cvt_pk_bf16_f32 v129, v114, v115
    v_mfma_f32_16x16x32_bf16 v[124:127], v[100:103], a[232:235], v[124:127]
    v_cvt_pk_bf16_f32 v130, v116, v117
    v_mfma_f32_16x16x32_bf16 v[120:123], v[104:107], a[236:239], v[120:123]
    v_cvt_pk_bf16_f32 v131, v118, v119
    v_mfma_f32_16x16x32_bf16 v[124:127], v[108:111], a[236:239], v[124:127]
    buffer_store_dwordx4 v[128:131], v13, s[36:39], s62 offen offset:0 sc1
    s_mov_b32 s63, s62
    s_add_u32 s62, s62, 1310720
    s_cmp_lt_u32 s6, 64
    s_cbranch_scc1 L_y_loop
    s_nop 7
    v_cvt_pk_bf16_f32 v132, v120, v121
    v_cvt_pk_bf16_f32 v133, v122, v123
    v_cvt_pk_bf16_f32 v134, v124, v125
    v_cvt_pk_bf16_f32 v135, v126, v127
    buffer_store_dwordx4 v[132:135], v13, s[36:39], s63 offen offset:1024 sc1
    s_waitcnt vmcnt(0) lgkmcnt(0)
    s_barrier
    s_cmp_lg_u32 s3, 0
    s_cbranch_scc1 L_sf_27
    v_mov_b32 v10, 64
    s_mov_b64 exec, 1
    buffer_store_dword v10, v8, s[36:39], s65 offen offset:0 sc1
    s_mov_b64 exec, -1
L_sf_27:
    s_branch L_tofinal
L_alpha:
    s_and_b32 s55, s52, 1
    s_lshl_b32 s6, s55, 5
    s_bitcmp1_b32 s5, 0
    s_cselect_b32 s55, 0, 18
    s_cselect_b32 s56, 18, 32
    s_add_u32 s64, s6, s56
    s_add_u32 s6, s6, s55
    s_mul_i32 s59, s6, 40960
    s_and_b32 s78, s52, 6
    s_lshl_b32 s78, s78, 1
    s_add_u32 s78, s78, s3
    s_mul_i32 s79, s78, 0x3334
    s_lshr_b32 s79, s79, 16
    s_mul_i32 s57, s79, 5
    s_sub_u32 s57, s78, s57
    s_lshr_b32 s56, s52, 3
    s_mul_i32 s56, s56, 5
    s_add_u32 s57, s57, s56
    s_mul_i32 s54, s79, 1280
    s_lshl_b32 s56, s57, 6
    s_add_u32 s54, s54, s56
    s_mul_i32 s63, s79, 2621440
    s_lshl_b32 s57, s57, 11
    s_add_u32 s63, s63, s57
    s_add_u32 s63, s63, s59
    s_add_u32 s63, s63, 12673024
    s_mov_b32 s88, 0x3fb8aa3b
    v_mov_b32 v116, 0x358637bd
    v_mov_b32 v117, 0x358637bd
    v_mov_b32 v118, 0x358637bd
    v_mov_b32 v119, 0x358637bd
    v_mov_b32 v120, 0xb5c1a2a0
    s_cmp_eq_u32 s79, 3
    s_cbranch_scc1 L_gate
    s_mov_b32 s40, s10
    s_and_b32 s41, s11, 0xffff
    s_mov_b32 s42, 2457600
    s_mov_b32 s43, 0x20000
    v_lshrrev_b32 v16, 2, v2
    v_mul_u32_u24 v17, 3840, v16
    v_lshrrev_b32 v16, 3, v16
    v_lshlrev_b32 v16, 1, v16
    v_and_b32 v18, 3, v2
    v_xor_b32 v16, v16, v18
    v_lshl_add_u32 v17, v16, 4, v17
    s_mul_i32 s58, s3, 40960
    v_lshrrev_b32 v16, 2, v0
    v_lshl_add_u32 v16, v1, 3, v16
    v_lshlrev_b32 v16, 6, v16
    v_and_b32 v18, 3, v0
    v_lshl_add_u32 v16, v18, 3, v16
    v_add_u32 v16, s58, v16
    v_and_b32 v18, 1, v1
    v_lshl_add_u32 v19, v18, 5, v16
    v_xor_b32 v18, 1, v18
    v_lshl_add_u32 v20, v18, 5, v16
    s_add_u32 m0, s58, 0
    s_add_u32 s55, s54, 0
    buffer_load_dwordx4 v17, s[40:43], s55 offen lds
    s_add_u32 m0, s58, 1024
    s_add_u32 s55, s54, 61440
    buffer_load_dwordx4 v17, s[40:43], s55 offen lds
    s_add_u32 m0, s58, 2048
    s_add_u32 s55, s54, 122880
    buffer_load_dwordx4 v17, s[40:43], s55 offen lds
    s_add_u32 m0, s58, 3072
    s_add_u32 s55, s54, 184320
    buffer_load_dwordx4 v17, s[40:43], s55 offen lds
    s_add_u32 m0, s58, 4096
    s_add_u32 s55, s54, 245760
    buffer_load_dwordx4 v17, s[40:43], s55 offen lds
    s_add_u32 m0, s58, 5120
    s_add_u32 s55, s54, 307200
    buffer_load_dwordx4 v17, s[40:43], s55 offen lds
    s_add_u32 m0, s58, 6144
    s_add_u32 s55, s54, 368640
    buffer_load_dwordx4 v17, s[40:43], s55 offen lds
    s_add_u32 m0, s58, 7168
    s_add_u32 s55, s54, 430080
    buffer_load_dwordx4 v17, s[40:43], s55 offen lds
    s_add_u32 m0, s58, 8192
    s_add_u32 s55, s54, 491520
    buffer_load_dwordx4 v17, s[40:43], s55 offen lds
    s_add_u32 m0, s58, 9216
    s_add_u32 s55, s54, 552960
    buffer_load_dwordx4 v17, s[40:43], s55 offen lds
    s_add_u32 m0, s58, 10240
    s_add_u32 s55, s54, 614400
    buffer_load_dwordx4 v17, s[40:43], s55 offen lds
    s_add_u32 m0, s58, 11264
    s_add_u32 s55, s54, 675840
    buffer_load_dwordx4 v17, s[40:43], s55 offen lds
    s_add_u32 m0, s58, 12288
    s_add_u32 s55, s54, 737280
    buffer_load_dwordx4 v17, s[40:43], s55 offen lds
    s_add_u32 m0, s58, 13312
    s_add_u32 s55, s54, 798720
    buffer_load_dwordx4 v17, s[40:43], s55 offen lds
    s_add_u32 m0, s58, 14336
    s_add_u32 s55, s54, 860160
    buffer_load_dwordx4 v17, s[40:43], s55 offen lds
    s_add_u32 m0, s58, 15360
    s_add_u32 s55, s54, 921600
    buffer_load_dwordx4 v17, s[40:43], s55 offen lds
    s_add_u32 m0, s58, 16384
    s_add_u32 s55, s54, 983040
    buffer_load_dwordx4 v17, s[40:43], s55 offen lds
    s_add_u32 m0, s58, 17408
    s_add_u32 s55, s54, 1044480
    buffer_load_dwordx4 v17, s[40:43], s55 offen lds
    s_add_u32 m0, s58, 18432
    s_add_u32 s55, s54, 1105920
    buffer_load_dwordx4 v17, s[40:43], s55 offen lds
    s_add_u32 m0, s58, 19456
    s_add_u32 s55, s54, 1167360
    buffer_load_dwordx4 v17, s[40:43], s55 offen lds
    s_add_u32 m0, s58, 20480
    s_add_u32 s55, s54, 1228800
    buffer_load_dwordx4 v17, s[40:43], s55 offen lds
    s_add_u32 m0, s58, 21504
    s_add_u32 s55, s54, 1290240
    buffer_load_dwordx4 v17, s[40:43], s55 offen lds
    s_add_u32 m0, s58, 22528
    s_add_u32 s55, s54, 1351680
    buffer_load_dwordx4 v17, s[40:43], s55 offen lds
    s_add_u32 m0, s58, 23552
    s_add_u32 s55, s54, 1413120
    buffer_load_dwordx4 v17, s[40:43], s55 offen lds
    s_add_u32 m0, s58, 24576
    s_add_u32 s55, s54, 1474560
    buffer_load_dwordx4 v17, s[40:43], s55 offen lds
    s_add_u32 m0, s58, 25600
    s_add_u32 s55, s54, 1536000
    buffer_load_dwordx4 v17, s[40:43], s55 offen lds
    s_add_u32 m0, s58, 26624
    s_add_u32 s55, s54, 1597440
    buffer_load_dwordx4 v17, s[40:43], s55 offen lds
    s_add_u32 m0, s58, 27648
    s_add_u32 s55, s54, 1658880
    buffer_load_dwordx4 v17, s[40:43], s55 offen lds
    s_add_u32 m0, s58, 28672
    s_add_u32 s55, s54, 1720320
    buffer_load_dwordx4 v17, s[40:43], s55 offen lds
    s_add_u32 m0, s58, 29696
    s_add_u32 s55, s54, 1781760
    buffer_load_dwordx4 v17, s[40:43], s55 offen lds
    s_add_u32 m0, s58, 30720
    s_add_u32 s55, s54, 1843200
    buffer_load_dwordx4 v17, s[40:43], s55 offen lds
    s_add_u32 m0, s58, 31744
    s_add_u32 s55, s54, 1904640
    buffer_load_dwordx4 v17, s[40:43], s55 offen lds
    s_add_u32 m0, s58, 32768
    s_add_u32 s55, s54, 1966080
    buffer_load_dwordx4 v17, s[40:43], s55 offen lds
    s_add_u32 m0, s58, 33792
    s_add_u32 s55, s54, 2027520
    buffer_load_dwordx4 v17, s[40:43], s55 offen lds
    s_add_u32 m0, s58, 34816
    s_add_u32 s55, s54, 2088960
    buffer_load_dwordx4 v17, s[40:43], s55 offen lds
    s_add_u32 m0, s58, 35840
    s_add_u32 s55, s54, 2150400
    buffer_load_dwordx4 v17, s[40:43], s55 offen lds
    s_add_u32 m0, s58, 36864
    s_add_u32 s55, s54, 2211840
    buffer_load_dwordx4 v17, s[40:43], s55 offen lds
    s_add_u32 m0, s58, 37888
    s_add_u32 s55, s54, 2273280
    buffer_load_dwordx4 v17, s[40:43], s55 offen lds
    s_add_u32 m0, s58, 38912
    s_add_u32 s55, s54, 2334720
    buffer_load_dwordx4 v17, s[40:43], s55 offen lds
    s_add_u32 m0, s58, 39936
    s_add_u32 s55, s54, 2396160
    buffer_load_dwordx4 v17, s[40:43], s55 offen lds
    s_waitcnt vmcnt(38) lgkmcnt(8)
    ds_read_b64_tr_b16 a[0:1], v19 offset:0
    ds_read_b64_tr_b16 a[2:3], v19 offset:256
    ds_read_b64_tr_b16 a[80:81], v20 offset:0
    ds_read_b64_tr_b16 a[82:83], v20 offset:256
    s_waitcnt vmcnt(36) lgkmcnt(8)
    ds_read_b64_tr_b16 a[4:5], v19 offset:2048
    ds_read_b64_tr_b16 a[6:7], v19 offset:2304
    ds_read_b64_tr_b16 a[84:85], v20 offset:2048
    ds_read_b64_tr_b16 a[86:87], v20 offset:2304
    s_waitcnt vmcnt(34) lgkmcnt(8)
    ds_read_b64_tr_b16 a[8:9], v19 offset:4096
    ds_read_b64_tr_b16 a[10:11], v19 offset:4352
    ds_read_b64_tr_b16 a[88:89], v20 offset:4096
    ds_read_b64_tr_b16 a[90:91], v20 offset:4352
    s_waitcnt vmcnt(32) lgkmcnt(8)
    ds_read_b64_tr_b16 a[12:13], v19 offset:6144
    ds_read_b64_tr_b16 a[14:15], v19 offset:6400
    ds_read_b64_tr_b16 a[92:93], v20 offset:6144
    ds_read_b64_tr_b16 a[94:95], v20 offset:6400
    s_waitcnt vmcnt(30) lgkmcnt(8)
    ds_read_b64_tr_b16 a[16:17], v19 offset:8192
    ds_read_b64_tr_b16 a[18:19], v19 offset:8448
    ds_read_b64_tr_b16 a[96:97], v20 offset:8192
    ds_read_b64_tr_b16 a[98:99], v20 offset:8448
    s_waitcnt vmcnt(28) lgkmcnt(8)
    ds_read_b64_tr_b16 a[20:21], v19 offset:10240
    ds_read_b64_tr_b16 a[22:23], v19 offset:10496
    ds_read_b64_tr_b16 a[100:101], v20 offset:10240
    ds_read_b64_tr_b16 a[102:103], v20 offset:10496
    s_waitcnt vmcnt(26) lgkmcnt(8)
    ds_read_b64_tr_b16 a[24:25], v19 offset:12288
    ds_read_b64_tr_b16 a[26:27], v19 offset:12544
    ds_read_b64_tr_b16 a[104:105], v20 offset:12288
    ds_read_b64_tr_b16 a[106:107], v20 offset:12544
    s_waitcnt vmcnt(24) lgkmcnt(8)
    ds_read_b64_tr_b16 a[28:29], v19 offset:14336
    ds_read_b64_tr_b16 a[30:31], v19 offset:14592
    ds_read_b64_tr_b16 a[108:109], v20 offset:14336
    ds_read_b64_tr_b16 a[110:111], v20 offset:14592
    s_waitcnt vmcnt(22) lgkmcnt(8)
    ds_read_b64_tr_b16 a[32:33], v19 offset:16384
    ds_read_b64_tr_b16 a[34:35], v19 offset:16640
    ds_read_b64_tr_b16 a[112:113], v20 offset:16384
    ds_read_b64_tr_b16 a[114:115], v20 offset:16640
    s_waitcnt vmcnt(20) lgkmcnt(8)
    ds_read_b64_tr_b16 a[36:37], v19 offset:18432
    ds_read_b64_tr_b16 a[38:39], v19 offset:18688
    ds_read_b64_tr_b16 a[116:117], v20 offset:18432
    ds_read_b64_tr_b16 a[118:119], v20 offset:18688
    s_waitcnt vmcnt(18) lgkmcnt(8)
    ds_read_b64_tr_b16 a[40:41], v19 offset:20480
    ds_read_b64_tr_b16 a[42:43], v19 offset:20736
    ds_read_b64_tr_b16 a[120:121], v20 offset:20480
    ds_read_b64_tr_b16 a[122:123], v20 offset:20736
    s_waitcnt vmcnt(16) lgkmcnt(8)
    ds_read_b64_tr_b16 a[44:45], v19 offset:22528
    ds_read_b64_tr_b16 a[46:47], v19 offset:22784
    ds_read_b64_tr_b16 a[124:125], v20 offset:22528
    ds_read_b64_tr_b16 a[126:127], v20 offset:22784
    s_waitcnt vmcnt(14) lgkmcnt(8)
    ds_read_b64_tr_b16 a[48:49], v19 offset:24576
    ds_read_b64_tr_b16 a[50:51], v19 offset:24832
    ds_read_b64_tr_b16 a[128:129], v20 offset:24576
    ds_read_b64_tr_b16 a[130:131], v20 offset:24832
    s_waitcnt vmcnt(12) lgkmcnt(8)
    ds_read_b64_tr_b16 a[52:53], v19 offset:26624
    ds_read_b64_tr_b16 a[54:55], v19 offset:26880
    ds_read_b64_tr_b16 a[132:133], v20 offset:26624
    ds_read_b64_tr_b16 a[134:135], v20 offset:26880
    s_waitcnt vmcnt(10) lgkmcnt(8)
    ds_read_b64_tr_b16 a[56:57], v19 offset:28672
    ds_read_b64_tr_b16 a[58:59], v19 offset:28928
    ds_read_b64_tr_b16 a[136:137], v20 offset:28672
    ds_read_b64_tr_b16 a[138:139], v20 offset:28928
    s_waitcnt vmcnt(8) lgkmcnt(8)
    ds_read_b64_tr_b16 a[60:61], v19 offset:30720
    ds_read_b64_tr_b16 a[62:63], v19 offset:30976
    ds_read_b64_tr_b16 a[140:141], v20 offset:30720
    ds_read_b64_tr_b16 a[142:143], v20 offset:30976
    s_waitcnt vmcnt(6) lgkmcnt(8)
    ds_read_b64_tr_b16 a[64:65], v19 offset:32768
    ds_read_b64_tr_b16 a[66:67], v19 offset:33024
    ds_read_b64_tr_b16 a[144:145], v20 offset:32768
    ds_read_b64_tr_b16 a[146:147], v20 offset:33024
    s_waitcnt vmcnt(4) lgkmcnt(8)
    ds_read_b64_tr_b16 a[68:69], v19 offset:34816
    ds_read_b64_tr_b16 a[70:71], v19 offset:35072
    ds_read_b64_tr_b16 a[148:149], v20 offset:34816
    ds_read_b64_tr_b16 a[150:151], v20 offset:35072
    s_waitcnt vmcnt(2) lgkmcnt(8)
    ds_read_b64_tr_b16 a[72:73], v19 offset:36864
    ds_read_b64_tr_b16 a[74:75], v19 offset:37120
    ds_read_b64_tr_b16 a[152:153], v20 offset:36864
    ds_read_b64_tr_b16 a[154:155], v20 offset:37120
    s_waitcnt vmcnt(0) lgkmcnt(8)
    ds_read_b64_tr_b16 a[76:77], v19 offset:38912
    ds_read_b64_tr_b16 a[78:79], v19 offset:39168
    ds_read_b64_tr_b16 a[156:157], v20 offset:38912
    ds_read_b64_tr_b16 a[158:159], v20 offset:39168
    s_waitcnt lgkmcnt(0)
    s_barrier
    s_mov_b32 s44, s8
    s_and_b32 s45, s9, 0xffff
    s_mov_b32 s46, 2621440
    s_mov_b32 s47, 0x20000
    v_lshrrev_b32 v10, 3, v2
    v_mul_u32_u24 v5, 1280, v10
    v_lshrrev_b32 v10, 1, v10
    s_and_b32 s55, s3, 1
    s_lshl_b32 s55, s55, 2
    v_add_u32 v10, s55, v10
    v_and_b32 v11, 7, v2
    v_xor_b32 v10, v10, v11
    v_lshl_add_u32 v5, v10, 4, v5
    s_mul_i32 s55, s3, 10240
    s_add_u32 s59, s59, s55
    s_mul_i32 s60, s3, 10240
    v_lshrrev_b32 v10, 3, v0
    v_mul_u32_u24 v10, 10240, v10
    v_and_b32 v11, 7, v0
    v_lshl_add_u32 v10, v11, 7, v10
    v_lshrrev_b32 v11, 1, v0
    v_xor_b32 v11, v11, v1
    v_lshl_add_u32 v6, v11, 4, v10
    v_xor_b32 v11, 4, v11
    v_lshl_add_u32 v7, v11, 4, v10
    s_mov_b32 s61, 0
    s_cmp_eq_u32 s79, 1
    s_cbranch_scc1 L_alk
    s_cmp_eq_u32 s79, 2
    s_cbranch_scc1 L_alv
    s_add_u32 m0, s60, 0
    s_nop 0
    buffer_load_dwordx4 v5, s[44:47], s59 offen offset:0 lds
    s_add_u32 m0, s60, 896
    s_nop 0
    buffer_load_dwordx4 v5, s[44:47], s59 offen offset:128 lds
    s_add_u32 m0, s60, 1792
    s_nop 0
    buffer_load_dwordx4 v5, s[44:47], s59 offen offset:256 lds
    s_add_u32 m0, s60, 2688
    s_nop 0
    buffer_load_dwordx4 v5, s[44:47], s59 offen offset:384 lds
    s_add_u32 m0, s60, 3584
    s_nop 0
    buffer_load_dwordx4 v5, s[44:47], s59 offen offset:512 lds
    s_add_u32 m0, s60, 4480
    s_nop 0
    buffer_load_dwordx4 v5, s[44:47], s59 offen offset:640 lds
    s_add_u32 m0, s60, 5376
    s_nop 0
    buffer_load_dwordx4 v5, s[44:47], s59 offen offset:768 lds
    s_add_u32 m0, s60, 6272
    s_nop 0
    buffer_load_dwordx4 v5, s[44:47], s59 offen offset:896 lds
    s_add_u32 m0, s60, 7168
    s_nop 0
    buffer_load_dwordx4 v5, s[44:47], s59 offen offset:1024 lds
    s_add_u32 m0, s60, 8064
    s_nop 0
    buffer_load_dwordx4 v5, s[44:47], s59 offen offset:1152 lds
    s_add_u32 s59, s59, 40960
    s_add_u32 s60, s60, 40960
    s_cmp_ge_u32 s60, 122880
    s_cselect_b32 s55, 122880, 0
    s_sub_u32 s60, s60, s55
    s_add_u32 m0, s60, 0
    s_nop 0
    buffer_load_dwordx4 v5, s[44:47], s59 offen offset:0 lds
    s_add_u32 m0, s60, 896
    s_nop 0
    buffer_load_dwordx4 v5, s[44:47], s59 offen offset:128 lds
    s_add_u32 m0, s60, 1792
    s_nop 0
    buffer_load_dwordx4 v5, s[44:47], s59 offen offset:256 lds
    s_add_u32 m0, s60, 2688
    s_nop 0
    buffer_load_dwordx4 v5, s[44:47], s59 offen offset:384 lds
    s_add_u32 m0, s60, 3584
    s_nop 0
    buffer_load_dwordx4 v5, s[44:47], s59 offen offset:512 lds
    s_add_u32 m0, s60, 4480
    s_nop 0
    buffer_load_dwordx4 v5, s[44:47], s59 offen offset:640 lds
    s_add_u32 m0, s60, 5376
    s_nop 0
    buffer_load_dwordx4 v5, s[44:47], s59 offen offset:768 lds
    s_add_u32 m0, s60, 6272
    s_nop 0
    buffer_load_dwordx4 v5, s[44:47], s59 offen offset:896 lds
    s_add_u32 m0, s60, 7168
    s_nop 0
    buffer_load_dwordx4 v5, s[44:47], s59 offen offset:1024 lds
    s_add_u32 m0, s60, 8064
    s_nop 0
    buffer_load_dwordx4 v5, s[44:47], s59 offen offset:1152 lds
    s_add_u32 s59, s59, 40960
    s_add_u32 s60, s60, 40960
    s_cmp_ge_u32 s60, 122880
    s_cselect_b32 s55, 122880, 0
    s_sub_u32 s60, s60, s55
    s_waitcnt vmcnt(10)
    s_barrier
    ds_read_b128 v[16:19], v6 offset:0
    ds_read_b128 v[20:23], v6 offset:20480
    ds_read_b128 v[24:27], v7 offset:0
    ds_read_b128 v[28:31], v7 offset:20480
    s_mov_b32 s62, 4026531840
    s_waitcnt lgkmcnt(2)
    .p2align 6
L_alq_loop:
    v_mfma_f32_16x16x32_bf16 v[48:51], a[0:3], v[16:19], v[116:119]
    ds_read_b128 v[32:35], v6 offset:1024
    s_add_u32 s61, s61, 40960
    s_cmp_ge_u32 s61, 122880
    s_cselect_b32 s94, 122880, 0
    v_mfma_f32_16x16x32_bf16 v[52:55], a[0:3], v[20:23], v[116:119]
    ds_read_b128 v[36:39], v6 offset:21504
    s_sub_u32 s61, s61, s94
    s_sub_u32 s94, 40960, s94
    v_mfma_f32_16x16x32_bf16 v[56:59], a[80:83], v[16:19], v[116:119]
    s_add_u32 m0, s60, 0
    v_mfma_f32_16x16x32_bf16 v[60:63], a[80:83], v[20:23], v[116:119]
    s_waitcnt lgkmcnt(2)
    v_mfma_f32_16x16x32_bf16 v[48:51], a[4:7], v[24:27], v[48:51]
    ds_read_b128 v[40:43], v7 offset:1024
    buffer_load_dwordx4 v5, s[44:47], s59 offen offset:0 lds
    v_mfma_f32_16x16x32_bf16 v[52:55], a[4:7], v[28:31], v[52:55]
    ds_read_b128 v[44:47], v7 offset:21504
    v_mfma_f32_16x16x32_bf16 v[56:59], a[84:87], v[24:27], v[56:59]
    v_mfma_f32_16x16x32_bf16 v[60:63], a[84:87], v[28:31], v[60:63]
    s_waitcnt lgkmcnt(2)
    s_add_u32 m0, s60, 896
    v_fma_f32 v112, v72, s88, v120
    v_mfma_f32_16x16x32_bf16 v[48:51], a[8:11], v[32:35], v[48:51]
    ds_read_b128 v[16:19], v6 offset:2048
    v_fma_f32 v113, v73, s88, v120
    v_fma_f32 v114, v74, s88, v120
    v_mfma_f32_16x16x32_bf16 v[52:55], a[8:11], v[36:39], v[52:55]
    ds_read_b128 v[20:23], v6 offset:22528
    v_fma_f32 v115, v75, s88, v120
    v_mfma_f32_16x16x32_bf16 v[56:59], a[88:91], v[32:35], v[56:59]
    buffer_load_dwordx4 v5, s[44:47], s59 offen offset:128 lds
    v_exp_f32 v112, v112 clamp
    v_mfma_f32_16x16x32_bf16 v[60:63], a[88:91], v[36:39], v[60:63]
    s_waitcnt lgkmcnt(2)
    v_exp_f32 v113, v113 clamp
    v_mfma_f32_16x16x32_bf16 v[48:51], a[12:15], v[40:43], v[48:51]
    ds_read_b128 v[24:27], v7 offset:2048
    v_exp_f32 v114, v114 clamp
    v_mfma_f32_16x16x32_bf16 v[52:55], a[12:15], v[44:47], v[52:55]
    ds_read_b128 v[28:31], v7 offset:22528
    s_add_u32 m0, s60, 1792
    v_mfma_f32_16x16x32_bf16 v[56:59], a[92:95], v[40:43], v[56:59]
    v_exp_f32 v115, v115 clamp
    v_mfma_f32_16x16x32_bf16 v[60:63], a[92:95], v[44:47], v[60:63]
    s_waitcnt lgkmcnt(2)
    v_max_f32 v72, v116, v72
    v_max_f32 v73, v116, v73
    v_mfma_f32_16x16x32_bf16 v[48:51], a[16:19], v[16:19], v[48:51]
    ds_read_b128 v[32:35], v6 offset:3072
    buffer_load_dwordx4 v5, s[44:47], s59 offen offset:256 lds
    v_max_f32 v74, v116, v74
    v_mfma_f32_16x16x32_bf16 v[52:55], a[16:19], v[20:23], v[52:55]
    ds_read_b128 v[36:39], v6 offset:23552
    v_max_f32 v75, v116, v75
    v_add_f32 v72, v72, v112
    v_mfma_f32_16x16x32_bf16 v[56:59], a[96:99], v[16:19], v[56:59]
    s_add_u32 m0, s60, 2688
    v_add_f32 v73, v73, v113
    v_add_f32 v74, v74, v114
    v_mfma_f32_16x16x32_bf16 v[60:63], a[96:99], v[20:23], v[60:63]
    s_waitcnt lgkmcnt(2)
    v_add_f32 v75, v75, v115
    v_cvt_pk_bf16_f32 v96, v72, v73
    v_mfma_f32_16x16x32_bf16 v[48:51], a[20:23], v[24:27], v[48:51]
    ds_read_b128 v[40:43], v7 offset:3072
    v_cvt_pk_bf16_f32 v97, v74, v75
    v_fma_f32 v112, v76, s88, v120
    v_mfma_f32_16x16x32_bf16 v[52:55], a[20:23], v[28:31], v[52:55]
    ds_read_b128 v[44:47], v7 offset:23552
    buffer_load_dwordx4 v5, s[44:47], s59 offen offset:384 lds
    v_fma_f32 v113, v77, s88, v120
    v_mfma_f32_16x16x32_bf16 v[56:59], a[100:103], v[24:27], v[56:59]
    v_fma_f32 v114, v78, s88, v120
    v_fma_f32 v115, v79, s88, v120
    v_mfma_f32_16x16x32_bf16 v[60:63], a[100:103], v[28:31], v[60:63]
    s_waitcnt lgkmcnt(2)
    v_exp_f32 v112, v112 clamp
    v_mfma_f32_16x16x32_bf16 v[48:51], a[24:27], v[32:35], v[48:51]
    ds_read_b128 v[16:19], v6 offset:4096
    s_add_u32 m0, s60, 3584
    v_mfma_f32_16x16x32_bf16 v[52:55], a[24:27], v[36:39], v[52:55]
    ds_read_b128 v[20:23], v6 offset:24576
    v_exp_f32 v113, v113 clamp
    v_mfma_f32_16x16x32_bf16 v[56:59], a[104:107], v[32:35], v[56:59]
    v_exp_f32 v114, v114 clamp
    v_mfma_f32_16x16x32_bf16 v[60:63], a[104:107], v[36:39], v[60:63]
    s_waitcnt lgkmcnt(2)
    buffer_load_dwordx4 v5, s[44:47], s59 offen offset:512 lds
    v_mfma_f32_16x16x32_bf16 v[48:51], a[28:31], v[40:43], v[48:51]
    ds_read_b128 v[24:27], v7 offset:4096
    v_exp_f32 v115, v115 clamp
    v_mfma_f32_16x16x32_bf16 v[52:55], a[28:31], v[44:47], v[52:55]
    ds_read_b128 v[28:31], v7 offset:24576
    v_max_f32 v76, v116, v76
    v_max_f32 v77, v116, v77
    v_mfma_f32_16x16x32_bf16 v[56:59], a[108:111], v[40:43], v[56:59]
    s_add_u32 m0, s60, 4480
    v_max_f32 v78, v116, v78
    v_max_f32 v79, v116, v79
    v_mfma_f32_16x16x32_bf16 v[60:63], a[108:111], v[44:47], v[60:63]
    s_waitcnt lgkmcnt(2)
    v_add_f32 v76, v76, v112
    v_add_f32 v77, v77, v113
    v_mfma_f32_16x16x32_bf16 v[48:51], a[32:35], v[16:19], v[48:51]
    ds_read_b128 v[32:35], v6 offset:5120
    v_add_f32 v78, v78, v114
    v_add_f32 v79, v79, v115
    v_mfma_f32_16x16x32_bf16 v[52:55], a[32:35], v[20:23], v[52:55]
    ds_read_b128 v[36:39], v6 offset:25600
    buffer_load_dwordx4 v5, s[44:47], s59 offen offset:640 lds
    v_cvt_pk_bf16_f32 v98, v76, v77
    v_mfma_f32_16x16x32_bf16 v[56:59], a[112:115], v[16:19], v[56:59]
    v_cvt_pk_bf16_f32 v99, v78, v79
    buffer_store_dwordx4 v[96:99], v3, s[36:39], s62 offen offset:0
    v_mfma_f32_16x16x32_bf16 v[60:63], a[112:115], v[20:23], v[60:63]
    s_waitcnt lgkmcnt(2)
    s_add_u32 m0, s60, 5376
    v_fma_f32 v112, v80, s88, v120
    v_mfma_f32_16x16x32_bf16 v[48:51], a[36:39], v[24:27], v[48:51]
    ds_read_b128 v[40:43], v7 offset:5120
    v_fma_f32 v113, v81, s88, v120
    v_fma_f32 v114, v82, s88, v120
    v_mfma_f32_16x16x32_bf16 v[52:55], a[36:39], v[28:31], v[52:55]
    ds_read_b128 v[44:47], v7 offset:25600
    v_fma_f32 v115, v83, s88, v120
    v_mfma_f32_16x16x32_bf16 v[56:59], a[116:119], v[24:27], v[56:59]
    buffer_load_dwordx4 v5, s[44:47], s59 offen offset:768 lds
    v_exp_f32 v112, v112 clamp
    v_mfma_f32_16x16x32_bf16 v[60:63], a[116:119], v[28:31], v[60:63]
    s_waitcnt lgkmcnt(2)
    v_exp_f32 v113, v113 clamp
    v_mfma_f32_16x16x32_bf16 v[48:51], a[40:43], v[32:35], v[48:51]
    ds_read_b128 v[16:19], v6 offset:6144
    v_exp_f32 v114, v114 clamp
    v_mfma_f32_16x16x32_bf16 v[52:55], a[40:43], v[36:39], v[52:55]
    ds_read_b128 v[20:23], v6 offset:26624
    s_add_u32 m0, s60, 6272
    v_mfma_f32_16x16x32_bf16 v[56:59], a[120:123], v[32:35], v[56:59]
    v_exp_f32 v115, v115 clamp
    v_mfma_f32_16x16x32_bf16 v[60:63], a[120:123], v[36:39], v[60:63]
    s_waitcnt lgkmcnt(2)
    v_max_f32 v80, v116, v80
    v_max_f32 v81, v116, v81
    v_mfma_f32_16x16x32_bf16 v[48:51], a[44:47], v[40:43], v[48:51]
    ds_read_b128 v[24:27], v7 offset:6144
    buffer_load_dwordx4 v5, s[44:47], s59 offen offset:896 lds
    v_max_f32 v82, v116, v82
    v_mfma_f32_16x16x32_bf16 v[52:55], a[44:47], v[44:47], v[52:55]
    ds_read_b128 v[28:31], v7 offset:26624
    v_max_f32 v83, v116, v83
    v_add_f32 v80, v80, v112
    v_mfma_f32_16x16x32_bf16 v[56:59], a[124:127], v[40:43], v[56:59]
    v_add_f32 v81, v81, v113
    v_add_f32 v82, v82, v114
    v_mfma_f32_16x16x32_bf16 v[60:63], a[124:127], v[44:47], v[60:63]
    s_waitcnt lgkmcnt(2)
    s_add_u32 m0, s60, 7168
    v_add_f32 v83, v83, v115
    v_mfma_f32_16x16x32_bf16 v[48:51], a[48:51], v[16:19], v[48:51]
    ds_read_b128 v[32:35], v6 offset:7168
    v_cvt_pk_bf16_f32 v100, v80, v81
    v_cvt_pk_bf16_f32 v101, v82, v83
    v_mfma_f32_16x16x32_bf16 v[52:55], a[48:51], v[20:23], v[52:55]
    ds_read_b128 v[36:39], v6 offset:27648
    v_fma_f32 v112, v84, s88, v120
    v_fma_f32 v113, v85, s88, v120
    v_mfma_f32_16x16x32_bf16 v[56:59], a[128:131], v[16:19], v[56:59]
    buffer_load_dwordx4 v5, s[44:47], s59 offen offset:1024 lds
    v_fma_f32 v114, v86, s88, v120
    v_fma_f32 v115, v87, s88, v120
    v_mfma_f32_16x16x32_bf16 v[60:63], a[128:131], v[20:23], v[60:63]
    s_waitcnt lgkmcnt(2)
    v_exp_f32 v112, v112 clamp
    v_mfma_f32_16x16x32_bf16 v[48:51], a[52:55], v[24:27], v[48:51]
    ds_read_b128 v[40:43], v7 offset:7168
    s_add_u32 m0, s60, 8064
    v_mfma_f32_16x16x32_bf16 v[52:55], a[52:55], v[28:31], v[52:55]
    ds_read_b128 v[44:47], v7 offset:27648
    v_exp_f32 v113, v113 clamp
    v_mfma_f32_16x16x32_bf16 v[56:59], a[132:135], v[24:27], v[56:59]
    v_exp_f32 v114, v114 clamp
    v_mfma_f32_16x16x32_bf16 v[60:63], a[132:135], v[28:31], v[60:63]
    s_waitcnt lgkmcnt(2)
    buffer_load_dwordx4 v5, s[44:47], s59 offen offset:1152 lds
    v_mfma_f32_16x16x32_bf16 v[48:51], a[56:59], v[32:35], v[48:51]
    ds_read_b128 v[16:19], v6 offset:8192
    v_exp_f32 v115, v115 clamp
    v_mfma_f32_16x16x32_bf16 v[52:55], a[56:59], v[36:39], v[52:55]
    ds_read_b128 v[20:23], v6 offset:28672
    v_max_f32 v84, v116, v84
    v_max_f32 v85, v116, v85
    v_mfma_f32_16x16x32_bf16 v[56:59], a[136:139], v[32:35], v[56:59]
    s_add_u32 s59, s59, 40960
    v_max_f32 v86, v116, v86
    v_max_f32 v87, v116, v87
    v_mfma_f32_16x16x32_bf16 v[60:63], a[136:139], v[36:39], v[60:63]
    s_waitcnt lgkmcnt(2)
    v_add_f32 v84, v84, v112
    v_add_f32 v85, v85, v113
    v_mfma_f32_16x16x32_bf16 v[48:51], a[60:63], v[40:43], v[48:51]
    ds_read_b128 v[24:27], v7 offset:8192
    v_add_f32 v86, v86, v114
    v_add_f32 v87, v87, v115
    v_mfma_f32_16x16x32_bf16 v[52:55], a[60:63], v[44:47], v[52:55]
    ds_read_b128 v[28:31], v7 offset:28672
    s_add_u32 s60, s60, 40960
    v_cvt_pk_bf16_f32 v102, v84, v85
    v_mfma_f32_16x16x32_bf16 v[56:59], a[140:143], v[40:43], v[56:59]
    v_cvt_pk_bf16_f32 v103, v86, v87
    buffer_store_dwordx4 v[100:103], v3, s[36:39], s62 offen offset:1024
    v_mfma_f32_16x16x32_bf16 v[60:63], a[140:143], v[44:47], v[60:63]
    s_waitcnt lgkmcnt(2)
    s_add_u32 s63, s63, 40960
    v_mfma_f32_16x16x32_bf16 v[48:51], a[64:67], v[16:19], v[48:51]
    ds_read_b128 v[32:35], v6 offset:9216
    s_cmp_ge_u32 s60, 122880
    s_cselect_b32 s55, 122880, 0
    v_mfma_f32_16x16x32_bf16 v[52:55], a[64:67], v[20:23], v[52:55]
    ds_read_b128 v[36:39], v6 offset:29696
    v_mfma_f32_16x16x32_bf16 v[56:59], a[144:147], v[16:19], v[56:59]
    v_mfma_f32_16x16x32_bf16 v[60:63], a[144:147], v[20:23], v[60:63]
    s_waitcnt lgkmcnt(2)
    s_sub_u32 s60, s60, s55
    v_mfma_f32_16x16x32_bf16 v[48:51], a[68:71], v[24:27], v[48:51]
    ds_read_b128 v[40:43], v7 offset:9216
    v_add_u32 v6, s94, v6
    v_mfma_f32_16x16x32_bf16 v[52:55], a[68:71], v[28:31], v[52:55]
    ds_read_b128 v[44:47], v7 offset:29696
    v_add_u32 v7, s94, v7
    v_mfma_f32_16x16x32_bf16 v[56:59], a[148:151], v[24:27], v[56:59]
    v_mfma_f32_16x16x32_bf16 v[60:63], a[148:151], v[28:31], v[60:63]
    s_waitcnt vmcnt(12) lgkmcnt(0)
    s_barrier
    v_mfma_f32_16x16x32_bf16 v[48:51], a[72:75], v[32:35], v[48:51]
    ds_read_b128 v[16:19], v6 offset:0
    v_mfma_f32_16x16x32_bf16 v[52:55], a[72:75], v[36:39], v[52:55]
    ds_read_b128 v[20:23], v6 offset:20480
    v_mfma_f32_16x16x32_bf16 v[56:59], a[152:155], v[32:35], v[56:59]
    v_mfma_f32_16x16x32_bf16 v[60:63], a[152:155], v[36:39], v[60:63]
    v_mfma_f32_16x16x32_bf16 v[48:51], a[76:79], v[40:43], v[48:51]
    ds_read_b128 v[24:27], v7 offset:0
    v_mfma_f32_16x16x32_bf16 v[52:55], a[76:79], v[44:47], v[52:55]
    ds_read_b128 v[28:31], v7 offset:20480
    v_mfma_f32_16x16x32_bf16 v[56:59], a[156:159], v[40:43], v[56:59]
    v_mfma_f32_16x16x32_bf16 v[60:63], a[156:159], v[44:47], v[60:63]
    s_waitcnt lgkmcnt(2)
    s_mov_b32 s62, s63
    s_add_u32 s6, s6, 1
    v_mfma_f32_16x16x32_bf16 v[72:75], a[0:3], v[16:19], v[116:119]
    ds_read_b128 v[32:35], v6 offset:1024
    s_add_u32 s61, s61, 40960
    s_cmp_ge_u32 s61, 122880
    s_cselect_b32 s94, 122880, 0
    v_mfma_f32_16x16x32_bf16 v[76:79], a[0:3], v[20:23], v[116:119]
    ds_read_b128 v[36:39], v6 offset:21504
    s_sub_u32 s61, s61, s94
    s_sub_u32 s94, 40960, s94
    v_mfma_f32_16x16x32_bf16 v[80:83], a[80:83], v[16:19], v[116:119]
    s_add_u32 m0, s60, 0
    v_mfma_f32_16x16x32_bf16 v[84:87], a[80:83], v[20:23], v[116:119]
    s_waitcnt lgkmcnt(2)
    v_mfma_f32_16x16x32_bf16 v[72:75], a[4:7], v[24:27], v[72:75]
    ds_read_b128 v[40:43], v7 offset:1024
    buffer_load_dwordx4 v5, s[44:47], s59 offen offset:0 lds
    v_mfma_f32_16x16x32_bf16 v[76:79], a[4:7], v[28:31], v[76:79]
    ds_read_b128 v[44:47], v7 offset:21504
    v_mfma_f32_16x16x32_bf16 v[80:83], a[84:87], v[24:27], v[80:83]
    v_mfma_f32_16x16x32_bf16 v[84:87], a[84:87], v[28:31], v[84:87]
    s_waitcnt lgkmcnt(2)
    s_add_u32 m0, s60, 896
    v_fma_f32 v112, v48, s88, v120
    v_mfma_f32_16x16x32_bf16 v[72:75], a[8:11], v[32:35], v[72:75]
    ds_read_b128 v[16:19], v6 offset:2048
    v_fma_f32 v113, v49, s88, v120
    v_fma_f32 v114, v50, s88, v120
    v_mfma_f32_16x16x32_bf16 v[76:79], a[8:11], v[36:39], v[76:79]
    ds_read_b128 v[20:23], v6 offset:22528
    v_fma_f32 v115, v51, s88, v120
    v_mfma_f32_16x16x32_bf16 v[80:83], a[88:91], v[32:35], v[80:83]
    buffer_load_dwordx4 v5, s[44:47], s59 offen offset:128 lds
    v_exp_f32 v112, v112 clamp
    v_mfma_f32_16x16x32_bf16 v[84:87], a[88:91], v[36:39], v[84:87]
    s_waitcnt lgkmcnt(2)
    v_exp_f32 v113, v113 clamp
    v_mfma_f32_16x16x32_bf16 v[72:75], a[12:15], v[40:43], v[72:75]
    ds_read_b128 v[24:27], v7 offset:2048
    v_exp_f32 v114, v114 clamp
    v_mfma_f32_16x16x32_bf16 v[76:79], a[12:15], v[44:47], v[76:79]
    ds_read_b128 v[28:31], v7 offset:22528
    s_add_u32 m0, s60, 1792
    v_mfma_f32_16x16x32_bf16 v[80:83], a[92:95], v[40:43], v[80:83]
    v_exp_f32 v115, v115 clamp
    v_mfma_f32_16x16x32_bf16 v[84:87], a[92:95], v[44:47], v[84:87]
    s_waitcnt lgkmcnt(2)
    v_max_f32 v48, v116, v48
    v_max_f32 v49, v116, v49
    v_mfma_f32_16x16x32_bf16 v[72:75], a[16:19], v[16:19], v[72:75]
    ds_read_b128 v[32:35], v6 offset:3072
    buffer_load_dwordx4 v5, s[44:47], s59 offen offset:256 lds
    v_max_f32 v50, v116, v50
    v_mfma_f32_16x16x32_bf16 v[76:79], a[16:19], v[20:23], v[76:79]
    ds_read_b128 v[36:39], v6 offset:23552
    v_max_f32 v51, v116, v51
    v_add_f32 v48, v48, v112
    v_mfma_f32_16x16x32_bf16 v[80:83], a[96:99], v[16:19], v[80:83]
    s_add_u32 m0, s60, 2688
    v_add_f32 v49, v49, v113
    v_add_f32 v50, v50, v114
    v_mfma_f32_16x16x32_bf16 v[84:87], a[96:99], v[20:23], v[84:87]
    s_waitcnt lgkmcnt(2)
    v_add_f32 v51, v51, v115
    v_cvt_pk_bf16_f32 v96, v48, v49
    v_mfma_f32_16x16x32_bf16 v[72:75], a[20:23], v[24:27], v[72:75]
    ds_read_b128 v[40:43], v7 offset:3072
    v_cvt_pk_bf16_f32 v97, v50, v51
    v_fma_f32 v112, v52, s88, v120
    v_mfma_f32_16x16x32_bf16 v[76:79], a[20:23], v[28:31], v[76:79]
    ds_read_b128 v[44:47], v7 offset:23552
    buffer_load_dwordx4 v5, s[44:47], s59 offen offset:384 lds
    v_fma_f32 v113, v53, s88, v120
    v_mfma_f32_16x16x32_bf16 v[80:83], a[100:103], v[24:27], v[80:83]
    v_fma_f32 v114, v54, s88, v120
    v_fma_f32 v115, v55, s88, v120
    v_mfma_f32_16x16x32_bf16 v[84:87], a[100:103], v[28:31], v[84:87]
    s_waitcnt lgkmcnt(2)
    v_exp_f32 v112, v112 clamp
    v_mfma_f32_16x16x32_bf16 v[72:75], a[24:27], v[32:35], v[72:75]
    ds_read_b128 v[16:19], v6 offset:4096
    s_add_u32 m0, s60, 3584
    v_mfma_f32_16x16x32_bf16 v[76:79], a[24:27], v[36:39], v[76:79]
    ds_read_b128 v[20:23], v6 offset:24576
    v_exp_f32 v113, v113 clamp
    v_mfma_f32_16x16x32_bf16 v[80:83], a[104:107], v[32:35], v[80:83]
    v_exp_f32 v114, v114 clamp
    v_mfma_f32_16x16x32_bf16 v[84:87], a[104:107], v[36:39], v[84:87]
    s_waitcnt lgkmcnt(2)
    buffer_load_dwordx4 v5, s[44:47], s59 offen offset:512 lds
    v_mfma_f32_16x16x32_bf16 v[72:75], a[28:31], v[40:43], v[72:75]
    ds_read_b128 v[24:27], v7 offset:4096
    v_exp_f32 v115, v115 clamp
    v_mfma_f32_16x16x32_bf16 v[76:79], a[28:31], v[44:47], v[76:79]
    ds_read_b128 v[28:31], v7 offset:24576
    v_max_f32 v52, v116, v52
    v_max_f32 v53, v116, v53
    v_mfma_f32_16x16x32_bf16 v[80:83], a[108:111], v[40:43], v[80:83]
    s_add_u32 m0, s60, 4480
    v_max_f32 v54, v116, v54
    v_max_f32 v55, v116, v55
    v_mfma_f32_16x16x32_bf16 v[84:87], a[108:111], v[44:47], v[84:87]
    s_waitcnt lgkmcnt(2)
    v_add_f32 v52, v52, v112
    v_add_f32 v53, v53, v113
    v_mfma_f32_16x16x32_bf16 v[72:75], a[32:35], v[16:19], v[72:75]
    ds_read_b128 v[32:35], v6 offset:5120
    v_add_f32 v54, v54, v114
    v_add_f32 v55, v55, v115
    v_mfma_f32_16x16x32_bf16 v[76:79], a[32:35], v[20:23], v[76:79]
    ds_read_b128 v[36:39], v6 offset:25600
    buffer_load_dwordx4 v5, s[44:47], s59 offen offset:640 lds
    v_cvt_pk_bf16_f32 v98, v52, v53
    v_mfma_f32_16x16x32_bf16 v[80:83], a[112:115], v[16:19], v[80:83]
    v_cvt_pk_bf16_f32 v99, v54, v55
    buffer_store_dwordx4 v[96:99], v3, s[36:39], s62 offen offset:0
    v_mfma_f32_16x16x32_bf16 v[84:87], a[112:115], v[20:23], v[84:87]
    s_waitcnt lgkmcnt(2)
    s_add_u32 m0, s60, 5376
    v_fma_f32 v112, v56, s88, v120
    v_mfma_f32_16x16x32_bf16 v[72:75], a[36:39], v[24:27], v[72:75]
    ds_read_b128 v[40:43], v7 offset:5120
    v_fma_f32 v113, v57, s88, v120
    v_fma_f32 v114, v58, s88, v120
    v_mfma_f32_16x16x32_bf16 v[76:79], a[36:39], v[28:31], v[76:79]
    ds_read_b128 v[44:47], v7 offset:25600
    v_fma_f32 v115, v59, s88, v120
    v_mfma_f32_16x16x32_bf16 v[80:83], a[116:119], v[24:27], v[80:83]
    buffer_load_dwordx4 v5, s[44:47], s59 offen offset:768 lds
    v_exp_f32 v112, v112 clamp
    v_mfma_f32_16x16x32_bf16 v[84:87], a[116:119], v[28:31], v[84:87]
    s_waitcnt lgkmcnt(2)
    v_exp_f32 v113, v113 clamp
    v_mfma_f32_16x16x32_bf16 v[72:75], a[40:43], v[32:35], v[72:75]
    ds_read_b128 v[16:19], v6 offset:6144
    v_exp_f32 v114, v114 clamp
    v_mfma_f32_16x16x32_bf16 v[76:79], a[40:43], v[36:39], v[76:79]
    ds_read_b128 v[20:23], v6 offset:26624
    s_add_u32 m0, s60, 6272
    v_mfma_f32_16x16x32_bf16 v[80:83], a[120:123], v[32:35], v[80:83]
    v_exp_f32 v115, v115 clamp
    v_mfma_f32_16x16x32_bf16 v[84:87], a[120:123], v[36:39], v[84:87]
    s_waitcnt lgkmcnt(2)
    v_max_f32 v56, v116, v56
    v_max_f32 v57, v116, v57
    v_mfma_f32_16x16x32_bf16 v[72:75], a[44:47], v[40:43], v[72:75]
    ds_read_b128 v[24:27], v7 offset:6144
    buffer_load_dwordx4 v5, s[44:47], s59 offen offset:896 lds
    v_max_f32 v58, v116, v58
    v_mfma_f32_16x16x32_bf16 v[76:79], a[44:47], v[44:47], v[76:79]
    ds_read_b128 v[28:31], v7 offset:26624
    v_max_f32 v59, v116, v59
    v_add_f32 v56, v56, v112
    v_mfma_f32_16x16x32_bf16 v[80:83], a[124:127], v[40:43], v[80:83]
    v_add_f32 v57, v57, v113
    v_add_f32 v58, v58, v114
    v_mfma_f32_16x16x32_bf16 v[84:87], a[124:127], v[44:47], v[84:87]
    s_waitcnt lgkmcnt(2)
    s_add_u32 m0, s60, 7168
    v_add_f32 v59, v59, v115
    v_mfma_f32_16x16x32_bf16 v[72:75], a[48:51], v[16:19], v[72:75]
    ds_read_b128 v[32:35], v6 offset:7168
    v_cvt_pk_bf16_f32 v100, v56, v57
    v_cvt_pk_bf16_f32 v101, v58, v59
    v_mfma_f32_16x16x32_bf16 v[76:79], a[48:51], v[20:23], v[76:79]
    ds_read_b128 v[36:39], v6 offset:27648
    v_fma_f32 v112, v60, s88, v120
    v_fma_f32 v113, v61, s88, v120
    v_mfma_f32_16x16x32_bf16 v[80:83], a[128:131], v[16:19], v[80:83]
    buffer_load_dwordx4 v5, s[44:47], s59 offen offset:1024 lds
    v_fma_f32 v114, v62, s88, v120
    v_fma_f32 v115, v63, s88, v120
    v_mfma_f32_16x16x32_bf16 v[84:87], a[128:131], v[20:23], v[84:87]
    s_waitcnt lgkmcnt(2)
    v_exp_f32 v112, v112 clamp
    v_mfma_f32_16x16x32_bf16 v[72:75], a[52:55], v[24:27], v[72:75]
    ds_read_b128 v[40:43], v7 offset:7168
    s_add_u32 m0, s60, 8064
    v_mfma_f32_16x16x32_bf16 v[76:79], a[52:55], v[28:31], v[76:79]
    ds_read_b128 v[44:47], v7 offset:27648
    v_exp_f32 v113, v113 clamp
    v_mfma_f32_16x16x32_bf16 v[80:83], a[132:135], v[24:27], v[80:83]
    v_exp_f32 v114, v114 clamp
    v_mfma_f32_16x16x32_bf16 v[84:87], a[132:135], v[28:31], v[84:87]
    s_waitcnt lgkmcnt(2)
    buffer_load_dwordx4 v5, s[44:47], s59 offen offset:1152 lds
    v_mfma_f32_16x16x32_bf16 v[72:75], a[56:59], v[32:35], v[72:75]
    ds_read_b128 v[16:19], v6 offset:8192
    v_exp_f32 v115, v115 clamp
    v_mfma_f32_16x16x32_bf16 v[76:79], a[56:59], v[36:39], v[76:79]
    ds_read_b128 v[20:23], v6 offset:28672
    v_max_f32 v60, v116, v60
    v_max_f32 v61, v116, v61
    v_mfma_f32_16x16x32_bf16 v[80:83], a[136:139], v[32:35], v[80:83]
    s_add_u32 s59, s59, 40960
    v_max_f32 v62, v116, v62
    v_max_f32 v63, v116, v63
    v_mfma_f32_16x16x32_bf16 v[84:87], a[136:139], v[36:39], v[84:87]
    s_waitcnt lgkmcnt(2)
    v_add_f32 v60, v60, v112
    v_add_f32 v61, v61, v113
    v_mfma_f32_16x16x32_bf16 v[72:75], a[60:63], v[40:43], v[72:75]
    ds_read_b128 v[24:27], v7 offset:8192
    v_add_f32 v62, v62, v114
    v_add_f32 v63, v63, v115
    v_mfma_f32_16x16x32_bf16 v[76:79], a[60:63], v[44:47], v[76:79]
    ds_read_b128 v[28:31], v7 offset:28672
    s_add_u32 s60, s60, 40960
    v_cvt_pk_bf16_f32 v102, v60, v61
    v_mfma_f32_16x16x32_bf16 v[80:83], a[140:143], v[40:43], v[80:83]
    v_cvt_pk_bf16_f32 v103, v62, v63
    buffer_store_dwordx4 v[100:103], v3, s[36:39], s62 offen offset:1024
    v_mfma_f32_16x16x32_bf16 v[84:87], a[140:143], v[44:47], v[84:87]
    s_waitcnt lgkmcnt(2)
    s_add_u32 s63, s63, 40960
    v_mfma_f32_16x16x32_bf16 v[72:75], a[64:67], v[16:19], v[72:75]
    ds_read_b128 v[32:35], v6 offset:9216
    s_cmp_ge_u32 s60, 122880
    s_cselect_b32 s55, 122880, 0
    v_mfma_f32_16x16x32_bf16 v[76:79], a[64:67], v[20:23], v[76:79]
    ds_read_b128 v[36:39], v6 offset:29696
    v_mfma_f32_16x16x32_bf16 v[80:83], a[144:147], v[16:19], v[80:83]
    v_mfma_f32_16x16x32_bf16 v[84:87], a[144:147], v[20:23], v[84:87]
    s_waitcnt lgkmcnt(2)
    s_sub_u32 s60, s60, s55
    v_mfma_f32_16x16x32_bf16 v[72:75], a[68:71], v[24:27], v[72:75]
    ds_read_b128 v[40:43], v7 offset:9216
    v_add_u32 v6, s94, v6
    v_mfma_f32_16x16x32_bf16 v[76:79], a[68:71], v[28:31], v[76:79]
    ds_read_b128 v[44:47], v7 offset:29696
    v_add_u32 v7, s94, v7
    v_mfma_f32_16x16x32_bf16 v[80:83], a[148:151], v[24:27], v[80:83]
    v_mfma_f32_16x16x32_bf16 v[84:87], a[148:151], v[28:31], v[84:87]
    s_waitcnt vmcnt(12) lgkmcnt(0)
    s_barrier
    v_mfma_f32_16x16x32_bf16 v[72:75], a[72:75], v[32:35], v[72:75]
    ds_read_b128 v[16:19], v6 offset:0
    v_mfma_f32_16x16x32_bf16 v[76:79], a[72:75], v[36:39], v[76:79]
    ds_read_b128 v[20:23], v6 offset:20480
    v_mfma_f32_16x16x32_bf16 v[80:83], a[152:155], v[32:35], v[80:83]
    v_mfma_f32_16x16x32_bf16 v[84:87], a[152:155], v[36:39], v[84:87]
    v_mfma_f32_16x16x32_bf16 v[72:75], a[76:79], v[40:43], v[72:75]
    ds_read_b128 v[24:27], v7 offset:0
    v_mfma_f32_16x16x32_bf16 v[76:79], a[76:79], v[44:47], v[76:79]
    ds_read_b128 v[28:31], v7 offset:20480
    v_mfma_f32_16x16x32_bf16 v[80:83], a[156:159], v[40:43], v[80:83]
    v_mfma_f32_16x16x32_bf16 v[84:87], a[156:159], v[44:47], v[84:87]
    s_waitcnt lgkmcnt(2)
    s_mov_b32 s62, s63
    s_add_u32 s6, s6, 1
    s_cmp_lt_u32 s6, s64
    s_cbranch_scc1 L_alq_loop
    s_nop 7
    v_fma_f32 v112, v72, s88, v120
    v_fma_f32 v113, v73, s88, v120
    v_fma_f32 v114, v74, s88, v120
    v_fma_f32 v115, v75, s88, v120
    v_exp_f32 v112, v112 clamp
    v_exp_f32 v113, v113 clamp
    v_exp_f32 v114, v114 clamp
    v_exp_f32 v115, v115 clamp
    v_max_f32 v72, v116, v72
    v_max_f32 v73, v116, v73
    v_max_f32 v74, v116, v74
    v_max_f32 v75, v116, v75
    v_add_f32 v72, v72, v112
    v_add_f32 v73, v73, v113
    v_add_f32 v74, v74, v114
    v_add_f32 v75, v75, v115
    v_cvt_pk_bf16_f32 v96, v72, v73
    v_cvt_pk_bf16_f32 v97, v74, v75
    v_fma_f32 v112, v76, s88, v120
    v_fma_f32 v113, v77, s88, v120
    v_fma_f32 v114, v78, s88, v120
    v_fma_f32 v115, v79, s88, v120
    v_exp_f32 v112, v112 clamp
    v_exp_f32 v113, v113 clamp
    v_exp_f32 v114, v114 clamp
    v_exp_f32 v115, v115 clamp
    v_max_f32 v76, v116, v76
    v_max_f32 v77, v116, v77
    v_max_f32 v78, v116, v78
    v_max_f32 v79, v116, v79
    v_add_f32 v76, v76, v112
    v_add_f32 v77, v77, v113
    v_add_f32 v78, v78, v114
    v_add_f32 v79, v79, v115
    v_cvt_pk_bf16_f32 v98, v76, v77
    v_cvt_pk_bf16_f32 v99, v78, v79
    buffer_store_dwordx4 v[96:99], v3, s[36:39], s62 offen offset:0
    v_fma_f32 v112, v80, s88, v120
    v_fma_f32 v113, v81, s88, v120
    v_fma_f32 v114, v82, s88, v120
    v_fma_f32 v115, v83, s88, v120
    v_exp_f32 v112, v112 clamp
    v_exp_f32 v113, v113 clamp
    v_exp_f32 v114, v114 clamp
    v_exp_f32 v115, v115 clamp
    v_max_f32 v80, v116, v80
    v_max_f32 v81, v116, v81
    v_max_f32 v82, v116, v82
    v_max_f32 v83, v116, v83
    v_add_f32 v80, v80, v112
    v_add_f32 v81, v81, v113
    v_add_f32 v82, v82, v114
    v_add_f32 v83, v83, v115
    v_cvt_pk_bf16_f32 v100, v80, v81
    v_cvt_pk_bf16_f32 v101, v82, v83
    v_fma_f32 v112, v84, s88, v120
    v_fma_f32 v113, v85, s88, v120
    v_fma_f32 v114, v86, s88, v120
    v_fma_f32 v115, v87, s88, v120
    v_exp_f32 v112, v112 clamp
    v_exp_f32 v113, v113 clamp
    v_exp_f32 v114, v114 clamp
    v_exp_f32 v115, v115 clamp
    v_max_f32 v84, v116, v84
    v_max_f32 v85, v116, v85
    v_max_f32 v86, v116, v86
    v_max_f32 v87, v116, v87
    v_add_f32 v84, v84, v112
    v_add_f32 v85, v85, v113
    v_add_f32 v86, v86, v114
    v_add_f32 v87, v87, v115
    v_cvt_pk_bf16_f32 v102, v84, v85
    v_cvt_pk_bf16_f32 v103, v86, v87
    buffer_store_dwordx4 v[100:103], v3, s[36:39], s62 offen offset:1024
    s_add_u32 s63, s63, 40960
    s_waitcnt vmcnt(0) lgkmcnt(0)
    s_barrier
    s_branch L_alpha_done
L_alk:
    s_add_u32 m0, s60, 0
    s_nop 0
    buffer_load_dwordx4 v5, s[44:47], s59 offen offset:0 lds
    s_add_u32 m0, s60, 896
    s_nop 0
    buffer_load_dwordx4 v5, s[44:47], s59 offen offset:128 lds
    s_add_u32 m0, s60, 1792
    s_nop 0
    buffer_load_dwordx4 v5, s[44:47], s59 offen offset:256 lds
    s_add_u32 m0, s60, 2688
    s_nop 0
    buffer_load_dwordx4 v5, s[44:47], s59 offen offset:384 lds
    s_add_u32 m0, s60, 3584
    s_nop 0
    buffer_load_dwordx4 v5, s[44:47], s59 offen offset:512 lds
    s_add_u32 m0, s60, 4480
    s_nop 0
    buffer_load_dwordx4 v5, s[44:47], s59 offen offset:640 lds
    s_add_u32 m0, s60, 5376
    s_nop 0
    buffer_load_dwordx4 v5, s[44:47], s59 offen offset:768 lds
    s_add_u32 m0, s60, 6272
    s_nop 0
    buffer_load_dwordx4 v5, s[44:47], s59 offen offset:896 lds
    s_add_u32 m0, s60, 7168
    s_nop 0
    buffer_load_dwordx4 v5, s[44:47], s59 offen offset:1024 lds
    s_add_u32 m0, s60, 8064
    s_nop 0
    buffer_load_dwordx4 v5, s[44:47], s59 offen offset:1152 lds
    s_add_u32 s59, s59, 40960
    s_add_u32 s60, s60, 40960
    s_cmp_ge_u32 s60, 122880
    s_cselect_b32 s55, 122880, 0
    s_sub_u32 s60, s60, s55
    s_add_u32 m0, s60, 0
    s_nop 0
    buffer_load_dwordx4 v5, s[44:47], s59 offen offset:0 lds
    s_add_u32 m0, s60, 896
    s_nop 0
    buffer_load_dwordx4 v5, s[44:47], s59 offen offset:128 lds
    s_add_u32 m0, s60, 1792
    s_nop 0
    buffer_load_dwordx4 v5, s[44:47], s59 offen offset:256 lds
    s_add_u32 m0, s60, 2688
    s_nop 0
    buffer_load_dwordx4 v5, s[44:47], s59 offen offset:384 lds
    s_add_u32 m0, s60, 3584
    s_nop 0
    buffer_load_dwordx4 v5, s[44:47], s59 offen offset:512 lds
    s_add_u32 m0, s60, 4480
    s_nop 0
    buffer_load_dwordx4 v5, s[44:47], s59 offen offset:640 lds
    s_add_u32 m0, s60, 5376
    s_nop 0
    buffer_load_dwordx4 v5, s[44:47], s59 offen offset:768 lds
    s_add_u32 m0, s60, 6272
    s_nop 0
    buffer_load_dwordx4 v5, s[44:47], s59 offen offset:896 lds
    s_add_u32 m0, s60, 7168
    s_nop 0
    buffer_load_dwordx4 v5, s[44:47], s59 offen offset:1024 lds
    s_add_u32 m0, s60, 8064
    s_nop 0
    buffer_load_dwordx4 v5, s[44:47], s59 offen offset:1152 lds
    s_add_u32 s59, s59, 40960
    s_add_u32 s60, s60, 40960
    s_cmp_ge_u32 s60, 122880
    s_cselect_b32 s55, 122880, 0
    s_sub_u32 s60, s60, s55
    s_waitcnt vmcnt(10)
    s_barrier
    ds_read_b128 v[16:19], v6 offset:0
    ds_read_b128 v[20:23], v6 offset:20480
    ds_read_b128 v[24:27], v7 offset:0
    ds_read_b128 v[28:31], v7 offset:20480
    s_mov_b32 s62, 4026531840
    s_waitcnt lgkmcnt(2)
    .p2align 6
L_alk_loop:
    v_mfma_f32_16x16x32_bf16 v[48:51], v[16:19], a[0:3], v[116:119]
    ds_read_b128 v[32:35], v6 offset:1024
    s_add_u32 s61, s61, 40960
    s_cmp_ge_u32 s61, 122880
    s_cselect_b32 s94, 122880, 0
    v_mfma_f32_16x16x32_bf16 v[52:55], v[20:23], a[0:3], v[116:119]
    ds_read_b128 v[36:39], v6 offset:21504
    s_sub_u32 s61, s61, s94
    s_sub_u32 s94, 40960, s94
    v_mfma_f32_16x16x32_bf16 v[56:59], v[16:19], a[80:83], v[116:119]
    s_add_u32 m0, s60, 0
    v_mfma_f32_16x16x32_bf16 v[60:63], v[20:23], a[80:83], v[116:119]
    s_waitcnt lgkmcnt(2)
    v_mfma_f32_16x16x32_bf16 v[48:51], v[24:27], a[4:7], v[48:51]
    ds_read_b128 v[40:43], v7 offset:1024
    buffer_load_dwordx4 v5, s[44:47], s59 offen offset:0 lds
    v_mfma_f32_16x16x32_bf16 v[52:55], v[28:31], a[4:7], v[52:55]
    ds_read_b128 v[44:47], v7 offset:21504
    v_mfma_f32_16x16x32_bf16 v[56:59], v[24:27], a[84:87], v[56:59]
    v_mfma_f32_16x16x32_bf16 v[60:63], v[28:31], a[84:87], v[60:63]
    s_waitcnt lgkmcnt(2)
    s_add_u32 m0, s60, 896
    v_fma_f32 v112, v72, s88, v120
    v_mfma_f32_16x16x32_bf16 v[48:51], v[32:35], a[8:11], v[48:51]
    ds_read_b128 v[16:19], v6 offset:2048
    v_fma_f32 v113, v73, s88, v120
    v_fma_f32 v114, v74, s88, v120
    v_mfma_f32_16x16x32_bf16 v[52:55], v[36:39], a[8:11], v[52:55]
    ds_read_b128 v[20:23], v6 offset:22528
    v_fma_f32 v115, v75, s88, v120
    v_mfma_f32_16x16x32_bf16 v[56:59], v[32:35], a[88:91], v[56:59]
    buffer_load_dwordx4 v5, s[44:47], s59 offen offset:128 lds
    v_exp_f32 v112, v112 clamp
    v_mfma_f32_16x16x32_bf16 v[60:63], v[36:39], a[88:91], v[60:63]
    s_waitcnt lgkmcnt(2)
    v_exp_f32 v113, v113 clamp
    v_mfma_f32_16x16x32_bf16 v[48:51], v[40:43], a[12:15], v[48:51]
    ds_read_b128 v[24:27], v7 offset:2048
    v_exp_f32 v114, v114 clamp
    v_mfma_f32_16x16x32_bf16 v[52:55], v[44:47], a[12:15], v[52:55]
    ds_read_b128 v[28:31], v7 offset:22528
    s_add_u32 m0, s60, 1792
    v_mfma_f32_16x16x32_bf16 v[56:59], v[40:43], a[92:95], v[56:59]
    v_exp_f32 v115, v115 clamp
    v_mfma_f32_16x16x32_bf16 v[60:63], v[44:47], a[92:95], v[60:63]
    s_waitcnt lgkmcnt(2)
    v_max_f32 v72, v116, v72
    v_max_f32 v73, v116, v73
    v_mfma_f32_16x16x32_bf16 v[48:51], v[16:19], a[16:19], v[48:51]
    ds_read_b128 v[32:35], v6 offset:3072
    buffer_load_dwordx4 v5, s[44:47], s59 offen offset:256 lds
    v_max_f32 v74, v116, v74
    v_mfma_f32_16x16x32_bf16 v[52:55], v[20:23], a[16:19], v[52:55]
    ds_read_b128 v[36:39], v6 offset:23552
    v_max_f32 v75, v116, v75
    v_add_f32 v72, v72, v112
    v_mfma_f32_16x16x32_bf16 v[56:59], v[16:19], a[96:99], v[56:59]
    s_add_u32 m0, s60, 2688
    v_add_f32 v73, v73, v113
    v_add_f32 v74, v74, v114
    v_mfma_f32_16x16x32_bf16 v[60:63], v[20:23], a[96:99], v[60:63]
    s_waitcnt lgkmcnt(2)
    v_add_f32 v75, v75, v115
    v_cvt_pk_bf16_f32 v96, v72, v73
    v_mfma_f32_16x16x32_bf16 v[48:51], v[24:27], a[20:23], v[48:51]
    ds_read_b128 v[40:43], v7 offset:3072
    v_cvt_pk_bf16_f32 v97, v74, v75
    v_fma_f32 v112, v76, s88, v120
    v_mfma_f32_16x16x32_bf16 v[52:55], v[28:31], a[20:23], v[52:55]
    ds_read_b128 v[44:47], v7 offset:23552
    buffer_load_dwordx4 v5, s[44:47], s59 offen offset:384 lds
    v_fma_f32 v113, v77, s88, v120
    v_mfma_f32_16x16x32_bf16 v[56:59], v[24:27], a[100:103], v[56:59]
    v_fma_f32 v114, v78, s88, v120
    v_fma_f32 v115, v79, s88, v120
    v_mfma_f32_16x16x32_bf16 v[60:63], v[28:31], a[100:103], v[60:63]
    s_waitcnt lgkmcnt(2)
    v_exp_f32 v112, v112 clamp
    v_mfma_f32_16x16x32_bf16 v[48:51], v[32:35], a[24:27], v[48:51]
    ds_read_b128 v[16:19], v6 offset:4096
    s_add_u32 m0, s60, 3584
    v_mfma_f32_16x16x32_bf16 v[52:55], v[36:39], a[24:27], v[52:55]
    ds_read_b128 v[20:23], v6 offset:24576
    v_exp_f32 v113, v113 clamp
    v_mfma_f32_16x16x32_bf16 v[56:59], v[32:35], a[104:107], v[56:59]
    v_exp_f32 v114, v114 clamp
    v_mfma_f32_16x16x32_bf16 v[60:63], v[36:39], a[104:107], v[60:63]
    s_waitcnt lgkmcnt(2)
    buffer_load_dwordx4 v5, s[44:47], s59 offen offset:512 lds
    v_mfma_f32_16x16x32_bf16 v[48:51], v[40:43], a[28:31], v[48:51]
    ds_read_b128 v[24:27], v7 offset:4096
    v_exp_f32 v115, v115 clamp
    v_mfma_f32_16x16x32_bf16 v[52:55], v[44:47], a[28:31], v[52:55]
    ds_read_b128 v[28:31], v7 offset:24576
    v_max_f32 v76, v116, v76
    v_max_f32 v77, v116, v77
    v_mfma_f32_16x16x32_bf16 v[56:59], v[40:43], a[108:111], v[56:59]
    s_add_u32 m0, s60, 4480
    v_max_f32 v78, v116, v78
    v_max_f32 v79, v116, v79
    v_mfma_f32_16x16x32_bf16 v[60:63], v[44:47], a[108:111], v[60:63]
    s_waitcnt lgkmcnt(2)
    v_add_f32 v76, v76, v112
    v_add_f32 v77, v77, v113
    v_mfma_f32_16x16x32_bf16 v[48:51], v[16:19], a[32:35], v[48:51]
    ds_read_b128 v[32:35], v6 offset:5120
    v_add_f32 v78, v78, v114
    v_add_f32 v79, v79, v115
    v_mfma_f32_16x16x32_bf16 v[52:55], v[20:23], a[32:35], v[52:55]
    ds_read_b128 v[36:39], v6 offset:25600
    buffer_load_dwordx4 v5, s[44:47], s59 offen offset:640 lds
    v_cvt_pk_bf16_f32 v98, v76, v77
    v_mfma_f32_16x16x32_bf16 v[56:59], v[16:19], a[112:115], v[56:59]
    v_cvt_pk_bf16_f32 v99, v78, v79
    buffer_store_dwordx4 v[96:99], v3, s[36:39], s62 offen offset:0
    v_mfma_f32_16x16x32_bf16 v[60:63], v[20:23], a[112:115], v[60:63]
    s_waitcnt lgkmcnt(2)
    s_add_u32 m0, s60, 5376
    v_fma_f32 v112, v80, s88, v120
    v_mfma_f32_16x16x32_bf16 v[48:51], v[24:27], a[36:39], v[48:51]
    ds_read_b128 v[40:43], v7 offset:5120
    v_fma_f32 v113, v81, s88, v120
    v_fma_f32 v114, v82, s88, v120
    v_mfma_f32_16x16x32_bf16 v[52:55], v[28:31], a[36:39], v[52:55]
    ds_read_b128 v[44:47], v7 offset:25600
    v_fma_f32 v115, v83, s88, v120
    v_mfma_f32_16x16x32_bf16 v[56:59], v[24:27], a[116:119], v[56:59]
    buffer_load_dwordx4 v5, s[44:47], s59 offen offset:768 lds
    v_exp_f32 v112, v112 clamp
    v_mfma_f32_16x16x32_bf16 v[60:63], v[28:31], a[116:119], v[60:63]
    s_waitcnt lgkmcnt(2)
    v_exp_f32 v113, v113 clamp
    v_mfma_f32_16x16x32_bf16 v[48:51], v[32:35], a[40:43], v[48:51]
    ds_read_b128 v[16:19], v6 offset:6144
    v_exp_f32 v114, v114 clamp
    v_mfma_f32_16x16x32_bf16 v[52:55], v[36:39], a[40:43], v[52:55]
    ds_read_b128 v[20:23], v6 offset:26624
    s_add_u32 m0, s60, 6272
    v_mfma_f32_16x16x32_bf16 v[56:59], v[32:35], a[120:123], v[56:59]
    v_exp_f32 v115, v115 clamp
    v_mfma_f32_16x16x32_bf16 v[60:63], v[36:39], a[120:123], v[60:63]
    s_waitcnt lgkmcnt(2)
    v_max_f32 v80, v116, v80
    v_max_f32 v81, v116, v81
    v_mfma_f32_16x16x32_bf16 v[48:51], v[40:43], a[44:47], v[48:51]
    ds_read_b128 v[24:27], v7 offset:6144
    buffer_load_dwordx4 v5, s[44:47], s59 offen offset:896 lds
    v_max_f32 v82, v116, v82
    v_mfma_f32_16x16x32_bf16 v[52:55], v[44:47], a[44:47], v[52:55]
    ds_read_b128 v[28:31], v7 offset:26624
    v_max_f32 v83, v116, v83
    v_add_f32 v80, v80, v112
    v_mfma_f32_16x16x32_bf16 v[56:59], v[40:43], a[124:127], v[56:59]
    v_add_f32 v81, v81, v113
    v_add_f32 v82, v82, v114
    v_mfma_f32_16x16x32_bf16 v[60:63], v[44:47], a[124:127], v[60:63]
    s_waitcnt lgkmcnt(2)
    s_add_u32 m0, s60, 7168
    v_add_f32 v83, v83, v115
    v_mfma_f32_16x16x32_bf16 v[48:51], v[16:19], a[48:51], v[48:51]
    ds_read_b128 v[32:35], v6 offset:7168
    v_cvt_pk_bf16_f32 v100, v80, v81
    v_cvt_pk_bf16_f32 v101, v82, v83
    v_mfma_f32_16x16x32_bf16 v[52:55], v[20:23], a[48:51], v[52:55]
    ds_read_b128 v[36:39], v6 offset:27648
    v_fma_f32 v112, v84, s88, v120
    v_fma_f32 v113, v85, s88, v120
    v_mfma_f32_16x16x32_bf16 v[56:59], v[16:19], a[128:131], v[56:59]
    buffer_load_dwordx4 v5, s[44:47], s59 offen offset:1024 lds
    v_fma_f32 v114, v86, s88, v120
    v_fma_f32 v115, v87, s88, v120
    v_mfma_f32_16x16x32_bf16 v[60:63], v[20:23], a[128:131], v[60:63]
    s_waitcnt lgkmcnt(2)
    v_exp_f32 v112, v112 clamp
    v_mfma_f32_16x16x32_bf16 v[48:51], v[24:27], a[52:55], v[48:51]
    ds_read_b128 v[40:43], v7 offset:7168
    s_add_u32 m0, s60, 8064
    v_mfma_f32_16x16x32_bf16 v[52:55], v[28:31], a[52:55], v[52:55]
    ds_read_b128 v[44:47], v7 offset:27648
    v_exp_f32 v113, v113 clamp
    v_mfma_f32_16x16x32_bf16 v[56:59], v[24:27], a[132:135], v[56:59]
    v_exp_f32 v114, v114 clamp
    v_mfma_f32_16x16x32_bf16 v[60:63], v[28:31], a[132:135], v[60:63]
    s_waitcnt lgkmcnt(2)
    buffer_load_dwordx4 v5, s[44:47], s59 offen offset:1152 lds
    v_mfma_f32_16x16x32_bf16 v[48:51], v[32:35], a[56:59], v[48:51]
    ds_read_b128 v[16:19], v6 offset:8192
    v_exp_f32 v115, v115 clamp
    v_mfma_f32_16x16x32_bf16 v[52:55], v[36:39], a[56:59], v[52:55]
    ds_read_b128 v[20:23], v6 offset:28672
    v_max_f32 v84, v116, v84
    v_max_f32 v85, v116, v85
    v_mfma_f32_16x16x32_bf16 v[56:59], v[32:35], a[136:139], v[56:59]
    s_add_u32 s59, s59, 40960
    v_max_f32 v86, v116, v86
    v_max_f32 v87, v116, v87
    v_mfma_f32_16x16x32_bf16 v[60:63], v[36:39], a[136:139], v[60:63]
    s_waitcnt lgkmcnt(2)
    v_add_f32 v84, v84, v112
    v_add_f32 v85, v85, v113
    v_mfma_f32_16x16x32_bf16 v[48:51], v[40:43], a[60:63], v[48:51]
    ds_read_b128 v[24:27], v7 offset:8192
    v_add_f32 v86, v86, v114
    v_add_f32 v87, v87, v115
    v_mfma_f32_16x16x32_bf16 v[52:55], v[44:47], a[60:63], v[52:55]
    ds_read_b128 v[28:31], v7 offset:28672
    s_add_u32 s60, s60, 40960
    v_cvt_pk_bf16_f32 v102, v84, v85
    v_mfma_f32_16x16x32_bf16 v[56:59], v[40:43], a[140:143], v[56:59]
    v_cvt_pk_bf16_f32 v103, v86, v87
    buffer_store_dwordx4 v[100:103], v3, s[36:39], s62 offen offset:1024
    v_mfma_f32_16x16x32_bf16 v[60:63], v[44:47], a[140:143], v[60:63]
    s_waitcnt lgkmcnt(2)
    s_add_u32 s63, s63, 40960
    v_mfma_f32_16x16x32_bf16 v[48:51], v[16:19], a[64:67], v[48:51]
    ds_read_b128 v[32:35], v6 offset:9216
    s_cmp_ge_u32 s60, 122880
    s_cselect_b32 s55, 122880, 0
    v_mfma_f32_16x16x32_bf16 v[52:55], v[20:23], a[64:67], v[52:55]
    ds_read_b128 v[36:39], v6 offset:29696
    v_mfma_f32_16x16x32_bf16 v[56:59], v[16:19], a[144:147], v[56:59]
    v_mfma_f32_16x16x32_bf16 v[60:63], v[20:23], a[144:147], v[60:63]
    s_waitcnt lgkmcnt(2)
    s_sub_u32 s60, s60, s55
    v_mfma_f32_16x16x32_bf16 v[48:51], v[24:27], a[68:71], v[48:51]
    ds_read_b128 v[40:43], v7 offset:9216
    v_add_u32 v6, s94, v6
    v_mfma_f32_16x16x32_bf16 v[52:55], v[28:31], a[68:71], v[52:55]
    ds_read_b128 v[44:47], v7 offset:29696
    v_add_u32 v7, s94, v7
    v_mfma_f32_16x16x32_bf16 v[56:59], v[24:27], a[148:151], v[56:59]
    v_mfma_f32_16x16x32_bf16 v[60:63], v[28:31], a[148:151], v[60:63]
    s_waitcnt vmcnt(12) lgkmcnt(0)
    s_barrier
    v_mfma_f32_16x16x32_bf16 v[48:51], v[32:35], a[72:75], v[48:51]
    ds_read_b128 v[16:19], v6 offset:0
    v_mfma_f32_16x16x32_bf16 v[52:55], v[36:39], a[72:75], v[52:55]
    ds_read_b128 v[20:23], v6 offset:20480
    v_mfma_f32_16x16x32_bf16 v[56:59], v[32:35], a[152:155], v[56:59]
    v_mfma_f32_16x16x32_bf16 v[60:63], v[36:39], a[152:155], v[60:63]
    v_mfma_f32_16x16x32_bf16 v[48:51], v[40:43], a[76:79], v[48:51]
    ds_read_b128 v[24:27], v7 offset:0
    v_mfma_f32_16x16x32_bf16 v[52:55], v[44:47], a[76:79], v[52:55]
    ds_read_b128 v[28:31], v7 offset:20480
    v_mfma_f32_16x16x32_bf16 v[56:59], v[40:43], a[156:159], v[56:59]
    v_mfma_f32_16x16x32_bf16 v[60:63], v[44:47], a[156:159], v[60:63]
    s_waitcnt lgkmcnt(2)
    s_mov_b32 s62, s63
    s_add_u32 s6, s6, 1
    v_mfma_f32_16x16x32_bf16 v[72:75], v[16:19], a[0:3], v[116:119]
    ds_read_b128 v[32:35], v6 offset:1024
    s_add_u32 s61, s61, 40960
    s_cmp_ge_u32 s61, 122880
    s_cselect_b32 s94, 122880, 0
    v_mfma_f32_16x16x32_bf16 v[76:79], v[20:23], a[0:3], v[116:119]
    ds_read_b128 v[36:39], v6 offset:21504
    s_sub_u32 s61, s61, s94
    s_sub_u32 s94, 40960, s94
    v_mfma_f32_16x16x32_bf16 v[80:83], v[16:19], a[80:83], v[116:119]
    s_add_u32 m0, s60, 0
    v_mfma_f32_16x16x32_bf16 v[84:87], v[20:23], a[80:83], v[116:119]
    s_waitcnt lgkmcnt(2)
    v_mfma_f32_16x16x32_bf16 v[72:75], v[24:27], a[4:7], v[72:75]
    ds_read_b128 v[40:43], v7 offset:1024
    buffer_load_dwordx4 v5, s[44:47], s59 offen offset:0 lds
    v_mfma_f32_16x16x32_bf16 v[76:79], v[28:31], a[4:7], v[76:79]
    ds_read_b128 v[44:47], v7 offset:21504
    v_mfma_f32_16x16x32_bf16 v[80:83], v[24:27], a[84:87], v[80:83]
    v_mfma_f32_16x16x32_bf16 v[84:87], v[28:31], a[84:87], v[84:87]
    s_waitcnt lgkmcnt(2)
    s_add_u32 m0, s60, 896
    v_fma_f32 v112, v48, s88, v120
    v_mfma_f32_16x16x32_bf16 v[72:75], v[32:35], a[8:11], v[72:75]
    ds_read_b128 v[16:19], v6 offset:2048
    v_fma_f32 v113, v49, s88, v120
    v_fma_f32 v114, v50, s88, v120
    v_mfma_f32_16x16x32_bf16 v[76:79], v[36:39], a[8:11], v[76:79]
    ds_read_b128 v[20:23], v6 offset:22528
    v_fma_f32 v115, v51, s88, v120
    v_mfma_f32_16x16x32_bf16 v[80:83], v[32:35], a[88:91], v[80:83]
    buffer_load_dwordx4 v5, s[44:47], s59 offen offset:128 lds
    v_exp_f32 v112, v112 clamp
    v_mfma_f32_16x16x32_bf16 v[84:87], v[36:39], a[88:91], v[84:87]
    s_waitcnt lgkmcnt(2)
    v_exp_f32 v113, v113 clamp
    v_mfma_f32_16x16x32_bf16 v[72:75], v[40:43], a[12:15], v[72:75]
    ds_read_b128 v[24:27], v7 offset:2048
    v_exp_f32 v114, v114 clamp
    v_mfma_f32_16x16x32_bf16 v[76:79], v[44:47], a[12:15], v[76:79]
    ds_read_b128 v[28:31], v7 offset:22528
    s_add_u32 m0, s60, 1792
    v_mfma_f32_16x16x32_bf16 v[80:83], v[40:43], a[92:95], v[80:83]
    v_exp_f32 v115, v115 clamp
    v_mfma_f32_16x16x32_bf16 v[84:87], v[44:47], a[92:95], v[84:87]
    s_waitcnt lgkmcnt(2)
    v_max_f32 v48, v116, v48
    v_max_f32 v49, v116, v49
    v_mfma_f32_16x16x32_bf16 v[72:75], v[16:19], a[16:19], v[72:75]
    ds_read_b128 v[32:35], v6 offset:3072
    buffer_load_dwordx4 v5, s[44:47], s59 offen offset:256 lds
    v_max_f32 v50, v116, v50
    v_mfma_f32_16x16x32_bf16 v[76:79], v[20:23], a[16:19], v[76:79]
    ds_read_b128 v[36:39], v6 offset:23552
    v_max_f32 v51, v116, v51
    v_add_f32 v48, v48, v112
    v_mfma_f32_16x16x32_bf16 v[80:83], v[16:19], a[96:99], v[80:83]
    s_add_u32 m0, s60, 2688
    v_add_f32 v49, v49, v113
    v_add_f32 v50, v50, v114
    v_mfma_f32_16x16x32_bf16 v[84:87], v[20:23], a[96:99], v[84:87]
    s_waitcnt lgkmcnt(2)
    v_add_f32 v51, v51, v115
    v_cvt_pk_bf16_f32 v96, v48, v49
    v_mfma_f32_16x16x32_bf16 v[72:75], v[24:27], a[20:23], v[72:75]
    ds_read_b128 v[40:43], v7 offset:3072
    v_cvt_pk_bf16_f32 v97, v50, v51
    v_fma_f32 v112, v52, s88, v120
    v_mfma_f32_16x16x32_bf16 v[76:79], v[28:31], a[20:23], v[76:79]
    ds_read_b128 v[44:47], v7 offset:23552
    buffer_load_dwordx4 v5, s[44:47], s59 offen offset:384 lds
    v_fma_f32 v113, v53, s88, v120
    v_mfma_f32_16x16x32_bf16 v[80:83], v[24:27], a[100:103], v[80:83]
    v_fma_f32 v114, v54, s88, v120
    v_fma_f32 v115, v55, s88, v120
    v_mfma_f32_16x16x32_bf16 v[84:87], v[28:31], a[100:103], v[84:87]
    s_waitcnt lgkmcnt(2)
    v_exp_f32 v112, v112 clamp
    v_mfma_f32_16x16x32_bf16 v[72:75], v[32:35], a[24:27], v[72:75]
    ds_read_b128 v[16:19], v6 offset:4096
    s_add_u32 m0, s60, 3584
    v_mfma_f32_16x16x32_bf16 v[76:79], v[36:39], a[24:27], v[76:79]
    ds_read_b128 v[20:23], v6 offset:24576
    v_exp_f32 v113, v113 clamp
    v_mfma_f32_16x16x32_bf16 v[80:83], v[32:35], a[104:107], v[80:83]
    v_exp_f32 v114, v114 clamp
    v_mfma_f32_16x16x32_bf16 v[84:87], v[36:39], a[104:107], v[84:87]
    s_waitcnt lgkmcnt(2)
    buffer_load_dwordx4 v5, s[44:47], s59 offen offset:512 lds
    v_mfma_f32_16x16x32_bf16 v[72:75], v[40:43], a[28:31], v[72:75]
    ds_read_b128 v[24:27], v7 offset:4096
    v_exp_f32 v115, v115 clamp
    v_mfma_f32_16x16x32_bf16 v[76:79], v[44:47], a[28:31], v[76:79]
    ds_read_b128 v[28:31], v7 offset:24576
    v_max_f32 v52, v116, v52
    v_max_f32 v53, v116, v53
    v_mfma_f32_16x16x32_bf16 v[80:83], v[40:43], a[108:111], v[80:83]
    s_add_u32 m0, s60, 4480
    v_max_f32 v54, v116, v54
    v_max_f32 v55, v116, v55
    v_mfma_f32_16x16x32_bf16 v[84:87], v[44:47], a[108:111], v[84:87]
    s_waitcnt lgkmcnt(2)
    v_add_f32 v52, v52, v112
    v_add_f32 v53, v53, v113
    v_mfma_f32_16x16x32_bf16 v[72:75], v[16:19], a[32:35], v[72:75]
    ds_read_b128 v[32:35], v6 offset:5120
    v_add_f32 v54, v54, v114
    v_add_f32 v55, v55, v115
    v_mfma_f32_16x16x32_bf16 v[76:79], v[20:23], a[32:35], v[76:79]
    ds_read_b128 v[36:39], v6 offset:25600
    buffer_load_dwordx4 v5, s[44:47], s59 offen offset:640 lds
    v_cvt_pk_bf16_f32 v98, v52, v53
    v_mfma_f32_16x16x32_bf16 v[80:83], v[16:19], a[112:115], v[80:83]
    v_cvt_pk_bf16_f32 v99, v54, v55
    buffer_store_dwordx4 v[96:99], v3, s[36:39], s62 offen offset:0
    v_mfma_f32_16x16x32_bf16 v[84:87], v[20:23], a[112:115], v[84:87]
    s_waitcnt lgkmcnt(2)
    s_add_u32 m0, s60, 5376
    v_fma_f32 v112, v56, s88, v120
    v_mfma_f32_16x16x32_bf16 v[72:75], v[24:27], a[36:39], v[72:75]
    ds_read_b128 v[40:43], v7 offset:5120
    v_fma_f32 v113, v57, s88, v120
    v_fma_f32 v114, v58, s88, v120
    v_mfma_f32_16x16x32_bf16 v[76:79], v[28:31], a[36:39], v[76:79]
    ds_read_b128 v[44:47], v7 offset:25600
    v_fma_f32 v115, v59, s88, v120
    v_mfma_f32_16x16x32_bf16 v[80:83], v[24:27], a[116:119], v[80:83]
    buffer_load_dwordx4 v5, s[44:47], s59 offen offset:768 lds
    v_exp_f32 v112, v112 clamp
    v_mfma_f32_16x16x32_bf16 v[84:87], v[28:31], a[116:119], v[84:87]
    s_waitcnt lgkmcnt(2)
    v_exp_f32 v113, v113 clamp
    v_mfma_f32_16x16x32_bf16 v[72:75], v[32:35], a[40:43], v[72:75]
    ds_read_b128 v[16:19], v6 offset:6144
    v_exp_f32 v114, v114 clamp
    v_mfma_f32_16x16x32_bf16 v[76:79], v[36:39], a[40:43], v[76:79]
    ds_read_b128 v[20:23], v6 offset:26624
    s_add_u32 m0, s60, 6272
    v_mfma_f32_16x16x32_bf16 v[80:83], v[32:35], a[120:123], v[80:83]
    v_exp_f32 v115, v115 clamp
    v_mfma_f32_16x16x32_bf16 v[84:87], v[36:39], a[120:123], v[84:87]
    s_waitcnt lgkmcnt(2)
    v_max_f32 v56, v116, v56
    v_max_f32 v57, v116, v57
    v_mfma_f32_16x16x32_bf16 v[72:75], v[40:43], a[44:47], v[72:75]
    ds_read_b128 v[24:27], v7 offset:6144
    buffer_load_dwordx4 v5, s[44:47], s59 offen offset:896 lds
    v_max_f32 v58, v116, v58
    v_mfma_f32_16x16x32_bf16 v[76:79], v[44:47], a[44:47], v[76:79]
    ds_read_b128 v[28:31], v7 offset:26624
    v_max_f32 v59, v116, v59
    v_add_f32 v56, v56, v112
    v_mfma_f32_16x16x32_bf16 v[80:83], v[40:43], a[124:127], v[80:83]
    v_add_f32 v57, v57, v113
    v_add_f32 v58, v58, v114
    v_mfma_f32_16x16x32_bf16 v[84:87], v[44:47], a[124:127], v[84:87]
    s_waitcnt lgkmcnt(2)
    s_add_u32 m0, s60, 7168
    v_add_f32 v59, v59, v115
    v_mfma_f32_16x16x32_bf16 v[72:75], v[16:19], a[48:51], v[72:75]
    ds_read_b128 v[32:35], v6 offset:7168
    v_cvt_pk_bf16_f32 v100, v56, v57
    v_cvt_pk_bf16_f32 v101, v58, v59
    v_mfma_f32_16x16x32_bf16 v[76:79], v[20:23], a[48:51], v[76:79]
    ds_read_b128 v[36:39], v6 offset:27648
    v_fma_f32 v112, v60, s88, v120
    v_fma_f32 v113, v61, s88, v120
    v_mfma_f32_16x16x32_bf16 v[80:83], v[16:19], a[128:131], v[80:83]
    buffer_load_dwordx4 v5, s[44:47], s59 offen offset:1024 lds
    v_fma_f32 v114, v62, s88, v120
    v_fma_f32 v115, v63, s88, v120
    v_mfma_f32_16x16x32_bf16 v[84:87], v[20:23], a[128:131], v[84:87]
    s_waitcnt lgkmcnt(2)
    v_exp_f32 v112, v112 clamp
    v_mfma_f32_16x16x32_bf16 v[72:75], v[24:27], a[52:55], v[72:75]
    ds_read_b128 v[40:43], v7 offset:7168
    s_add_u32 m0, s60, 8064
    v_mfma_f32_16x16x32_bf16 v[76:79], v[28:31], a[52:55], v[76:79]
    ds_read_b128 v[44:47], v7 offset:27648
    v_exp_f32 v113, v113 clamp
    v_mfma_f32_16x16x32_bf16 v[80:83], v[24:27], a[132:135], v[80:83]
    v_exp_f32 v114, v114 clamp
    v_mfma_f32_16x16x32_bf16 v[84:87], v[28:31], a[132:135], v[84:87]
    s_waitcnt lgkmcnt(2)
    buffer_load_dwordx4 v5, s[44:47], s59 offen offset:1152 lds
    v_mfma_f32_16x16x32_bf16 v[72:75], v[32:35], a[56:59], v[72:75]
    ds_read_b128 v[16:19], v6 offset:8192
    v_exp_f32 v115, v115 clamp
    v_mfma_f32_16x16x32_bf16 v[76:79], v[36:39], a[56:59], v[76:79]
    ds_read_b128 v[20:23], v6 offset:28672
    v_max_f32 v60, v116, v60
    v_max_f32 v61, v116, v61
    v_mfma_f32_16x16x32_bf16 v[80:83], v[32:35], a[136:139], v[80:83]
    s_add_u32 s59, s59, 40960
    v_max_f32 v62, v116, v62
    v_max_f32 v63, v116, v63
    v_mfma_f32_16x16x32_bf16 v[84:87], v[36:39], a[136:139], v[84:87]
    s_waitcnt lgkmcnt(2)
    v_add_f32 v60, v60, v112
    v_add_f32 v61, v61, v113
    v_mfma_f32_16x16x32_bf16 v[72:75], v[40:43], a[60:63], v[72:75]
    ds_read_b128 v[24:27], v7 offset:8192
    v_add_f32 v62, v62, v114
    v_add_f32 v63, v63, v115
    v_mfma_f32_16x16x32_bf16 v[76:79], v[44:47], a[60:63], v[76:79]
    ds_read_b128 v[28:31], v7 offset:28672
    s_add_u32 s60, s60, 40960
    v_cvt_pk_bf16_f32 v102, v60, v61
    v_mfma_f32_16x16x32_bf16 v[80:83], v[40:43], a[140:143], v[80:83]
    v_cvt_pk_bf16_f32 v103, v62, v63
    buffer_store_dwordx4 v[100:103], v3, s[36:39], s62 offen offset:1024
    v_mfma_f32_16x16x32_bf16 v[84:87], v[44:47], a[140:143], v[84:87]
    s_waitcnt lgkmcnt(2)
    s_add_u32 s63, s63, 40960
    v_mfma_f32_16x16x32_bf16 v[72:75], v[16:19], a[64:67], v[72:75]
    ds_read_b128 v[32:35], v6 offset:9216
    s_cmp_ge_u32 s60, 122880
    s_cselect_b32 s55, 122880, 0
    v_mfma_f32_16x16x32_bf16 v[76:79], v[20:23], a[64:67], v[76:79]
    ds_read_b128 v[36:39], v6 offset:29696
    v_mfma_f32_16x16x32_bf16 v[80:83], v[16:19], a[144:147], v[80:83]
    v_mfma_f32_16x16x32_bf16 v[84:87], v[20:23], a[144:147], v[84:87]
    s_waitcnt lgkmcnt(2)
    s_sub_u32 s60, s60, s55
    v_mfma_f32_16x16x32_bf16 v[72:75], v[24:27], a[68:71], v[72:75]
    ds_read_b128 v[40:43], v7 offset:9216
    v_add_u32 v6, s94, v6
    v_mfma_f32_16x16x32_bf16 v[76:79], v[28:31], a[68:71], v[76:79]
    ds_read_b128 v[44:47], v7 offset:29696
    v_add_u32 v7, s94, v7
    v_mfma_f32_16x16x32_bf16 v[80:83], v[24:27], a[148:151], v[80:83]
    v_mfma_f32_16x16x32_bf16 v[84:87], v[28:31], a[148:151], v[84:87]
    s_waitcnt vmcnt(12) lgkmcnt(0)
    s_barrier
    v_mfma_f32_16x16x32_bf16 v[72:75], v[32:35], a[72:75], v[72:75]
    ds_read_b128 v[16:19], v6 offset:0
    v_mfma_f32_16x16x32_bf16 v[76:79], v[36:39], a[72:75], v[76:79]
    ds_read_b128 v[20:23], v6 offset:20480
    v_mfma_f32_16x16x32_bf16 v[80:83], v[32:35], a[152:155], v[80:83]
    v_mfma_f32_16x16x32_bf16 v[84:87], v[36:39], a[152:155], v[84:87]
    v_mfma_f32_16x16x32_bf16 v[72:75], v[40:43], a[76:79], v[72:75]
    ds_read_b128 v[24:27], v7 offset:0
    v_mfma_f32_16x16x32_bf16 v[76:79], v[44:47], a[76:79], v[76:79]
    ds_read_b128 v[28:31], v7 offset:20480
    v_mfma_f32_16x16x32_bf16 v[80:83], v[40:43], a[156:159], v[80:83]
    v_mfma_f32_16x16x32_bf16 v[84:87], v[44:47], a[156:159], v[84:87]
    s_waitcnt lgkmcnt(2)
    s_mov_b32 s62, s63
    s_add_u32 s6, s6, 1
    s_cmp_lt_u32 s6, s64
    s_cbranch_scc1 L_alk_loop
    s_nop 7
    v_fma_f32 v112, v72, s88, v120
    v_fma_f32 v113, v73, s88, v120
    v_fma_f32 v114, v74, s88, v120
    v_fma_f32 v115, v75, s88, v120
    v_exp_f32 v112, v112 clamp
    v_exp_f32 v113, v113 clamp
    v_exp_f32 v114, v114 clamp
    v_exp_f32 v115, v115 clamp
    v_max_f32 v72, v116, v72
    v_max_f32 v73, v116, v73
    v_max_f32 v74, v116, v74
    v_max_f32 v75, v116, v75
    v_add_f32 v72, v72, v112
    v_add_f32 v73, v73, v113
    v_add_f32 v74, v74, v114
    v_add_f32 v75, v75, v115
    v_cvt_pk_bf16_f32 v96, v72, v73
    v_cvt_pk_bf16_f32 v97, v74, v75
    v_fma_f32 v112, v76, s88, v120
    v_fma_f32 v113, v77, s88, v120
    v_fma_f32 v114, v78, s88, v120
    v_fma_f32 v115, v79, s88, v120
    v_exp_f32 v112, v112 clamp
    v_exp_f32 v113, v113 clamp
    v_exp_f32 v114, v114 clamp
    v_exp_f32 v115, v115 clamp
    v_max_f32 v76, v116, v76
    v_max_f32 v77, v116, v77
    v_max_f32 v78, v116, v78
    v_max_f32 v79, v116, v79
    v_add_f32 v76, v76, v112
    v_add_f32 v77, v77, v113
    v_add_f32 v78, v78, v114
    v_add_f32 v79, v79, v115
    v_cvt_pk_bf16_f32 v98, v76, v77
    v_cvt_pk_bf16_f32 v99, v78, v79
    buffer_store_dwordx4 v[96:99], v3, s[36:39], s62 offen offset:0
    v_fma_f32 v112, v80, s88, v120
    v_fma_f32 v113, v81, s88, v120
    v_fma_f32 v114, v82, s88, v120
    v_fma_f32 v115, v83, s88, v120
    v_exp_f32 v112, v112 clamp
    v_exp_f32 v113, v113 clamp
    v_exp_f32 v114, v114 clamp
    v_exp_f32 v115, v115 clamp
    v_max_f32 v80, v116, v80
    v_max_f32 v81, v116, v81
    v_max_f32 v82, v116, v82
    v_max_f32 v83, v116, v83
    v_add_f32 v80, v80, v112
    v_add_f32 v81, v81, v113
    v_add_f32 v82, v82, v114
    v_add_f32 v83, v83, v115
    v_cvt_pk_bf16_f32 v100, v80, v81
    v_cvt_pk_bf16_f32 v101, v82, v83
    v_fma_f32 v112, v84, s88, v120
    v_fma_f32 v113, v85, s88, v120
    v_fma_f32 v114, v86, s88, v120
    v_fma_f32 v115, v87, s88, v120
    v_exp_f32 v112, v112 clamp
    v_exp_f32 v113, v113 clamp
    v_exp_f32 v114, v114 clamp
    v_exp_f32 v115, v115 clamp
    v_max_f32 v84, v116, v84
    v_max_f32 v85, v116, v85
    v_max_f32 v86, v116, v86
    v_max_f32 v87, v116, v87
    v_add_f32 v84, v84, v112
    v_add_f32 v85, v85, v113
    v_add_f32 v86, v86, v114
    v_add_f32 v87, v87, v115
    v_cvt_pk_bf16_f32 v102, v84, v85
    v_cvt_pk_bf16_f32 v103, v86, v87
    buffer_store_dwordx4 v[100:103], v3, s[36:39], s62 offen offset:1024
    s_add_u32 s63, s63, 40960
    s_waitcnt vmcnt(0) lgkmcnt(0)
    s_barrier
    s_branch L_alpha_done
L_alv:
    s_add_u32 m0, s60, 0
    s_nop 0
    buffer_load_dwordx4 v5, s[44:47], s59 offen offset:0 lds
    s_add_u32 m0, s60, 896
    s_nop 0
    buffer_load_dwordx4 v5, s[44:47], s59 offen offset:128 lds
    s_add_u32 m0, s60, 1792
    s_nop 0
    buffer_load_dwordx4 v5, s[44:47], s59 offen offset:256 lds
    s_add_u32 m0, s60, 2688
    s_nop 0
    buffer_load_dwordx4 v5, s[44:47], s59 offen offset:384 lds
    s_add_u32 m0, s60, 3584
    s_nop 0
    buffer_load_dwordx4 v5, s[44:47], s59 offen offset:512 lds
    s_add_u32 m0, s60, 4480
    s_nop 0
    buffer_load_dwordx4 v5, s[44:47], s59 offen offset:640 lds
    s_add_u32 m0, s60, 5376
    s_nop 0
    buffer_load_dwordx4 v5, s[44:47], s59 offen offset:768 lds
    s_add_u32 m0, s60, 6272
    s_nop 0
    buffer_load_dwordx4 v5, s[44:47], s59 offen offset:896 lds
    s_add_u32 m0, s60, 7168
    s_nop 0
    buffer_load_dwordx4 v5, s[44:47], s59 offen offset:1024 lds
    s_add_u32 m0, s60, 8064
    s_nop 0
    buffer_load_dwordx4 v5, s[44:47], s59 offen offset:1152 lds
    s_add_u32 s59, s59, 40960
    s_add_u32 s60, s60, 40960
    s_cmp_ge_u32 s60, 122880
    s_cselect_b32 s55, 122880, 0
    s_sub_u32 s60, s60, s55
    s_add_u32 m0, s60, 0
    s_nop 0
    buffer_load_dwordx4 v5, s[44:47], s59 offen offset:0 lds
    s_add_u32 m0, s60, 896
    s_nop 0
    buffer_load_dwordx4 v5, s[44:47], s59 offen offset:128 lds
    s_add_u32 m0, s60, 1792
    s_nop 0
    buffer_load_dwordx4 v5, s[44:47], s59 offen offset:256 lds
    s_add_u32 m0, s60, 2688
    s_nop 0
    buffer_load_dwordx4 v5, s[44:47], s59 offen offset:384 lds
    s_add_u32 m0, s60, 3584
    s_nop 0
    buffer_load_dwordx4 v5, s[44:47], s59 offen offset:512 lds
    s_add_u32 m0, s60, 4480
    s_nop 0
    buffer_load_dwordx4 v5, s[44:47], s59 offen offset:640 lds
    s_add_u32 m0, s60, 5376
    s_nop 0
    buffer_load_dwordx4 v5, s[44:47], s59 offen offset:768 lds
    s_add_u32 m0, s60, 6272
    s_nop 0
    buffer_load_dwordx4 v5, s[44:47], s59 offen offset:896 lds
    s_add_u32 m0, s60, 7168
    s_nop 0
    buffer_load_dwordx4 v5, s[44:47], s59 offen offset:1024 lds
    s_add_u32 m0, s60, 8064
    s_nop 0
    buffer_load_dwordx4 v5, s[44:47], s59 offen offset:1152 lds
    s_add_u32 s59, s59, 40960
    s_add_u32 s60, s60, 40960
    s_cmp_ge_u32 s60, 122880
    s_cselect_b32 s55, 122880, 0
    s_sub_u32 s60, s60, s55
    s_waitcnt vmcnt(10)
    s_barrier
    ds_read_b128 v[16:19], v6 offset:0
    ds_read_b128 v[20:23], v6 offset:20480
    ds_read_b128 v[24:27], v7 offset:0
    ds_read_b128 v[28:31], v7 offset:20480
    s_mov_b32 s62, 4026531840
    s_waitcnt lgkmcnt(2)
    .p2align 6
L_alv_loop:
    v_mfma_f32_16x16x32_bf16 v[48:51], v[16:19], a[0:3], 0
    ds_read_b128 v[32:35], v6 offset:1024
    s_add_u32 s61, s61, 40960
    s_cmp_ge_u32 s61, 122880
    s_cselect_b32 s94, 122880, 0
    v_mfma_f32_16x16x32_bf16 v[52:55], v[20:23], a[0:3], 0
    ds_read_b128 v[36:39], v6 offset:21504
    s_sub_u32 s61, s61, s94
    s_sub_u32 s94, 40960, s94
    v_mfma_f32_16x16x32_bf16 v[56:59], v[16:19], a[80:83], 0
    s_add_u32 m0, s60, 0
    v_mfma_f32_16x16x32_bf16 v[60:63], v[20:23], a[80:83], 0
    s_waitcnt lgkmcnt(2)
    v_mfma_f32_16x16x32_bf16 v[48:51], v[24:27], a[4:7], v[48:51]
    ds_read_b128 v[40:43], v7 offset:1024
    buffer_load_dwordx4 v5, s[44:47], s59 offen offset:0 lds
    v_mfma_f32_16x16x32_bf16 v[52:55], v[28:31], a[4:7], v[52:55]
    ds_read_b128 v[44:47], v7 offset:21504
    v_mfma_f32_16x16x32_bf16 v[56:59], v[24:27], a[84:87], v[56:59]
    v_mfma_f32_16x16x32_bf16 v[60:63], v[28:31], a[84:87], v[60:63]
    s_waitcnt lgkmcnt(2)
    s_add_u32 m0, s60, 896
    v_cvt_pk_bf16_f32 v96, v72, v73
    v_mfma_f32_16x16x32_bf16 v[48:51], v[32:35], a[8:11], v[48:51]
    ds_read_b128 v[16:19], v6 offset:2048
    v_cvt_pk_bf16_f32 v97, v74, v75
    v_cvt_pk_bf16_f32 v98, v76, v77
    v_mfma_f32_16x16x32_bf16 v[52:55], v[36:39], a[8:11], v[52:55]
    ds_read_b128 v[20:23], v6 offset:22528
    v_cvt_pk_bf16_f32 v99, v78, v79
    buffer_store_dwordx4 v[96:99], v3, s[36:39], s62 offen offset:0
    v_mfma_f32_16x16x32_bf16 v[56:59], v[32:35], a[88:91], v[56:59]
    buffer_load_dwordx4 v5, s[44:47], s59 offen offset:128 lds
    v_cvt_pk_bf16_f32 v100, v80, v81
    v_cvt_pk_bf16_f32 v101, v82, v83
    v_mfma_f32_16x16x32_bf16 v[60:63], v[36:39], a[88:91], v[60:63]
    s_waitcnt lgkmcnt(2)
    v_cvt_pk_bf16_f32 v102, v84, v85
    v_cvt_pk_bf16_f32 v103, v86, v87
    v_mfma_f32_16x16x32_bf16 v[48:51], v[40:43], a[12:15], v[48:51]
    ds_read_b128 v[24:27], v7 offset:2048
    buffer_store_dwordx4 v[100:103], v3, s[36:39], s62 offen offset:1024
    s_add_u32 s63, s63, 40960
    v_mfma_f32_16x16x32_bf16 v[52:55], v[44:47], a[12:15], v[52:55]
    ds_read_b128 v[28:31], v7 offset:22528
    s_add_u32 m0, s60, 1792
    v_mfma_f32_16x16x32_bf16 v[56:59], v[40:43], a[92:95], v[56:59]
    v_mfma_f32_16x16x32_bf16 v[60:63], v[44:47], a[92:95], v[60:63]
    s_waitcnt lgkmcnt(2)
    v_mfma_f32_16x16x32_bf16 v[48:51], v[16:19], a[16:19], v[48:51]
    ds_read_b128 v[32:35], v6 offset:3072
    buffer_load_dwordx4 v5, s[44:47], s59 offen offset:256 lds
    v_mfma_f32_16x16x32_bf16 v[52:55], v[20:23], a[16:19], v[52:55]
    ds_read_b128 v[36:39], v6 offset:23552
    v_mfma_f32_16x16x32_bf16 v[56:59], v[16:19], a[96:99], v[56:59]
    s_add_u32 m0, s60, 2688
    v_mfma_f32_16x16x32_bf16 v[60:63], v[20:23], a[96:99], v[60:63]
    s_waitcnt lgkmcnt(2)
    v_mfma_f32_16x16x32_bf16 v[48:51], v[24:27], a[20:23], v[48:51]
    ds_read_b128 v[40:43], v7 offset:3072
    v_mfma_f32_16x16x32_bf16 v[52:55], v[28:31], a[20:23], v[52:55]
    ds_read_b128 v[44:47], v7 offset:23552
    buffer_load_dwordx4 v5, s[44:47], s59 offen offset:384 lds
    v_mfma_f32_16x16x32_bf16 v[56:59], v[24:27], a[100:103], v[56:59]
    v_mfma_f32_16x16x32_bf16 v[60:63], v[28:31], a[100:103], v[60:63]
    s_waitcnt lgkmcnt(2)
    v_mfma_f32_16x16x32_bf16 v[48:51], v[32:35], a[24:27], v[48:51]
    ds_read_b128 v[16:19], v6 offset:4096
    s_add_u32 m0, s60, 3584
    v_mfma_f32_16x16x32_bf16 v[52:55], v[36:39], a[24:27], v[52:55]
    ds_read_b128 v[20:23], v6 offset:24576
    v_mfma_f32_16x16x32_bf16 v[56:59], v[32:35], a[104:107], v[56:59]
    v_mfma_f32_16x16x32_bf16 v[60:63], v[36:39], a[104:107], v[60:63]
    s_waitcnt lgkmcnt(2)
    buffer_load_dwordx4 v5, s[44:47], s59 offen offset:512 lds
    v_mfma_f32_16x16x32_bf16 v[48:51], v[40:43], a[28:31], v[48:51]
    ds_read_b128 v[24:27], v7 offset:4096
    v_mfma_f32_16x16x32_bf16 v[52:55], v[44:47], a[28:31], v[52:55]
    ds_read_b128 v[28:31], v7 offset:24576
    v_mfma_f32_16x16x32_bf16 v[56:59], v[40:43], a[108:111], v[56:59]
    s_add_u32 m0, s60, 4480
    v_mfma_f32_16x16x32_bf16 v[60:63], v[44:47], a[108:111], v[60:63]
    s_waitcnt lgkmcnt(2)
    v_mfma_f32_16x16x32_bf16 v[48:51], v[16:19], a[32:35], v[48:51]
    ds_read_b128 v[32:35], v6 offset:5120
    v_mfma_f32_16x16x32_bf16 v[52:55], v[20:23], a[32:35], v[52:55]
    ds_read_b128 v[36:39], v6 offset:25600
    buffer_load_dwordx4 v5, s[44:47], s59 offen offset:640 lds
    v_mfma_f32_16x16x32_bf16 v[56:59], v[16:19], a[112:115], v[56:59]
    v_mfma_f32_16x16x32_bf16 v[60:63], v[20:23], a[112:115], v[60:63]
    s_waitcnt lgkmcnt(2)
    s_add_u32 m0, s60, 5376
    v_mfma_f32_16x16x32_bf16 v[48:51], v[24:27], a[36:39], v[48:51]
    ds_read_b128 v[40:43], v7 offset:5120
    v_mfma_f32_16x16x32_bf16 v[52:55], v[28:31], a[36:39], v[52:55]
    ds_read_b128 v[44:47], v7 offset:25600
    v_mfma_f32_16x16x32_bf16 v[56:59], v[24:27], a[116:119], v[56:59]
    buffer_load_dwordx4 v5, s[44:47], s59 offen offset:768 lds
    v_mfma_f32_16x16x32_bf16 v[60:63], v[28:31], a[116:119], v[60:63]
    s_waitcnt lgkmcnt(2)
    v_mfma_f32_16x16x32_bf16 v[48:51], v[32:35], a[40:43], v[48:51]
    ds_read_b128 v[16:19], v6 offset:6144
    v_mfma_f32_16x16x32_bf16 v[52:55], v[36:39], a[40:43], v[52:55]
    ds_read_b128 v[20:23], v6 offset:26624
    s_add_u32 m0, s60, 6272
    v_mfma_f32_16x16x32_bf16 v[56:59], v[32:35], a[120:123], v[56:59]
    v_mfma_f32_16x16x32_bf16 v[60:63], v[36:39], a[120:123], v[60:63]
    s_waitcnt lgkmcnt(2)
    v_mfma_f32_16x16x32_bf16 v[48:51], v[40:43], a[44:47], v[48:51]
    ds_read_b128 v[24:27], v7 offset:6144
    buffer_load_dwordx4 v5, s[44:47], s59 offen offset:896 lds
    v_mfma_f32_16x16x32_bf16 v[52:55], v[44:47], a[44:47], v[52:55]
    ds_read_b128 v[28:31], v7 offset:26624
    v_mfma_f32_16x16x32_bf16 v[56:59], v[40:43], a[124:127], v[56:59]
    v_mfma_f32_16x16x32_bf16 v[60:63], v[44:47], a[124:127], v[60:63]
    s_waitcnt lgkmcnt(2)
    s_add_u32 m0, s60, 7168
    v_mfma_f32_16x16x32_bf16 v[48:51], v[16:19], a[48:51], v[48:51]
    ds_read_b128 v[32:35], v6 offset:7168
    v_mfma_f32_16x16x32_bf16 v[52:55], v[20:23], a[48:51], v[52:55]
    ds_read_b128 v[36:39], v6 offset:27648
    v_mfma_f32_16x16x32_bf16 v[56:59], v[16:19], a[128:131], v[56:59]
    buffer_load_dwordx4 v5, s[44:47], s59 offen offset:1024 lds
    v_mfma_f32_16x16x32_bf16 v[60:63], v[20:23], a[128:131], v[60:63]
    s_waitcnt lgkmcnt(2)
    v_mfma_f32_16x16x32_bf16 v[48:51], v[24:27], a[52:55], v[48:51]
    ds_read_b128 v[40:43], v7 offset:7168
    s_add_u32 m0, s60, 8064
    v_mfma_f32_16x16x32_bf16 v[52:55], v[28:31], a[52:55], v[52:55]
    ds_read_b128 v[44:47], v7 offset:27648
    v_mfma_f32_16x16x32_bf16 v[56:59], v[24:27], a[132:135], v[56:59]
    v_mfma_f32_16x16x32_bf16 v[60:63], v[28:31], a[132:135], v[60:63]
    s_waitcnt lgkmcnt(2)
    buffer_load_dwordx4 v5, s[44:47], s59 offen offset:1152 lds
    v_mfma_f32_16x16x32_bf16 v[48:51], v[32:35], a[56:59], v[48:51]
    ds_read_b128 v[16:19], v6 offset:8192
    v_mfma_f32_16x16x32_bf16 v[52:55], v[36:39], a[56:59], v[52:55]
    ds_read_b128 v[20:23], v6 offset:28672
    v_mfma_f32_16x16x32_bf16 v[56:59], v[32:35], a[136:139], v[56:59]
    s_add_u32 s59, s59, 40960
    v_mfma_f32_16x16x32_bf16 v[60:63], v[36:39], a[136:139], v[60:63]
    s_waitcnt lgkmcnt(2)
    v_mfma_f32_16x16x32_bf16 v[48:51], v[40:43], a[60:63], v[48:51]
    ds_read_b128 v[24:27], v7 offset:8192
    v_mfma_f32_16x16x32_bf16 v[52:55], v[44:47], a[60:63], v[52:55]
    ds_read_b128 v[28:31], v7 offset:28672
    s_add_u32 s60, s60, 40960
    v_mfma_f32_16x16x32_bf16 v[56:59], v[40:43], a[140:143], v[56:59]
    v_mfma_f32_16x16x32_bf16 v[60:63], v[44:47], a[140:143], v[60:63]
    s_waitcnt lgkmcnt(2)
    v_mfma_f32_16x16x32_bf16 v[48:51], v[16:19], a[64:67], v[48:51]
    ds_read_b128 v[32:35], v6 offset:9216
    s_cmp_ge_u32 s60, 122880
    s_cselect_b32 s55, 122880, 0
    v_mfma_f32_16x16x32_bf16 v[52:55], v[20:23], a[64:67], v[52:55]
    ds_read_b128 v[36:39], v6 offset:29696
    v_mfma_f32_16x16x32_bf16 v[56:59], v[16:19], a[144:147], v[56:59]
    v_mfma_f32_16x16x32_bf16 v[60:63], v[20:23], a[144:147], v[60:63]
    s_waitcnt lgkmcnt(2)
    s_sub_u32 s60, s60, s55
    v_mfma_f32_16x16x32_bf16 v[48:51], v[24:27], a[68:71], v[48:51]
    ds_read_b128 v[40:43], v7 offset:9216
    v_add_u32 v6, s94, v6
    v_mfma_f32_16x16x32_bf16 v[52:55], v[28:31], a[68:71], v[52:55]
    ds_read_b128 v[44:47], v7 offset:29696
    v_add_u32 v7, s94, v7
    v_mfma_f32_16x16x32_bf16 v[56:59], v[24:27], a[148:151], v[56:59]
    v_mfma_f32_16x16x32_bf16 v[60:63], v[28:31], a[148:151], v[60:63]
    s_waitcnt vmcnt(12) lgkmcnt(0)
    s_barrier
    v_mfma_f32_16x16x32_bf16 v[48:51], v[32:35], a[72:75], v[48:51]
    ds_read_b128 v[16:19], v6 offset:0
    v_mfma_f32_16x16x32_bf16 v[52:55], v[36:39], a[72:75], v[52:55]
    ds_read_b128 v[20:23], v6 offset:20480
    v_mfma_f32_16x16x32_bf16 v[56:59], v[32:35], a[152:155], v[56:59]
    v_mfma_f32_16x16x32_bf16 v[60:63], v[36:39], a[152:155], v[60:63]
    v_mfma_f32_16x16x32_bf16 v[48:51], v[40:43], a[76:79], v[48:51]
    ds_read_b128 v[24:27], v7 offset:0
    v_mfma_f32_16x16x32_bf16 v[52:55], v[44:47], a[76:79], v[52:55]
    ds_read_b128 v[28:31], v7 offset:20480
    v_mfma_f32_16x16x32_bf16 v[56:59], v[40:43], a[156:159], v[56:59]
    v_mfma_f32_16x16x32_bf16 v[60:63], v[44:47], a[156:159], v[60:63]
    s_waitcnt lgkmcnt(2)
    s_mov_b32 s62, s63
    s_add_u32 s6, s6, 1
    v_mfma_f32_16x16x32_bf16 v[72:75], v[16:19], a[0:3], 0
    ds_read_b128 v[32:35], v6 offset:1024
    s_add_u32 s61, s61, 40960
    s_cmp_ge_u32 s61, 122880
    s_cselect_b32 s94, 122880, 0
    v_mfma_f32_16x16x32_bf16 v[76:79], v[20:23], a[0:3], 0
    ds_read_b128 v[36:39], v6 offset:21504
    s_sub_u32 s61, s61, s94
    s_sub_u32 s94, 40960, s94
    v_mfma_f32_16x16x32_bf16 v[80:83], v[16:19], a[80:83], 0
    s_add_u32 m0, s60, 0
    v_mfma_f32_16x16x32_bf16 v[84:87], v[20:23], a[80:83], 0
    s_waitcnt lgkmcnt(2)
    v_mfma_f32_16x16x32_bf16 v[72:75], v[24:27], a[4:7], v[72:75]
    ds_read_b128 v[40:43], v7 offset:1024
    buffer_load_dwordx4 v5, s[44:47], s59 offen offset:0 lds
    v_mfma_f32_16x16x32_bf16 v[76:79], v[28:31], a[4:7], v[76:79]
    ds_read_b128 v[44:47], v7 offset:21504
    v_mfma_f32_16x16x32_bf16 v[80:83], v[24:27], a[84:87], v[80:83]
    v_mfma_f32_16x16x32_bf16 v[84:87], v[28:31], a[84:87], v[84:87]
    s_waitcnt lgkmcnt(2)
    s_add_u32 m0, s60, 896
    v_cvt_pk_bf16_f32 v96, v48, v49
    v_mfma_f32_16x16x32_bf16 v[72:75], v[32:35], a[8:11], v[72:75]
    ds_read_b128 v[16:19], v6 offset:2048
    v_cvt_pk_bf16_f32 v97, v50, v51
    v_cvt_pk_bf16_f32 v98, v52, v53
    v_mfma_f32_16x16x32_bf16 v[76:79], v[36:39], a[8:11], v[76:79]
    ds_read_b128 v[20:23], v6 offset:22528
    v_cvt_pk_bf16_f32 v99, v54, v55
    buffer_store_dwordx4 v[96:99], v3, s[36:39], s62 offen offset:0
    v_mfma_f32_16x16x32_bf16 v[80:83], v[32:35], a[88:91], v[80:83]
    buffer_load_dwordx4 v5, s[44:47], s59 offen offset:128 lds
    v_cvt_pk_bf16_f32 v100, v56, v57
    v_cvt_pk_bf16_f32 v101, v58, v59
    v_mfma_f32_16x16x32_bf16 v[84:87], v[36:39], a[88:91], v[84:87]
    s_waitcnt lgkmcnt(2)
    v_cvt_pk_bf16_f32 v102, v60, v61
    v_cvt_pk_bf16_f32 v103, v62, v63
    v_mfma_f32_16x16x32_bf16 v[72:75], v[40:43], a[12:15], v[72:75]
    ds_read_b128 v[24:27], v7 offset:2048
    buffer_store_dwordx4 v[100:103], v3, s[36:39], s62 offen offset:1024
    s_add_u32 s63, s63, 40960
    v_mfma_f32_16x16x32_bf16 v[76:79], v[44:47], a[12:15], v[76:79]
    ds_read_b128 v[28:31], v7 offset:22528
    s_add_u32 m0, s60, 1792
    v_mfma_f32_16x16x32_bf16 v[80:83], v[40:43], a[92:95], v[80:83]
    v_mfma_f32_16x16x32_bf16 v[84:87], v[44:47], a[92:95], v[84:87]
    s_waitcnt lgkmcnt(2)
    v_mfma_f32_16x16x32_bf16 v[72:75], v[16:19], a[16:19], v[72:75]
    ds_read_b128 v[32:35], v6 offset:3072
    buffer_load_dwordx4 v5, s[44:47], s59 offen offset:256 lds
    v_mfma_f32_16x16x32_bf16 v[76:79], v[20:23], a[16:19], v[76:79]
    ds_read_b128 v[36:39], v6 offset:23552
    v_mfma_f32_16x16x32_bf16 v[80:83], v[16:19], a[96:99], v[80:83]
    s_add_u32 m0, s60, 2688
    v_mfma_f32_16x16x32_bf16 v[84:87], v[20:23], a[96:99], v[84:87]
    s_waitcnt lgkmcnt(2)
    v_mfma_f32_16x16x32_bf16 v[72:75], v[24:27], a[20:23], v[72:75]
    ds_read_b128 v[40:43], v7 offset:3072
    v_mfma_f32_16x16x32_bf16 v[76:79], v[28:31], a[20:23], v[76:79]
    ds_read_b128 v[44:47], v7 offset:23552
    buffer_load_dwordx4 v5, s[44:47], s59 offen offset:384 lds
    v_mfma_f32_16x16x32_bf16 v[80:83], v[24:27], a[100:103], v[80:83]
    v_mfma_f32_16x16x32_bf16 v[84:87], v[28:31], a[100:103], v[84:87]
    s_waitcnt lgkmcnt(2)
    v_mfma_f32_16x16x32_bf16 v[72:75], v[32:35], a[24:27], v[72:75]
    ds_read_b128 v[16:19], v6 offset:4096
    s_add_u32 m0, s60, 3584
    v_mfma_f32_16x16x32_bf16 v[76:79], v[36:39], a[24:27], v[76:79]
    ds_read_b128 v[20:23], v6 offset:24576
    v_mfma_f32_16x16x32_bf16 v[80:83], v[32:35], a[104:107], v[80:83]
    v_mfma_f32_16x16x32_bf16 v[84:87], v[36:39], a[104:107], v[84:87]
    s_waitcnt lgkmcnt(2)
    buffer_load_dwordx4 v5, s[44:47], s59 offen offset:512 lds
    v_mfma_f32_16x16x32_bf16 v[72:75], v[40:43], a[28:31], v[72:75]
    ds_read_b128 v[24:27], v7 offset:4096
    v_mfma_f32_16x16x32_bf16 v[76:79], v[44:47], a[28:31], v[76:79]
    ds_read_b128 v[28:31], v7 offset:24576
    v_mfma_f32_16x16x32_bf16 v[80:83], v[40:43], a[108:111], v[80:83]
    s_add_u32 m0, s60, 4480
    v_mfma_f32_16x16x32_bf16 v[84:87], v[44:47], a[108:111], v[84:87]
    s_waitcnt lgkmcnt(2)
    v_mfma_f32_16x16x32_bf16 v[72:75], v[16:19], a[32:35], v[72:75]
    ds_read_b128 v[32:35], v6 offset:5120
    v_mfma_f32_16x16x32_bf16 v[76:79], v[20:23], a[32:35], v[76:79]
    ds_read_b128 v[36:39], v6 offset:25600
    buffer_load_dwordx4 v5, s[44:47], s59 offen offset:640 lds
    v_mfma_f32_16x16x32_bf16 v[80:83], v[16:19], a[112:115], v[80:83]
    v_mfma_f32_16x16x32_bf16 v[84:87], v[20:23], a[112:115], v[84:87]
    s_waitcnt lgkmcnt(2)
    s_add_u32 m0, s60, 5376
    v_mfma_f32_16x16x32_bf16 v[72:75], v[24:27], a[36:39], v[72:75]
    ds_read_b128 v[40:43], v7 offset:5120
    v_mfma_f32_16x16x32_bf16 v[76:79], v[28:31], a[36:39], v[76:79]
    ds_read_b128 v[44:47], v7 offset:25600
    v_mfma_f32_16x16x32_bf16 v[80:83], v[24:27], a[116:119], v[80:83]
    buffer_load_dwordx4 v5, s[44:47], s59 offen offset:768 lds
    v_mfma_f32_16x16x32_bf16 v[84:87], v[28:31], a[116:119], v[84:87]
    s_waitcnt lgkmcnt(2)
    v_mfma_f32_16x16x32_bf16 v[72:75], v[32:35], a[40:43], v[72:75]
    ds_read_b128 v[16:19], v6 offset:6144
    v_mfma_f32_16x16x32_bf16 v[76:79], v[36:39], a[40:43], v[76:79]
    ds_read_b128 v[20:23], v6 offset:26624
    s_add_u32 m0, s60, 6272
    v_mfma_f32_16x16x32_bf16 v[80:83], v[32:35], a[120:123], v[80:83]
    v_mfma_f32_16x16x32_bf16 v[84:87], v[36:39], a[120:123], v[84:87]
    s_waitcnt lgkmcnt(2)
    v_mfma_f32_16x16x32_bf16 v[72:75], v[40:43], a[44:47], v[72:75]
    ds_read_b128 v[24:27], v7 offset:6144
    buffer_load_dwordx4 v5, s[44:47], s59 offen offset:896 lds
    v_mfma_f32_16x16x32_bf16 v[76:79], v[44:47], a[44:47], v[76:79]
    ds_read_b128 v[28:31], v7 offset:26624
    v_mfma_f32_16x16x32_bf16 v[80:83], v[40:43], a[124:127], v[80:83]
    v_mfma_f32_16x16x32_bf16 v[84:87], v[44:47], a[124:127], v[84:87]
    s_waitcnt lgkmcnt(2)
    s_add_u32 m0, s60, 7168
    v_mfma_f32_16x16x32_bf16 v[72:75], v[16:19], a[48:51], v[72:75]
    ds_read_b128 v[32:35], v6 offset:7168
    v_mfma_f32_16x16x32_bf16 v[76:79], v[20:23], a[48:51], v[76:79]
    ds_read_b128 v[36:39], v6 offset:27648
    v_mfma_f32_16x16x32_bf16 v[80:83], v[16:19], a[128:131], v[80:83]
    buffer_load_dwordx4 v5, s[44:47], s59 offen offset:1024 lds
    v_mfma_f32_16x16x32_bf16 v[84:87], v[20:23], a[128:131], v[84:87]
    s_waitcnt lgkmcnt(2)
    v_mfma_f32_16x16x32_bf16 v[72:75], v[24:27], a[52:55], v[72:75]
    ds_read_b128 v[40:43], v7 offset:7168
    s_add_u32 m0, s60, 8064
    v_mfma_f32_16x16x32_bf16 v[76:79], v[28:31], a[52:55], v[76:79]
    ds_read_b128 v[44:47], v7 offset:27648
    v_mfma_f32_16x16x32_bf16 v[80:83], v[24:27], a[132:135], v[80:83]
    v_mfma_f32_16x16x32_bf16 v[84:87], v[28:31], a[132:135], v[84:87]
    s_waitcnt lgkmcnt(2)
    buffer_load_dwordx4 v5, s[44:47], s59 offen offset:1152 lds
    v_mfma_f32_16x16x32_bf16 v[72:75], v[32:35], a[56:59], v[72:75]
    ds_read_b128 v[16:19], v6 offset:8192
    v_mfma_f32_16x16x32_bf16 v[76:79], v[36:39], a[56:59], v[76:79]
    ds_read_b128 v[20:23], v6 offset:28672
    v_mfma_f32_16x16x32_bf16 v[80:83], v[32:35], a[136:139], v[80:83]
    s_add_u32 s59, s59, 40960
    v_mfma_f32_16x16x32_bf16 v[84:87], v[36:39], a[136:139], v[84:87]
    s_waitcnt lgkmcnt(2)
    v_mfma_f32_16x16x32_bf16 v[72:75], v[40:43], a[60:63], v[72:75]
    ds_read_b128 v[24:27], v7 offset:8192
    v_mfma_f32_16x16x32_bf16 v[76:79], v[44:47], a[60:63], v[76:79]
    ds_read_b128 v[28:31], v7 offset:28672
    s_add_u32 s60, s60, 40960
    v_mfma_f32_16x16x32_bf16 v[80:83], v[40:43], a[140:143], v[80:83]
    v_mfma_f32_16x16x32_bf16 v[84:87], v[44:47], a[140:143], v[84:87]
    s_waitcnt lgkmcnt(2)
    v_mfma_f32_16x16x32_bf16 v[72:75], v[16:19], a[64:67], v[72:75]
    ds_read_b128 v[32:35], v6 offset:9216
    s_cmp_ge_u32 s60, 122880
    s_cselect_b32 s55, 122880, 0
    v_mfma_f32_16x16x32_bf16 v[76:79], v[20:23], a[64:67], v[76:79]
    ds_read_b128 v[36:39], v6 offset:29696
    v_mfma_f32_16x16x32_bf16 v[80:83], v[16:19], a[144:147], v[80:83]
    v_mfma_f32_16x16x32_bf16 v[84:87], v[20:23], a[144:147], v[84:87]
    s_waitcnt lgkmcnt(2)
    s_sub_u32 s60, s60, s55
    v_mfma_f32_16x16x32_bf16 v[72:75], v[24:27], a[68:71], v[72:75]
    ds_read_b128 v[40:43], v7 offset:9216
    v_add_u32 v6, s94, v6
    v_mfma_f32_16x16x32_bf16 v[76:79], v[28:31], a[68:71], v[76:79]
    ds_read_b128 v[44:47], v7 offset:29696
    v_add_u32 v7, s94, v7
    v_mfma_f32_16x16x32_bf16 v[80:83], v[24:27], a[148:151], v[80:83]
    v_mfma_f32_16x16x32_bf16 v[84:87], v[28:31], a[148:151], v[84:87]
    s_waitcnt vmcnt(12) lgkmcnt(0)
    s_barrier
    v_mfma_f32_16x16x32_bf16 v[72:75], v[32:35], a[72:75], v[72:75]
    ds_read_b128 v[16:19], v6 offset:0
    v_mfma_f32_16x16x32_bf16 v[76:79], v[36:39], a[72:75], v[76:79]
    ds_read_b128 v[20:23], v6 offset:20480
    v_mfma_f32_16x16x32_bf16 v[80:83], v[32:35], a[152:155], v[80:83]
    v_mfma_f32_16x16x32_bf16 v[84:87], v[36:39], a[152:155], v[84:87]
    v_mfma_f32_16x16x32_bf16 v[72:75], v[40:43], a[76:79], v[72:75]
    ds_read_b128 v[24:27], v7 offset:0
    v_mfma_f32_16x16x32_bf16 v[76:79], v[44:47], a[76:79], v[76:79]
    ds_read_b128 v[28:31], v7 offset:20480
    v_mfma_f32_16x16x32_bf16 v[80:83], v[40:43], a[156:159], v[80:83]
    v_mfma_f32_16x16x32_bf16 v[84:87], v[44:47], a[156:159], v[84:87]
    s_waitcnt lgkmcnt(2)
    s_mov_b32 s62, s63
    s_add_u32 s6, s6, 1
    s_cmp_lt_u32 s6, s64
    s_cbranch_scc1 L_alv_loop
    s_nop 7
    v_cvt_pk_bf16_f32 v96, v72, v73
    v_cvt_pk_bf16_f32 v97, v74, v75
    v_cvt_pk_bf16_f32 v98, v76, v77
    v_cvt_pk_bf16_f32 v99, v78, v79
    buffer_store_dwordx4 v[96:99], v3, s[36:39], s62 offen offset:0
    v_cvt_pk_bf16_f32 v100, v80, v81
    v_cvt_pk_bf16_f32 v101, v82, v83
    v_cvt_pk_bf16_f32 v102, v84, v85
    v_cvt_pk_bf16_f32 v103, v86, v87
    buffer_store_dwordx4 v[100:103], v3, s[36:39], s62 offen offset:1024
    s_add_u32 s63, s63, 40960
    s_waitcnt vmcnt(0) lgkmcnt(0)
    s_barrier
    s_branch L_alpha_done
L_gate:
    s_mov_b32 s40, s28
    s_and_b32 s41, s29, 0xffff
    s_mov_b32 s42, 1280
    s_mov_b32 s43, 0x20000
    v_lshlrev_b32 v10, 4, v1
    buffer_load_dwordx4 a[0:3], v10, s[40:43], 0 offen offset:0
    buffer_load_dwordx4 a[4:7], v10, s[40:43], 0 offen offset:64
    buffer_load_dwordx4 a[8:11], v10, s[40:43], 0 offen offset:128
    buffer_load_dwordx4 a[12:15], v10, s[40:43], 0 offen offset:192
    buffer_load_dwordx4 a[16:19], v10, s[40:43], 0 offen offset:256
    buffer_load_dwordx4 a[20:23], v10, s[40:43], 0 offen offset:320
    buffer_load_dwordx4 a[24:27], v10, s[40:43], 0 offen offset:384
    buffer_load_dwordx4 a[28:31], v10, s[40:43], 0 offen offset:448
    buffer_load_dwordx4 a[32:35], v10, s[40:43], 0 offen offset:512
    buffer_load_dwordx4 a[36:39], v10, s[40:43], 0 offen offset:576
    buffer_load_dwordx4 a[40:43], v10, s[40:43], 0 offen offset:640
    buffer_load_dwordx4 a[44:47], v10, s[40:43], 0 offen offset:704
    buffer_load_dwordx4 a[48:51], v10, s[40:43], 0 offen offset:768
    buffer_load_dwordx4 a[52:55], v10, s[40:43], 0 offen offset:832
    buffer_load_dwordx4 a[56:59], v10, s[40:43], 0 offen offset:896
    buffer_load_dwordx4 a[60:63], v10, s[40:43], 0 offen offset:960
    buffer_load_dwordx4 a[64:67], v10, s[40:43], 0 offen offset:1024
    buffer_load_dwordx4 a[68:71], v10, s[40:43], 0 offen offset:1088
    buffer_load_dwordx4 a[72:75], v10, s[40:43], 0 offen offset:1152
    buffer_load_dwordx4 a[76:79], v10, s[40:43], 0 offen offset:1216
    s_lshl_b32 s63, s6, 7
    s_lshl_b32 s55, s4, 13
    s_add_u32 s63, s63, s55
    s_add_u32 s63, s63, 23199616
    v_lshlrev_b32 v9, 2, v0
    s_waitcnt vmcnt(0)
    s_barrier
    s_mov_b32 s44, s8
    s_and_b32 s45, s9, 0xffff
    s_mov_b32 s46, 2621440
    s_mov_b32 s47, 0x20000
    v_lshrrev_b32 v10, 3, v2
    v_mul_u32_u24 v5, 1280, v10
    v_lshrrev_b32 v10, 1, v10
    s_and_b32 s55, s3, 1
    s_lshl_b32 s55, s55, 2
    v_add_u32 v10, s55, v10
    v_and_b32 v11, 7, v2
    v_xor_b32 v10, v10, v11
    v_lshl_add_u32 v5, v10, 4, v5
    s_mul_i32 s55, s3, 10240
    s_add_u32 s59, s59, s55
    s_mul_i32 s60, s3, 10240
    v_lshrrev_b32 v10, 3, v0
    v_mul_u32_u24 v10, 10240, v10
    v_and_b32 v11, 7, v0
    v_lshl_add_u32 v10, v11, 7, v10
    v_lshrrev_b32 v11, 1, v0
    v_xor_b32 v11, v11, v1
    v_lshl_add_u32 v6, v11, 4, v10
    v_xor_b32 v11, 4, v11
    v_lshl_add_u32 v7, v11, 4, v10
    s_mov_b32 s61, 0
    s_add_u32 m0, s60, 0
    s_nop 0
    buffer_load_dwordx4 v5, s[44:47], s59 offen offset:0 lds
    s_add_u32 m0, s60, 896
    s_nop 0
    buffer_load_dwordx4 v5, s[44:47], s59 offen offset:128 lds
    s_add_u32 m0, s60, 1792
    s_nop 0
    buffer_load_dwordx4 v5, s[44:47], s59 offen offset:256 lds
    s_add_u32 m0, s60, 2688
    s_nop 0
    buffer_load_dwordx4 v5, s[44:47], s59 offen offset:384 lds
    s_add_u32 m0, s60, 3584
    s_nop 0
    buffer_load_dwordx4 v5, s[44:47], s59 offen offset:512 lds
    s_add_u32 m0, s60, 4480
    s_nop 0
    buffer_load_dwordx4 v5, s[44:47], s59 offen offset:640 lds
    s_add_u32 m0, s60, 5376
    s_nop 0
    buffer_load_dwordx4 v5, s[44:47], s59 offen offset:768 lds
    s_add_u32 m0, s60, 6272
    s_nop 0
    buffer_load_dwordx4 v5, s[44:47], s59 offen offset:896 lds
    s_add_u32 m0, s60, 7168
    s_nop 0
    buffer_load_dwordx4 v5, s[44:47], s59 offen offset:1024 lds
    s_add_u32 m0, s60, 8064
    s_nop 0
    buffer_load_dwordx4 v5, s[44:47], s59 offen offset:1152 lds
    s_add_u32 s59, s59, 40960
    s_add_u32 s60, s60, 40960
    s_cmp_ge_u32 s60, 122880
    s_cselect_b32 s55, 122880, 0
    s_sub_u32 s60, s60, s55
    s_add_u32 m0, s60, 0
    s_nop 0
    buffer_load_dwordx4 v5, s[44:47], s59 offen offset:0 lds
    s_add_u32 m0, s60, 896
    s_nop 0
    buffer_load_dwordx4 v5, s[44:47], s59 offen offset:128 lds
    s_add_u32 m0, s60, 1792
    s_nop 0
    buffer_load_dwordx4 v5, s[44:47], s59 offen offset:256 lds
    s_add_u32 m0, s60, 2688
    s_nop 0
    buffer_load_dwordx4 v5, s[44:47], s59 offen offset:384 lds
    s_add_u32 m0, s60, 3584
    s_nop 0
    buffer_load_dwordx4 v5, s[44:47], s59 offen offset:512 lds
    s_add_u32 m0, s60, 4480
    s_nop 0
    buffer_load_dwordx4 v5, s[44:47], s59 offen offset:640 lds
    s_add_u32 m0, s60, 5376
    s_nop 0
    buffer_load_dwordx4 v5, s[44:47], s59 offen offset:768 lds
    s_add_u32 m0, s60, 6272
    s_nop 0
    buffer_load_dwordx4 v5, s[44:47], s59 offen offset:896 lds
    s_add_u32 m0, s60, 7168
    s_nop 0
    buffer_load_dwordx4 v5, s[44:47], s59 offen offset:1024 lds
    s_add_u32 m0, s60, 8064
    s_nop 0
    buffer_load_dwordx4 v5, s[44:47], s59 offen offset:1152 lds
    s_add_u32 s59, s59, 40960
    s_add_u32 s60, s60, 40960
    s_cmp_ge_u32 s60, 122880
    s_cselect_b32 s55, 122880, 0
    s_sub_u32 s60, s60, s55
    s_waitcnt vmcnt(10)
    s_barrier
    ds_read_b128 v[16:19], v6 offset:0
    ds_read_b128 v[20:23], v6 offset:20480
    ds_read_b128 v[24:27], v7 offset:0
    ds_read_b128 v[28:31], v7 offset:20480
    s_mov_b32 s62, 4026531840
    s_waitcnt lgkmcnt(2)
    .p2align 6
L_gate_loop:
    v_mfma_f32_16x16x32_bf16 v[48:51], a[0:3], v[16:19], 0
    ds_read_b128 v[32:35], v6 offset:1024
    s_add_u32 s61, s61, 40960
    s_cmp_ge_u32 s61, 122880
    s_cselect_b32 s94, 122880, 0
    v_mfma_f32_16x16x32_bf16 v[52:55], a[0:3], v[20:23], 0
    ds_read_b128 v[36:39], v6 offset:21504
    s_waitcnt lgkmcnt(2)
    s_sub_u32 s61, s61, s94
    s_sub_u32 s94, 40960, s94
    v_mfma_f32_16x16x32_bf16 v[48:51], a[4:7], v[24:27], v[48:51]
    ds_read_b128 v[40:43], v7 offset:1024
    s_add_u32 m0, s60, 0
    v_mfma_f32_16x16x32_bf16 v[52:55], a[4:7], v[28:31], v[52:55]
    ds_read_b128 v[44:47], v7 offset:21504
    s_waitcnt lgkmcnt(2)
    buffer_load_dwordx4 v5, s[44:47], s59 offen offset:0 lds
    v_mfma_f32_16x16x32_bf16 v[48:51], a[8:11], v[32:35], v[48:51]
    ds_read_b128 v[16:19], v6 offset:2048
    s_add_u32 m0, s60, 896
    v_mfma_f32_16x16x32_bf16 v[52:55], a[8:11], v[36:39], v[52:55]
    ds_read_b128 v[20:23], v6 offset:22528
    s_waitcnt lgkmcnt(2)
    buffer_load_dwordx4 v5, s[44:47], s59 offen offset:128 lds
    v_mfma_f32_16x16x32_bf16 v[48:51], a[12:15], v[40:43], v[48:51]
    ds_read_b128 v[24:27], v7 offset:2048
    v_mfma_f32_16x16x32_bf16 v[52:55], a[12:15], v[44:47], v[52:55]
    ds_read_b128 v[28:31], v7 offset:22528
    s_waitcnt lgkmcnt(2)
    s_add_u32 m0, s60, 1792
    v_mul_f32 v96, s88, v72
    v_mfma_f32_16x16x32_bf16 v[48:51], a[16:19], v[16:19], v[48:51]
    ds_read_b128 v[32:35], v6 offset:3072
    buffer_load_dwordx4 v5, s[44:47], s59 offen offset:256 lds
    v_mfma_f32_16x16x32_bf16 v[52:55], a[16:19], v[20:23], v[52:55]
    ds_read_b128 v[36:39], v6 offset:23552
    s_waitcnt lgkmcnt(2)
    s_add_u32 m0, s60, 2688
    v_mfma_f32_16x16x32_bf16 v[48:51], a[20:23], v[24:27], v[48:51]
    ds_read_b128 v[40:43], v7 offset:3072
    v_exp_f32 v96, -v96
    v_mfma_f32_16x16x32_bf16 v[52:55], a[20:23], v[28:31], v[52:55]
    ds_read_b128 v[44:47], v7 offset:23552
    s_waitcnt lgkmcnt(2)
    buffer_load_dwordx4 v5, s[44:47], s59 offen offset:384 lds
    v_add_f32 v96, 1.0, v96
    v_mfma_f32_16x16x32_bf16 v[48:51], a[24:27], v[32:35], v[48:51]
    ds_read_b128 v[16:19], v6 offset:4096
    s_add_u32 m0, s60, 3584
    v_mfma_f32_16x16x32_bf16 v[52:55], a[24:27], v[36:39], v[52:55]
    ds_read_b128 v[20:23], v6 offset:24576
    s_waitcnt lgkmcnt(2)
    buffer_load_dwordx4 v5, s[44:47], s59 offen offset:512 lds
    v_mfma_f32_16x16x32_bf16 v[48:51], a[28:31], v[40:43], v[48:51]
    ds_read_b128 v[24:27], v7 offset:4096
    v_rcp_f32 v96, v96
    v_mfma_f32_16x16x32_bf16 v[52:55], a[28:31], v[44:47], v[52:55]
    ds_read_b128 v[28:31], v7 offset:24576
    s_waitcnt lgkmcnt(2)
    s_add_u32 m0, s60, 4480
    buffer_store_dword v96, v9, s[36:39], s62 offen offset:0
    v_mfma_f32_16x16x32_bf16 v[48:51], a[32:35], v[16:19], v[48:51]
    ds_read_b128 v[32:35], v6 offset:5120
    buffer_load_dwordx4 v5, s[44:47], s59 offen offset:640 lds
    v_mul_f32 v97, s88, v76
    v_mfma_f32_16x16x32_bf16 v[52:55], a[32:35], v[20:23], v[52:55]
    ds_read_b128 v[36:39], v6 offset:25600
    s_waitcnt lgkmcnt(2)
    s_add_u32 m0, s60, 5376
    v_mfma_f32_16x16x32_bf16 v[48:51], a[36:39], v[24:27], v[48:51]
    ds_read_b128 v[40:43], v7 offset:5120
    v_exp_f32 v97, -v97
    v_mfma_f32_16x16x32_bf16 v[52:55], a[36:39], v[28:31], v[52:55]
    ds_read_b128 v[44:47], v7 offset:25600
    s_waitcnt lgkmcnt(2)
    buffer_load_dwordx4 v5, s[44:47], s59 offen offset:768 lds
    v_add_f32 v97, 1.0, v97
    v_mfma_f32_16x16x32_bf16 v[48:51], a[40:43], v[32:35], v[48:51]
    ds_read_b128 v[16:19], v6 offset:6144
    s_add_u32 m0, s60, 6272
    v_mfma_f32_16x16x32_bf16 v[52:55], a[40:43], v[36:39], v[52:55]
    ds_read_b128 v[20:23], v6 offset:26624
    s_waitcnt lgkmcnt(2)
    buffer_load_dwordx4 v5, s[44:47], s59 offen offset:896 lds
    v_mfma_f32_16x16x32_bf16 v[48:51], a[44:47], v[40:43], v[48:51]
    ds_read_b128 v[24:27], v7 offset:6144
    v_rcp_f32 v97, v97
    v_mfma_f32_16x16x32_bf16 v[52:55], a[44:47], v[44:47], v[52:55]
    ds_read_b128 v[28:31], v7 offset:26624
    s_waitcnt lgkmcnt(2)
    s_add_u32 m0, s60, 7168
    buffer_store_dword v97, v9, s[36:39], s62 offen offset:64
    v_mfma_f32_16x16x32_bf16 v[48:51], a[48:51], v[16:19], v[48:51]
    ds_read_b128 v[32:35], v6 offset:7168
    buffer_load_dwordx4 v5, s[44:47], s59 offen offset:1024 lds
    s_add_u32 s63, s63, 128
    v_mfma_f32_16x16x32_bf16 v[52:55], a[48:51], v[20:23], v[52:55]
    ds_read_b128 v[36:39], v6 offset:27648
    s_waitcnt lgkmcnt(2)
    s_add_u32 m0, s60, 8064
    v_mfma_f32_16x16x32_bf16 v[48:51], a[52:55], v[24:27], v[48:51]
    ds_read_b128 v[40:43], v7 offset:7168
    v_mfma_f32_16x16x32_bf16 v[52:55], a[52:55], v[28:31], v[52:55]
    ds_read_b128 v[44:47], v7 offset:27648
    s_waitcnt lgkmcnt(2)
    buffer_load_dwordx4 v5, s[44:47], s59 offen offset:1152 lds
    v_mfma_f32_16x16x32_bf16 v[48:51], a[56:59], v[32:35], v[48:51]
    ds_read_b128 v[16:19], v6 offset:8192
    s_add_u32 s59, s59, 40960
    v_mfma_f32_16x16x32_bf16 v[52:55], a[56:59], v[36:39], v[52:55]
    ds_read_b128 v[20:23], v6 offset:28672
    s_waitcnt lgkmcnt(2)
    s_add_u32 s60, s60, 40960
    v_mfma_f32_16x16x32_bf16 v[48:51], a[60:63], v[40:43], v[48:51]
    ds_read_b128 v[24:27], v7 offset:8192
    v_mfma_f32_16x16x32_bf16 v[52:55], a[60:63], v[44:47], v[52:55]
    ds_read_b128 v[28:31], v7 offset:28672
    s_waitcnt lgkmcnt(2)
    s_cmp_ge_u32 s60, 122880
    s_cselect_b32 s55, 122880, 0
    v_mfma_f32_16x16x32_bf16 v[48:51], a[64:67], v[16:19], v[48:51]
    ds_read_b128 v[32:35], v6 offset:9216
    s_sub_u32 s60, s60, s55
    v_mfma_f32_16x16x32_bf16 v[52:55], a[64:67], v[20:23], v[52:55]
    ds_read_b128 v[36:39], v6 offset:29696
    s_waitcnt lgkmcnt(2)
    v_mfma_f32_16x16x32_bf16 v[48:51], a[68:71], v[24:27], v[48:51]
    ds_read_b128 v[40:43], v7 offset:9216
    v_add_u32 v6, s94, v6
    v_mfma_f32_16x16x32_bf16 v[52:55], a[68:71], v[28:31], v[52:55]
    ds_read_b128 v[44:47], v7 offset:29696
    v_add_u32 v7, s94, v7
    s_waitcnt vmcnt(12) lgkmcnt(0)
    s_barrier
    v_mfma_f32_16x16x32_bf16 v[48:51], a[72:75], v[32:35], v[48:51]
    ds_read_b128 v[16:19], v6 offset:0
    v_mfma_f32_16x16x32_bf16 v[52:55], a[72:75], v[36:39], v[52:55]
    ds_read_b128 v[20:23], v6 offset:20480
    v_mfma_f32_16x16x32_bf16 v[48:51], a[76:79], v[40:43], v[48:51]
    ds_read_b128 v[24:27], v7 offset:0
    v_mfma_f32_16x16x32_bf16 v[52:55], a[76:79], v[44:47], v[52:55]
    ds_read_b128 v[28:31], v7 offset:20480
    s_waitcnt lgkmcnt(2)
    s_mov_b32 s62, s63
    s_add_u32 s6, s6, 1
    v_mfma_f32_16x16x32_bf16 v[72:75], a[0:3], v[16:19], 0
    ds_read_b128 v[32:35], v6 offset:1024
    s_add_u32 s61, s61, 40960
    s_cmp_ge_u32 s61, 122880
    s_cselect_b32 s94, 122880, 0
    v_mfma_f32_16x16x32_bf16 v[76:79], a[0:3], v[20:23], 0
    ds_read_b128 v[36:39], v6 offset:21504
    s_waitcnt lgkmcnt(2)
    s_sub_u32 s61, s61, s94
    s_sub_u32 s94, 40960, s94
    v_mfma_f32_16x16x32_bf16 v[72:75], a[4:7], v[24:27], v[72:75]
    ds_read_b128 v[40:43], v7 offset:1024
    s_add_u32 m0, s60, 0
    v_mfma_f32_16x16x32_bf16 v[76:79], a[4:7], v[28:31], v[76:79]
    ds_read_b128 v[44:47], v7 offset:21504
    s_waitcnt lgkmcnt(2)
    buffer_load_dwordx4 v5, s[44:47], s59 offen offset:0 lds
    v_mfma_f32_16x16x32_bf16 v[72:75], a[8:11], v[32:35], v[72:75]
    ds_read_b128 v[16:19], v6 offset:2048
    s_add_u32 m0, s60, 896
    v_mfma_f32_16x16x32_bf16 v[76:79], a[8:11], v[36:39], v[76:79]
    ds_read_b128 v[20:23], v6 offset:22528
    s_waitcnt lgkmcnt(2)
    buffer_load_dwordx4 v5, s[44:47], s59 offen offset:128 lds
    v_mfma_f32_16x16x32_bf16 v[72:75], a[12:15], v[40:43], v[72:75]
    ds_read_b128 v[24:27], v7 offset:2048
    v_mfma_f32_16x16x32_bf16 v[76:79], a[12:15], v[44:47], v[76:79]
    ds_read_b128 v[28:31], v7 offset:22528
    s_waitcnt lgkmcnt(2)
    s_add_u32 m0, s60, 1792
    v_mul_f32 v96, s88, v48
    v_mfma_f32_16x16x32_bf16 v[72:75], a[16:19], v[16:19], v[72:75]
    ds_read_b128 v[32:35], v6 offset:3072
    buffer_load_dwordx4 v5, s[44:47], s59 offen offset:256 lds
    v_mfma_f32_16x16x32_bf16 v[76:79], a[16:19], v[20:23], v[76:79]
    ds_read_b128 v[36:39], v6 offset:23552
    s_waitcnt lgkmcnt(2)
    s_add_u32 m0, s60, 2688
    v_mfma_f32_16x16x32_bf16 v[72:75], a[20:23], v[24:27], v[72:75]
    ds_read_b128 v[40:43], v7 offset:3072
    v_exp_f32 v96, -v96
    v_mfma_f32_16x16x32_bf16 v[76:79], a[20:23], v[28:31], v[76:79]
    ds_read_b128 v[44:47], v7 offset:23552
    s_waitcnt lgkmcnt(2)
    buffer_load_dwordx4 v5, s[44:47], s59 offen offset:384 lds
    v_add_f32 v96, 1.0, v96
    v_mfma_f32_16x16x32_bf16 v[72:75], a[24:27], v[32:35], v[72:75]
    ds_read_b128 v[16:19], v6 offset:4096
    s_add_u32 m0, s60, 3584
    v_mfma_f32_16x16x32_bf16 v[76:79], a[24:27], v[36:39], v[76:79]
    ds_read_b128 v[20:23], v6 offset:24576
    s_waitcnt lgkmcnt(2)
    buffer_load_dwordx4 v5, s[44:47], s59 offen offset:512 lds
    v_mfma_f32_16x16x32_bf16 v[72:75], a[28:31], v[40:43], v[72:75]
    ds_read_b128 v[24:27], v7 offset:4096
    v_rcp_f32 v96, v96
    v_mfma_f32_16x16x32_bf16 v[76:79], a[28:31], v[44:47], v[76:79]
    ds_read_b128 v[28:31], v7 offset:24576
    s_waitcnt lgkmcnt(2)
    s_add_u32 m0, s60, 4480
    buffer_store_dword v96, v9, s[36:39], s62 offen offset:0
    v_mfma_f32_16x16x32_bf16 v[72:75], a[32:35], v[16:19], v[72:75]
    ds_read_b128 v[32:35], v6 offset:5120
    buffer_load_dwordx4 v5, s[44:47], s59 offen offset:640 lds
    v_mul_f32 v97, s88, v52
    v_mfma_f32_16x16x32_bf16 v[76:79], a[32:35], v[20:23], v[76:79]
    ds_read_b128 v[36:39], v6 offset:25600
    s_waitcnt lgkmcnt(2)
    s_add_u32 m0, s60, 5376
    v_mfma_f32_16x16x32_bf16 v[72:75], a[36:39], v[24:27], v[72:75]
    ds_read_b128 v[40:43], v7 offset:5120
    v_exp_f32 v97, -v97
    v_mfma_f32_16x16x32_bf16 v[76:79], a[36:39], v[28:31], v[76:79]
    ds_read_b128 v[44:47], v7 offset:25600
    s_waitcnt lgkmcnt(2)
    buffer_load_dwordx4 v5, s[44:47], s59 offen offset:768 lds
    v_add_f32 v97, 1.0, v97
    v_mfma_f32_16x16x32_bf16 v[72:75], a[40:43], v[32:35], v[72:75]
    ds_read_b128 v[16:19], v6 offset:6144
    s_add_u32 m0, s60, 6272
    v_mfma_f32_16x16x32_bf16 v[76:79], a[40:43], v[36:39], v[76:79]
    ds_read_b128 v[20:23], v6 offset:26624
    s_waitcnt lgkmcnt(2)
    buffer_load_dwordx4 v5, s[44:47], s59 offen offset:896 lds
    v_mfma_f32_16x16x32_bf16 v[72:75], a[44:47], v[40:43], v[72:75]
    ds_read_b128 v[24:27], v7 offset:6144
    v_rcp_f32 v97, v97
    v_mfma_f32_16x16x32_bf16 v[76:79], a[44:47], v[44:47], v[76:79]
    ds_read_b128 v[28:31], v7 offset:26624
    s_waitcnt lgkmcnt(2)
    s_add_u32 m0, s60, 7168
    buffer_store_dword v97, v9, s[36:39], s62 offen offset:64
    v_mfma_f32_16x16x32_bf16 v[72:75], a[48:51], v[16:19], v[72:75]
    ds_read_b128 v[32:35], v6 offset:7168
    buffer_load_dwordx4 v5, s[44:47], s59 offen offset:1024 lds
    s_add_u32 s63, s63, 128
    v_mfma_f32_16x16x32_bf16 v[76:79], a[48:51], v[20:23], v[76:79]
    ds_read_b128 v[36:39], v6 offset:27648
    s_waitcnt lgkmcnt(2)
    s_add_u32 m0, s60, 8064
    v_mfma_f32_16x16x32_bf16 v[72:75], a[52:55], v[24:27], v[72:75]
    ds_read_b128 v[40:43], v7 offset:7168
    v_mfma_f32_16x16x32_bf16 v[76:79], a[52:55], v[28:31], v[76:79]
    ds_read_b128 v[44:47], v7 offset:27648
    s_waitcnt lgkmcnt(2)
    buffer_load_dwordx4 v5, s[44:47], s59 offen offset:1152 lds
    v_mfma_f32_16x16x32_bf16 v[72:75], a[56:59], v[32:35], v[72:75]
    ds_read_b128 v[16:19], v6 offset:8192
    s_add_u32 s59, s59, 40960
    v_mfma_f32_16x16x32_bf16 v[76:79], a[56:59], v[36:39], v[76:79]
    ds_read_b128 v[20:23], v6 offset:28672
    s_waitcnt lgkmcnt(2)
    s_add_u32 s60, s60, 40960
    v_mfma_f32_16x16x32_bf16 v[72:75], a[60:63], v[40:43], v[72:75]
    ds_read_b128 v[24:27], v7 offset:8192
    v_mfma_f32_16x16x32_bf16 v[76:79], a[60:63], v[44:47], v[76:79]
    ds_read_b128 v[28:31], v7 offset:28672
    s_waitcnt lgkmcnt(2)
    s_cmp_ge_u32 s60, 122880
    s_cselect_b32 s55, 122880, 0
    v_mfma_f32_16x16x32_bf16 v[72:75], a[64:67], v[16:19], v[72:75]
    ds_read_b128 v[32:35], v6 offset:9216
    s_sub_u32 s60, s60, s55
    v_mfma_f32_16x16x32_bf16 v[76:79], a[64:67], v[20:23], v[76:79]
    ds_read_b128 v[36:39], v6 offset:29696
    s_waitcnt lgkmcnt(2)
    v_mfma_f32_16x16x32_bf16 v[72:75], a[68:71], v[24:27], v[72:75]
    ds_read_b128 v[40:43], v7 offset:9216
    v_add_u32 v6, s94, v6
    v_mfma_f32_16x16x32_bf16 v[76:79], a[68:71], v[28:31], v[76:79]
    ds_read_b128 v[44:47], v7 offset:29696
    v_add_u32 v7, s94, v7
    s_waitcnt vmcnt(12) lgkmcnt(0)
    s_barrier
    v_mfma_f32_16x16x32_bf16 v[72:75], a[72:75], v[32:35], v[72:75]
    ds_read_b128 v[16:19], v6 offset:0
    v_mfma_f32_16x16x32_bf16 v[76:79], a[72:75], v[36:39], v[76:79]
    ds_read_b128 v[20:23], v6 offset:20480
    v_mfma_f32_16x16x32_bf16 v[72:75], a[76:79], v[40:43], v[72:75]
    ds_read_b128 v[24:27], v7 offset:0
    v_mfma_f32_16x16x32_bf16 v[76:79], a[76:79], v[44:47], v[76:79]
    ds_read_b128 v[28:31], v7 offset:20480
    s_waitcnt lgkmcnt(2)
    s_mov_b32 s62, s63
    s_add_u32 s6, s6, 1
    s_cmp_lt_u32 s6, s64
    s_cbranch_scc1 L_gate_loop
    s_nop 7
    v_mul_f32 v96, s88, v72
    v_exp_f32 v96, -v96
    s_nop 0
    v_add_f32 v96, 1.0, v96
    v_rcp_f32 v96, v96
    s_nop 0
    buffer_store_dword v96, v9, s[36:39], s62 offen offset:0
    v_mul_f32 v97, s88, v76
    v_exp_f32 v97, -v97
    s_nop 0
    v_add_f32 v97, 1.0, v97
    v_rcp_f32 v97, v97
    s_nop 0
    buffer_store_dword v97, v9, s[36:39], s62 offen offset:64
    s_add_u32 s63, s63, 128
    s_waitcnt vmcnt(0) lgkmcnt(0)
    s_barrier
L_alpha_done:
    s_cmp_lg_u32 s3, 0
    s_cbranch_scc1 L_sf_28
    v_mov_b32 v10, 65
    s_mov_b64 exec, 1
    buffer_store_dword v10, v8, s[36:39], s65 offen offset:0 sc1
    s_mov_b64 exec, -1
L_sf_28:
    s_bitcmp0_b32 s5, 0
    s_cbranch_scc1 L_k2q
L_beta:
    v_and_b32 v9, 31, v2
    v_lshlrev_b32 v9, 9, v9
    v_add_u32 v9, 1458176, v9
    v_mov_b32 v11, 4
    s_branch L_wi_29_go
L_wi_29:
    s_sleep 4
    s_add_u32 s7, s7, 1
    s_cmp_gt_u32 s7, 400000
    s_cbranch_scc1 L_exit
L_wi_29_go:
    buffer_load_dword v10, v11, s[48:51], 0 offen sc1
    s_waitcnt vmcnt(0)
    v_cmp_gt_u32 vcc, 128, v10
    s_cbranch_vccnz L_wi_29
    v_and_b32 v12, 7, v2
    v_lshlrev_b32 v12, 9, v12
    v_bfe_u32 v13, v2, 3, 1
    v_lshl_add_u32 v12, v13, 7, v12
    s_lshl_b32 s57, s4, 12
    s_add_u32 s57, s57, 1441792
    s_branch L_wf_30_go
L_wf_30:
    s_sleep 2
    s_add_u32 s7, s7, 1
    s_cmp_gt_u32 s7, 400000
    s_cbranch_scc1 L_exit
L_wf_30_go:
    buffer_load_dword v10, v12, s[36:39], s57 offen offset:0 sc1
    s_waitcnt vmcnt(0)
    v_cmp_gt_u32 vcc, 65, v10
    s_cbranch_vccnz L_wf_30
    s_lshr_b32 s78, s52, 2
    s_and_b32 s79, s52, 3
    s_lshl_b32 s55, s79, 2
    s_add_u32 s55, s55, s3
    s_lshl_b32 s55, s55, 2
    s_lshl_b32 s71, s55, 7
    s_lshl_b32 s56, s4, 13
    s_add_u32 s71, s71, s56
    s_add_u32 s71, s71, 23199744
    s_mul_i32 s77, s55, 40960
    s_mul_i32 s57, s78, 5120
    s_add_u32 s77, s77, s57
    v_add_u32 v11, 4096, v3
    v_mov_b32 v12, 0x3f803f80
    v_mov_b32 v13, 0x3f803f80
    v_mov_b32 v14, 0x3f803f80
    v_mov_b32 v15, 0x3f803f80
    s_add_u32 s55, s77, 15335424
    s_add_u32 s56, s77, 17956864
    buffer_load_dwordx4 v[96:99], v3, s[36:39], s55 offen offset:0 sc1
    buffer_load_dwordx4 v[100:103], v3, s[36:39], s55 offen offset:1024 sc1
    buffer_load_dwordx4 v[104:107], v3, s[36:39], s55 offen offset:2048 sc1
    buffer_load_dwordx4 v[108:111], v3, s[36:39], s55 offen offset:3072 sc1
    buffer_load_dwordx4 v[112:115], v11, s[36:39], s55 offen offset:0 sc1
    buffer_load_dwordx4 v[116:119], v3, s[36:39], s56 offen offset:0 sc1
    buffer_load_dwordx4 v[120:123], v3, s[36:39], s56 offen offset:1024 sc1
    buffer_load_dwordx4 v[124:127], v3, s[36:39], s56 offen offset:2048 sc1
    buffer_load_dwordx4 v[128:131], v3, s[36:39], s56 offen offset:3072 sc1
    buffer_load_dwordx4 v[132:135], v11, s[36:39], s56 offen offset:0 sc1
    s_add_u32 s55, s77, 15376384
    s_add_u32 s56, s77, 17997824
    buffer_load_dwordx4 v[136:139], v3, s[36:39], s55 offen offset:0 sc1
    buffer_load_dwordx4 v[140:143], v3, s[36:39], s55 offen offset:1024 sc1
    buffer_load_dwordx4 v[144:147], v3, s[36:39], s55 offen offset:2048 sc1
    buffer_load_dwordx4 v[148:151], v3, s[36:39], s55 offen offset:3072 sc1
    buffer_load_dwordx4 v[152:155], v11, s[36:39], s55 offen offset:0 sc1
    buffer_load_dwordx4 v[156:159], v3, s[36:39], s56 offen offset:0 sc1
    buffer_load_dwordx4 v[160:163], v3, s[36:39], s56 offen offset:1024 sc1
    buffer_load_dwordx4 v[164:167], v3, s[36:39], s56 offen offset:2048 sc1
    buffer_load_dwordx4 v[168:171], v3, s[36:39], s56 offen offset:3072 sc1
    buffer_load_dwordx4 v[172:175], v11, s[36:39], s56 offen offset:0 sc1
    s_add_u32 s55, s77, 15417344
    s_add_u32 s56, s77, 18038784
    buffer_load_dwordx4 v[176:179], v3, s[36:39], s55 offen offset:0 sc1
    buffer_load_dwordx4 v[180:183], v3, s[36:39], s55 offen offset:1024 sc1
    buffer_load_dwordx4 v[184:187], v3, s[36:39], s55 offen offset:2048 sc1
    buffer_load_dwordx4 v[188:191], v3, s[36:39], s55 offen offset:3072 sc1
    buffer_load_dwordx4 v[192:195], v11, s[36:39], s55 offen offset:0 sc1
    buffer_load_dwordx4 v[196:199], v3, s[36:39], s56 offen offset:0 sc1
    buffer_load_dwordx4 v[200:203], v3, s[36:39], s56 offen offset:1024 sc1
    buffer_load_dwordx4 v[204:207], v3, s[36:39], s56 offen offset:2048 sc1
    buffer_load_dwordx4 v[208:211], v3, s[36:39], s56 offen offset:3072 sc1
    buffer_load_dwordx4 v[212:215], v11, s[36:39], s56 offen offset:0 sc1
    s_add_u32 s55, s77, 15458304
    s_add_u32 s56, s77, 18079744
    buffer_load_dwordx4 v[216:219], v3, s[36:39], s55 offen offset:0 sc1
    buffer_load_dwordx4 v[220:223], v3, s[36:39], s55 offen offset:1024 sc1
    buffer_load_dwordx4 v[224:227], v3, s[36:39], s55 offen offset:2048 sc1
    buffer_load_dwordx4 v[228:231], v3, s[36:39], s55 offen offset:3072 sc1
    buffer_load_dwordx4 v[232:235], v11, s[36:39], s55 offen offset:0 sc1
    buffer_load_dwordx4 v[236:239], v3, s[36:39], s56 offen offset:0 sc1
    buffer_load_dwordx4 v[240:243], v3, s[36:39], s56 offen offset:1024 sc1
    buffer_load_dwordx4 v[244:247], v3, s[36:39], s56 offen offset:2048 sc1
    buffer_load_dwordx4 v[248:251], v3, s[36:39], s56 offen offset:3072 sc1
    buffer_load_dwordx4 v[252:255], v11, s[36:39], s56 offen offset:0 sc1
    s_waitcnt vmcnt(30)
    v_mfma_f32_16x16x32_bf16 v[16:19], v[96:99], v[116:119], 0
    v_mfma_f32_16x16x32_bf16 v[20:23], v[96:99], v[120:123], 0
    v_mfma_f32_16x16x32_bf16 v[24:27], v[100:103], v[116:119], 0
    v_mfma_f32_16x16x32_bf16 v[28:31], v[100:103], v[120:123], 0
    v_mfma_f32_16x16x32_bf16 v[32:35], v[100:103], v[124:127], 0
    v_mfma_f32_16x16x32_bf16 v[36:39], v[104:107], v[120:123], 0
    v_mfma_f32_16x16x32_bf16 v[40:43], v[104:107], v[124:127], 0
    v_mfma_f32_16x16x32_bf16 v[44:47], v[104:107], v[128:131], 0
    v_mfma_f32_16x16x32_bf16 v[48:51], v[108:111], v[124:127], 0
    v_mfma_f32_16x16x32_bf16 v[52:55], v[108:111], v[128:131], 0
    v_mfma_f32_16x16x32_bf16 v[56:59], v[108:111], v[132:135], 0
    v_mfma_f32_16x16x32_bf16 v[60:63], v[112:115], v[128:131], 0
    v_mfma_f32_16x16x32_bf16 v[64:67], v[112:115], v[132:135], 0
    v_mfma_f32_16x16x32_bf16 v[68:71], v[96:99], v[12:15], 0
    v_mfma_f32_16x16x32_bf16 v[72:75], v[100:103], v[12:15], 0
    v_mfma_f32_16x16x32_bf16 v[76:79], v[104:107], v[12:15], 0
    v_mfma_f32_16x16x32_bf16 v[80:83], v[108:111], v[12:15], 0
    v_mfma_f32_16x16x32_bf16 v[84:87], v[112:115], v[12:15], 0
    s_waitcnt vmcnt(20)
    v_mfma_f32_16x16x32_bf16 v[16:19], v[136:139], v[156:159], v[16:19]
    v_mfma_f32_16x16x32_bf16 v[20:23], v[136:139], v[160:163], v[20:23]
    v_mfma_f32_16x16x32_bf16 v[24:27], v[140:143], v[156:159], v[24:27]
    v_mfma_f32_16x16x32_bf16 v[28:31], v[140:143], v[160:163], v[28:31]
    v_mfma_f32_16x16x32_bf16 v[32:35], v[140:143], v[164:167], v[32:35]
    v_mfma_f32_16x16x32_bf16 v[36:39], v[144:147], v[160:163], v[36:39]
    v_mfma_f32_16x16x32_bf16 v[40:43], v[144:147], v[164:167], v[40:43]
    v_mfma_f32_16x16x32_bf16 v[44:47], v[144:147], v[168:171], v[44:47]
    v_mfma_f32_16x16x32_bf16 v[48:51], v[148:151], v[164:167], v[48:51]
    v_mfma_f32_16x16x32_bf16 v[52:55], v[148:151], v[168:171], v[52:55]
    v_mfma_f32_16x16x32_bf16 v[56:59], v[148:151], v[172:175], v[56:59]
    v_mfma_f32_16x16x32_bf16 v[60:63], v[152:155], v[168:171], v[60:63]
    v_mfma_f32_16x16x32_bf16 v[64:67], v[152:155], v[172:175], v[64:67]
    v_mfma_f32_16x16x32_bf16 v[68:71], v[136:139], v[12:15], v[68:71]
    v_mfma_f32_16x16x32_bf16 v[72:75], v[140:143], v[12:15], v[72:75]
    v_mfma_f32_16x16x32_bf16 v[76:79], v[144:147], v[12:15], v[76:79]
    v_mfma_f32_16x16x32_bf16 v[80:83], v[148:151], v[12:15], v[80:83]
    v_mfma_f32_16x16x32_bf16 v[84:87], v[152:155], v[12:15], v[84:87]
    s_waitcnt vmcnt(10)
    v_mfma_f32_16x16x32_bf16 v[16:19], v[176:179], v[196:199], v[16:19]
    v_mfma_f32_16x16x32_bf16 v[20:23], v[176:179], v[200:203], v[20:23]
    v_mfma_f32_16x16x32_bf16 v[24:27], v[180:183], v[196:199], v[24:27]
    v_mfma_f32_16x16x32_bf16 v[28:31], v[180:183], v[200:203], v[28:31]
    v_mfma_f32_16x16x32_bf16 v[32:35], v[180:183], v[204:207], v[32:35]
    v_mfma_f32_16x16x32_bf16 v[36:39], v[184:187], v[200:203], v[36:39]
    v_mfma_f32_16x16x32_bf16 v[40:43], v[184:187], v[204:207], v[40:43]
    v_mfma_f32_16x16x32_bf16 v[44:47], v[184:187], v[208:211], v[44:47]
    v_mfma_f32_16x16x32_bf16 v[48:51], v[188:191], v[204:207], v[48:51]
    v_mfma_f32_16x16x32_bf16 v[52:55], v[188:191], v[208:211], v[52:55]
    v_mfma_f32_16x16x32_bf16 v[56:59], v[188:191], v[212:215], v[56:59]
    v_mfma_f32_16x16x32_bf16 v[60:63], v[192:195], v[208:211], v[60:63]
    v_mfma_f32_16x16x32_bf16 v[64:67], v[192:195], v[212:215], v[64:67]
    v_mfma_f32_16x16x32_bf16 v[68:71], v[176:179], v[12:15], v[68:71]
    v_mfma_f32_16x16x32_bf16 v[72:75], v[180:183], v[12:15], v[72:75]
    v_mfma_f32_16x16x32_bf16 v[76:79], v[184:187], v[12:15], v[76:79]
    v_mfma_f32_16x16x32_bf16 v[80:83], v[188:191], v[12:15], v[80:83]
    v_mfma_f32_16x16x32_bf16 v[84:87], v[192:195], v[12:15], v[84:87]
    s_waitcnt vmcnt(0)
    v_mfma_f32_16x16x32_bf16 v[16:19], v[216:219], v[236:239], v[16:19]
    v_mfma_f32_16x16x32_bf16 v[20:23], v[216:219], v[240:243], v[20:23]
    v_mfma_f32_16x16x32_bf16 v[24:27], v[220:223], v[236:239], v[24:27]
    v_mfma_f32_16x16x32_bf16 v[28:31], v[220:223], v[240:243], v[28:31]
    v_mfma_f32_16x16x32_bf16 v[32:35], v[220:223], v[244:247], v[32:35]
    v_mfma_f32_16x16x32_bf16 v[36:39], v[224:227], v[240:243], v[36:39]
    v_mfma_f32_16x16x32_bf16 v[40:43], v[224:227], v[244:247], v[40:43]
    v_mfma_f32_16x16x32_bf16 v[44:47], v[224:227], v[248:251], v[44:47]
    v_mfma_f32_16x16x32_bf16 v[48:51], v[228:231], v[244:247], v[48:51]
    v_mfma_f32_16x16x32_bf16 v[52:55], v[228:231], v[248:251], v[52:55]
    v_mfma_f32_16x16x32_bf16 v[56:59], v[228:231], v[252:255], v[56:59]
    v_mfma_f32_16x16x32_bf16 v[60:63], v[232:235], v[248:251], v[60:63]
    v_mfma_f32_16x16x32_bf16 v[64:67], v[232:235], v[252:255], v[64:67]
    v_mfma_f32_16x16x32_bf16 v[68:71], v[216:219], v[12:15], v[68:71]
    v_mfma_f32_16x16x32_bf16 v[72:75], v[220:223], v[12:15], v[72:75]
    v_mfma_f32_16x16x32_bf16 v[76:79], v[224:227], v[12:15], v[76:79]
    v_mfma_f32_16x16x32_bf16 v[80:83], v[228:231], v[12:15], v[80:83]
    v_mfma_f32_16x16x32_bf16 v[84:87], v[232:235], v[12:15], v[84:87]
    s_mul_i32 s55, s3, 20480
    v_add_u32 v88, s55, v3
    s_lshl_b32 s55, s3, 10
    v_add_u32 v89, s55, v3
    v_add_u32 v90, 40960, v89
    s_mul_i32 s69, s78, 81920
    s_add_u32 s69, s69, 23265280
    ds_write_b128 v88, v[16:19] offset:0
    ds_write_b128 v88, v[20:23] offset:1024
    ds_write_b128 v88, v[24:27] offset:2048
    ds_write_b128 v88, v[28:31] offset:3072
    ds_write_b128 v88, v[32:35] offset:4096
    ds_write_b128 v88, v[36:39] offset:5120
    ds_write_b128 v88, v[40:43] offset:6144
    ds_write_b128 v88, v[44:47] offset:7168
    s_waitcnt lgkmcnt(4)
    ds_write_b128 v88, v[48:51] offset:8192
    ds_write_b128 v88, v[52:55] offset:9216
    ds_write_b128 v88, v[56:59] offset:10240
    ds_write_b128 v88, v[60:63] offset:11264
    ds_write_b128 v88, v[64:67] offset:12288
    ds_write_b128 v88, v[68:71] offset:13312
    ds_write_b128 v88, v[72:75] offset:14336
    ds_write_b128 v88, v[76:79] offset:15360
    s_waitcnt lgkmcnt(4)
    ds_write_b128 v88, v[80:83] offset:16384
    ds_write_b128 v88, v[84:87] offset:17408
    s_waitcnt lgkmcnt(0)
    s_barrier
    ds_read_b128 v[176:179], v89 offset:0
    ds_read_b128 v[180:183], v89 offset:20480
    ds_read_b128 v[184:187], v90 offset:0
    ds_read_b128 v[188:191], v90 offset:20480
    ds_read_b128 v[192:195], v89 offset:4096
    ds_read_b128 v[196:199], v89 offset:24576
    ds_read_b128 v[200:203], v90 offset:4096
    ds_read_b128 v[204:207], v90 offset:24576
    ds_read_b128 v[208:211], v89 offset:8192
    ds_read_b128 v[212:215], v89 offset:28672
    ds_read_b128 v[216:219], v90 offset:8192
    ds_read_b128 v[220:223], v90 offset:28672
    s_waitcnt lgkmcnt(8)
    ds_read_b128 v[224:227], v89 offset:12288
    ds_read_b128 v[228:231], v89 offset:32768
    ds_read_b128 v[232:235], v90 offset:12288
    ds_read_b128 v[236:239], v90 offset:32768
    s_waitcnt lgkmcnt(8)
    ds_read_b128 v[240:243], v89 offset:16384
    ds_read_b128 v[244:247], v89 offset:36864
    ds_read_b128 v[248:251], v90 offset:16384
    ds_read_b128 v[252:255], v90 offset:36864
    s_waitcnt lgkmcnt(8)
    s_mul_i32 s55, s79, 20480
    s_add_u32 s55, s55, s69
    s_waitcnt lgkmcnt(0)
    v_pk_add_f32 v[176:177], v[176:177], v[180:181]
    v_pk_add_f32 v[178:179], v[178:179], v[182:183]
    v_pk_add_f32 v[184:185], v[184:185], v[188:189]
    v_pk_add_f32 v[186:187], v[186:187], v[190:191]
    v_pk_add_f32 v[176:177], v[176:177], v[184:185]
    v_pk_add_f32 v[178:179], v[178:179], v[186:187]
    buffer_store_dwordx4 v[176:179], v89, s[36:39], s55 offen offset:0
    s_add_u32 s55, s55, 4096
    v_pk_add_f32 v[192:193], v[192:193], v[196:197]
    v_pk_add_f32 v[194:195], v[194:195], v[198:199]
    v_pk_add_f32 v[200:201], v[200:201], v[204:205]
    v_pk_add_f32 v[202:203], v[202:203], v[206:207]
    v_pk_add_f32 v[192:193], v[192:193], v[200:201]
    v_pk_add_f32 v[194:195], v[194:195], v[202:203]
    buffer_store_dwordx4 v[192:195], v89, s[36:39], s55 offen offset:0
    s_add_u32 s55, s55, 4096
    v_pk_add_f32 v[208:209], v[208:209], v[212:213]
    v_pk_add_f32 v[210:211], v[210:211], v[214:215]
    v_pk_add_f32 v[216:217], v[216:217], v[220:221]
    v_pk_add_f32 v[218:219], v[218:219], v[222:223]
    v_pk_add_f32 v[208:209], v[208:209], v[216:217]
    v_pk_add_f32 v[210:211], v[210:211], v[218:219]
    buffer_store_dwordx4 v[208:211], v89, s[36:39], s55 offen offset:0
    s_add_u32 s55, s55, 4096
    v_pk_add_f32 v[224:225], v[224:225], v[228:229]
    v_pk_add_f32 v[226:227], v[226:227], v[230:231]
    v_pk_add_f32 v[232:233], v[232:233], v[236:237]
    v_pk_add_f32 v[234:235], v[234:235], v[238:239]
    v_pk_add_f32 v[224:225], v[224:225], v[232:233]
    v_pk_add_f32 v[226:227], v[226:227], v[234:235]
    buffer_store_dwordx4 v[224:227], v89, s[36:39], s55 offen offset:0
    s_add_u32 s55, s55, 4096
    v_pk_add_f32 v[240:241], v[240:241], v[244:245]
    v_pk_add_f32 v[242:243], v[242:243], v[246:247]
    v_pk_add_f32 v[248:249], v[248:249], v[252:253]
    v_pk_add_f32 v[250:251], v[250:251], v[254:255]
    v_pk_add_f32 v[240:241], v[240:241], v[248:249]
    v_pk_add_f32 v[242:243], v[242:243], v[250:251]
    buffer_store_dwordx4 v[240:243], v89, s[36:39], s55 offen offset:0
    s_add_u32 s55, s55, 4096
    s_waitcnt vmcnt(0)
    s_barrier
    s_cmp_lg_u32 s3, 0
    s_cbranch_scc1 L_sf_31
    v_mov_b32 v10, 66
    s_mov_b64 exec, 1
    buffer_store_dword v10, v8, s[36:39], s65 offen offset:0 sc1
    s_mov_b64 exec, -1
L_sf_31:
    v_and_b32 v12, 3, v2
    v_lshlrev_b32 v12, 9, v12
    s_lshl_b32 s57, s78, 11
    s_add_u32 s57, s57, 1458304
    s_branch L_wf_32_go
L_wf_32:
    s_sleep 1
    s_add_u32 s7, s7, 1
    s_cmp_gt_u32 s7, 400000
    s_cbranch_scc1 L_exit
L_wf_32_go:
    buffer_load_dword v10, v12, s[36:39], s57 offen offset:0 sc1
    s_waitcnt vmcnt(0)
    v_cmp_gt_u32 vcc, 66, v10
    s_cbranch_vccnz L_wf_32
    s_add_u32 s55, s69, 0
    buffer_load_dwordx4 v[176:179], v89, s[36:39], s55 offen offset:0 sc1
    s_add_u32 s55, s69, 4096
    buffer_load_dwordx4 v[192:195], v89, s[36:39], s55 offen offset:0 sc1
    s_add_u32 s55, s69, 8192
    buffer_load_dwordx4 v[208:211], v89, s[36:39], s55 offen offset:0 sc1
    s_add_u32 s55, s69, 12288
    buffer_load_dwordx4 v[224:227], v89, s[36:39], s55 offen offset:0 sc1
    s_add_u32 s55, s69, 16384
    buffer_load_dwordx4 v[240:243], v89, s[36:39], s55 offen offset:0 sc1
    s_add_u32 s55, s69, 20480
    buffer_load_dwordx4 v[180:183], v89, s[36:39], s55 offen offset:0 sc1
    s_add_u32 s55, s69, 24576
    buffer_load_dwordx4 v[196:199], v89, s[36:39], s55 offen offset:0 sc1
    s_add_u32 s55, s69, 28672
    buffer_load_dwordx4 v[212:215], v89, s[36:39], s55 offen offset:0 sc1
    s_add_u32 s55, s69, 32768
    buffer_load_dwordx4 v[228:231], v89, s[36:39], s55 offen offset:0 sc1
    s_add_u32 s55, s69, 36864
    buffer_load_dwordx4 v[244:247], v89, s[36:39], s55 offen offset:0 sc1
    s_add_u32 s55, s69, 40960
    buffer_load_dwordx4 v[184:187], v89, s[36:39], s55 offen offset:0 sc1
    s_add_u32 s55, s69, 45056
    buffer_load_dwordx4 v[200:203], v89, s[36:39], s55 offen offset:0 sc1
    s_add_u32 s55, s69, 49152
    buffer_load_dwordx4 v[216:219], v89, s[36:39], s55 offen offset:0 sc1
    s_add_u32 s55, s69, 53248
    buffer_load_dwordx4 v[232:235], v89, s[36:39], s55 offen offset:0 sc1
    s_add_u32 s55, s69, 57344
    buffer_load_dwordx4 v[248:251], v89, s[36:39], s55 offen offset:0 sc1
    s_add_u32 s55, s69, 61440
    buffer_load_dwordx4 v[188:191], v89, s[36:39], s55 offen offset:0 sc1
    s_add_u32 s55, s69, 65536
    buffer_load_dwordx4 v[204:207], v89, s[36:39], s55 offen offset:0 sc1
    s_add_u32 s55, s69, 69632
    buffer_load_dwordx4 v[220:223], v89, s[36:39], s55 offen offset:0 sc1
    s_add_u32 s55, s69, 73728
    buffer_load_dwordx4 v[236:239], v89, s[36:39], s55 offen offset:0 sc1
    s_add_u32 s55, s69, 77824
    buffer_load_dwordx4 v[252:255], v89, s[36:39], s55 offen offset:0 sc1
    v_lshlrev_b32 v10, 2, v0
    s_add_u32 s55, s77, 12713984
    buffer_load_dwordx4 v[96:99], v3, s[36:39], s55 offen offset:0 sc1
    buffer_load_dwordx4 v[100:103], v3, s[36:39], s55 offen offset:1024 sc1
    buffer_load_dwordx4 v[104:107], v3, s[36:39], s55 offen offset:2048 sc1
    buffer_load_dwordx4 v[108:111], v3, s[36:39], s55 offen offset:3072 sc1
    buffer_load_dwordx4 v[112:115], v11, s[36:39], s55 offen offset:0 sc1
    buffer_load_dword a0, v10, s[36:39], s71 offen offset:0 sc1
    buffer_load_dword a1, v10, s[36:39], s71 offen offset:64 sc1
    s_add_u32 s55, s77, 12754944
    buffer_load_dwordx4 v[116:119], v3, s[36:39], s55 offen offset:0 sc1
    buffer_load_dwordx4 v[120:123], v3, s[36:39], s55 offen offset:1024 sc1
    buffer_load_dwordx4 v[124:127], v3, s[36:39], s55 offen offset:2048 sc1
    buffer_load_dwordx4 v[128:131], v3, s[36:39], s55 offen offset:3072 sc1
    buffer_load_dwordx4 v[132:135], v11, s[36:39], s55 offen offset:0 sc1
    buffer_load_dword a2, v10, s[36:39], s71 offen offset:128 sc1
    buffer_load_dword a3, v10, s[36:39], s71 offen offset:192 sc1
    s_add_u32 s55, s77, 12795904
    buffer_load_dwordx4 v[136:139], v3, s[36:39], s55 offen offset:0 sc1
    buffer_load_dwordx4 v[140:143], v3, s[36:39], s55 offen offset:1024 sc1
    buffer_load_dwordx4 v[144:147], v3, s[36:39], s55 offen offset:2048 sc1
    buffer_load_dwordx4 v[148:151], v3, s[36:39], s55 offen offset:3072 sc1
    buffer_load_dwordx4 v[152:155], v11, s[36:39], s55 offen offset:0 sc1
    buffer_load_dword a4, v10, s[36:39], s71 offen offset:256 sc1
    buffer_load_dword a5, v10, s[36:39], s71 offen offset:320 sc1
    s_add_u32 s55, s77, 12836864
    buffer_load_dwordx4 v[156:159], v3, s[36:39], s55 offen offset:0 sc1
    buffer_load_dwordx4 v[160:163], v3, s[36:39], s55 offen offset:1024 sc1
    buffer_load_dwordx4 v[164:167], v3, s[36:39], s55 offen offset:2048 sc1
    buffer_load_dwordx4 v[168:171], v3, s[36:39], s55 offen offset:3072 sc1
    buffer_load_dwordx4 v[172:175], v11, s[36:39], s55 offen offset:0 sc1
    buffer_load_dword a6, v10, s[36:39], s71 offen offset:384 sc1
    buffer_load_dword a7, v10, s[36:39], s71 offen offset:448 sc1
    v_lshrrev_b32 v88, 1, v89
    v_lshrrev_b32 v90, 1, v3
    s_waitcnt vmcnt(28)
    v_pk_add_f32 v[176:177], v[176:177], v[180:181]
    v_pk_add_f32 v[178:179], v[178:179], v[182:183]
    v_pk_add_f32 v[184:185], v[184:185], v[188:189]
    v_pk_add_f32 v[186:187], v[186:187], v[190:191]
    v_pk_add_f32 v[176:177], v[176:177], v[184:185]
    v_pk_add_f32 v[178:179], v[178:179], v[186:187]
    v_cvt_pk_bf16_f32 v176, v176, v177
    v_cvt_pk_bf16_f32 v177, v178, v179
    ds_write_b64 v88, v[176:177] offset:0
    v_pk_add_f32 v[192:193], v[192:193], v[196:197]
    v_pk_add_f32 v[194:195], v[194:195], v[198:199]
    v_pk_add_f32 v[200:201], v[200:201], v[204:205]
    v_pk_add_f32 v[202:203], v[202:203], v[206:207]
    v_pk_add_f32 v[192:193], v[192:193], v[200:201]
    v_pk_add_f32 v[194:195], v[194:195], v[202:203]
    v_cvt_pk_bf16_f32 v192, v192, v193
    v_cvt_pk_bf16_f32 v193, v194, v195
    ds_write_b64 v88, v[192:193] offset:2048
    v_pk_add_f32 v[208:209], v[208:209], v[212:213]
    v_pk_add_f32 v[210:211], v[210:211], v[214:215]
    v_pk_add_f32 v[216:217], v[216:217], v[220:221]
    v_pk_add_f32 v[218:219], v[218:219], v[222:223]
    v_pk_add_f32 v[208:209], v[208:209], v[216:217]
    v_pk_add_f32 v[210:211], v[210:211], v[218:219]
    v_cvt_pk_bf16_f32 v208, v208, v209
    v_cvt_pk_bf16_f32 v209, v210, v211
    ds_write_b64 v88, v[208:209] offset:4096
    v_pk_add_f32 v[224:225], v[224:225], v[228:229]
    v_pk_add_f32 v[226:227], v[226:227], v[230:231]
    v_pk_add_f32 v[232:233], v[232:233], v[236:237]
    v_pk_add_f32 v[234:235], v[234:235], v[238:239]
    v_pk_add_f32 v[224:225], v[224:225], v[232:233]
    v_pk_add_f32 v[226:227], v[226:227], v[234:235]
    v_cvt_pk_bf16_f32 v224, v224, v225
    v_cvt_pk_bf16_f32 v225, v226, v227
    ds_write_b64 v88, v[224:225] offset:6144
    v_pk_add_f32 v[240:241], v[240:241], v[244:245]
    v_pk_add_f32 v[242:243], v[242:243], v[246:247]
    v_pk_add_f32 v[248:249], v[248:249], v[252:253]
    v_pk_add_f32 v[250:251], v[250:251], v[254:255]
    v_pk_add_f32 v[240:241], v[240:241], v[248:249]
    v_pk_add_f32 v[242:243], v[242:243], v[250:251]
    v_cvt_pk_bf16_f32 v240, v240, v241
    v_cvt_pk_bf16_f32 v241, v242, v243
    ds_write_b64 v88, v[240:241] offset:8192
    s_waitcnt lgkmcnt(0)
    s_barrier
    ds_read_b64 v[16:17], v90 offset:0
    ds_read_b64 v[18:19], v90 offset:512
    ds_read_b64 v[20:21], v90 offset:1024
    ds_read_b64 v[22:23], v90 offset:1536
    ds_read_b64 v[24:25], v90 offset:2048
    ds_read_b64 v[26:27], v90 offset:2560
    ds_read_b64 v[28:29], v90 offset:3072
    ds_read_b64 v[30:31], v90 offset:3584
    ds_read_b64 v[32:33], v90 offset:4096
    ds_read_b64 v[34:35], v90 offset:4608
    s_waitcnt lgkmcnt(4)
    ds_read_b64 v[36:37], v90 offset:5120
    ds_read_b64 v[38:39], v90 offset:5632
    ds_read_b64 v[40:41], v90 offset:6144
    ds_read_b64 v[42:43], v90 offset:6656
    ds_read_b64 v[44:45], v90 offset:7168
    ds_read_b64 v[46:47], v90 offset:7680
    ds_read_b64 v[48:49], v90 offset:8192
    ds_read_b64 v[50:51], v90 offset:8704
    v_lshlrev_b32 v184, 2, v1
    v_add_u32 v184, 0, v184
    v_mul_u32_u24 v184, 0xccd, v184
    v_lshrrev_b32 v184, 16, v184
    v_add_u32 v189, 0, v0
    v_mul_u32_u24 v189, 0xccd, v189
    v_lshrrev_b32 v189, 16, v189
    v_lshlrev_b32 v185, 2, v1
    v_add_u32 v185, 16, v185
    v_mul_u32_u24 v185, 0xccd, v185
    v_lshrrev_b32 v185, 16, v185
    v_add_u32 v190, 16, v0
    v_mul_u32_u24 v190, 0xccd, v190
    v_lshrrev_b32 v190, 16, v190
    v_lshlrev_b32 v186, 2, v1
    v_add_u32 v186, 32, v186
    v_mul_u32_u24 v186, 0xccd, v186
    v_lshrrev_b32 v186, 16, v186
    v_add_u32 v191, 32, v0
    v_mul_u32_u24 v191, 0xccd, v191
    v_lshrrev_b32 v191, 16, v191
    v_lshlrev_b32 v187, 2, v1
    v_add_u32 v187, 48, v187
    v_mul_u32_u24 v187, 0xccd, v187
    v_lshrrev_b32 v187, 16, v187
    v_add_u32 v192, 48, v0
    v_mul_u32_u24 v192, 0xccd, v192
    v_lshrrev_b32 v192, 16, v192
    v_lshlrev_b32 v188, 2, v1
    v_add_u32 v188, 64, v188
    v_mul_u32_u24 v188, 0xccd, v188
    v_lshrrev_b32 v188, 16, v188
    v_add_u32 v193, 64, v0
    v_mul_u32_u24 v193, 0xccd, v193
    v_lshrrev_b32 v193, 16, v193
    s_waitcnt lgkmcnt(0)
    v_cmp_eq_u32 vcc, v184, v189
    s_nop 1
    v_cndmask_b32 v200, 0, v16, vcc
    v_cndmask_b32 v201, 0, v17, vcc
    v_cndmask_b32 v226, 0, v42, vcc
    v_cndmask_b32 v227, 0, v43, vcc
    v_cmp_eq_u32 vcc, v184, v190
    s_nop 1
    v_cndmask_b32 v202, 0, v18, vcc
    v_cndmask_b32 v203, 0, v19, vcc
    v_cndmask_b32 v228, 0, v42, vcc
    v_cndmask_b32 v229, 0, v43, vcc
    v_cmp_eq_u32 vcc, v185, v189
    s_nop 1
    v_cndmask_b32 v204, 0, v20, vcc
    v_cndmask_b32 v205, 0, v21, vcc
    v_cndmask_b32 v230, 0, v44, vcc
    v_cndmask_b32 v231, 0, v45, vcc
    v_cmp_eq_u32 vcc, v185, v190
    s_nop 1
    v_cndmask_b32 v206, 0, v22, vcc
    v_cndmask_b32 v207, 0, v23, vcc
    v_cndmask_b32 v232, 0, v44, vcc
    v_cndmask_b32 v233, 0, v45, vcc
    v_cmp_eq_u32 vcc, v185, v191
    s_nop 1
    v_cndmask_b32 v208, 0, v24, vcc
    v_cndmask_b32 v209, 0, v25, vcc
    v_cndmask_b32 v234, 0, v44, vcc
    v_cndmask_b32 v235, 0, v45, vcc
    v_cmp_eq_u32 vcc, v186, v190
    s_nop 1
    v_cndmask_b32 v210, 0, v26, vcc
    v_cndmask_b32 v211, 0, v27, vcc
    v_cndmask_b32 v236, 0, v46, vcc
    v_cndmask_b32 v237, 0, v47, vcc
    v_cmp_eq_u32 vcc, v186, v191
    s_nop 1
    v_cndmask_b32 v212, 0, v28, vcc
    v_cndmask_b32 v213, 0, v29, vcc
    v_cndmask_b32 v238, 0, v46, vcc
    v_cndmask_b32 v239, 0, v47, vcc
    v_cmp_eq_u32 vcc, v186, v192
    s_nop 1
    v_cndmask_b32 v214, 0, v30, vcc
    v_cndmask_b32 v215, 0, v31, vcc
    v_cndmask_b32 v240, 0, v46, vcc
    v_cndmask_b32 v241, 0, v47, vcc
    v_cmp_eq_u32 vcc, v187, v191
    s_nop 1
    v_cndmask_b32 v216, 0, v32, vcc
    v_cndmask_b32 v217, 0, v33, vcc
    v_cndmask_b32 v242, 0, v48, vcc
    v_cndmask_b32 v243, 0, v49, vcc
    v_cmp_eq_u32 vcc, v187, v192
    s_nop 1
    v_cndmask_b32 v218, 0, v34, vcc
    v_cndmask_b32 v219, 0, v35, vcc
    v_cndmask_b32 v244, 0, v48, vcc
    v_cndmask_b32 v245, 0, v49, vcc
    v_cmp_eq_u32 vcc, v187, v193
    s_nop 1
    v_cndmask_b32 v220, 0, v36, vcc
    v_cndmask_b32 v221, 0, v37, vcc
    v_cndmask_b32 v246, 0, v48, vcc
    v_cndmask_b32 v247, 0, v49, vcc
    v_cmp_eq_u32 vcc, v188, v192
    s_nop 1
    v_cndmask_b32 v222, 0, v38, vcc
    v_cndmask_b32 v223, 0, v39, vcc
    v_cndmask_b32 v248, 0, v50, vcc
    v_cndmask_b32 v249, 0, v51, vcc
    v_cmp_eq_u32 vcc, v188, v193
    s_nop 1
    v_cndmask_b32 v224, 0, v40, vcc
    v_cndmask_b32 v225, 0, v41, vcc
    v_cndmask_b32 v250, 0, v50, vcc
    v_cndmask_b32 v251, 0, v51, vcc
    s_mov_b32 s58, 0x358637bd
    s_waitcnt vmcnt(0)
    v_mfma_f32_16x16x16_bf16 v[16:19], v[200:201], v[96:97], 0
    v_mfma_f32_16x16x16_bf16 v[16:19], v[204:205], v[100:101], v[16:19]
    v_mfma_f32_16x16x16_bf16 v[56:59], v[226:227], v[96:97], 0
    v_mfma_f32_16x16x16_bf16 v[56:59], v[230:231], v[100:101], v[56:59]
    v_mfma_f32_16x16x16_bf16 v[20:23], v[200:201], v[98:99], 0
    v_mfma_f32_16x16x16_bf16 v[20:23], v[204:205], v[102:103], v[20:23]
    v_mfma_f32_16x16x16_bf16 v[60:63], v[226:227], v[98:99], 0
    v_mfma_f32_16x16x16_bf16 v[60:63], v[230:231], v[102:103], v[60:63]
    v_mfma_f32_16x16x16_bf16 v[24:27], v[202:203], v[96:97], 0
    v_mfma_f32_16x16x16_bf16 v[24:27], v[206:207], v[100:101], v[24:27]
    v_mfma_f32_16x16x16_bf16 v[24:27], v[210:211], v[104:105], v[24:27]
    v_mfma_f32_16x16x16_bf16 v[64:67], v[228:229], v[96:97], 0
    v_mfma_f32_16x16x16_bf16 v[64:67], v[232:233], v[100:101], v[64:67]
    v_mfma_f32_16x16x16_bf16 v[64:67], v[236:237], v[104:105], v[64:67]
    v_mfma_f32_16x16x16_bf16 v[28:31], v[202:203], v[98:99], 0
    v_mfma_f32_16x16x16_bf16 v[28:31], v[206:207], v[102:103], v[28:31]
    v_mfma_f32_16x16x16_bf16 v[28:31], v[210:211], v[106:107], v[28:31]
    v_mfma_f32_16x16x16_bf16 v[68:71], v[228:229], v[98:99], 0
    v_mfma_f32_16x16x16_bf16 v[68:71], v[232:233], v[102:103], v[68:71]
    v_mfma_f32_16x16x16_bf16 v[68:71], v[236:237], v[106:107], v[68:71]
    v_mfma_f32_16x16x16_bf16 v[32:35], v[208:209], v[100:101], 0
    v_mfma_f32_16x16x16_bf16 v[32:35], v[212:213], v[104:105], v[32:35]
    v_mfma_f32_16x16x16_bf16 v[32:35], v[216:217], v[108:109], v[32:35]
    v_mfma_f32_16x16x16_bf16 v[72:75], v[234:235], v[100:101], 0
    v_mfma_f32_16x16x16_bf16 v[72:75], v[238:239], v[104:105], v[72:75]
    v_mfma_f32_16x16x16_bf16 v[72:75], v[242:243], v[108:109], v[72:75]
    v_mfma_f32_16x16x16_bf16 v[36:39], v[208:209], v[102:103], 0
    v_mfma_f32_16x16x16_bf16 v[36:39], v[212:213], v[106:107], v[36:39]
    v_mfma_f32_16x16x16_bf16 v[36:39], v[216:217], v[110:111], v[36:39]
    v_mfma_f32_16x16x16_bf16 v[76:79], v[234:235], v[102:103], 0
    v_mfma_f32_16x16x16_bf16 v[76:79], v[238:239], v[106:107], v[76:79]
    v_mfma_f32_16x16x16_bf16 v[76:79], v[242:243], v[110:111], v[76:79]
    v_mfma_f32_16x16x16_bf16 v[40:43], v[214:215], v[104:105], 0
    v_mfma_f32_16x16x16_bf16 v[40:43], v[218:219], v[108:109], v[40:43]
    v_mfma_f32_16x16x16_bf16 v[40:43], v[222:223], v[112:113], v[40:43]
    v_mfma_f32_16x16x16_bf16 v[80:83], v[240:241], v[104:105], 0
    v_mfma_f32_16x16x16_bf16 v[80:83], v[244:245], v[108:109], v[80:83]
    v_mfma_f32_16x16x16_bf16 v[80:83], v[248:249], v[112:113], v[80:83]
    v_mfma_f32_16x16x16_bf16 v[44:47], v[214:215], v[106:107], 0
    v_mfma_f32_16x16x16_bf16 v[44:47], v[218:219], v[110:111], v[44:47]
    v_mfma_f32_16x16x16_bf16 v[44:47], v[222:223], v[114:115], v[44:47]
    v_mfma_f32_16x16x16_bf16 v[84:87], v[240:241], v[106:107], 0
    v_mfma_f32_16x16x16_bf16 v[84:87], v[244:245], v[110:111], v[84:87]
    v_mfma_f32_16x16x16_bf16 v[84:87], v[248:249], v[114:115], v[84:87]
    v_mfma_f32_16x16x16_bf16 v[48:51], v[220:221], v[108:109], 0
    v_mfma_f32_16x16x16_bf16 v[48:51], v[224:225], v[112:113], v[48:51]
    v_mfma_f32_16x16x16_bf16 v[88:91], v[246:247], v[108:109], 0
    v_mfma_f32_16x16x16_bf16 v[88:91], v[250:251], v[112:113], v[88:91]
    v_mfma_f32_16x16x16_bf16 v[52:55], v[220:221], v[110:111], 0
    v_mfma_f32_16x16x16_bf16 v[52:55], v[224:225], v[114:115], v[52:55]
    v_mfma_f32_16x16x16_bf16 v[92:95], v[246:247], v[110:111], 0
    v_mfma_f32_16x16x16_bf16 v[92:95], v[250:251], v[114:115], v[92:95]
    s_add_u32 s55, s77, 20578304
    v_accvgpr_read_b32 v176, a0
    v_accvgpr_read_b32 v177, a1
    s_nop 4
    v_add_f32 v56, s58, v56
    v_add_f32 v60, s58, v60
    v_add_f32 v64, s58, v64
    v_add_f32 v68, s58, v68
    v_add_f32 v72, s58, v72
    v_add_f32 v76, s58, v76
    v_add_f32 v80, s58, v80
    v_add_f32 v84, s58, v84
    v_add_f32 v88, s58, v88
    v_add_f32 v92, s58, v92
    v_rcp_f32 v56, v56
    v_rcp_f32 v60, v60
    v_rcp_f32 v64, v64
    v_rcp_f32 v68, v68
    v_rcp_f32 v72, v72
    v_rcp_f32 v76, v76
    v_rcp_f32 v80, v80
    v_rcp_f32 v84, v84
    v_rcp_f32 v88, v88
    v_rcp_f32 v92, v92
    v_mul_f32 v56, v56, v176
    v_mul_f32 v60, v60, v177
    v_mul_f32 v64, v64, v176
    v_mul_f32 v68, v68, v177
    v_mul_f32 v72, v72, v176
    v_mul_f32 v76, v76, v177
    v_mul_f32 v80, v80, v176
    v_mul_f32 v84, v84, v177
    v_mul_f32 v88, v88, v176
    v_mul_f32 v92, v92, v177
    v_pk_mul_f32 v[16:17], v[16:17], v[56:57] op_sel_hi:[1,0]
    v_pk_mul_f32 v[18:19], v[18:19], v[56:57] op_sel_hi:[1,0]
    v_cvt_pk_bf16_f32 v184, v16, v17
    v_cvt_pk_bf16_f32 v185, v18, v19
    v_pk_mul_f32 v[20:21], v[20:21], v[60:61] op_sel_hi:[1,0]
    v_pk_mul_f32 v[22:23], v[22:23], v[60:61] op_sel_hi:[1,0]
    v_cvt_pk_bf16_f32 v186, v20, v21
    v_cvt_pk_bf16_f32 v187, v22, v23
    buffer_store_dwordx4 v[184:187], v3, s[36:39], s55 offen offset:0 sc1
    v_pk_mul_f32 v[24:25], v[24:25], v[64:65] op_sel_hi:[1,0]
    v_pk_mul_f32 v[26:27], v[26:27], v[64:65] op_sel_hi:[1,0]
    v_cvt_pk_bf16_f32 v188, v24, v25
    v_cvt_pk_bf16_f32 v189, v26, v27
    v_pk_mul_f32 v[28:29], v[28:29], v[68:69] op_sel_hi:[1,0]
    v_pk_mul_f32 v[30:31], v[30:31], v[68:69] op_sel_hi:[1,0]
    v_cvt_pk_bf16_f32 v190, v28, v29
    v_cvt_pk_bf16_f32 v191, v30, v31
    buffer_store_dwordx4 v[188:191], v3, s[36:39], s55 offen offset:1024 sc1
    v_pk_mul_f32 v[32:33], v[32:33], v[72:73] op_sel_hi:[1,0]
    v_pk_mul_f32 v[34:35], v[34:35], v[72:73] op_sel_hi:[1,0]
    v_cvt_pk_bf16_f32 v184, v32, v33
    v_cvt_pk_bf16_f32 v185, v34, v35
    v_pk_mul_f32 v[36:37], v[36:37], v[76:77] op_sel_hi:[1,0]
    v_pk_mul_f32 v[38:39], v[38:39], v[76:77] op_sel_hi:[1,0]
    v_cvt_pk_bf16_f32 v186, v36, v37
    v_cvt_pk_bf16_f32 v187, v38, v39
    buffer_store_dwordx4 v[184:187], v3, s[36:39], s55 offen offset:2048 sc1
    v_pk_mul_f32 v[40:41], v[40:41], v[80:81] op_sel_hi:[1,0]
    v_pk_mul_f32 v[42:43], v[42:43], v[80:81] op_sel_hi:[1,0]
    v_cvt_pk_bf16_f32 v188, v40, v41
    v_cvt_pk_bf16_f32 v189, v42, v43
    v_pk_mul_f32 v[44:45], v[44:45], v[84:85] op_sel_hi:[1,0]
    v_pk_mul_f32 v[46:47], v[46:47], v[84:85] op_sel_hi:[1,0]
    v_cvt_pk_bf16_f32 v190, v44, v45
    v_cvt_pk_bf16_f32 v191, v46, v47
    buffer_store_dwordx4 v[188:191], v3, s[36:39], s55 offen offset:3072 sc1
    v_pk_mul_f32 v[48:49], v[48:49], v[88:89] op_sel_hi:[1,0]
    v_pk_mul_f32 v[50:51], v[50:51], v[88:89] op_sel_hi:[1,0]
    v_cvt_pk_bf16_f32 v184, v48, v49
    v_cvt_pk_bf16_f32 v185, v50, v51
    v_pk_mul_f32 v[52:53], v[52:53], v[92:93] op_sel_hi:[1,0]
    v_pk_mul_f32 v[54:55], v[54:55], v[92:93] op_sel_hi:[1,0]
    v_cvt_pk_bf16_f32 v186, v52, v53
    v_cvt_pk_bf16_f32 v187, v54, v55
    buffer_store_dwordx4 v[184:187], v11, s[36:39], s55 offen offset:0 sc1
    v_mfma_f32_16x16x16_bf16 v[16:19], v[200:201], v[116:117], 0
    v_mfma_f32_16x16x16_bf16 v[16:19], v[204:205], v[120:121], v[16:19]
    v_mfma_f32_16x16x16_bf16 v[56:59], v[226:227], v[116:117], 0
    v_mfma_f32_16x16x16_bf16 v[56:59], v[230:231], v[120:121], v[56:59]
    v_mfma_f32_16x16x16_bf16 v[20:23], v[200:201], v[118:119], 0
    v_mfma_f32_16x16x16_bf16 v[20:23], v[204:205], v[122:123], v[20:23]
    v_mfma_f32_16x16x16_bf16 v[60:63], v[226:227], v[118:119], 0
    v_mfma_f32_16x16x16_bf16 v[60:63], v[230:231], v[122:123], v[60:63]
    v_mfma_f32_16x16x16_bf16 v[24:27], v[202:203], v[116:117], 0
    v_mfma_f32_16x16x16_bf16 v[24:27], v[206:207], v[120:121], v[24:27]
    v_mfma_f32_16x16x16_bf16 v[24:27], v[210:211], v[124:125], v[24:27]
    v_mfma_f32_16x16x16_bf16 v[64:67], v[228:229], v[116:117], 0
    v_mfma_f32_16x16x16_bf16 v[64:67], v[232:233], v[120:121], v[64:67]
    v_mfma_f32_16x16x16_bf16 v[64:67], v[236:237], v[124:125], v[64:67]
    v_mfma_f32_16x16x16_bf16 v[28:31], v[202:203], v[118:119], 0
    v_mfma_f32_16x16x16_bf16 v[28:31], v[206:207], v[122:123], v[28:31]
    v_mfma_f32_16x16x16_bf16 v[28:31], v[210:211], v[126:127], v[28:31]
    v_mfma_f32_16x16x16_bf16 v[68:71], v[228:229], v[118:119], 0
    v_mfma_f32_16x16x16_bf16 v[68:71], v[232:233], v[122:123], v[68:71]
    v_mfma_f32_16x16x16_bf16 v[68:71], v[236:237], v[126:127], v[68:71]
    v_mfma_f32_16x16x16_bf16 v[32:35], v[208:209], v[120:121], 0
    v_mfma_f32_16x16x16_bf16 v[32:35], v[212:213], v[124:125], v[32:35]
    v_mfma_f32_16x16x16_bf16 v[32:35], v[216:217], v[128:129], v[32:35]
    v_mfma_f32_16x16x16_bf16 v[72:75], v[234:235], v[120:121], 0
    v_mfma_f32_16x16x16_bf16 v[72:75], v[238:239], v[124:125], v[72:75]
    v_mfma_f32_16x16x16_bf16 v[72:75], v[242:243], v[128:129], v[72:75]
    v_mfma_f32_16x16x16_bf16 v[36:39], v[208:209], v[122:123], 0
    v_mfma_f32_16x16x16_bf16 v[36:39], v[212:213], v[126:127], v[36:39]
    v_mfma_f32_16x16x16_bf16 v[36:39], v[216:217], v[130:131], v[36:39]
    v_mfma_f32_16x16x16_bf16 v[76:79], v[234:235], v[122:123], 0
    v_mfma_f32_16x16x16_bf16 v[76:79], v[238:239], v[126:127], v[76:79]
    v_mfma_f32_16x16x16_bf16 v[76:79], v[242:243], v[130:131], v[76:79]
    v_mfma_f32_16x16x16_bf16 v[40:43], v[214:215], v[124:125], 0
    v_mfma_f32_16x16x16_bf16 v[40:43], v[218:219], v[128:129], v[40:43]
    v_mfma_f32_16x16x16_bf16 v[40:43], v[222:223], v[132:133], v[40:43]
    v_mfma_f32_16x16x16_bf16 v[80:83], v[240:241], v[124:125], 0
    v_mfma_f32_16x16x16_bf16 v[80:83], v[244:245], v[128:129], v[80:83]
    v_mfma_f32_16x16x16_bf16 v[80:83], v[248:249], v[132:133], v[80:83]
    v_mfma_f32_16x16x16_bf16 v[44:47], v[214:215], v[126:127], 0
    v_mfma_f32_16x16x16_bf16 v[44:47], v[218:219], v[130:131], v[44:47]
    v_mfma_f32_16x16x16_bf16 v[44:47], v[222:223], v[134:135], v[44:47]
    v_mfma_f32_16x16x16_bf16 v[84:87], v[240:241], v[126:127], 0
    v_mfma_f32_16x16x16_bf16 v[84:87], v[244:245], v[130:131], v[84:87]
    v_mfma_f32_16x16x16_bf16 v[84:87], v[248:249], v[134:135], v[84:87]
    v_mfma_f32_16x16x16_bf16 v[48:51], v[220:221], v[128:129], 0
    v_mfma_f32_16x16x16_bf16 v[48:51], v[224:225], v[132:133], v[48:51]
    v_mfma_f32_16x16x16_bf16 v[88:91], v[246:247], v[128:129], 0
    v_mfma_f32_16x16x16_bf16 v[88:91], v[250:251], v[132:133], v[88:91]
    v_mfma_f32_16x16x16_bf16 v[52:55], v[220:221], v[130:131], 0
    v_mfma_f32_16x16x16_bf16 v[52:55], v[224:225], v[134:135], v[52:55]
    v_mfma_f32_16x16x16_bf16 v[92:95], v[246:247], v[130:131], 0
    v_mfma_f32_16x16x16_bf16 v[92:95], v[250:251], v[134:135], v[92:95]
    s_add_u32 s55, s77, 20619264
    v_accvgpr_read_b32 v176, a2
    v_accvgpr_read_b32 v177, a3
    s_nop 4
    v_add_f32 v56, s58, v56
    v_add_f32 v60, s58, v60
    v_add_f32 v64, s58, v64
    v_add_f32 v68, s58, v68
    v_add_f32 v72, s58, v72
    v_add_f32 v76, s58, v76
    v_add_f32 v80, s58, v80
    v_add_f32 v84, s58, v84
    v_add_f32 v88, s58, v88
    v_add_f32 v92, s58, v92
    v_rcp_f32 v56, v56
    v_rcp_f32 v60, v60
    v_rcp_f32 v64, v64
    v_rcp_f32 v68, v68
    v_rcp_f32 v72, v72
    v_rcp_f32 v76, v76
    v_rcp_f32 v80, v80
    v_rcp_f32 v84, v84
    v_rcp_f32 v88, v88
    v_rcp_f32 v92, v92
    v_mul_f32 v56, v56, v176
    v_mul_f32 v60, v60, v177
    v_mul_f32 v64, v64, v176
    v_mul_f32 v68, v68, v177
    v_mul_f32 v72, v72, v176
    v_mul_f32 v76, v76, v177
    v_mul_f32 v80, v80, v176
    v_mul_f32 v84, v84, v177
    v_mul_f32 v88, v88, v176
    v_mul_f32 v92, v92, v177
    v_pk_mul_f32 v[16:17], v[16:17], v[56:57] op_sel_hi:[1,0]
    v_pk_mul_f32 v[18:19], v[18:19], v[56:57] op_sel_hi:[1,0]
    v_cvt_pk_bf16_f32 v184, v16, v17
    v_cvt_pk_bf16_f32 v185, v18, v19
    v_pk_mul_f32 v[20:21], v[20:21], v[60:61] op_sel_hi:[1,0]
    v_pk_mul_f32 v[22:23], v[22:23], v[60:61] op_sel_hi:[1,0]
    v_cvt_pk_bf16_f32 v186, v20, v21
    v_cvt_pk_bf16_f32 v187, v22, v23
    buffer_store_dwordx4 v[184:187], v3, s[36:39], s55 offen offset:0 sc1
    v_pk_mul_f32 v[24:25], v[24:25], v[64:65] op_sel_hi:[1,0]
    v_pk_mul_f32 v[26:27], v[26:27], v[64:65] op_sel_hi:[1,0]
    v_cvt_pk_bf16_f32 v188, v24, v25
    v_cvt_pk_bf16_f32 v189, v26, v27
    v_pk_mul_f32 v[28:29], v[28:29], v[68:69] op_sel_hi:[1,0]
    v_pk_mul_f32 v[30:31], v[30:31], v[68:69] op_sel_hi:[1,0]
    v_cvt_pk_bf16_f32 v190, v28, v29
    v_cvt_pk_bf16_f32 v191, v30, v31
    buffer_store_dwordx4 v[188:191], v3, s[36:39], s55 offen offset:1024 sc1
    v_pk_mul_f32 v[32:33], v[32:33], v[72:73] op_sel_hi:[1,0]
    v_pk_mul_f32 v[34:35], v[34:35], v[72:73] op_sel_hi:[1,0]
    v_cvt_pk_bf16_f32 v184, v32, v33
    v_cvt_pk_bf16_f32 v185, v34, v35
    v_pk_mul_f32 v[36:37], v[36:37], v[76:77] op_sel_hi:[1,0]
    v_pk_mul_f32 v[38:39], v[38:39], v[76:77] op_sel_hi:[1,0]
    v_cvt_pk_bf16_f32 v186, v36, v37
    v_cvt_pk_bf16_f32 v187, v38, v39
    buffer_store_dwordx4 v[184:187], v3, s[36:39], s55 offen offset:2048 sc1
    v_pk_mul_f32 v[40:41], v[40:41], v[80:81] op_sel_hi:[1,0]
    v_pk_mul_f32 v[42:43], v[42:43], v[80:81] op_sel_hi:[1,0]
    v_cvt_pk_bf16_f32 v188, v40, v41
    v_cvt_pk_bf16_f32 v189, v42, v43
    v_pk_mul_f32 v[44:45], v[44:45], v[84:85] op_sel_hi:[1,0]
    v_pk_mul_f32 v[46:47], v[46:47], v[84:85] op_sel_hi:[1,0]
    v_cvt_pk_bf16_f32 v190, v44, v45
    v_cvt_pk_bf16_f32 v191, v46, v47
    buffer_store_dwordx4 v[188:191], v3, s[36:39], s55 offen offset:3072 sc1
    v_pk_mul_f32 v[48:49], v[48:49], v[88:89] op_sel_hi:[1,0]
    v_pk_mul_f32 v[50:51], v[50:51], v[88:89] op_sel_hi:[1,0]
    v_cvt_pk_bf16_f32 v184, v48, v49
    v_cvt_pk_bf16_f32 v185, v50, v51
    v_pk_mul_f32 v[52:53], v[52:53], v[92:93] op_sel_hi:[1,0]
    v_pk_mul_f32 v[54:55], v[54:55], v[92:93] op_sel_hi:[1,0]
    v_cvt_pk_bf16_f32 v186, v52, v53
    v_cvt_pk_bf16_f32 v187, v54, v55
    buffer_store_dwordx4 v[184:187], v11, s[36:39], s55 offen offset:0 sc1
    v_mfma_f32_16x16x16_bf16 v[16:19], v[200:201], v[136:137], 0
    v_mfma_f32_16x16x16_bf16 v[16:19], v[204:205], v[140:141], v[16:19]
    v_mfma_f32_16x16x16_bf16 v[56:59], v[226:227], v[136:137], 0
    v_mfma_f32_16x16x16_bf16 v[56:59], v[230:231], v[140:141], v[56:59]
    v_mfma_f32_16x16x16_bf16 v[20:23], v[200:201], v[138:139], 0
    v_mfma_f32_16x16x16_bf16 v[20:23], v[204:205], v[142:143], v[20:23]
    v_mfma_f32_16x16x16_bf16 v[60:63], v[226:227], v[138:139], 0
    v_mfma_f32_16x16x16_bf16 v[60:63], v[230:231], v[142:143], v[60:63]
    v_mfma_f32_16x16x16_bf16 v[24:27], v[202:203], v[136:137], 0
    v_mfma_f32_16x16x16_bf16 v[24:27], v[206:207], v[140:141], v[24:27]
    v_mfma_f32_16x16x16_bf16 v[24:27], v[210:211], v[144:145], v[24:27]
    v_mfma_f32_16x16x16_bf16 v[64:67], v[228:229], v[136:137], 0
    v_mfma_f32_16x16x16_bf16 v[64:67], v[232:233], v[140:141], v[64:67]
    v_mfma_f32_16x16x16_bf16 v[64:67], v[236:237], v[144:145], v[64:67]
    v_mfma_f32_16x16x16_bf16 v[28:31], v[202:203], v[138:139], 0
    v_mfma_f32_16x16x16_bf16 v[28:31], v[206:207], v[142:143], v[28:31]
    v_mfma_f32_16x16x16_bf16 v[28:31], v[210:211], v[146:147], v[28:31]
    v_mfma_f32_16x16x16_bf16 v[68:71], v[228:229], v[138:139], 0
    v_mfma_f32_16x16x16_bf16 v[68:71], v[232:233], v[142:143], v[68:71]
    v_mfma_f32_16x16x16_bf16 v[68:71], v[236:237], v[146:147], v[68:71]
    v_mfma_f32_16x16x16_bf16 v[32:35], v[208:209], v[140:141], 0
    v_mfma_f32_16x16x16_bf16 v[32:35], v[212:213], v[144:145], v[32:35]
    v_mfma_f32_16x16x16_bf16 v[32:35], v[216:217], v[148:149], v[32:35]
    v_mfma_f32_16x16x16_bf16 v[72:75], v[234:235], v[140:141], 0
    v_mfma_f32_16x16x16_bf16 v[72:75], v[238:239], v[144:145], v[72:75]
    v_mfma_f32_16x16x16_bf16 v[72:75], v[242:243], v[148:149], v[72:75]
    v_mfma_f32_16x16x16_bf16 v[36:39], v[208:209], v[142:143], 0
    v_mfma_f32_16x16x16_bf16 v[36:39], v[212:213], v[146:147], v[36:39]
    v_mfma_f32_16x16x16_bf16 v[36:39], v[216:217], v[150:151], v[36:39]
    v_mfma_f32_16x16x16_bf16 v[76:79], v[234:235], v[142:143], 0
    v_mfma_f32_16x16x16_bf16 v[76:79], v[238:239], v[146:147], v[76:79]
    v_mfma_f32_16x16x16_bf16 v[76:79], v[242:243], v[150:151], v[76:79]
    v_mfma_f32_16x16x16_bf16 v[40:43], v[214:215], v[144:145], 0
    v_mfma_f32_16x16x16_bf16 v[40:43], v[218:219], v[148:149], v[40:43]
    v_mfma_f32_16x16x16_bf16 v[40:43], v[222:223], v[152:153], v[40:43]
    v_mfma_f32_16x16x16_bf16 v[80:83], v[240:241], v[144:145], 0
    v_mfma_f32_16x16x16_bf16 v[80:83], v[244:245], v[148:149], v[80:83]
    v_mfma_f32_16x16x16_bf16 v[80:83], v[248:249], v[152:153], v[80:83]
    v_mfma_f32_16x16x16_bf16 v[44:47], v[214:215], v[146:147], 0
    v_mfma_f32_16x16x16_bf16 v[44:47], v[218:219], v[150:151], v[44:47]
    v_mfma_f32_16x16x16_bf16 v[44:47], v[222:223], v[154:155], v[44:47]
    v_mfma_f32_16x16x16_bf16 v[84:87], v[240:241], v[146:147], 0
    v_mfma_f32_16x16x16_bf16 v[84:87], v[244:245], v[150:151], v[84:87]
    v_mfma_f32_16x16x16_bf16 v[84:87], v[248:249], v[154:155], v[84:87]
    v_mfma_f32_16x16x16_bf16 v[48:51], v[220:221], v[148:149], 0
    v_mfma_f32_16x16x16_bf16 v[48:51], v[224:225], v[152:153], v[48:51]
    v_mfma_f32_16x16x16_bf16 v[88:91], v[246:247], v[148:149], 0
    v_mfma_f32_16x16x16_bf16 v[88:91], v[250:251], v[152:153], v[88:91]
    v_mfma_f32_16x16x16_bf16 v[52:55], v[220:221], v[150:151], 0
    v_mfma_f32_16x16x16_bf16 v[52:55], v[224:225], v[154:155], v[52:55]
    v_mfma_f32_16x16x16_bf16 v[92:95], v[246:247], v[150:151], 0
    v_mfma_f32_16x16x16_bf16 v[92:95], v[250:251], v[154:155], v[92:95]
    s_add_u32 s55, s77, 20660224
    v_accvgpr_read_b32 v176, a4
    v_accvgpr_read_b32 v177, a5
    s_nop 4
    v_add_f32 v56, s58, v56
    v_add_f32 v60, s58, v60
    v_add_f32 v64, s58, v64
    v_add_f32 v68, s58, v68
    v_add_f32 v72, s58, v72
    v_add_f32 v76, s58, v76
    v_add_f32 v80, s58, v80
    v_add_f32 v84, s58, v84
    v_add_f32 v88, s58, v88
    v_add_f32 v92, s58, v92
    v_rcp_f32 v56, v56
    v_rcp_f32 v60, v60
    v_rcp_f32 v64, v64
    v_rcp_f32 v68, v68
    v_rcp_f32 v72, v72
    v_rcp_f32 v76, v76
    v_rcp_f32 v80, v80
    v_rcp_f32 v84, v84
    v_rcp_f32 v88, v88
    v_rcp_f32 v92, v92
    v_mul_f32 v56, v56, v176
    v_mul_f32 v60, v60, v177
    v_mul_f32 v64, v64, v176
    v_mul_f32 v68, v68, v177
    v_mul_f32 v72, v72, v176
    v_mul_f32 v76, v76, v177
    v_mul_f32 v80, v80, v176
    v_mul_f32 v84, v84, v177
    v_mul_f32 v88, v88, v176
    v_mul_f32 v92, v92, v177
    v_pk_mul_f32 v[16:17], v[16:17], v[56:57] op_sel_hi:[1,0]
    v_pk_mul_f32 v[18:19], v[18:19], v[56:57] op_sel_hi:[1,0]
    v_cvt_pk_bf16_f32 v184, v16, v17
    v_cvt_pk_bf16_f32 v185, v18, v19
    v_pk_mul_f32 v[20:21], v[20:21], v[60:61] op_sel_hi:[1,0]
    v_pk_mul_f32 v[22:23], v[22:23], v[60:61] op_sel_hi:[1,0]
    v_cvt_pk_bf16_f32 v186, v20, v21
    v_cvt_pk_bf16_f32 v187, v22, v23
    buffer_store_dwordx4 v[184:187], v3, s[36:39], s55 offen offset:0 sc1
    v_pk_mul_f32 v[24:25], v[24:25], v[64:65] op_sel_hi:[1,0]
    v_pk_mul_f32 v[26:27], v[26:27], v[64:65] op_sel_hi:[1,0]
    v_cvt_pk_bf16_f32 v188, v24, v25
    v_cvt_pk_bf16_f32 v189, v26, v27
    v_pk_mul_f32 v[28:29], v[28:29], v[68:69] op_sel_hi:[1,0]
    v_pk_mul_f32 v[30:31], v[30:31], v[68:69] op_sel_hi:[1,0]
    v_cvt_pk_bf16_f32 v190, v28, v29
    v_cvt_pk_bf16_f32 v191, v30, v31
    buffer_store_dwordx4 v[188:191], v3, s[36:39], s55 offen offset:1024 sc1
    v_pk_mul_f32 v[32:33], v[32:33], v[72:73] op_sel_hi:[1,0]
    v_pk_mul_f32 v[34:35], v[34:35], v[72:73] op_sel_hi:[1,0]
    v_cvt_pk_bf16_f32 v184, v32, v33
    v_cvt_pk_bf16_f32 v185, v34, v35
    v_pk_mul_f32 v[36:37], v[36:37], v[76:77] op_sel_hi:[1,0]
    v_pk_mul_f32 v[38:39], v[38:39], v[76:77] op_sel_hi:[1,0]
    v_cvt_pk_bf16_f32 v186, v36, v37
    v_cvt_pk_bf16_f32 v187, v38, v39
    buffer_store_dwordx4 v[184:187], v3, s[36:39], s55 offen offset:2048 sc1
    v_pk_mul_f32 v[40:41], v[40:41], v[80:81] op_sel_hi:[1,0]
    v_pk_mul_f32 v[42:43], v[42:43], v[80:81] op_sel_hi:[1,0]
    v_cvt_pk_bf16_f32 v188, v40, v41
    v_cvt_pk_bf16_f32 v189, v42, v43
    v_pk_mul_f32 v[44:45], v[44:45], v[84:85] op_sel_hi:[1,0]
    v_pk_mul_f32 v[46:47], v[46:47], v[84:85] op_sel_hi:[1,0]
    v_cvt_pk_bf16_f32 v190, v44, v45
    v_cvt_pk_bf16_f32 v191, v46, v47
    buffer_store_dwordx4 v[188:191], v3, s[36:39], s55 offen offset:3072 sc1
    v_pk_mul_f32 v[48:49], v[48:49], v[88:89] op_sel_hi:[1,0]
    v_pk_mul_f32 v[50:51], v[50:51], v[88:89] op_sel_hi:[1,0]
    v_cvt_pk_bf16_f32 v184, v48, v49
    v_cvt_pk_bf16_f32 v185, v50, v51
    v_pk_mul_f32 v[52:53], v[52:53], v[92:93] op_sel_hi:[1,0]
    v_pk_mul_f32 v[54:55], v[54:55], v[92:93] op_sel_hi:[1,0]
    v_cvt_pk_bf16_f32 v186, v52, v53
    v_cvt_pk_bf16_f32 v187, v54, v55
    buffer_store_dwordx4 v[184:187], v11, s[36:39], s55 offen offset:0 sc1
    v_mfma_f32_16x16x16_bf16 v[16:19], v[200:201], v[156:157], 0
    v_mfma_f32_16x16x16_bf16 v[16:19], v[204:205], v[160:161], v[16:19]
    v_mfma_f32_16x16x16_bf16 v[56:59], v[226:227], v[156:157], 0
    v_mfma_f32_16x16x16_bf16 v[56:59], v[230:231], v[160:161], v[56:59]
    v_mfma_f32_16x16x16_bf16 v[20:23], v[200:201], v[158:159], 0
    v_mfma_f32_16x16x16_bf16 v[20:23], v[204:205], v[162:163], v[20:23]
    v_mfma_f32_16x16x16_bf16 v[60:63], v[226:227], v[158:159], 0
    v_mfma_f32_16x16x16_bf16 v[60:63], v[230:231], v[162:163], v[60:63]
    v_mfma_f32_16x16x16_bf16 v[24:27], v[202:203], v[156:157], 0
    v_mfma_f32_16x16x16_bf16 v[24:27], v[206:207], v[160:161], v[24:27]
    v_mfma_f32_16x16x16_bf16 v[24:27], v[210:211], v[164:165], v[24:27]
    v_mfma_f32_16x16x16_bf16 v[64:67], v[228:229], v[156:157], 0
    v_mfma_f32_16x16x16_bf16 v[64:67], v[232:233], v[160:161], v[64:67]
    v_mfma_f32_16x16x16_bf16 v[64:67], v[236:237], v[164:165], v[64:67]
    v_mfma_f32_16x16x16_bf16 v[28:31], v[202:203], v[158:159], 0
    v_mfma_f32_16x16x16_bf16 v[28:31], v[206:207], v[162:163], v[28:31]
    v_mfma_f32_16x16x16_bf16 v[28:31], v[210:211], v[166:167], v[28:31]
    v_mfma_f32_16x16x16_bf16 v[68:71], v[228:229], v[158:159], 0
    v_mfma_f32_16x16x16_bf16 v[68:71], v[232:233], v[162:163], v[68:71]
    v_mfma_f32_16x16x16_bf16 v[68:71], v[236:237], v[166:167], v[68:71]
    v_mfma_f32_16x16x16_bf16 v[32:35], v[208:209], v[160:161], 0
    v_mfma_f32_16x16x16_bf16 v[32:35], v[212:213], v[164:165], v[32:35]
    v_mfma_f32_16x16x16_bf16 v[32:35], v[216:217], v[168:169], v[32:35]
    v_mfma_f32_16x16x16_bf16 v[72:75], v[234:235], v[160:161], 0
    v_mfma_f32_16x16x16_bf16 v[72:75], v[238:239], v[164:165], v[72:75]
    v_mfma_f32_16x16x16_bf16 v[72:75], v[242:243], v[168:169], v[72:75]
    v_mfma_f32_16x16x16_bf16 v[36:39], v[208:209], v[162:163], 0
    v_mfma_f32_16x16x16_bf16 v[36:39], v[212:213], v[166:167], v[36:39]
    v_mfma_f32_16x16x16_bf16 v[36:39], v[216:217], v[170:171], v[36:39]
    v_mfma_f32_16x16x16_bf16 v[76:79], v[234:235], v[162:163], 0
    v_mfma_f32_16x16x16_bf16 v[76:79], v[238:239], v[166:167], v[76:79]
    v_mfma_f32_16x16x16_bf16 v[76:79], v[242:243], v[170:171], v[76:79]
    v_mfma_f32_16x16x16_bf16 v[40:43], v[214:215], v[164:165], 0
    v_mfma_f32_16x16x16_bf16 v[40:43], v[218:219], v[168:169], v[40:43]
    v_mfma_f32_16x16x16_bf16 v[40:43], v[222:223], v[172:173], v[40:43]
    v_mfma_f32_16x16x16_bf16 v[80:83], v[240:241], v[164:165], 0
    v_mfma_f32_16x16x16_bf16 v[80:83], v[244:245], v[168:169], v[80:83]
    v_mfma_f32_16x16x16_bf16 v[80:83], v[248:249], v[172:173], v[80:83]
    v_mfma_f32_16x16x16_bf16 v[44:47], v[214:215], v[166:167], 0
    v_mfma_f32_16x16x16_bf16 v[44:47], v[218:219], v[170:171], v[44:47]
    v_mfma_f32_16x16x16_bf16 v[44:47], v[222:223], v[174:175], v[44:47]
    v_mfma_f32_16x16x16_bf16 v[84:87], v[240:241], v[166:167], 0
    v_mfma_f32_16x16x16_bf16 v[84:87], v[244:245], v[170:171], v[84:87]
    v_mfma_f32_16x16x16_bf16 v[84:87], v[248:249], v[174:175], v[84:87]
    v_mfma_f32_16x16x16_bf16 v[48:51], v[220:221], v[168:169], 0
    v_mfma_f32_16x16x16_bf16 v[48:51], v[224:225], v[172:173], v[48:51]
    v_mfma_f32_16x16x16_bf16 v[88:91], v[246:247], v[168:169], 0
    v_mfma_f32_16x16x16_bf16 v[88:91], v[250:251], v[172:173], v[88:91]
    v_mfma_f32_16x16x16_bf16 v[52:55], v[220:221], v[170:171], 0
    v_mfma_f32_16x16x16_bf16 v[52:55], v[224:225], v[174:175], v[52:55]
    v_mfma_f32_16x16x16_bf16 v[92:95], v[246:247], v[170:171], 0
    v_mfma_f32_16x16x16_bf16 v[92:95], v[250:251], v[174:175], v[92:95]
    s_add_u32 s55, s77, 20701184
    v_accvgpr_read_b32 v176, a6
    v_accvgpr_read_b32 v177, a7
    s_nop 4
    v_add_f32 v56, s58, v56
    v_add_f32 v60, s58, v60
    v_add_f32 v64, s58, v64
    v_add_f32 v68, s58, v68
    v_add_f32 v72, s58, v72
    v_add_f32 v76, s58, v76
    v_add_f32 v80, s58, v80
    v_add_f32 v84, s58, v84
    v_add_f32 v88, s58, v88
    v_add_f32 v92, s58, v92
    v_rcp_f32 v56, v56
    v_rcp_f32 v60, v60
    v_rcp_f32 v64, v64
    v_rcp_f32 v68, v68
    v_rcp_f32 v72, v72
    v_rcp_f32 v76, v76
    v_rcp_f32 v80, v80
    v_rcp_f32 v84, v84
    v_rcp_f32 v88, v88
    v_rcp_f32 v92, v92
    v_mul_f32 v56, v56, v176
    v_mul_f32 v60, v60, v177
    v_mul_f32 v64, v64, v176
    v_mul_f32 v68, v68, v177
    v_mul_f32 v72, v72, v176
    v_mul_f32 v76, v76, v177
    v_mul_f32 v80, v80, v176
    v_mul_f32 v84, v84, v177
    v_mul_f32 v88, v88, v176
    v_mul_f32 v92, v92, v177
    v_pk_mul_f32 v[16:17], v[16:17], v[56:57] op_sel_hi:[1,0]
    v_pk_mul_f32 v[18:19], v[18:19], v[56:57] op_sel_hi:[1,0]
    v_cvt_pk_bf16_f32 v184, v16, v17
    v_cvt_pk_bf16_f32 v185, v18, v19
    v_pk_mul_f32 v[20:21], v[20:21], v[60:61] op_sel_hi:[1,0]
    v_pk_mul_f32 v[22:23], v[22:23], v[60:61] op_sel_hi:[1,0]
    v_cvt_pk_bf16_f32 v186, v20, v21
    v_cvt_pk_bf16_f32 v187, v22, v23
    buffer_store_dwordx4 v[184:187], v3, s[36:39], s55 offen offset:0 sc1
    v_pk_mul_f32 v[24:25], v[24:25], v[64:65] op_sel_hi:[1,0]
    v_pk_mul_f32 v[26:27], v[26:27], v[64:65] op_sel_hi:[1,0]
    v_cvt_pk_bf16_f32 v188, v24, v25
    v_cvt_pk_bf16_f32 v189, v26, v27
    v_pk_mul_f32 v[28:29], v[28:29], v[68:69] op_sel_hi:[1,0]
    v_pk_mul_f32 v[30:31], v[30:31], v[68:69] op_sel_hi:[1,0]
    v_cvt_pk_bf16_f32 v190, v28, v29
    v_cvt_pk_bf16_f32 v191, v30, v31
    buffer_store_dwordx4 v[188:191], v3, s[36:39], s55 offen offset:1024 sc1
    v_pk_mul_f32 v[32:33], v[32:33], v[72:73] op_sel_hi:[1,0]
    v_pk_mul_f32 v[34:35], v[34:35], v[72:73] op_sel_hi:[1,0]
    v_cvt_pk_bf16_f32 v184, v32, v33
    v_cvt_pk_bf16_f32 v185, v34, v35
    v_pk_mul_f32 v[36:37], v[36:37], v[76:77] op_sel_hi:[1,0]
    v_pk_mul_f32 v[38:39], v[38:39], v[76:77] op_sel_hi:[1,0]
    v_cvt_pk_bf16_f32 v186, v36, v37
    v_cvt_pk_bf16_f32 v187, v38, v39
    buffer_store_dwordx4 v[184:187], v3, s[36:39], s55 offen offset:2048 sc1
    v_pk_mul_f32 v[40:41], v[40:41], v[80:81] op_sel_hi:[1,0]
    v_pk_mul_f32 v[42:43], v[42:43], v[80:81] op_sel_hi:[1,0]
    v_cvt_pk_bf16_f32 v188, v40, v41
    v_cvt_pk_bf16_f32 v189, v42, v43
    v_pk_mul_f32 v[44:45], v[44:45], v[84:85] op_sel_hi:[1,0]
    v_pk_mul_f32 v[46:47], v[46:47], v[84:85] op_sel_hi:[1,0]
    v_cvt_pk_bf16_f32 v190, v44, v45
    v_cvt_pk_bf16_f32 v191, v46, v47
    buffer_store_dwordx4 v[188:191], v3, s[36:39], s55 offen offset:3072 sc1
    v_pk_mul_f32 v[48:49], v[48:49], v[88:89] op_sel_hi:[1,0]
    v_pk_mul_f32 v[50:51], v[50:51], v[88:89] op_sel_hi:[1,0]
    v_cvt_pk_bf16_f32 v184, v48, v49
    v_cvt_pk_bf16_f32 v185, v50, v51
    v_pk_mul_f32 v[52:53], v[52:53], v[92:93] op_sel_hi:[1,0]
    v_pk_mul_f32 v[54:55], v[54:55], v[92:93] op_sel_hi:[1,0]
    v_cvt_pk_bf16_f32 v186, v52, v53
    v_cvt_pk_bf16_f32 v187, v54, v55
    buffer_store_dwordx4 v[184:187], v11, s[36:39], s55 offen offset:0 sc1
    s_waitcnt vmcnt(0)
    s_barrier
    s_cmp_lg_u32 s3, 0
    s_cbranch_scc1 L_sf_33
    v_mov_b32 v10, 67
    s_mov_b64 exec, 1
    buffer_store_dword v10, v8, s[36:39], s65 offen offset:0 sc1
    s_mov_b64 exec, -1
L_sf_33:
L_tofinal:
    s_and_b32 s55, s5, 2
    s_mul_i32 s55, s55, 15
    s_add_u32 s72, s52, s55
    s_cmp_ge_u32 s52, 30
    s_cbranch_scc1 L_exit
L_final:
    s_mul_i32 s6, s72, 0x199a
    s_lshr_b32 s6, s6, 16
    s_mul_i32 s73, s6, 10
    s_sub_u32 s73, s72, s73
    s_add_u32 s90, s6, 42
    s_add_u32 s91, s6, 55
    s_cmp_lt_u32 s6, 2
    s_cselect_b32 s94, 2, 4
    s_cselect_b32 s91, s90, s91
    s_cselect_b32 s64, 57, 64
    s_mov_b32 s40, s12
    s_and_b32 s41, s13, 0xffff
    s_mov_b32 s42, 819200
    s_mov_b32 s43, 0x20000
    s_mul_i32 s54, s3, 204800
    s_lshl_b32 s55, s73, 7
    s_add_u32 s54, s54, s55
    v_lshrrev_b32 v22, 3, v2
    v_mul_u32_u24 v16, 1280, v22
    v_lshrrev_b32 v22, 1, v22
    v_lshlrev_b32 v22, 1, v22
    v_and_b32 v23, 7, v2
    v_xor_b32 v22, v22, v23
    v_lshl_add_u32 v16, v22, 4, v16
    v_lshrrev_b32 v22, 2, v0
    v_lshl_add_u32 v17, v1, 2, v22
    v_lshlrev_b32 v17, 7, v17
    v_and_b32 v23, 3, v0
    v_lshl_add_u32 v17, v23, 3, v17
    v_lshrrev_b32 v22, 1, v22
    v_and_b32 v23, 1, v1
    v_lshl_add_u32 v22, v23, 1, v22
    s_mul_i32 s58, s3, 20480
    s_mov_b32 s57, s54
    v_add_u32 v17, s58, v17
    s_add_u32 s55, 0, 0
    s_and_b32 s56, s55, 3
    s_lshr_b32 s55, s55, 2
    s_mul_i32 s55, s55, 20480
    v_xor_b32 v23, s56, v22
    v_lshl_add_u32 v23, v23, 5, v17
    v_add_u32 v18, s55, v23
    s_add_u32 s55, 0, 1
    s_and_b32 s56, s55, 3
    s_lshr_b32 s55, s55, 2
    s_mul_i32 s55, s55, 20480
    v_xor_b32 v23, s56, v22
    v_lshl_add_u32 v23, v23, 5, v17
    v_add_u32 v19, s55, v23
    s_add_u32 s55, 0, 2
    s_and_b32 s56, s55, 3
    s_lshr_b32 s55, s55, 2
    s_mul_i32 s55, s55, 20480
    v_xor_b32 v23, s56, v22
    v_lshl_add_u32 v23, v23, 5, v17
    v_add_u32 v20, s55, v23
    s_add_u32 s55, 0, 3
    s_and_b32 s56, s55, 3
    s_lshr_b32 s55, s55, 2
    s_mul_i32 s55, s55, 20480
    v_xor_b32 v23, s56, v22
    v_lshl_add_u32 v23, v23, 5, v17
    v_add_u32 v21, s55, v23
    s_add_u32 m0, s58, 0
    s_add_u32 s55, s57, 0
    buffer_load_dwordx4 v16, s[40:43], s55 offen lds
    s_add_u32 m0, s58, 1024
    s_add_u32 s55, s57, 10240
    buffer_load_dwordx4 v16, s[40:43], s55 offen lds
    s_add_u32 m0, s58, 2048
    s_add_u32 s55, s57, 20480
    buffer_load_dwordx4 v16, s[40:43], s55 offen lds
    s_add_u32 m0, s58, 3072
    s_add_u32 s55, s57, 30720
    buffer_load_dwordx4 v16, s[40:43], s55 offen lds
    s_add_u32 m0, s58, 4096
    s_add_u32 s55, s57, 40960
    buffer_load_dwordx4 v16, s[40:43], s55 offen lds
    s_add_u32 m0, s58, 5120
    s_add_u32 s55, s57, 51200
    buffer_load_dwordx4 v16, s[40:43], s55 offen lds
    s_add_u32 m0, s58, 6144
    s_add_u32 s55, s57, 61440
    buffer_load_dwordx4 v16, s[40:43], s55 offen lds
    s_add_u32 m0, s58, 7168
    s_add_u32 s55, s57, 71680
    buffer_load_dwordx4 v16, s[40:43], s55 offen lds
    s_add_u32 m0, s58, 8192
    s_add_u32 s55, s57, 81920
    buffer_load_dwordx4 v16, s[40:43], s55 offen lds
    s_add_u32 m0, s58, 9216
    s_add_u32 s55, s57, 92160
    buffer_load_dwordx4 v16, s[40:43], s55 offen lds
    s_add_u32 m0, s58, 10240
    s_add_u32 s55, s57, 102400
    buffer_load_dwordx4 v16, s[40:43], s55 offen lds
    s_add_u32 m0, s58, 11264
    s_add_u32 s55, s57, 112640
    buffer_load_dwordx4 v16, s[40:43], s55 offen lds
    s_add_u32 m0, s58, 12288
    s_add_u32 s55, s57, 122880
    buffer_load_dwordx4 v16, s[40:43], s55 offen lds
    s_add_u32 m0, s58, 13312
    s_add_u32 s55, s57, 133120
    buffer_load_dwordx4 v16, s[40:43], s55 offen lds
    s_add_u32 m0, s58, 14336
    s_add_u32 s55, s57, 143360
    buffer_load_dwordx4 v16, s[40:43], s55 offen lds
    s_add_u32 m0, s58, 15360
    s_add_u32 s55, s57, 153600
    buffer_load_dwordx4 v16, s[40:43], s55 offen lds
    s_add_u32 m0, s58, 16384
    s_add_u32 s55, s57, 163840
    buffer_load_dwordx4 v16, s[40:43], s55 offen lds
    s_add_u32 m0, s58, 17408
    s_add_u32 s55, s57, 174080
    buffer_load_dwordx4 v16, s[40:43], s55 offen lds
    s_add_u32 m0, s58, 18432
    s_add_u32 s55, s57, 184320
    buffer_load_dwordx4 v16, s[40:43], s55 offen lds
    s_add_u32 m0, s58, 19456
    s_add_u32 s55, s57, 194560
    buffer_load_dwordx4 v16, s[40:43], s55 offen lds
    s_waitcnt vmcnt(0)
    v_add_u32 v23, 0, v18
    ds_read_b64_tr_b16 a[0:1], v23 offset:0
    ds_read_b64_tr_b16 a[2:3], v23 offset:2048
    ds_read_b64_tr_b16 a[16:17], v23 offset:4096
    ds_read_b64_tr_b16 a[18:19], v23 offset:6144
    ds_read_b64_tr_b16 a[32:33], v23 offset:8192
    ds_read_b64_tr_b16 a[34:35], v23 offset:10240
    ds_read_b64_tr_b16 a[48:49], v23 offset:12288
    ds_read_b64_tr_b16 a[50:51], v23 offset:14336
    s_waitcnt lgkmcnt(6)
    ds_read_b64_tr_b16 a[64:65], v23 offset:16384
    ds_read_b64_tr_b16 a[66:67], v23 offset:18432
    v_add_u32 v24, 0, v19
    ds_read_b64_tr_b16 a[4:5], v24 offset:0
    ds_read_b64_tr_b16 a[6:7], v24 offset:2048
    ds_read_b64_tr_b16 a[20:21], v24 offset:4096
    ds_read_b64_tr_b16 a[22:23], v24 offset:6144
    ds_read_b64_tr_b16 a[36:37], v24 offset:8192
    ds_read_b64_tr_b16 a[38:39], v24 offset:10240
    s_waitcnt lgkmcnt(6)
    ds_read_b64_tr_b16 a[52:53], v24 offset:12288
    ds_read_b64_tr_b16 a[54:55], v24 offset:14336
    ds_read_b64_tr_b16 a[68:69], v24 offset:16384
    ds_read_b64_tr_b16 a[70:71], v24 offset:18432
    v_add_u32 v23, 0, v20
    ds_read_b64_tr_b16 a[8:9], v23 offset:0
    ds_read_b64_tr_b16 a[10:11], v23 offset:2048
    ds_read_b64_tr_b16 a[24:25], v23 offset:4096
    ds_read_b64_tr_b16 a[26:27], v23 offset:6144
    s_waitcnt lgkmcnt(6)
    ds_read_b64_tr_b16 a[40:41], v23 offset:8192
    ds_read_b64_tr_b16 a[42:43], v23 offset:10240
    ds_read_b64_tr_b16 a[56:57], v23 offset:12288
    ds_read_b64_tr_b16 a[58:59], v23 offset:14336
    ds_read_b64_tr_b16 a[72:73], v23 offset:16384
    ds_read_b64_tr_b16 a[74:75], v23 offset:18432
    v_add_u32 v24, 0, v21
    ds_read_b64_tr_b16 a[12:13], v24 offset:0
    ds_read_b64_tr_b16 a[14:15], v24 offset:2048
    s_waitcnt lgkmcnt(6)
    ds_read_b64_tr_b16 a[28:29], v24 offset:4096
    ds_read_b64_tr_b16 a[30:31], v24 offset:6144
    ds_read_b64_tr_b16 a[44:45], v24 offset:8192
    ds_read_b64_tr_b16 a[46:47], v24 offset:10240
    ds_read_b64_tr_b16 a[60:61], v24 offset:12288
    ds_read_b64_tr_b16 a[62:63], v24 offset:14336
    ds_read_b64_tr_b16 a[76:77], v24 offset:16384
    ds_read_b64_tr_b16 a[78:79], v24 offset:18432
    s_waitcnt lgkmcnt(6)
    s_waitcnt lgkmcnt(0)
    s_mov_b32 s44, s30
    s_and_b32 s45, s31, 0xffff
    s_mov_b32 s46, 2621440
    s_mov_b32 s47, 0x20000
    v_and_b32 v9, 31, v2
    v_lshlrev_b32 v9, 9, v9
    v_add_u32 v9, 1458176, v9
    v_add_u32 v13, 4096, v3
    s_mul_i32 s55, s3, 8448
    v_add_u32 v14, s55, v3
    v_lshrrev_b32 v10, 3, v2
    s_lshl_b32 s55, s3, 3
    v_add_u32 v10, s55, v10
    v_and_b32 v11, 7, v2
    v_mul_u32_u24 v5, 1280, v10
    v_lshl_add_u32 v5, v11, 4, v5
    v_lshrrev_b32 v15, 4, v10
    v_and_b32 v12, 6, v11
    v_add_u32 v15, v12, v15
    v_mul_u32_u24 v15, 1056, v15
    v_and_b32 v10, 15, v10
    v_lshl_add_u32 v15, v10, 4, v15
    v_and_b32 v11, 1, v11
    v_lshl_add_u32 v15, v11, 9, v15
    s_mov_b32 s80, 0
    s_mov_b32 s81, -1
    s_barrier
    s_sub_u32 s66, s65, 16384
    s_mov_b32 s57, 128
    s_cmp_lg_u32 s3, 0
    s_cbranch_scc1 L_w0_34
    s_branch L_wf_35_go
L_wf_35:
    s_sleep 8
    s_add_u32 s7, s7, 1
    s_cmp_gt_u32 s7, 400000
    s_cbranch_scc1 L_exit
L_wf_35_go:
    buffer_load_dword v10, v9, s[36:39], s57 offen offset:0 sc1
    s_waitcnt vmcnt(0)
    v_cmp_gt_u32 vcc, 67, v10
    s_cbranch_vccnz L_wf_35
L_w0_34:
    s_waitcnt vmcnt(0)
    s_barrier
    v_lshrrev_b32 v10, 2, v0
    v_cmp_eq_u32 vcc, v10, v1
    v_and_b32 v10, 1, v0
    v_lshlrev_b32 v10, 4, v10
    v_mov_b32 v11, 0x3f80
    v_lshlrev_b32 v10, v10, v11
    v_cndmask_b32 v10, 0, v10, vcc
    v_and_b32 v11, 2, v0
    v_cmp_eq_u32 vcc, 0, v11
    v_mov_b32 v222, 0
    v_mov_b32 v223, 0
    v_cndmask_b32 v220, 0, v10, vcc
    v_cndmask_b32 v221, v10, 0, vcc
    v_mov_b32 v224, 0
    v_mov_b32 v225, 0
    v_mov_b32 v226, v220
    v_mov_b32 v227, v221
    v_lshlrev_b32 v215, 2, v0
    s_lshl_b32 s56, s4, 13
    v_add_u32 v215, s56, v215
L_final_next:
    s_cmp_ge_u32 s6, 57
    s_cbranch_scc1 L_final_heavy
    s_add_u32 s56, s6, 8
    s_mov_b32 s57, 1441792
    s_mov_b32 s58, 1449984
    v_lshlrev_b32 v204, 7, v2
    s_branch L_wf_37_go
L_wf_37:
    s_sleep 6
    s_add_u32 s7, s7, 1
    s_cmp_gt_u32 s7, 400000
    s_cbranch_scc1 L_exit
L_wf_37_go:
    buffer_load_dword v205, v8, s[36:39], s66 offen offset:0 sc1
    s_waitcnt vmcnt(0)
    v_cmp_gt_u32 vcc, s56, v205
    s_cbranch_vccnz L_wf_37
    s_branch L_lw_36_go
L_lw_36:
    s_sleep 4
    s_add_u32 s7, s7, 1
    s_cmp_gt_u32 s7, 400000
    s_cbranch_scc1 L_exit
L_lw_36_go:
    buffer_load_dword v205, v204, s[36:39], s57 offen offset:0 sc1
    buffer_load_dword v206, v204, s[36:39], s58 offen offset:0 sc1
    s_waitcnt vmcnt(0)
    v_min_u32 v205, v205, v206
    v_cmp_gt_u32 vcc, s56, v205
    s_cbranch_vccnz L_lw_36
    s_lshl_b32 s55, s6, 5
    s_lshl_b32 s56, s3, 3
    s_add_u32 s55, s55, s56
    s_lshl_b32 s57, s73, 12
    s_mul_i32 s74, s55, 40960
    s_add_u32 s74, s74, s57
    s_add_u32 s74, s74, 98566144
    s_mul_i32 s77, s55, 1280
    s_add_u32 s77, s77, 20578304
    s_lshl_b32 s76, s55, 11
    s_add_u32 s76, s76, 8519680
    s_mul_i32 s75, s55, 10240
    s_add_u32 s75, s75, s57
    s_add_u32 s69, s75, 24248320
    s_add_u32 s75, s75, 26869760
    s_lshl_b32 s71, s6, 7
    s_add_u32 s71, s71, 23199744
    buffer_load_dword v207, v8, s[36:39], s66 offen offset:0 sc1
    buffer_load_dword v216, v215, s[36:39], s71 offen offset:0 sc1
    buffer_load_dword v217, v215, s[36:39], s71 offen offset:64 sc1
    s_add_u32 s55, s77, 0
    buffer_load_dwordx4 v[128:131], v3, s[36:39], s55 offen offset:0 sc1
    buffer_load_dwordx4 v[132:135], v3, s[36:39], s55 offen offset:1024 sc1
    s_add_u32 s55, s77, 2048
    buffer_load_dwordx4 v[136:139], v3, s[36:39], s55 offen offset:0 sc1
    buffer_load_dwordx4 v[140:143], v3, s[36:39], s55 offen offset:1024 sc1
    s_add_u32 s55, s77, 4096
    buffer_load_dwordx4 v[144:147], v3, s[36:39], s55 offen offset:0 sc1
    buffer_load_dwordx4 v[148:151], v3, s[36:39], s55 offen offset:1024 sc1
    s_add_u32 s55, s77, 6144
    buffer_load_dwordx4 v[152:155], v3, s[36:39], s55 offen offset:0 sc1
    buffer_load_dwordx4 v[156:159], v3, s[36:39], s55 offen offset:1024 sc1
    s_add_u32 s55, s77, 8192
    buffer_load_dwordx4 v[160:163], v3, s[36:39], s55 offen offset:0 sc1
    buffer_load_dwordx4 v[164:167], v3, s[36:39], s55 offen offset:1024 sc1
    s_add_u32 s55, s69, 0
    buffer_load_dwordx4 v[48:51], v3, s[36:39], s55 offen offset:0 sc1
    buffer_load_dwordx4 v[52:55], v3, s[36:39], s55 offen offset:1024 sc1
    buffer_load_dwordx4 v[56:59], v3, s[36:39], s55 offen offset:2048 sc1
    buffer_load_dwordx4 v[60:63], v3, s[36:39], s55 offen offset:3072 sc1
    s_add_u32 s55, s69, 40960
    buffer_load_dwordx4 v[64:67], v3, s[36:39], s55 offen offset:0 sc1
    buffer_load_dwordx4 v[68:71], v3, s[36:39], s55 offen offset:1024 sc1
    buffer_load_dwordx4 v[72:75], v3, s[36:39], s55 offen offset:2048 sc1
    buffer_load_dwordx4 v[76:79], v3, s[36:39], s55 offen offset:3072 sc1
    buffer_load_dword v10, v8, s[36:39], s65 offen offset:0
    .p2align 6
L_final_loop:
    s_waitcnt vmcnt(19)
    v_sub_f32 v218, 1.0, v216
    v_sub_f32 v219, 1.0, v217
    s_mul_i32 s62, s6, 40960
    s_lshl_b32 s57, s73, 7
    s_add_u32 s62, s62, s57
    s_cmp_lt_u32 s6, 42
    s_cselect_b32 s55, 6, s94
    s_add_u32 s6, s6, s55
    s_cmp_eq_u32 s6, s90
    s_cselect_b32 s6, s91, s6
    s_cmp_ge_u32 s6, s64
    s_cselect_b32 s6, 64, s6
    v_readfirstlane_b32 s55, v207
    s_add_u32 s56, s6, 9
    s_cmp_lt_u32 s6, 54
    s_cselect_b32 s56, s56, 999
    s_cmp_ge_u32 s55, s56
    s_cbranch_scc0 L_final_last
    s_lshl_b32 s55, s6, 5
    s_lshl_b32 s56, s3, 3
    s_add_u32 s55, s55, s56
    s_lshl_b32 s57, s73, 12
    s_mul_i32 s74, s55, 40960
    s_add_u32 s74, s74, s57
    s_add_u32 s74, s74, 98566144
    s_mul_i32 s77, s55, 1280
    s_add_u32 s77, s77, 20578304
    s_lshl_b32 s76, s55, 11
    s_add_u32 s76, s76, 8519680
    s_mul_i32 s75, s55, 10240
    s_add_u32 s75, s75, s57
    s_add_u32 s69, s75, 24248320
    s_add_u32 s75, s75, 26869760
    s_lshl_b32 s71, s6, 7
    s_add_u32 s71, s71, 23199744
    buffer_load_dword v207, v8, s[36:39], s66 offen offset:0 sc1
    buffer_load_dword v216, v215, s[36:39], s71 offen offset:0 sc1
    buffer_load_dword v217, v215, s[36:39], s71 offen offset:64 sc1
    s_waitcnt vmcnt(20)
    v_swap_b32 v130, v132
    v_swap_b32 v131, v133
    s_nop 1
    v_mfma_f32_16x16x32_bf16 v[16:19], a[0:3], v[128:131], 0
    v_mfma_f32_16x16x32_bf16 v[20:23], a[0:3], v[132:135], 0
    v_mfma_f32_16x16x32_bf16 v[24:27], a[4:7], v[128:131], 0
    v_mfma_f32_16x16x32_bf16 v[28:31], a[4:7], v[132:135], 0
    v_mfma_f32_16x16x32_bf16 v[32:35], a[8:11], v[128:131], 0
    v_mfma_f32_16x16x32_bf16 v[36:39], a[8:11], v[132:135], 0
    v_mfma_f32_16x16x32_bf16 v[40:43], a[12:15], v[128:131], 0
    v_mfma_f32_16x16x32_bf16 v[44:47], a[12:15], v[132:135], 0
    s_add_u32 s55, s77, 0
    buffer_load_dwordx4 v[128:131], v3, s[36:39], s55 offen offset:0 sc1
    buffer_load_dwordx4 v[132:135], v3, s[36:39], s55 offen offset:1024 sc1
    s_waitcnt vmcnt(20)
    v_swap_b32 v138, v140
    v_swap_b32 v139, v141
    s_nop 1
    v_mfma_f32_16x16x32_bf16 v[16:19], a[16:19], v[136:139], v[16:19]
    v_mfma_f32_16x16x32_bf16 v[20:23], a[16:19], v[140:143], v[20:23]
    v_mfma_f32_16x16x32_bf16 v[24:27], a[20:23], v[136:139], v[24:27]
    v_mfma_f32_16x16x32_bf16 v[28:31], a[20:23], v[140:143], v[28:31]
    v_mfma_f32_16x16x32_bf16 v[32:35], a[24:27], v[136:139], v[32:35]
    v_mfma_f32_16x16x32_bf16 v[36:39], a[24:27], v[140:143], v[36:39]
    v_mfma_f32_16x16x32_bf16 v[40:43], a[28:31], v[136:139], v[40:43]
    v_mfma_f32_16x16x32_bf16 v[44:47], a[28:31], v[140:143], v[44:47]
    s_add_u32 s55, s77, 2048
    buffer_load_dwordx4 v[136:139], v3, s[36:39], s55 offen offset:0 sc1
    buffer_load_dwordx4 v[140:143], v3, s[36:39], s55 offen offset:1024 sc1
    s_waitcnt vmcnt(20)
    v_swap_b32 v146, v148
    v_swap_b32 v147, v149
    s_nop 1
    v_mfma_f32_16x16x32_bf16 v[16:19], a[32:35], v[144:147], v[16:19]
    v_mfma_f32_16x16x32_bf16 v[20:23], a[32:35], v[148:151], v[20:23]
    v_mfma_f32_16x16x32_bf16 v[24:27], a[36:39], v[144:147], v[24:27]
    v_mfma_f32_16x16x32_bf16 v[28:31], a[36:39], v[148:151], v[28:31]
    v_mfma_f32_16x16x32_bf16 v[32:35], a[40:43], v[144:147], v[32:35]
    v_mfma_f32_16x16x32_bf16 v[36:39], a[40:43], v[148:151], v[36:39]
    v_mfma_f32_16x16x32_bf16 v[40:43], a[44:47], v[144:147], v[40:43]
    v_mfma_f32_16x16x32_bf16 v[44:47], a[44:47], v[148:151], v[44:47]
    s_add_u32 s55, s77, 4096
    buffer_load_dwordx4 v[144:147], v3, s[36:39], s55 offen offset:0 sc1
    buffer_load_dwordx4 v[148:151], v3, s[36:39], s55 offen offset:1024 sc1
    s_waitcnt vmcnt(20)
    v_swap_b32 v154, v156
    v_swap_b32 v155, v157
    s_nop 1
    v_mfma_f32_16x16x32_bf16 v[16:19], a[48:51], v[152:155], v[16:19]
    v_mfma_f32_16x16x32_bf16 v[20:23], a[48:51], v[156:159], v[20:23]
    v_mfma_f32_16x16x32_bf16 v[24:27], a[52:55], v[152:155], v[24:27]
    v_mfma_f32_16x16x32_bf16 v[28:31], a[52:55], v[156:159], v[28:31]
    v_mfma_f32_16x16x32_bf16 v[32:35], a[56:59], v[152:155], v[32:35]
    v_mfma_f32_16x16x32_bf16 v[36:39], a[56:59], v[156:159], v[36:39]
    v_mfma_f32_16x16x32_bf16 v[40:43], a[60:63], v[152:155], v[40:43]
    v_mfma_f32_16x16x32_bf16 v[44:47], a[60:63], v[156:159], v[44:47]
    s_add_u32 s55, s77, 6144
    buffer_load_dwordx4 v[152:155], v3, s[36:39], s55 offen offset:0 sc1
    buffer_load_dwordx4 v[156:159], v3, s[36:39], s55 offen offset:1024 sc1
    s_waitcnt vmcnt(20)
    v_swap_b32 v162, v164
    v_swap_b32 v163, v165
    s_nop 1
    v_mfma_f32_16x16x32_bf16 v[16:19], a[64:67], v[160:163], v[16:19]
    v_mfma_f32_16x16x32_bf16 v[20:23], a[64:67], v[164:167], v[20:23]
    v_mfma_f32_16x16x32_bf16 v[24:27], a[68:71], v[160:163], v[24:27]
    v_mfma_f32_16x16x32_bf16 v[28:31], a[68:71], v[164:167], v[28:31]
    v_mfma_f32_16x16x32_bf16 v[32:35], a[72:75], v[160:163], v[32:35]
    v_mfma_f32_16x16x32_bf16 v[36:39], a[72:75], v[164:167], v[36:39]
    v_mfma_f32_16x16x32_bf16 v[40:43], a[76:79], v[160:163], v[40:43]
    v_mfma_f32_16x16x32_bf16 v[44:47], a[76:79], v[164:167], v[44:47]
    s_add_u32 s55, s77, 8192
    buffer_load_dwordx4 v[160:163], v3, s[36:39], s55 offen offset:0 sc1
    buffer_load_dwordx4 v[164:167], v3, s[36:39], s55 offen offset:1024 sc1
    s_waitcnt vmcnt(18)
    v_mfma_f32_16x16x32_bf16 v[168:171], v[220:223], v[48:51], 0
    v_mfma_f32_16x16x32_bf16 v[172:175], v[224:227], v[48:51], 0
    s_add_u32 s55, s69, 0
    buffer_load_dwordx4 v[48:51], v3, s[36:39], s55 offen offset:0 sc1
    v_mfma_f32_16x16x32_bf16 v[176:179], v[220:223], v[52:55], 0
    v_mfma_f32_16x16x32_bf16 v[180:183], v[224:227], v[52:55], 0
    buffer_load_dwordx4 v[52:55], v3, s[36:39], s55 offen offset:1024 sc1
    v_mfma_f32_16x16x32_bf16 v[184:187], v[220:223], v[56:59], 0
    v_mfma_f32_16x16x32_bf16 v[188:191], v[224:227], v[56:59], 0
    buffer_load_dwordx4 v[56:59], v3, s[36:39], s55 offen offset:2048 sc1
    v_mfma_f32_16x16x32_bf16 v[192:195], v[220:223], v[60:63], 0
    v_mfma_f32_16x16x32_bf16 v[196:199], v[224:227], v[60:63], 0
    buffer_load_dwordx4 v[60:63], v3, s[36:39], s55 offen offset:3072 sc1
    s_waitcnt vmcnt(18)
    v_mfma_f32_16x16x32_bf16 v[168:171], v[220:223], v[64:67], v[168:171]
    v_mfma_f32_16x16x32_bf16 v[172:175], v[224:227], v[64:67], v[172:175]
    s_add_u32 s55, s69, 40960
    buffer_load_dwordx4 v[64:67], v3, s[36:39], s55 offen offset:0 sc1
    v_mfma_f32_16x16x32_bf16 v[176:179], v[220:223], v[68:71], v[176:179]
    v_mfma_f32_16x16x32_bf16 v[180:183], v[224:227], v[68:71], v[180:183]
    buffer_load_dwordx4 v[68:71], v3, s[36:39], s55 offen offset:1024 sc1
    v_mfma_f32_16x16x32_bf16 v[184:187], v[220:223], v[72:75], v[184:187]
    v_mfma_f32_16x16x32_bf16 v[188:191], v[224:227], v[72:75], v[188:191]
    buffer_load_dwordx4 v[72:75], v3, s[36:39], s55 offen offset:2048 sc1
    v_mfma_f32_16x16x32_bf16 v[192:195], v[220:223], v[76:79], v[192:195]
    v_mfma_f32_16x16x32_bf16 v[196:199], v[224:227], v[76:79], v[196:199]
    buffer_load_dwordx4 v[76:79], v3, s[36:39], s55 offen offset:3072 sc1
    s_nop 0
    v_fmac_f32 v16, v168, v218
    v_fmac_f32 v17, v169, v218
    v_fmac_f32 v18, v170, v218
    v_fmac_f32 v19, v171, v218
    v_fmac_f32 v20, v172, v219
    v_fmac_f32 v21, v173, v219
    v_fmac_f32 v22, v174, v219
    v_fmac_f32 v23, v175, v219
    v_fmac_f32 v24, v176, v218
    v_fmac_f32 v25, v177, v218
    v_fmac_f32 v26, v178, v218
    v_fmac_f32 v27, v179, v218
    v_fmac_f32 v28, v180, v219
    v_fmac_f32 v29, v181, v219
    v_fmac_f32 v30, v182, v219
    v_fmac_f32 v31, v183, v219
    v_fmac_f32 v32, v184, v218
    v_fmac_f32 v33, v185, v218
    v_fmac_f32 v34, v186, v218
    v_fmac_f32 v35, v187, v218
    v_fmac_f32 v36, v188, v219
    v_fmac_f32 v37, v189, v219
    v_fmac_f32 v38, v190, v219
    v_fmac_f32 v39, v191, v219
    v_fmac_f32 v40, v192, v218
    v_fmac_f32 v41, v193, v218
    v_fmac_f32 v42, v194, v218
    v_fmac_f32 v43, v195, v218
    v_fmac_f32 v44, v196, v219
    v_fmac_f32 v45, v197, v219
    v_fmac_f32 v46, v198, v219
    v_fmac_f32 v47, v199, v219
    ds_write_b128 v14, v[16:19] offset:0
    ds_write_b128 v14, v[20:23] offset:1056
    ds_write_b128 v14, v[24:27] offset:2112
    ds_write_b128 v14, v[28:31] offset:3168
    ds_write_b128 v14, v[32:35] offset:4224
    ds_write_b128 v14, v[36:39] offset:5280
    ds_write_b128 v14, v[40:43] offset:6336
    ds_write_b128 v14, v[44:47] offset:7392
    s_waitcnt lgkmcnt(0)
    s_barrier
    ds_read_b128 v[16:19], v15 offset:0
    ds_read_b128 v[20:23], v15 offset:256
    ds_read_b128 v[24:27], v15 offset:8448
    ds_read_b128 v[28:31], v15 offset:8704
    ds_read_b128 v[32:35], v15 offset:16896
    ds_read_b128 v[36:39], v15 offset:17152
    ds_read_b128 v[40:43], v15 offset:25344
    ds_read_b128 v[44:47], v15 offset:25600
    s_waitcnt lgkmcnt(0)
    s_barrier
    v_pk_add_f32 v[16:17], v[16:17], v[24:25]
    v_pk_add_f32 v[18:19], v[18:19], v[26:27]
    v_pk_add_f32 v[20:21], v[20:21], v[28:29]
    v_pk_add_f32 v[22:23], v[22:23], v[30:31]
    v_pk_add_f32 v[32:33], v[32:33], v[40:41]
    v_pk_add_f32 v[34:35], v[34:35], v[42:43]
    v_pk_add_f32 v[36:37], v[36:37], v[44:45]
    v_pk_add_f32 v[38:39], v[38:39], v[46:47]
    v_pk_add_f32 v[16:17], v[16:17], v[32:33]
    v_cvt_pk_bf16_f32 v200, v16, v17
    v_pk_add_f32 v[18:19], v[18:19], v[34:35]
    v_cvt_pk_bf16_f32 v201, v18, v19
    v_pk_add_f32 v[20:21], v[20:21], v[36:37]
    v_cvt_pk_bf16_f32 v202, v20, v21
    v_pk_add_f32 v[22:23], v[22:23], v[38:39]
    v_cvt_pk_bf16_f32 v203, v22, v23
    buffer_store_dwordx4 v[200:203], v5, s[44:47], s62 offen
    s_branch L_final_loop
L_final_last:
    s_waitcnt vmcnt(17)
    v_swap_b32 v130, v132
    v_swap_b32 v131, v133
    s_nop 1
    v_mfma_f32_16x16x32_bf16 v[16:19], a[0:3], v[128:131], 0
    v_mfma_f32_16x16x32_bf16 v[20:23], a[0:3], v[132:135], 0
    v_mfma_f32_16x16x32_bf16 v[24:27], a[4:7], v[128:131], 0
    v_mfma_f32_16x16x32_bf16 v[28:31], a[4:7], v[132:135], 0
    v_mfma_f32_16x16x32_bf16 v[32:35], a[8:11], v[128:131], 0
    v_mfma_f32_16x16x32_bf16 v[36:39], a[8:11], v[132:135], 0
    v_mfma_f32_16x16x32_bf16 v[40:43], a[12:15], v[128:131], 0
    v_mfma_f32_16x16x32_bf16 v[44:47], a[12:15], v[132:135], 0
    s_waitcnt vmcnt(15)
    v_swap_b32 v138, v140
    v_swap_b32 v139, v141
    s_nop 1
    v_mfma_f32_16x16x32_bf16 v[16:19], a[16:19], v[136:139], v[16:19]
    v_mfma_f32_16x16x32_bf16 v[20:23], a[16:19], v[140:143], v[20:23]
    v_mfma_f32_16x16x32_bf16 v[24:27], a[20:23], v[136:139], v[24:27]
    v_mfma_f32_16x16x32_bf16 v[28:31], a[20:23], v[140:143], v[28:31]
    v_mfma_f32_16x16x32_bf16 v[32:35], a[24:27], v[136:139], v[32:35]
    v_mfma_f32_16x16x32_bf16 v[36:39], a[24:27], v[140:143], v[36:39]
    v_mfma_f32_16x16x32_bf16 v[40:43], a[28:31], v[136:139], v[40:43]
    v_mfma_f32_16x16x32_bf16 v[44:47], a[28:31], v[140:143], v[44:47]
    s_waitcnt vmcnt(13)
    v_swap_b32 v146, v148
    v_swap_b32 v147, v149
    s_nop 1
    v_mfma_f32_16x16x32_bf16 v[16:19], a[32:35], v[144:147], v[16:19]
    v_mfma_f32_16x16x32_bf16 v[20:23], a[32:35], v[148:151], v[20:23]
    v_mfma_f32_16x16x32_bf16 v[24:27], a[36:39], v[144:147], v[24:27]
    v_mfma_f32_16x16x32_bf16 v[28:31], a[36:39], v[148:151], v[28:31]
    v_mfma_f32_16x16x32_bf16 v[32:35], a[40:43], v[144:147], v[32:35]
    v_mfma_f32_16x16x32_bf16 v[36:39], a[40:43], v[148:151], v[36:39]
    v_mfma_f32_16x16x32_bf16 v[40:43], a[44:47], v[144:147], v[40:43]
    v_mfma_f32_16x16x32_bf16 v[44:47], a[44:47], v[148:151], v[44:47]
    s_waitcnt vmcnt(11)
    v_swap_b32 v154, v156
    v_swap_b32 v155, v157
    s_nop 1
    v_mfma_f32_16x16x32_bf16 v[16:19], a[48:51], v[152:155], v[16:19]
    v_mfma_f32_16x16x32_bf16 v[20:23], a[48:51], v[156:159], v[20:23]
    v_mfma_f32_16x16x32_bf16 v[24:27], a[52:55], v[152:155], v[24:27]
    v_mfma_f32_16x16x32_bf16 v[28:31], a[52:55], v[156:159], v[28:31]
    v_mfma_f32_16x16x32_bf16 v[32:35], a[56:59], v[152:155], v[32:35]
    v_mfma_f32_16x16x32_bf16 v[36:39], a[56:59], v[156:159], v[36:39]
    v_mfma_f32_16x16x32_bf16 v[40:43], a[60:63], v[152:155], v[40:43]
    v_mfma_f32_16x16x32_bf16 v[44:47], a[60:63], v[156:159], v[44:47]
    s_waitcnt vmcnt(9)
    v_swap_b32 v162, v164
    v_swap_b32 v163, v165
    s_nop 1
    v_mfma_f32_16x16x32_bf16 v[16:19], a[64:67], v[160:163], v[16:19]
    v_mfma_f32_16x16x32_bf16 v[20:23], a[64:67], v[164:167], v[20:23]
    v_mfma_f32_16x16x32_bf16 v[24:27], a[68:71], v[160:163], v[24:27]
    v_mfma_f32_16x16x32_bf16 v[28:31], a[68:71], v[164:167], v[28:31]
    v_mfma_f32_16x16x32_bf16 v[32:35], a[72:75], v[160:163], v[32:35]
    v_mfma_f32_16x16x32_bf16 v[36:39], a[72:75], v[164:167], v[36:39]
    v_mfma_f32_16x16x32_bf16 v[40:43], a[76:79], v[160:163], v[40:43]
    v_mfma_f32_16x16x32_bf16 v[44:47], a[76:79], v[164:167], v[44:47]
    s_waitcnt vmcnt(5)
    v_mfma_f32_16x16x32_bf16 v[168:171], v[220:223], v[48:51], 0
    v_mfma_f32_16x16x32_bf16 v[172:175], v[224:227], v[48:51], 0
    v_mfma_f32_16x16x32_bf16 v[176:179], v[220:223], v[52:55], 0
    v_mfma_f32_16x16x32_bf16 v[180:183], v[224:227], v[52:55], 0
    v_mfma_f32_16x16x32_bf16 v[184:187], v[220:223], v[56:59], 0
    v_mfma_f32_16x16x32_bf16 v[188:191], v[224:227], v[56:59], 0
    v_mfma_f32_16x16x32_bf16 v[192:195], v[220:223], v[60:63], 0
    v_mfma_f32_16x16x32_bf16 v[196:199], v[224:227], v[60:63], 0
    s_waitcnt vmcnt(1)
    v_mfma_f32_16x16x32_bf16 v[168:171], v[220:223], v[64:67], v[168:171]
    v_mfma_f32_16x16x32_bf16 v[172:175], v[224:227], v[64:67], v[172:175]
    v_mfma_f32_16x16x32_bf16 v[176:179], v[220:223], v[68:71], v[176:179]
    v_mfma_f32_16x16x32_bf16 v[180:183], v[224:227], v[68:71], v[180:183]
    v_mfma_f32_16x16x32_bf16 v[184:187], v[220:223], v[72:75], v[184:187]
    v_mfma_f32_16x16x32_bf16 v[188:191], v[224:227], v[72:75], v[188:191]
    v_mfma_f32_16x16x32_bf16 v[192:195], v[220:223], v[76:79], v[192:195]
    v_mfma_f32_16x16x32_bf16 v[196:199], v[224:227], v[76:79], v[196:199]
    s_nop 0
    v_fmac_f32 v16, v168, v218
    v_fmac_f32 v17, v169, v218
    v_fmac_f32 v18, v170, v218
    v_fmac_f32 v19, v171, v218
    v_fmac_f32 v20, v172, v219
    v_fmac_f32 v21, v173, v219
    v_fmac_f32 v22, v174, v219
    v_fmac_f32 v23, v175, v219
    v_fmac_f32 v24, v176, v218
    v_fmac_f32 v25, v177, v218
    v_fmac_f32 v26, v178, v218
    v_fmac_f32 v27, v179, v218
    v_fmac_f32 v28, v180, v219
    v_fmac_f32 v29, v181, v219
    v_fmac_f32 v30, v182, v219
    v_fmac_f32 v31, v183, v219
    v_fmac_f32 v32, v184, v218
    v_fmac_f32 v33, v185, v218
    v_fmac_f32 v34, v186, v218
    v_fmac_f32 v35, v187, v218
    v_fmac_f32 v36, v188, v219
    v_fmac_f32 v37, v189, v219
    v_fmac_f32 v38, v190, v219
    v_fmac_f32 v39, v191, v219
    v_fmac_f32 v40, v192, v218
    v_fmac_f32 v41, v193, v218
    v_fmac_f32 v42, v194, v218
    v_fmac_f32 v43, v195, v218
    v_fmac_f32 v44, v196, v219
    v_fmac_f32 v45, v197, v219
    v_fmac_f32 v46, v198, v219
    v_fmac_f32 v47, v199, v219
    ds_write_b128 v14, v[16:19] offset:0
    ds_write_b128 v14, v[20:23] offset:1056
    ds_write_b128 v14, v[24:27] offset:2112
    ds_write_b128 v14, v[28:31] offset:3168
    ds_write_b128 v14, v[32:35] offset:4224
    ds_write_b128 v14, v[36:39] offset:5280
    ds_write_b128 v14, v[40:43] offset:6336
    ds_write_b128 v14, v[44:47] offset:7392
    s_waitcnt lgkmcnt(0)
    s_barrier
    ds_read_b128 v[16:19], v15 offset:0
    ds_read_b128 v[20:23], v15 offset:256
    ds_read_b128 v[24:27], v15 offset:8448
    ds_read_b128 v[28:31], v15 offset:8704
    ds_read_b128 v[32:35], v15 offset:16896
    ds_read_b128 v[36:39], v15 offset:17152
    ds_read_b128 v[40:43], v15 offset:25344
    ds_read_b128 v[44:47], v15 offset:25600
    s_waitcnt lgkmcnt(0)
    s_barrier
    v_pk_add_f32 v[16:17], v[16:17], v[24:25]
    v_pk_add_f32 v[18:19], v[18:19], v[26:27]
    v_pk_add_f32 v[20:21], v[20:21], v[28:29]
    v_pk_add_f32 v[22:23], v[22:23], v[30:31]
    v_pk_add_f32 v[32:33], v[32:33], v[40:41]
    v_pk_add_f32 v[34:35], v[34:35], v[42:43]
    v_pk_add_f32 v[36:37], v[36:37], v[44:45]
    v_pk_add_f32 v[38:39], v[38:39], v[46:47]
    v_pk_add_f32 v[16:17], v[16:17], v[32:33]
    v_cvt_pk_bf16_f32 v200, v16, v17
    v_pk_add_f32 v[18:19], v[18:19], v[34:35]
    v_cvt_pk_bf16_f32 v201, v18, v19
    v_pk_add_f32 v[20:21], v[20:21], v[36:37]
    v_cvt_pk_bf16_f32 v202, v20, v21
    v_pk_add_f32 v[22:23], v[22:23], v[38:39]
    v_cvt_pk_bf16_f32 v203, v22, v23
    buffer_store_dwordx4 v[200:203], v5, s[44:47], s62 offen
    s_branch L_final_next
L_final_heavy:
    s_cmp_ge_u32 s6, 64
    s_cbranch_scc1 L_exit
    s_add_u32 s56, s6, 1
    s_mov_b32 s57, 256
    s_cmp_lg_u32 s3, 0
    s_cbranch_scc1 L_w0_38
    s_branch L_wf_39_go
L_wf_39:
    s_sleep 8
    s_add_u32 s7, s7, 1
    s_cmp_gt_u32 s7, 400000
    s_cbranch_scc1 L_exit
L_wf_39_go:
    buffer_load_dword v10, v9, s[36:39], s57 offen offset:0 sc1
    s_waitcnt vmcnt(0)
    v_cmp_gt_u32 vcc, s56, v10
    s_cbranch_vccnz L_wf_39
L_w0_38:
    s_waitcnt vmcnt(0)
    s_barrier
    s_lshl_b32 s55, s6, 5
    s_lshl_b32 s56, s3, 3
    s_add_u32 s55, s55, s56
    s_lshl_b32 s57, s73, 12
    s_mul_i32 s74, s55, 40960
    s_add_u32 s74, s74, s57
    s_add_u32 s74, s74, 98566144
    s_mul_i32 s77, s55, 1280
    s_add_u32 s77, s77, 20578304
    s_lshl_b32 s76, s55, 11
    s_add_u32 s76, s76, 8519680
    s_mul_i32 s75, s55, 10240
    s_add_u32 s75, s75, s57
    s_add_u32 s69, s75, 24248320
    s_add_u32 s75, s75, 26869760
    s_lshl_b32 s71, s6, 7
    s_add_u32 s71, s71, 23199744
    buffer_load_dword v216, v215, s[36:39], s71 offen offset:0 sc1
    buffer_load_dword v217, v215, s[36:39], s71 offen offset:64 sc1
    s_add_u32 s55, s77, 0
    buffer_load_dwordx4 v[128:131], v3, s[36:39], s55 offen offset:0 sc1
    buffer_load_dwordx4 v[132:135], v3, s[36:39], s55 offen offset:1024 sc1
    s_add_u32 s55, s77, 2048
    buffer_load_dwordx4 v[136:139], v3, s[36:39], s55 offen offset:0 sc1
    buffer_load_dwordx4 v[140:143], v3, s[36:39], s55 offen offset:1024 sc1
    s_add_u32 s55, s77, 4096
    buffer_load_dwordx4 v[144:147], v3, s[36:39], s55 offen offset:0 sc1
    buffer_load_dwordx4 v[148:151], v3, s[36:39], s55 offen offset:1024 sc1
    s_add_u32 s55, s77, 6144
    buffer_load_dwordx4 v[152:155], v3, s[36:39], s55 offen offset:0 sc1
    buffer_load_dwordx4 v[156:159], v3, s[36:39], s55 offen offset:1024 sc1
    s_add_u32 s55, s77, 8192
    buffer_load_dwordx4 v[160:163], v3, s[36:39], s55 offen offset:0 sc1
    buffer_load_dwordx4 v[164:167], v3, s[36:39], s55 offen offset:1024 sc1
    s_add_u32 s55, s74, 0
    buffer_load_dwordx4 a[80:83], v4, s[36:39], s55 offen offset:0 sc1
    buffer_load_dwordx4 a[84:87], v4, s[36:39], s55 offen offset:1024 sc1
    buffer_load_dwordx4 a[88:91], v4, s[36:39], s55 offen offset:2048 sc1
    buffer_load_dwordx4 a[92:95], v4, s[36:39], s55 offen offset:3072 sc1
    s_add_u32 s55, s74, 40960
    buffer_load_dwordx4 a[96:99], v4, s[36:39], s55 offen offset:0 sc1
    buffer_load_dwordx4 a[100:103], v4, s[36:39], s55 offen offset:1024 sc1
    buffer_load_dwordx4 a[104:107], v4, s[36:39], s55 offen offset:2048 sc1
    buffer_load_dwordx4 a[108:111], v4, s[36:39], s55 offen offset:3072 sc1
    s_add_u32 s55, s74, 81920
    buffer_load_dwordx4 a[112:115], v4, s[36:39], s55 offen offset:0 sc1
    buffer_load_dwordx4 a[116:119], v4, s[36:39], s55 offen offset:1024 sc1
    buffer_load_dwordx4 a[120:123], v4, s[36:39], s55 offen offset:2048 sc1
    buffer_load_dwordx4 a[124:127], v4, s[36:39], s55 offen offset:3072 sc1
    s_add_u32 s55, s74, 122880
    buffer_load_dwordx4 a[128:131], v4, s[36:39], s55 offen offset:0 sc1
    buffer_load_dwordx4 a[132:135], v4, s[36:39], s55 offen offset:1024 sc1
    buffer_load_dwordx4 a[136:139], v4, s[36:39], s55 offen offset:2048 sc1
    buffer_load_dwordx4 a[140:143], v4, s[36:39], s55 offen offset:3072 sc1
    s_add_u32 s55, s74, 163840
    buffer_load_dwordx4 a[144:147], v4, s[36:39], s55 offen offset:0 sc1
    buffer_load_dwordx4 a[148:151], v4, s[36:39], s55 offen offset:1024 sc1
    buffer_load_dwordx4 a[152:155], v4, s[36:39], s55 offen offset:2048 sc1
    buffer_load_dwordx4 a[156:159], v4, s[36:39], s55 offen offset:3072 sc1
    s_add_u32 s55, s74, 204800
    buffer_load_dwordx4 a[160:163], v4, s[36:39], s55 offen offset:0 sc1
    buffer_load_dwordx4 a[164:167], v4, s[36:39], s55 offen offset:1024 sc1
    buffer_load_dwordx4 a[168:171], v4, s[36:39], s55 offen offset:2048 sc1
    buffer_load_dwordx4 a[172:175], v4, s[36:39], s55 offen offset:3072 sc1
    s_add_u32 s55, s74, 245760
    buffer_load_dwordx4 a[176:179], v4, s[36:39], s55 offen offset:0 sc1
    buffer_load_dwordx4 a[180:183], v4, s[36:39], s55 offen offset:1024 sc1
    buffer_load_dwordx4 a[184:187], v4, s[36:39], s55 offen offset:2048 sc1
    buffer_load_dwordx4 a[188:191], v4, s[36:39], s55 offen offset:3072 sc1
    s_add_u32 s55, s74, 286720
    buffer_load_dwordx4 a[192:195], v4, s[36:39], s55 offen offset:0 sc1
    buffer_load_dwordx4 a[196:199], v4, s[36:39], s55 offen offset:1024 sc1
    buffer_load_dwordx4 a[200:203], v4, s[36:39], s55 offen offset:2048 sc1
    buffer_load_dwordx4 a[204:207], v4, s[36:39], s55 offen offset:3072 sc1
    s_waitcnt vmcnt(42)
    v_sub_f32 v218, 1.0, v216
    v_sub_f32 v219, 1.0, v217
    s_waitcnt vmcnt(40)
    v_swap_b32 v130, v132
    v_swap_b32 v131, v133
    s_nop 1
    v_mfma_f32_16x16x32_bf16 v[16:19], a[0:3], v[128:131], 0
    v_mfma_f32_16x16x32_bf16 v[20:23], a[0:3], v[132:135], 0
    v_mfma_f32_16x16x32_bf16 v[24:27], a[4:7], v[128:131], 0
    v_mfma_f32_16x16x32_bf16 v[28:31], a[4:7], v[132:135], 0
    v_mfma_f32_16x16x32_bf16 v[32:35], a[8:11], v[128:131], 0
    v_mfma_f32_16x16x32_bf16 v[36:39], a[8:11], v[132:135], 0
    v_mfma_f32_16x16x32_bf16 v[40:43], a[12:15], v[128:131], 0
    v_mfma_f32_16x16x32_bf16 v[44:47], a[12:15], v[132:135], 0
    s_waitcnt vmcnt(38)
    v_swap_b32 v138, v140
    v_swap_b32 v139, v141
    s_nop 1
    v_mfma_f32_16x16x32_bf16 v[16:19], a[16:19], v[136:139], v[16:19]
    v_mfma_f32_16x16x32_bf16 v[20:23], a[16:19], v[140:143], v[20:23]
    v_mfma_f32_16x16x32_bf16 v[24:27], a[20:23], v[136:139], v[24:27]
    v_mfma_f32_16x16x32_bf16 v[28:31], a[20:23], v[140:143], v[28:31]
    v_mfma_f32_16x16x32_bf16 v[32:35], a[24:27], v[136:139], v[32:35]
    v_mfma_f32_16x16x32_bf16 v[36:39], a[24:27], v[140:143], v[36:39]
    v_mfma_f32_16x16x32_bf16 v[40:43], a[28:31], v[136:139], v[40:43]
    v_mfma_f32_16x16x32_bf16 v[44:47], a[28:31], v[140:143], v[44:47]
    s_waitcnt vmcnt(36)
    v_swap_b32 v146, v148
    v_swap_b32 v147, v149
    s_nop 1
    v_mfma_f32_16x16x32_bf16 v[16:19], a[32:35], v[144:147], v[16:19]
    v_mfma_f32_16x16x32_bf16 v[20:23], a[32:35], v[148:151], v[20:23]
    v_mfma_f32_16x16x32_bf16 v[24:27], a[36:39], v[144:147], v[24:27]
    v_mfma_f32_16x16x32_bf16 v[28:31], a[36:39], v[148:151], v[28:31]
    v_mfma_f32_16x16x32_bf16 v[32:35], a[40:43], v[144:147], v[32:35]
    v_mfma_f32_16x16x32_bf16 v[36:39], a[40:43], v[148:151], v[36:39]
    v_mfma_f32_16x16x32_bf16 v[40:43], a[44:47], v[144:147], v[40:43]
    v_mfma_f32_16x16x32_bf16 v[44:47], a[44:47], v[148:151], v[44:47]
    s_waitcnt vmcnt(34)
    v_swap_b32 v154, v156
    v_swap_b32 v155, v157
    s_nop 1
    v_mfma_f32_16x16x32_bf16 v[16:19], a[48:51], v[152:155], v[16:19]
    v_mfma_f32_16x16x32_bf16 v[20:23], a[48:51], v[156:159], v[20:23]
    v_mfma_f32_16x16x32_bf16 v[24:27], a[52:55], v[152:155], v[24:27]
    v_mfma_f32_16x16x32_bf16 v[28:31], a[52:55], v[156:159], v[28:31]
    v_mfma_f32_16x16x32_bf16 v[32:35], a[56:59], v[152:155], v[32:35]
    v_mfma_f32_16x16x32_bf16 v[36:39], a[56:59], v[156:159], v[36:39]
    v_mfma_f32_16x16x32_bf16 v[40:43], a[60:63], v[152:155], v[40:43]
    v_mfma_f32_16x16x32_bf16 v[44:47], a[60:63], v[156:159], v[44:47]
    s_waitcnt vmcnt(32)
    v_swap_b32 v162, v164
    v_swap_b32 v163, v165
    s_nop 1
    v_mfma_f32_16x16x32_bf16 v[16:19], a[64:67], v[160:163], v[16:19]
    v_mfma_f32_16x16x32_bf16 v[20:23], a[64:67], v[164:167], v[20:23]
    v_mfma_f32_16x16x32_bf16 v[24:27], a[68:71], v[160:163], v[24:27]
    v_mfma_f32_16x16x32_bf16 v[28:31], a[68:71], v[164:167], v[28:31]
    v_mfma_f32_16x16x32_bf16 v[32:35], a[72:75], v[160:163], v[32:35]
    v_mfma_f32_16x16x32_bf16 v[36:39], a[72:75], v[164:167], v[36:39]
    v_mfma_f32_16x16x32_bf16 v[40:43], a[76:79], v[160:163], v[40:43]
    v_mfma_f32_16x16x32_bf16 v[44:47], a[76:79], v[164:167], v[44:47]
    s_cmp_lg_u32 s3, 0
    s_cbranch_scc1 L_w0_40
    s_and_b32 s55, s6, 1
    s_cmp_lt_u32 s6, 58
    s_cselect_b32 s55, 1, s55
    s_cmp_lg_u32 s55, 0
    s_cselect_b32 s56, 0, 128
    s_cselect_b32 s57, 384, 0
    s_add_u32 s56, s56, s6
    s_mov_b32 exec_hi, 0
    s_branch L_fw_41_go
L_fw_41:
    s_sleep 2
    s_add_u32 s7, s7, 1
    s_cmp_gt_u32 s7, 400000
    s_cbranch_scc1 L_exit
L_fw_41_go:
    buffer_load_dwordx4 v[208:211], v9, s[36:39], s57 offen offset:0 sc1
    s_waitcnt vmcnt(0)
    v_min3_u32 v208, v208, v209, v210
    v_min_u32 v208, v208, v211
    v_cmp_ge_u32 vcc, s56, v208
    s_cbranch_vccnz L_fw_41
    s_mov_b32 exec_hi, -1
L_w0_40:
    s_waitcnt vmcnt(0)
    s_barrier
    s_add_u32 s55, s76, 0
    buffer_load_dwordx4 v[48:51], v3, s[36:39], s55 offen offset:0 sc1
    buffer_load_dwordx4 v[52:55], v3, s[36:39], s55 offen offset:1024 sc1
    s_add_u32 s55, s76, 2048
    buffer_load_dwordx4 v[56:59], v3, s[36:39], s55 offen offset:0 sc1
    buffer_load_dwordx4 v[60:63], v3, s[36:39], s55 offen offset:1024 sc1
    s_add_u32 s55, s76, 4096
    buffer_load_dwordx4 v[64:67], v3, s[36:39], s55 offen offset:0 sc1
    buffer_load_dwordx4 v[68:71], v3, s[36:39], s55 offen offset:1024 sc1
    s_add_u32 s55, s76, 6144
    buffer_load_dwordx4 v[72:75], v3, s[36:39], s55 offen offset:0 sc1
    buffer_load_dwordx4 v[76:79], v3, s[36:39], s55 offen offset:1024 sc1
    s_add_u32 s55, s76, 8192
    buffer_load_dwordx4 v[80:83], v3, s[36:39], s55 offen offset:0 sc1
    buffer_load_dwordx4 v[84:87], v3, s[36:39], s55 offen offset:1024 sc1
    s_add_u32 s55, s76, 10240
    buffer_load_dwordx4 v[88:91], v3, s[36:39], s55 offen offset:0 sc1
    buffer_load_dwordx4 v[92:95], v3, s[36:39], s55 offen offset:1024 sc1
    s_add_u32 s55, s76, 12288
    buffer_load_dwordx4 v[96:99], v3, s[36:39], s55 offen offset:0 sc1
    buffer_load_dwordx4 v[100:103], v3, s[36:39], s55 offen offset:1024 sc1
    s_add_u32 s55, s76, 14336
    buffer_load_dwordx4 v[104:107], v3, s[36:39], s55 offen offset:0 sc1
    buffer_load_dwordx4 v[108:111], v3, s[36:39], s55 offen offset:1024 sc1
    s_add_u32 s55, s75, 0
    buffer_load_dwordx4 a[208:211], v4, s[36:39], s55 offen offset:0 sc1
    buffer_load_dwordx4 a[212:215], v4, s[36:39], s55 offen offset:1024 sc1
    buffer_load_dwordx4 a[216:219], v4, s[36:39], s55 offen offset:2048 sc1
    buffer_load_dwordx4 a[220:223], v4, s[36:39], s55 offen offset:3072 sc1
    s_add_u32 s55, s75, 40960
    buffer_load_dwordx4 a[224:227], v4, s[36:39], s55 offen offset:0 sc1
    buffer_load_dwordx4 a[228:231], v4, s[36:39], s55 offen offset:1024 sc1
    buffer_load_dwordx4 a[232:235], v4, s[36:39], s55 offen offset:2048 sc1
    buffer_load_dwordx4 a[236:239], v4, s[36:39], s55 offen offset:3072 sc1
    s_mul_i32 s62, s6, 40960
    s_lshl_b32 s57, s73, 7
    s_add_u32 s62, s62, s57
    s_cmp_lt_u32 s6, 42
    s_cselect_b32 s55, 6, s94
    s_add_u32 s6, s6, s55
    s_cmp_eq_u32 s6, s90
    s_cselect_b32 s6, s91, s6
    s_cmp_ge_u32 s6, s64
    s_cselect_b32 s6, 64, s6
    s_waitcnt vmcnt(22)
    v_mov_b32 v112, v50
    v_mov_b32 v116, v51
    v_mov_b32 v50, 0
    v_mov_b32 v51, 0
    v_mfma_f32_16x16x32_bf16 v[172:175], a[80:83], v[52:55], 0
    v_mfma_f32_16x16x32_bf16 v[180:183], a[84:87], v[52:55], 0
    v_mfma_f32_16x16x32_bf16 v[188:191], a[88:91], v[52:55], 0
    v_mfma_f32_16x16x32_bf16 v[196:199], a[92:95], v[52:55], 0
    v_mfma_f32_16x16x32_bf16 v[168:171], a[80:83], v[48:51], 0
    v_mfma_f32_16x16x32_bf16 v[176:179], a[84:87], v[48:51], 0
    v_mfma_f32_16x16x32_bf16 v[184:187], a[88:91], v[48:51], 0
    v_mfma_f32_16x16x32_bf16 v[192:195], a[92:95], v[48:51], 0
    s_waitcnt vmcnt(20)
    v_mov_b32 v113, v58
    v_mov_b32 v117, v59
    v_mov_b32 v58, 0
    v_mov_b32 v59, 0
    v_mfma_f32_16x16x32_bf16 v[172:175], a[96:99], v[60:63], v[172:175]
    v_mfma_f32_16x16x32_bf16 v[180:183], a[100:103], v[60:63], v[180:183]
    v_mfma_f32_16x16x32_bf16 v[188:191], a[104:107], v[60:63], v[188:191]
    v_mfma_f32_16x16x32_bf16 v[196:199], a[108:111], v[60:63], v[196:199]
    v_mfma_f32_16x16x32_bf16 v[168:171], a[96:99], v[56:59], v[168:171]
    v_mfma_f32_16x16x32_bf16 v[176:179], a[100:103], v[56:59], v[176:179]
    v_mfma_f32_16x16x32_bf16 v[184:187], a[104:107], v[56:59], v[184:187]
    v_mfma_f32_16x16x32_bf16 v[192:195], a[108:111], v[56:59], v[192:195]
    s_waitcnt vmcnt(18)
    v_mov_b32 v114, v66
    v_mov_b32 v118, v67
    v_mov_b32 v66, 0
    v_mov_b32 v67, 0
    v_mfma_f32_16x16x32_bf16 v[172:175], a[112:115], v[68:71], v[172:175]
    v_mfma_f32_16x16x32_bf16 v[180:183], a[116:119], v[68:71], v[180:183]
    v_mfma_f32_16x16x32_bf16 v[188:191], a[120:123], v[68:71], v[188:191]
    v_mfma_f32_16x16x32_bf16 v[196:199], a[124:127], v[68:71], v[196:199]
    v_mfma_f32_16x16x32_bf16 v[168:171], a[112:115], v[64:67], v[168:171]
    v_mfma_f32_16x16x32_bf16 v[176:179], a[116:119], v[64:67], v[176:179]
    v_mfma_f32_16x16x32_bf16 v[184:187], a[120:123], v[64:67], v[184:187]
    v_mfma_f32_16x16x32_bf16 v[192:195], a[124:127], v[64:67], v[192:195]
    s_waitcnt vmcnt(16)
    v_mov_b32 v115, v74
    v_mov_b32 v119, v75
    v_mov_b32 v74, 0
    v_mov_b32 v75, 0
    v_mfma_f32_16x16x32_bf16 v[172:175], a[128:131], v[76:79], v[172:175]
    v_mfma_f32_16x16x32_bf16 v[180:183], a[132:135], v[76:79], v[180:183]
    v_mfma_f32_16x16x32_bf16 v[188:191], a[136:139], v[76:79], v[188:191]
    v_mfma_f32_16x16x32_bf16 v[196:199], a[140:143], v[76:79], v[196:199]
    v_mfma_f32_16x16x32_bf16 v[168:171], a[128:131], v[72:75], v[168:171]
    v_mfma_f32_16x16x32_bf16 v[176:179], a[132:135], v[72:75], v[176:179]
    v_mfma_f32_16x16x32_bf16 v[184:187], a[136:139], v[72:75], v[184:187]
    v_mfma_f32_16x16x32_bf16 v[192:195], a[140:143], v[72:75], v[192:195]
    s_waitcnt vmcnt(14)
    v_mov_b32 v120, v82
    v_mov_b32 v124, v83
    v_mov_b32 v82, 0
    v_mov_b32 v83, 0
    v_mfma_f32_16x16x32_bf16 v[172:175], a[144:147], v[84:87], v[172:175]
    v_mfma_f32_16x16x32_bf16 v[180:183], a[148:151], v[84:87], v[180:183]
    v_mfma_f32_16x16x32_bf16 v[188:191], a[152:155], v[84:87], v[188:191]
    v_mfma_f32_16x16x32_bf16 v[196:199], a[156:159], v[84:87], v[196:199]
    v_mfma_f32_16x16x32_bf16 v[168:171], a[144:147], v[80:83], v[168:171]
    v_mfma_f32_16x16x32_bf16 v[176:179], a[148:151], v[80:83], v[176:179]
    v_mfma_f32_16x16x32_bf16 v[184:187], a[152:155], v[80:83], v[184:187]
    v_mfma_f32_16x16x32_bf16 v[192:195], a[156:159], v[80:83], v[192:195]
    s_waitcnt vmcnt(12)
    v_mov_b32 v121, v90
    v_mov_b32 v125, v91
    v_mov_b32 v90, 0
    v_mov_b32 v91, 0
    v_mfma_f32_16x16x32_bf16 v[172:175], a[160:163], v[92:95], v[172:175]
    v_mfma_f32_16x16x32_bf16 v[180:183], a[164:167], v[92:95], v[180:183]
    v_mfma_f32_16x16x32_bf16 v[188:191], a[168:171], v[92:95], v[188:191]
    v_mfma_f32_16x16x32_bf16 v[196:199], a[172:175], v[92:95], v[196:199]
    v_mfma_f32_16x16x32_bf16 v[168:171], a[160:163], v[88:91], v[168:171]
    v_mfma_f32_16x16x32_bf16 v[176:179], a[164:167], v[88:91], v[176:179]
    v_mfma_f32_16x16x32_bf16 v[184:187], a[168:171], v[88:91], v[184:187]
    v_mfma_f32_16x16x32_bf16 v[192:195], a[172:175], v[88:91], v[192:195]
    s_waitcnt vmcnt(10)
    v_mov_b32 v122, v98
    v_mov_b32 v126, v99
    v_mov_b32 v98, 0
    v_mov_b32 v99, 0
    v_mfma_f32_16x16x32_bf16 v[172:175], a[176:179], v[100:103], v[172:175]
    v_mfma_f32_16x16x32_bf16 v[180:183], a[180:183], v[100:103], v[180:183]
    v_mfma_f32_16x16x32_bf16 v[188:191], a[184:187], v[100:103], v[188:191]
    v_mfma_f32_16x16x32_bf16 v[196:199], a[188:191], v[100:103], v[196:199]
    v_mfma_f32_16x16x32_bf16 v[168:171], a[176:179], v[96:99], v[168:171]
    v_mfma_f32_16x16x32_bf16 v[176:179], a[180:183], v[96:99], v[176:179]
    v_mfma_f32_16x16x32_bf16 v[184:187], a[184:187], v[96:99], v[184:187]
    v_mfma_f32_16x16x32_bf16 v[192:195], a[188:191], v[96:99], v[192:195]
    s_waitcnt vmcnt(8)
    v_mov_b32 v123, v106
    v_mov_b32 v127, v107
    v_mov_b32 v106, 0
    v_mov_b32 v107, 0
    v_mfma_f32_16x16x32_bf16 v[172:175], a[192:195], v[108:111], v[172:175]
    v_mfma_f32_16x16x32_bf16 v[180:183], a[196:199], v[108:111], v[180:183]
    v_mfma_f32_16x16x32_bf16 v[188:191], a[200:203], v[108:111], v[188:191]
    v_mfma_f32_16x16x32_bf16 v[196:199], a[204:207], v[108:111], v[196:199]
    v_mfma_f32_16x16x32_bf16 v[168:171], a[192:195], v[104:107], v[168:171]
    v_mfma_f32_16x16x32_bf16 v[176:179], a[196:199], v[104:107], v[176:179]
    v_mfma_f32_16x16x32_bf16 v[184:187], a[200:203], v[104:107], v[184:187]
    v_mfma_f32_16x16x32_bf16 v[192:195], a[204:207], v[104:107], v[192:195]
    s_waitcnt vmcnt(4)
    v_mfma_f32_16x16x32_bf16 v[168:171], a[208:211], v[112:115], v[168:171]
    v_mfma_f32_16x16x32_bf16 v[172:175], a[208:211], v[116:119], v[172:175]
    v_mfma_f32_16x16x32_bf16 v[176:179], a[212:215], v[112:115], v[176:179]
    v_mfma_f32_16x16x32_bf16 v[180:183], a[212:215], v[116:119], v[180:183]
    v_mfma_f32_16x16x32_bf16 v[184:187], a[216:219], v[112:115], v[184:187]
    v_mfma_f32_16x16x32_bf16 v[188:191], a[216:219], v[116:119], v[188:191]
    v_mfma_f32_16x16x32_bf16 v[192:195], a[220:223], v[112:115], v[192:195]
    v_mfma_f32_16x16x32_bf16 v[196:199], a[220:223], v[116:119], v[196:199]
    s_waitcnt vmcnt(0)
    v_mfma_f32_16x16x32_bf16 v[168:171], a[224:227], v[120:123], v[168:171]
    v_mfma_f32_16x16x32_bf16 v[172:175], a[224:227], v[124:127], v[172:175]
    v_mfma_f32_16x16x32_bf16 v[176:179], a[228:231], v[120:123], v[176:179]
    v_mfma_f32_16x16x32_bf16 v[180:183], a[228:231], v[124:127], v[180:183]
    v_mfma_f32_16x16x32_bf16 v[184:187], a[232:235], v[120:123], v[184:187]
    v_mfma_f32_16x16x32_bf16 v[188:191], a[232:235], v[124:127], v[188:191]
    v_mfma_f32_16x16x32_bf16 v[192:195], a[236:239], v[120:123], v[192:195]
    v_mfma_f32_16x16x32_bf16 v[196:199], a[236:239], v[124:127], v[196:199]
    s_nop 0
    v_fmac_f32 v16, v168, v218
    v_fmac_f32 v17, v169, v218
    v_fmac_f32 v18, v170, v218
    v_fmac_f32 v19, v171, v218
    v_fmac_f32 v20, v172, v219
    v_fmac_f32 v21, v173, v219
    v_fmac_f32 v22, v174, v219
    v_fmac_f32 v23, v175, v219
    v_fmac_f32 v24, v176, v218
    v_fmac_f32 v25, v177, v218
    v_fmac_f32 v26, v178, v218
    v_fmac_f32 v27, v179, v218
    v_fmac_f32 v28, v180, v219
    v_fmac_f32 v29, v181, v219
    v_fmac_f32 v30, v182, v219
    v_fmac_f32 v31, v183, v219
    v_fmac_f32 v32, v184, v218
    v_fmac_f32 v33, v185, v218
    v_fmac_f32 v34, v186, v218
    v_fmac_f32 v35, v187, v218
    v_fmac_f32 v36, v188, v219
    v_fmac_f32 v37, v189, v219
    v_fmac_f32 v38, v190, v219
    v_fmac_f32 v39, v191, v219
    v_fmac_f32 v40, v192, v218
    v_fmac_f32 v41, v193, v218
    v_fmac_f32 v42, v194, v218
    v_fmac_f32 v43, v195, v218
    v_fmac_f32 v44, v196, v219
    v_fmac_f32 v45, v197, v219
    v_fmac_f32 v46, v198, v219
    v_fmac_f32 v47, v199, v219
    ds_write_b128 v14, v[16:19] offset:0
    ds_write_b128 v14, v[20:23] offset:1056
    ds_write_b128 v14, v[24:27] offset:2112
    ds_write_b128 v14, v[28:31] offset:3168
    ds_write_b128 v14, v[32:35] offset:4224
    ds_write_b128 v14, v[36:39] offset:5280
    ds_write_b128 v14, v[40:43] offset:6336
    ds_write_b128 v14, v[44:47] offset:7392
    s_waitcnt lgkmcnt(0)
    s_barrier
    ds_read_b128 v[16:19], v15 offset:0
    ds_read_b128 v[20:23], v15 offset:256
    ds_read_b128 v[24:27], v15 offset:8448
    ds_read_b128 v[28:31], v15 offset:8704
    ds_read_b128 v[32:35], v15 offset:16896
    ds_read_b128 v[36:39], v15 offset:17152
    ds_read_b128 v[40:43], v15 offset:25344
    ds_read_b128 v[44:47], v15 offset:25600
    s_waitcnt lgkmcnt(0)
    s_barrier
    v_pk_add_f32 v[16:17], v[16:17], v[24:25]
    v_pk_add_f32 v[18:19], v[18:19], v[26:27]
    v_pk_add_f32 v[20:21], v[20:21], v[28:29]
    v_pk_add_f32 v[22:23], v[22:23], v[30:31]
    v_pk_add_f32 v[32:33], v[32:33], v[40:41]
    v_pk_add_f32 v[34:35], v[34:35], v[42:43]
    v_pk_add_f32 v[36:37], v[36:37], v[44:45]
    v_pk_add_f32 v[38:39], v[38:39], v[46:47]
    v_pk_add_f32 v[16:17], v[16:17], v[32:33]
    v_cvt_pk_bf16_f32 v200, v16, v17
    v_pk_add_f32 v[18:19], v[18:19], v[34:35]
    v_cvt_pk_bf16_f32 v201, v18, v19
    v_pk_add_f32 v[20:21], v[20:21], v[36:37]
    v_cvt_pk_bf16_f32 v202, v20, v21
    v_pk_add_f32 v[22:23], v[22:23], v[38:39]
    v_cvt_pk_bf16_f32 v203, v22, v23
    buffer_store_dwordx4 v[200:203], v5, s[44:47], s62 offen
    s_branch L_final_heavy
L_exit:
    s_waitcnt vmcnt(0)
    s_endpgm
L_rec:
    v_and_b32 v62, 63, v0
    v_and_b32 v60, 15, v62
    v_lshrrev_b32 v61, 4, v62
    v_lshlrev_b32 v0, 4, v62
    s_and_b32 s68, s5, 1
    s_lshl_b32 s68, s68, 2
    s_add_u32 s68, s68, s3
    s_lshl_b32 s82, s4, 3
    s_add_u32 s82, s82, s68
    s_lshr_b32 s83, s5, 1
    s_lshr_b32 s84, s5, 2
    s_and_b32 s85, s5, 3
    s_lshl_b32 s69, s4, 3
    s_add_u32 s84, s84, s69
    s_lshl_b32 s69, s4, 5
    s_add_u32 s69, s69, s5
    s_mul_i32 s86, s69, 768
    s_lshl_b32 s55, s69, 10
    s_add_u32 s55, s55, 1245184
    s_lshl_b32 s56, s82, 12
    s_add_u32 s56, s56, 1245184
    s_mov_b32 s72, 0x0c0c0400
    s_mov_b32 s73, 0x0c040100
    s_mov_b32 s89, 0x04020100
    s_mov_b32 s74, 0x0c04000c
    s_mov_b32 s75, 0x0402010c
    s_mov_b32 s88, 0x3dd53b95
    s_mov_b32 s76, 0xff00ff00
    s_mov_b32 s77, 0xff00ff00
    s_mov_b32 s34, 0x33333333
    s_mov_b32 s35, 0x33333333
    s_mov_b32 s80, 0x00ff00ff
    s_mov_b32 s81, 0x00ff00ff
    s_mul_i32 s87, s4, 10240
    s_add_u32 s87, s87, 1048576
    s_mov_b32 s40, s24
    s_and_b32 s41, s25, 0xffff
    s_mov_b32 s42, 7864320
    s_mov_b32 s43, 0x20000
    s_mov_b32 s44, s22
    s_and_b32 s45, s23, 0xffff
    s_mov_b32 s46, 7864320
    s_mov_b32 s47, 0x20000
    v_mul_u32_u24 v56, 0x3334, v62
    v_lshrrev_b32 v56, 16, v56
    v_mul_u32_u24 v57, 5, v56
    v_sub_u32 v57, v62, v57
    v_mul_u32_u24 v56, 1280, v56
    v_lshl_add_u32 v56, v57, 4, v56
    s_mul_i32 s68, s82, 245760
    s_mul_i32 s69, s83, 80
    s_add_u32 s68, s68, s69
    s_mul_i32 s52, s3, 15360
    s_add_u32 s52, s52, 98304
    s_mov_b32 s78, -1
    s_mov_b32 s79, 0x0fffffff
    s_mov_b64 exec, s[78:79]
    s_add_u32 m0, s52, 0
    s_add_u32 s69, s68, 0
    buffer_load_dwordx4 v56, s[40:43], s69 offen  lds
    s_add_u32 m0, s52, 960
    s_add_u32 s69, s68, 15360
    buffer_load_dwordx4 v56, s[40:43], s69 offen  lds
    s_add_u32 m0, s52, 1920
    s_add_u32 s69, s68, 30720
    buffer_load_dwordx4 v56, s[40:43], s69 offen  lds
    s_add_u32 m0, s52, 2880
    s_add_u32 s69, s68, 46080
    buffer_load_dwordx4 v56, s[40:43], s69 offen  lds
    s_add_u32 m0, s52, 3840
    s_add_u32 s69, s68, 61440
    buffer_load_dwordx4 v56, s[40:43], s69 offen  lds
    s_add_u32 m0, s52, 4800
    s_add_u32 s69, s68, 76800
    buffer_load_dwordx4 v56, s[40:43], s69 offen  lds
    s_add_u32 m0, s52, 5760
    s_add_u32 s69, s68, 92160
    buffer_load_dwordx4 v56, s[40:43], s69 offen  lds
    s_add_u32 m0, s52, 6720
    s_add_u32 s69, s68, 107520
    buffer_load_dwordx4 v56, s[40:43], s69 offen  lds
    s_add_u32 m0, s52, 7680
    s_add_u32 s69, s68, 122880
    buffer_load_dwordx4 v56, s[40:43], s69 offen  lds
    s_add_u32 m0, s52, 8640
    s_add_u32 s69, s68, 138240
    buffer_load_dwordx4 v56, s[40:43], s69 offen  lds
    s_add_u32 m0, s52, 9600
    s_add_u32 s69, s68, 153600
    buffer_load_dwordx4 v56, s[40:43], s69 offen  lds
    s_add_u32 m0, s52, 10560
    s_add_u32 s69, s68, 168960
    buffer_load_dwordx4 v56, s[40:43], s69 offen  lds
    s_add_u32 m0, s52, 11520
    s_add_u32 s69, s68, 184320
    buffer_load_dwordx4 v56, s[40:43], s69 offen  lds
    s_add_u32 m0, s52, 12480
    s_add_u32 s69, s68, 199680
    buffer_load_dwordx4 v56, s[40:43], s69 offen  lds
    s_add_u32 m0, s52, 13440
    s_add_u32 s69, s68, 215040
    buffer_load_dwordx4 v56, s[40:43], s69 offen  lds
    s_add_u32 m0, s52, 14400
    s_add_u32 s69, s68, 230400
    buffer_load_dwordx4 v56, s[40:43], s69 offen  lds
    s_mov_b64 exec, -1
    s_lshl_b32 s94, s4, 5
    s_add_u32 s94, s94, s5
    s_lshl_b32 s94, s94, 7
    s_add_u32 s94, s94, 1441792
    s_lshl_b32 s92, s82, 9
    s_add_u32 s92, s92, 1458432
    s_lshl_b32 s93, s84, 9
    s_add_u32 s93, s93, 1458176
    v_lshrrev_b32 v58, 3, v62
    v_bfe_u32 v57, v58, 1, 1
    v_lshlrev_b32 v56, 3, v57
    v_bfe_u32 v57, v58, 2, 1
    v_lshl_add_u32 v56, v57, 2, v56
    v_and_b32 v57, 1, v58
    v_add_u32 v56, v56, v57
    v_mul_u32_u24 v56, 12288, v56
    v_lshrrev_b32 v58, 1, v58
    v_and_b32 v57, 7, v62
    v_xor_b32 v57, v57, v58
    v_lshl_add_u32 v1, v57, 4, v56
    v_xor_b32 v57, 4, v57
    v_lshl_add_u32 v2, v57, 4, v56
    v_add_u32 v2, 196608, v2
    s_mul_i32 s70, s3, 24576
    s_mul_i32 s53, s82, 384
    s_add_u32 s69, s53, 0
    s_add_u32 m0, s70, 0
    s_nop 0
    buffer_load_dwordx4 v1, s[44:47], s69 offen offset:0  lds
    s_add_u32 m0, s70, 896
    s_nop 0
    buffer_load_dwordx4 v1, s[44:47], s69 offen offset:128  lds
    s_add_u32 m0, s70, 1792
    s_nop 0
    buffer_load_dwordx4 v1, s[44:47], s69 offen offset:256  lds
    s_add_u32 m0, s70, 3072
    s_nop 0
    buffer_load_dwordx4 v2, s[44:47], s69 offen offset:0  lds
    s_add_u32 m0, s70, 3968
    s_nop 0
    buffer_load_dwordx4 v2, s[44:47], s69 offen offset:128  lds
    s_add_u32 m0, s70, 4864
    s_nop 0
    buffer_load_dwordx4 v2, s[44:47], s69 offen offset:256  lds
    s_add_u32 s69, s53, 24576
    s_add_u32 m0, s70, 6144
    s_nop 0
    buffer_load_dwordx4 v1, s[44:47], s69 offen offset:0  lds
    s_add_u32 m0, s70, 7040
    s_nop 0
    buffer_load_dwordx4 v1, s[44:47], s69 offen offset:128  lds
    s_add_u32 m0, s70, 7936
    s_nop 0
    buffer_load_dwordx4 v1, s[44:47], s69 offen offset:256  lds
    s_add_u32 m0, s70, 9216
    s_nop 0
    buffer_load_dwordx4 v2, s[44:47], s69 offen offset:0  lds
    s_add_u32 m0, s70, 10112
    s_nop 0
    buffer_load_dwordx4 v2, s[44:47], s69 offen offset:128  lds
    s_add_u32 m0, s70, 11008
    s_nop 0
    buffer_load_dwordx4 v2, s[44:47], s69 offen offset:256  lds
    s_add_u32 s69, s53, 393216
    s_add_u32 m0, s70, 12288
    s_nop 0
    buffer_load_dwordx4 v1, s[44:47], s69 offen offset:0  lds
    s_add_u32 m0, s70, 13184
    s_nop 0
    buffer_load_dwordx4 v1, s[44:47], s69 offen offset:128  lds
    s_add_u32 m0, s70, 14080
    s_nop 0
    buffer_load_dwordx4 v1, s[44:47], s69 offen offset:256  lds
    s_add_u32 m0, s70, 15360
    s_nop 0
    buffer_load_dwordx4 v2, s[44:47], s69 offen offset:0  lds
    s_add_u32 m0, s70, 16256
    s_nop 0
    buffer_load_dwordx4 v2, s[44:47], s69 offen offset:128  lds
    s_add_u32 m0, s70, 17152
    s_nop 0
    buffer_load_dwordx4 v2, s[44:47], s69 offen offset:256  lds
    s_add_u32 s69, s53, 417792
    s_add_u32 m0, s70, 18432
    s_nop 0
    buffer_load_dwordx4 v1, s[44:47], s69 offen offset:0  lds
    s_add_u32 m0, s70, 19328
    s_nop 0
    buffer_load_dwordx4 v1, s[44:47], s69 offen offset:128  lds
    s_add_u32 m0, s70, 20224
    s_nop 0
    buffer_load_dwordx4 v1, s[44:47], s69 offen offset:256  lds
    s_add_u32 m0, s70, 21504
    s_nop 0
    buffer_load_dwordx4 v2, s[44:47], s69 offen offset:0  lds
    s_add_u32 m0, s70, 22400
    s_nop 0
    buffer_load_dwordx4 v2, s[44:47], s69 offen offset:128  lds
    s_add_u32 m0, s70, 23296
    s_nop 0
    buffer_load_dwordx4 v2, s[44:47], s69 offen offset:256  lds
    v_lshrrev_b32 v56, 3, v60
    v_mul_u32_u24 v56, 3072, v56
    v_and_b32 v57, 7, v60
    v_lshl_add_u32 v56, v57, 7, v56
    v_add_u32 v56, s70, v56
    v_lshrrev_b32 v57, 1, v60
    v_xor_b32 v57, v57, v61
    v_lshl_add_u32 v3, v57, 4, v56
    v_xor_b32 v57, 4, v57
    v_lshl_add_u32 v4, v57, 4, v56
    v_add_u32 v57, 0, v62
    v_mul_u32_u24 v56, 0x2aab, v57
    v_lshrrev_b32 v56, 16, v56
    v_mul_u32_u24 v58, 6, v56
    v_sub_u32 v57, v57, v58
    v_mul_u32_u24 v56, 12288, v56
    v_lshl_add_u32 v5, v57, 4, v56
    v_add_u32 v57, 64, v62
    v_mul_u32_u24 v56, 0x2aab, v57
    v_lshrrev_b32 v56, 16, v56
    v_mul_u32_u24 v58, 6, v56
    v_sub_u32 v57, v57, v58
    v_mul_u32_u24 v56, 12288, v56
    v_lshl_add_u32 v6, v57, 4, v56
    v_add_u32 v57, 128, v62
    v_mul_u32_u24 v56, 0x2aab, v57
    v_lshrrev_b32 v56, 16, v56
    v_mul_u32_u24 v58, 6, v56
    v_sub_u32 v57, v57, v58
    v_mul_u32_u24 v56, 12288, v56
    v_lshl_add_u32 v7, v57, 4, v56
    s_mul_i32 s54, s84, 384
    s_mul_i32 s68, s85, 96
    s_add_u32 s54, s54, s68
    s_mul_i32 s68, s3, 1966080
    s_add_u32 s54, s54, s68
    v_lshrrev_b32 v56, 2, v60
    v_lshl_add_u32 v56, v61, 3, v56
    v_mul_u32_u24 v56, 80, v56
    v_add_u32 v56, s52, v56
    v_and_b32 v57, 1, v60
    v_lshl_add_u32 v58, v57, 3, v56
    v_and_b32 v57, 3, v60
    v_lshl_add_u32 v56, v57, 3, v56
    s_waitcnt vmcnt(24)
    ds_read_b64_tr_b16 v[8:9], v56 offset:0
    ds_read_b64_tr_b16 v[32:33], v56 offset:32
    ds_read_b64_tr_b16 v[64:65], v58 offset:64
    ds_read_b64_tr_b16 v[10:11], v56 offset:320
    ds_read_b64_tr_b16 v[34:35], v56 offset:352
    ds_read_b64_tr_b16 v[66:67], v58 offset:384
    s_waitcnt lgkmcnt(6)
    ds_read_b64_tr_b16 v[12:13], v56 offset:2560
    ds_read_b64_tr_b16 v[36:37], v56 offset:2592
    ds_read_b64_tr_b16 v[68:69], v58 offset:2624
    ds_read_b64_tr_b16 v[14:15], v56 offset:2880
    ds_read_b64_tr_b16 v[38:39], v56 offset:2912
    ds_read_b64_tr_b16 v[70:71], v58 offset:2944
    s_waitcnt lgkmcnt(6)
    ds_read_b64_tr_b16 v[16:17], v56 offset:5120
    ds_read_b64_tr_b16 v[40:41], v56 offset:5152
    ds_read_b64_tr_b16 v[72:73], v58 offset:5184
    ds_read_b64_tr_b16 v[18:19], v56 offset:5440
    ds_read_b64_tr_b16 v[42:43], v56 offset:5472
    ds_read_b64_tr_b16 v[74:75], v58 offset:5504
    s_waitcnt lgkmcnt(6)
    ds_read_b64_tr_b16 v[20:21], v56 offset:7680
    ds_read_b64_tr_b16 v[44:45], v56 offset:7712
    ds_read_b64_tr_b16 v[76:77], v58 offset:7744
    ds_read_b64_tr_b16 v[22:23], v56 offset:8000
    ds_read_b64_tr_b16 v[46:47], v56 offset:8032
    ds_read_b64_tr_b16 v[78:79], v58 offset:8064
    s_waitcnt lgkmcnt(6)
    ds_read_b64_tr_b16 v[24:25], v56 offset:10240
    ds_read_b64_tr_b16 v[48:49], v56 offset:10272
    ds_read_b64_tr_b16 v[80:81], v58 offset:10304
    ds_read_b64_tr_b16 v[26:27], v56 offset:10560
    ds_read_b64_tr_b16 v[50:51], v56 offset:10592
    ds_read_b64_tr_b16 v[82:83], v58 offset:10624
    s_waitcnt lgkmcnt(6)
    ds_read_b64_tr_b16 v[28:29], v56 offset:12800
    ds_read_b64_tr_b16 v[52:53], v56 offset:12832
    ds_read_b64_tr_b16 v[84:85], v58 offset:12864
    ds_read_b64_tr_b16 v[30:31], v56 offset:13120
    ds_read_b64_tr_b16 v[54:55], v56 offset:13152
    ds_read_b64_tr_b16 v[86:87], v58 offset:13184
    s_waitcnt lgkmcnt(6)
    s_mov_b32 s40, s20
    s_and_b32 s41, s21, 0xffff
    s_mov_b32 s42, 7864320
    s_mov_b32 s43, 0x20000
    v_lshrrev_b32 v88, 1, v61
    v_lshlrev_b32 v88, 4, v88
    v_and_b32 v57, 1, v61
    v_lshl_add_u32 v88, v57, 2, v88
    v_bfe_u32 v57, v60, 2, 1
    v_add_u32 v88, v88, v57
    v_lshrrev_b32 v57, 3, v60
    v_lshl_add_u32 v88, v57, 3, v88
    v_mul_u32_u24 v88, 96, v88
    v_and_b32 v57, 3, v60
    v_lshl_add_u32 v88, v57, 3, v88
    s_min_u32 s68, s3, 2
    s_lshl_b32 s68, s68, 5
    s_add_u32 s68, s68, 98304
    v_add_u32 v88, s68, v88
    s_waitcnt vmcnt(18) lgkmcnt(0)
    s_barrier
    ds_read_b128 v[96:99], v3 offset:0
    ds_read_b128 v[100:103], v4 offset:0
    ds_read_b128 v[104:107], v3 offset:1024
    ds_read_b128 v[108:111], v4 offset:1024
    ds_read_b128 v[112:115], v3 offset:2048
    ds_read_b128 v[116:119], v4 offset:2048
    s_waitcnt lgkmcnt(0)
    v_mfma_f32_16x16x32_bf16 v[144:147], v[96:99], v[8:11], 0
    s_add_u32 s69, s53, 786432
    s_add_u32 m0, s70, 0
    v_mfma_f32_16x16x32_bf16 v[148:151], v[96:99], v[32:35], 0
    buffer_load_dwordx4 v1, s[44:47], s69 offen offset:0  lds
    s_add_u32 m0, s70, 896
    v_mfma_f32_16x16x32_bf16 v[152:155], v[96:99], v[64:67], 0
    buffer_load_dwordx4 v1, s[44:47], s69 offen offset:128  lds
    s_add_u32 m0, s70, 1792
    v_mfma_f32_16x16x32_bf16 v[144:147], v[100:103], v[12:15], v[144:147]
    buffer_load_dwordx4 v1, s[44:47], s69 offen offset:256  lds
    s_add_u32 m0, s70, 3072
    v_mfma_f32_16x16x32_bf16 v[148:151], v[100:103], v[36:39], v[148:151]
    buffer_load_dwordx4 v2, s[44:47], s69 offen offset:0  lds
    s_add_u32 m0, s70, 3968
    v_mfma_f32_16x16x32_bf16 v[152:155], v[100:103], v[68:71], v[152:155]
    buffer_load_dwordx4 v2, s[44:47], s69 offen offset:128  lds
    s_add_u32 m0, s70, 4864
    v_mfma_f32_16x16x32_bf16 v[144:147], v[104:107], v[16:19], v[144:147]
    buffer_load_dwordx4 v2, s[44:47], s69 offen offset:256  lds
    v_mfma_f32_16x16x32_bf16 v[148:151], v[104:107], v[40:43], v[148:151]
    v_mfma_f32_16x16x32_bf16 v[152:155], v[104:107], v[72:75], v[152:155]
    v_mfma_f32_16x16x32_bf16 v[144:147], v[108:111], v[20:23], v[144:147]
    s_waitcnt vmcnt(18)
    v_mfma_f32_16x16x32_bf16 v[148:151], v[108:111], v[44:47], v[148:151]
    ds_read_b128 v[120:123], v3 offset:6144
    v_mfma_f32_16x16x32_bf16 v[152:155], v[108:111], v[76:79], v[152:155]
    ds_read_b128 v[124:127], v4 offset:6144
    v_mfma_f32_16x16x32_bf16 v[144:147], v[112:115], v[24:27], v[144:147]
    ds_read_b128 v[128:131], v3 offset:7168
    v_mfma_f32_16x16x32_bf16 v[148:151], v[112:115], v[48:51], v[148:151]
    ds_read_b128 v[132:135], v4 offset:7168
    v_mfma_f32_16x16x32_bf16 v[152:155], v[112:115], v[80:83], v[152:155]
    ds_read_b128 v[136:139], v3 offset:8192
    v_mfma_f32_16x16x32_bf16 v[144:147], v[116:119], v[28:31], v[144:147]
    ds_read_b128 v[140:143], v4 offset:8192
    v_mfma_f32_16x16x32_bf16 v[148:151], v[116:119], v[52:55], v[148:151]
    v_mfma_f32_16x16x32_bf16 v[152:155], v[116:119], v[84:87], v[152:155]
    s_waitcnt lgkmcnt(0)
    v_mfma_f32_16x16x32_bf16 v[156:159], v[120:123], v[8:11], 0
    s_add_u32 s69, s53, 811008
    s_add_u32 m0, s70, 6144
    v_mfma_f32_16x16x32_bf16 v[160:163], v[120:123], v[32:35], 0
    buffer_load_dwordx4 v1, s[44:47], s69 offen offset:0  lds
    s_add_u32 m0, s70, 7040
    v_mfma_f32_16x16x32_bf16 v[164:167], v[120:123], v[64:67], 0
    buffer_load_dwordx4 v1, s[44:47], s69 offen offset:128  lds
    s_add_u32 m0, s70, 7936
    v_mfma_f32_16x16x32_bf16 v[156:159], v[124:127], v[12:15], v[156:159]
    buffer_load_dwordx4 v1, s[44:47], s69 offen offset:256  lds
    s_add_u32 m0, s70, 9216
    v_mfma_f32_16x16x32_bf16 v[160:163], v[124:127], v[36:39], v[160:163]
    buffer_load_dwordx4 v2, s[44:47], s69 offen offset:0  lds
    s_add_u32 m0, s70, 10112
    v_mfma_f32_16x16x32_bf16 v[164:167], v[124:127], v[68:71], v[164:167]
    buffer_load_dwordx4 v2, s[44:47], s69 offen offset:128  lds
    s_add_u32 m0, s70, 11008
    v_mfma_f32_16x16x32_bf16 v[156:159], v[128:131], v[16:19], v[156:159]
    buffer_load_dwordx4 v2, s[44:47], s69 offen offset:256  lds
    v_mfma_f32_16x16x32_bf16 v[160:163], v[128:131], v[40:43], v[160:163]
    v_mfma_f32_16x16x32_bf16 v[164:167], v[128:131], v[72:75], v[164:167]
    v_cvt_pk_bf16_f32 v168, v144, v145
    v_mfma_f32_16x16x32_bf16 v[156:159], v[132:135], v[20:23], v[156:159]
    s_waitcnt vmcnt(18)
    v_cvt_pk_bf16_f32 v169, v146, v147
    v_mfma_f32_16x16x32_bf16 v[160:163], v[132:135], v[44:47], v[160:163]
    ds_read_b128 v[96:99], v3 offset:12288
    v_accvgpr_write_b32 a0, v168
    v_mfma_f32_16x16x32_bf16 v[164:167], v[132:135], v[76:79], v[164:167]
    ds_read_b128 v[100:103], v4 offset:12288
    v_accvgpr_write_b32 a1, v169
    v_mfma_f32_16x16x32_bf16 v[156:159], v[136:139], v[24:27], v[156:159]
    ds_read_b128 v[104:107], v3 offset:13312
    v_cvt_pk_bf16_f32 v170, v148, v149
    v_mfma_f32_16x16x32_bf16 v[160:163], v[136:139], v[48:51], v[160:163]
    ds_read_b128 v[108:111], v4 offset:13312
    v_cvt_pk_bf16_f32 v171, v150, v151
    v_mfma_f32_16x16x32_bf16 v[164:167], v[136:139], v[80:83], v[164:167]
    ds_read_b128 v[112:115], v3 offset:14336
    v_accvgpr_write_b32 a80, v170
    v_mfma_f32_16x16x32_bf16 v[156:159], v[140:143], v[28:31], v[156:159]
    ds_read_b128 v[116:119], v4 offset:14336
    v_accvgpr_write_b32 a81, v171
    v_mfma_f32_16x16x32_bf16 v[160:163], v[140:143], v[52:55], v[160:163]
    v_cvt_pk_bf16_f32 v172, v152, v153
    v_cvt_pk_bf16_f32 v173, v154, v155
    v_mfma_f32_16x16x32_bf16 v[164:167], v[140:143], v[84:87], v[164:167]
    v_accvgpr_write_b32 a160, v172
    v_accvgpr_write_b32 a161, v173
    s_waitcnt lgkmcnt(0)
    v_mfma_f32_16x16x32_bf16 v[144:147], v[96:99], v[8:11], 0
    s_add_u32 s69, s53, 1179648
    s_add_u32 m0, s70, 12288
    v_mfma_f32_16x16x32_bf16 v[148:151], v[96:99], v[32:35], 0
    buffer_load_dwordx4 v1, s[44:47], s69 offen offset:0  lds
    s_add_u32 m0, s70, 13184
    v_mfma_f32_16x16x32_bf16 v[152:155], v[96:99], v[64:67], 0
    buffer_load_dwordx4 v1, s[44:47], s69 offen offset:128  lds
    s_add_u32 m0, s70, 14080
    v_mfma_f32_16x16x32_bf16 v[144:147], v[100:103], v[12:15], v[144:147]
    buffer_load_dwordx4 v1, s[44:47], s69 offen offset:256  lds
    s_add_u32 m0, s70, 15360
    v_mfma_f32_16x16x32_bf16 v[148:151], v[100:103], v[36:39], v[148:151]
    buffer_load_dwordx4 v2, s[44:47], s69 offen offset:0  lds
    s_add_u32 m0, s70, 16256
    v_mfma_f32_16x16x32_bf16 v[152:155], v[100:103], v[68:71], v[152:155]
    buffer_load_dwordx4 v2, s[44:47], s69 offen offset:128  lds
    s_add_u32 m0, s70, 17152
    v_mfma_f32_16x16x32_bf16 v[144:147], v[104:107], v[16:19], v[144:147]
    buffer_load_dwordx4 v2, s[44:47], s69 offen offset:256  lds
    v_mfma_f32_16x16x32_bf16 v[148:151], v[104:107], v[40:43], v[148:151]
    v_mfma_f32_16x16x32_bf16 v[152:155], v[104:107], v[72:75], v[152:155]
    v_cvt_pk_bf16_f32 v168, v156, v157
    v_mfma_f32_16x16x32_bf16 v[144:147], v[108:111], v[20:23], v[144:147]
    s_waitcnt vmcnt(18)
    v_cvt_pk_bf16_f32 v169, v158, v159
    v_mfma_f32_16x16x32_bf16 v[148:151], v[108:111], v[44:47], v[148:151]
    ds_read_b128 v[120:123], v3 offset:18432
    v_accvgpr_write_b32 a2, v168
    v_mfma_f32_16x16x32_bf16 v[152:155], v[108:111], v[76:79], v[152:155]
    ds_read_b128 v[124:127], v4 offset:18432
    v_accvgpr_write_b32 a3, v169
    v_mfma_f32_16x16x32_bf16 v[144:147], v[112:115], v[24:27], v[144:147]
    ds_read_b128 v[128:131], v3 offset:19456
    v_cvt_pk_bf16_f32 v170, v160, v161
    v_mfma_f32_16x16x32_bf16 v[148:151], v[112:115], v[48:51], v[148:151]
    ds_read_b128 v[132:135], v4 offset:19456
    v_cvt_pk_bf16_f32 v171, v162, v163
    v_mfma_f32_16x16x32_bf16 v[152:155], v[112:115], v[80:83], v[152:155]
    ds_read_b128 v[136:139], v3 offset:20480
    v_accvgpr_write_b32 a82, v170
    v_mfma_f32_16x16x32_bf16 v[144:147], v[116:119], v[28:31], v[144:147]
    ds_read_b128 v[140:143], v4 offset:20480
    v_accvgpr_write_b32 a83, v171
    v_mfma_f32_16x16x32_bf16 v[148:151], v[116:119], v[52:55], v[148:151]
    v_cvt_pk_bf16_f32 v172, v164, v165
    v_cvt_pk_bf16_f32 v173, v166, v167
    v_mfma_f32_16x16x32_bf16 v[152:155], v[116:119], v[84:87], v[152:155]
    v_accvgpr_write_b32 a162, v172
    v_accvgpr_write_b32 a163, v173
    s_waitcnt lgkmcnt(0)
    v_mfma_f32_16x16x32_bf16 v[156:159], v[120:123], v[8:11], 0
    s_add_u32 s69, s53, 1204224
    s_add_u32 m0, s70, 18432
    v_mfma_f32_16x16x32_bf16 v[160:163], v[120:123], v[32:35], 0
    buffer_load_dwordx4 v1, s[44:47], s69 offen offset:0  lds
    s_add_u32 m0, s70, 19328
    v_mfma_f32_16x16x32_bf16 v[164:167], v[120:123], v[64:67], 0
    buffer_load_dwordx4 v1, s[44:47], s69 offen offset:128  lds
    s_add_u32 m0, s70, 20224
    v_mfma_f32_16x16x32_bf16 v[156:159], v[124:127], v[12:15], v[156:159]
    buffer_load_dwordx4 v1, s[44:47], s69 offen offset:256  lds
    s_add_u32 m0, s70, 21504
    v_mfma_f32_16x16x32_bf16 v[160:163], v[124:127], v[36:39], v[160:163]
    buffer_load_dwordx4 v2, s[44:47], s69 offen offset:0  lds
    s_add_u32 m0, s70, 22400
    v_mfma_f32_16x16x32_bf16 v[164:167], v[124:127], v[68:71], v[164:167]
    buffer_load_dwordx4 v2, s[44:47], s69 offen offset:128  lds
    s_add_u32 m0, s70, 23296
    v_mfma_f32_16x16x32_bf16 v[156:159], v[128:131], v[16:19], v[156:159]
    buffer_load_dwordx4 v2, s[44:47], s69 offen offset:256  lds
    v_mfma_f32_16x16x32_bf16 v[160:163], v[128:131], v[40:43], v[160:163]
    v_mfma_f32_16x16x32_bf16 v[164:167], v[128:131], v[72:75], v[164:167]
    v_cvt_pk_bf16_f32 v168, v144, v145
    v_mfma_f32_16x16x32_bf16 v[156:159], v[132:135], v[20:23], v[156:159]
    s_waitcnt vmcnt(18)
    v_cvt_pk_bf16_f32 v169, v146, v147
    v_mfma_f32_16x16x32_bf16 v[160:163], v[132:135], v[44:47], v[160:163]
    ds_read_b128 v[96:99], v3 offset:0
    v_accvgpr_write_b32 a4, v168
    v_mfma_f32_16x16x32_bf16 v[164:167], v[132:135], v[76:79], v[164:167]
    ds_read_b128 v[100:103], v4 offset:0
    v_accvgpr_write_b32 a5, v169
    v_mfma_f32_16x16x32_bf16 v[156:159], v[136:139], v[24:27], v[156:159]
    ds_read_b128 v[104:107], v3 offset:1024
    v_cvt_pk_bf16_f32 v170, v148, v149
    v_mfma_f32_16x16x32_bf16 v[160:163], v[136:139], v[48:51], v[160:163]
    ds_read_b128 v[108:111], v4 offset:1024
    v_cvt_pk_bf16_f32 v171, v150, v151
    v_mfma_f32_16x16x32_bf16 v[164:167], v[136:139], v[80:83], v[164:167]
    ds_read_b128 v[112:115], v3 offset:2048
    v_accvgpr_write_b32 a84, v170
    v_mfma_f32_16x16x32_bf16 v[156:159], v[140:143], v[28:31], v[156:159]
    ds_read_b128 v[116:119], v4 offset:2048
    v_accvgpr_write_b32 a85, v171
    v_mfma_f32_16x16x32_bf16 v[160:163], v[140:143], v[52:55], v[160:163]
    v_cvt_pk_bf16_f32 v172, v152, v153
    v_cvt_pk_bf16_f32 v173, v154, v155
    v_mfma_f32_16x16x32_bf16 v[164:167], v[140:143], v[84:87], v[164:167]
    v_accvgpr_write_b32 a164, v172
    v_accvgpr_write_b32 a165, v173
    s_waitcnt lgkmcnt(0)
    v_mfma_f32_16x16x32_bf16 v[144:147], v[96:99], v[8:11], 0
    s_add_u32 s69, s53, 1572864
    s_add_u32 m0, s70, 0
    v_mfma_f32_16x16x32_bf16 v[148:151], v[96:99], v[32:35], 0
    buffer_load_dwordx4 v1, s[44:47], s69 offen offset:0  lds
    s_add_u32 m0, s70, 896
    v_mfma_f32_16x16x32_bf16 v[152:155], v[96:99], v[64:67], 0
    buffer_load_dwordx4 v1, s[44:47], s69 offen offset:128  lds
    s_add_u32 m0, s70, 1792
    v_mfma_f32_16x16x32_bf16 v[144:147], v[100:103], v[12:15], v[144:147]
    buffer_load_dwordx4 v1, s[44:47], s69 offen offset:256  lds
    s_add_u32 m0, s70, 3072
    v_mfma_f32_16x16x32_bf16 v[148:151], v[100:103], v[36:39], v[148:151]
    buffer_load_dwordx4 v2, s[44:47], s69 offen offset:0  lds
    s_add_u32 m0, s70, 3968
    v_mfma_f32_16x16x32_bf16 v[152:155], v[100:103], v[68:71], v[152:155]
    buffer_load_dwordx4 v2, s[44:47], s69 offen offset:128  lds
    s_add_u32 m0, s70, 4864
    v_mfma_f32_16x16x32_bf16 v[144:147], v[104:107], v[16:19], v[144:147]
    buffer_load_dwordx4 v2, s[44:47], s69 offen offset:256  lds
    v_mfma_f32_16x16x32_bf16 v[148:151], v[104:107], v[40:43], v[148:151]
    v_mfma_f32_16x16x32_bf16 v[152:155], v[104:107], v[72:75], v[152:155]
    v_cvt_pk_bf16_f32 v168, v156, v157
    v_mfma_f32_16x16x32_bf16 v[144:147], v[108:111], v[20:23], v[144:147]
    s_waitcnt vmcnt(18)
    v_cvt_pk_bf16_f32 v169, v158, v159
    v_mfma_f32_16x16x32_bf16 v[148:151], v[108:111], v[44:47], v[148:151]
    ds_read_b128 v[120:123], v3 offset:6144
    v_accvgpr_write_b32 a6, v168
    v_mfma_f32_16x16x32_bf16 v[152:155], v[108:111], v[76:79], v[152:155]
    ds_read_b128 v[124:127], v4 offset:6144
    v_accvgpr_write_b32 a7, v169
    v_mfma_f32_16x16x32_bf16 v[144:147], v[112:115], v[24:27], v[144:147]
    ds_read_b128 v[128:131], v3 offset:7168
    v_cvt_pk_bf16_f32 v170, v160, v161
    v_mfma_f32_16x16x32_bf16 v[148:151], v[112:115], v[48:51], v[148:151]
    ds_read_b128 v[132:135], v4 offset:7168
    v_cvt_pk_bf16_f32 v171, v162, v163
    v_mfma_f32_16x16x32_bf16 v[152:155], v[112:115], v[80:83], v[152:155]
    ds_read_b128 v[136:139], v3 offset:8192
    v_accvgpr_write_b32 a86, v170
    v_mfma_f32_16x16x32_bf16 v[144:147], v[116:119], v[28:31], v[144:147]
    ds_read_b128 v[140:143], v4 offset:8192
    v_accvgpr_write_b32 a87, v171
    v_mfma_f32_16x16x32_bf16 v[148:151], v[116:119], v[52:55], v[148:151]
    v_cvt_pk_bf16_f32 v172, v164, v165
    v_cvt_pk_bf16_f32 v173, v166, v167
    v_mfma_f32_16x16x32_bf16 v[152:155], v[116:119], v[84:87], v[152:155]
    v_accvgpr_write_b32 a166, v172
    v_accvgpr_write_b32 a167, v173
    s_waitcnt lgkmcnt(0)
    v_mfma_f32_16x16x32_bf16 v[156:159], v[120:123], v[8:11], 0
    s_add_u32 s69, s53, 1597440
    s_add_u32 m0, s70, 6144
    v_mfma_f32_16x16x32_bf16 v[160:163], v[120:123], v[32:35], 0
    buffer_load_dwordx4 v1, s[44:47], s69 offen offset:0  lds
    s_add_u32 m0, s70, 7040
    v_mfma_f32_16x16x32_bf16 v[164:167], v[120:123], v[64:67], 0
    buffer_load_dwordx4 v1, s[44:47], s69 offen offset:128  lds
    s_add_u32 m0, s70, 7936
    v_mfma_f32_16x16x32_bf16 v[156:159], v[124:127], v[12:15], v[156:159]
    buffer_load_dwordx4 v1, s[44:47], s69 offen offset:256  lds
    s_add_u32 m0, s70, 9216
    v_mfma_f32_16x16x32_bf16 v[160:163], v[124:127], v[36:39], v[160:163]
    buffer_load_dwordx4 v2, s[44:47], s69 offen offset:0  lds
    s_add_u32 m0, s70, 10112
    v_mfma_f32_16x16x32_bf16 v[164:167], v[124:127], v[68:71], v[164:167]
    buffer_load_dwordx4 v2, s[44:47], s69 offen offset:128  lds
    s_add_u32 m0, s70, 11008
    v_mfma_f32_16x16x32_bf16 v[156:159], v[128:131], v[16:19], v[156:159]
    buffer_load_dwordx4 v2, s[44:47], s69 offen offset:256  lds
    v_mfma_f32_16x16x32_bf16 v[160:163], v[128:131], v[40:43], v[160:163]
    v_mfma_f32_16x16x32_bf16 v[164:167], v[128:131], v[72:75], v[164:167]
    v_cvt_pk_bf16_f32 v168, v144, v145
    v_mfma_f32_16x16x32_bf16 v[156:159], v[132:135], v[20:23], v[156:159]
    s_waitcnt vmcnt(18)
    v_cvt_pk_bf16_f32 v169, v146, v147
    v_mfma_f32_16x16x32_bf16 v[160:163], v[132:135], v[44:47], v[160:163]
    ds_read_b128 v[96:99], v3 offset:12288
    v_accvgpr_write_b32 a8, v168
    v_mfma_f32_16x16x32_bf16 v[164:167], v[132:135], v[76:79], v[164:167]
    ds_read_b128 v[100:103], v4 offset:12288
    v_accvgpr_write_b32 a9, v169
    v_mfma_f32_16x16x32_bf16 v[156:159], v[136:139], v[24:27], v[156:159]
    ds_read_b128 v[104:107], v3 offset:13312
    v_cvt_pk_bf16_f32 v170, v148, v149
    v_mfma_f32_16x16x32_bf16 v[160:163], v[136:139], v[48:51], v[160:163]
    ds_read_b128 v[108:111], v4 offset:13312
    v_cvt_pk_bf16_f32 v171, v150, v151
    v_mfma_f32_16x16x32_bf16 v[164:167], v[136:139], v[80:83], v[164:167]
    ds_read_b128 v[112:115], v3 offset:14336
    v_accvgpr_write_b32 a88, v170
    v_mfma_f32_16x16x32_bf16 v[156:159], v[140:143], v[28:31], v[156:159]
    ds_read_b128 v[116:119], v4 offset:14336
    v_accvgpr_write_b32 a89, v171
    v_mfma_f32_16x16x32_bf16 v[160:163], v[140:143], v[52:55], v[160:163]
    v_cvt_pk_bf16_f32 v172, v152, v153
    v_cvt_pk_bf16_f32 v173, v154, v155
    v_mfma_f32_16x16x32_bf16 v[164:167], v[140:143], v[84:87], v[164:167]
    v_accvgpr_write_b32 a168, v172
    v_accvgpr_write_b32 a169, v173
    s_waitcnt lgkmcnt(0)
    v_mfma_f32_16x16x32_bf16 v[144:147], v[96:99], v[8:11], 0
    s_add_u32 s69, s53, 1966080
    s_add_u32 m0, s70, 12288
    v_mfma_f32_16x16x32_bf16 v[148:151], v[96:99], v[32:35], 0
    buffer_load_dwordx4 v1, s[44:47], s69 offen offset:0  lds
    s_add_u32 m0, s70, 13184
    v_mfma_f32_16x16x32_bf16 v[152:155], v[96:99], v[64:67], 0
    buffer_load_dwordx4 v1, s[44:47], s69 offen offset:128  lds
    s_add_u32 m0, s70, 14080
    v_mfma_f32_16x16x32_bf16 v[144:147], v[100:103], v[12:15], v[144:147]
    buffer_load_dwordx4 v1, s[44:47], s69 offen offset:256  lds
    s_add_u32 m0, s70, 15360
    v_mfma_f32_16x16x32_bf16 v[148:151], v[100:103], v[36:39], v[148:151]
    buffer_load_dwordx4 v2, s[44:47], s69 offen offset:0  lds
    s_add_u32 m0, s70, 16256
    v_mfma_f32_16x16x32_bf16 v[152:155], v[100:103], v[68:71], v[152:155]
    buffer_load_dwordx4 v2, s[44:47], s69 offen offset:128  lds
    s_add_u32 m0, s70, 17152
    v_mfma_f32_16x16x32_bf16 v[144:147], v[104:107], v[16:19], v[144:147]
    buffer_load_dwordx4 v2, s[44:47], s69 offen offset:256  lds
    v_mfma_f32_16x16x32_bf16 v[148:151], v[104:107], v[40:43], v[148:151]
    v_mfma_f32_16x16x32_bf16 v[152:155], v[104:107], v[72:75], v[152:155]
    v_cvt_pk_bf16_f32 v168, v156, v157
    v_mfma_f32_16x16x32_bf16 v[144:147], v[108:111], v[20:23], v[144:147]
    s_waitcnt vmcnt(18)
    v_cvt_pk_bf16_f32 v169, v158, v159
    v_mfma_f32_16x16x32_bf16 v[148:151], v[108:111], v[44:47], v[148:151]
    ds_read_b128 v[120:123], v3 offset:18432
    v_accvgpr_write_b32 a10, v168
    v_mfma_f32_16x16x32_bf16 v[152:155], v[108:111], v[76:79], v[152:155]
    ds_read_b128 v[124:127], v4 offset:18432
    v_accvgpr_write_b32 a11, v169
    v_mfma_f32_16x16x32_bf16 v[144:147], v[112:115], v[24:27], v[144:147]
    ds_read_b128 v[128:131], v3 offset:19456
    v_cvt_pk_bf16_f32 v170, v160, v161
    v_mfma_f32_16x16x32_bf16 v[148:151], v[112:115], v[48:51], v[148:151]
    ds_read_b128 v[132:135], v4 offset:19456
    v_cvt_pk_bf16_f32 v171, v162, v163
    v_mfma_f32_16x16x32_bf16 v[152:155], v[112:115], v[80:83], v[152:155]
    ds_read_b128 v[136:139], v3 offset:20480
    v_accvgpr_write_b32 a90, v170
    v_mfma_f32_16x16x32_bf16 v[144:147], v[116:119], v[28:31], v[144:147]
    ds_read_b128 v[140:143], v4 offset:20480
    v_accvgpr_write_b32 a91, v171
    v_mfma_f32_16x16x32_bf16 v[148:151], v[116:119], v[52:55], v[148:151]
    v_cvt_pk_bf16_f32 v172, v164, v165
    v_cvt_pk_bf16_f32 v173, v166, v167
    v_mfma_f32_16x16x32_bf16 v[152:155], v[116:119], v[84:87], v[152:155]
    v_accvgpr_write_b32 a170, v172
    v_accvgpr_write_b32 a171, v173
    s_waitcnt lgkmcnt(0)
    v_mfma_f32_16x16x32_bf16 v[156:159], v[120:123], v[8:11], 0
    s_add_u32 s69, s53, 1990656
    s_add_u32 m0, s70, 18432
    v_mfma_f32_16x16x32_bf16 v[160:163], v[120:123], v[32:35], 0
    buffer_load_dwordx4 v1, s[44:47], s69 offen offset:0  lds
    s_add_u32 m0, s70, 19328
    v_mfma_f32_16x16x32_bf16 v[164:167], v[120:123], v[64:67], 0
    buffer_load_dwordx4 v1, s[44:47], s69 offen offset:128  lds
    s_add_u32 m0, s70, 20224
    v_mfma_f32_16x16x32_bf16 v[156:159], v[124:127], v[12:15], v[156:159]
    buffer_load_dwordx4 v1, s[44:47], s69 offen offset:256  lds
    s_add_u32 m0, s70, 21504
    v_mfma_f32_16x16x32_bf16 v[160:163], v[124:127], v[36:39], v[160:163]
    buffer_load_dwordx4 v2, s[44:47], s69 offen offset:0  lds
    s_add_u32 m0, s70, 22400
    v_mfma_f32_16x16x32_bf16 v[164:167], v[124:127], v[68:71], v[164:167]
    buffer_load_dwordx4 v2, s[44:47], s69 offen offset:128  lds
    s_add_u32 m0, s70, 23296
    v_mfma_f32_16x16x32_bf16 v[156:159], v[128:131], v[16:19], v[156:159]
    buffer_load_dwordx4 v2, s[44:47], s69 offen offset:256  lds
    v_mfma_f32_16x16x32_bf16 v[160:163], v[128:131], v[40:43], v[160:163]
    v_mfma_f32_16x16x32_bf16 v[164:167], v[128:131], v[72:75], v[164:167]
    v_cvt_pk_bf16_f32 v168, v144, v145
    v_mfma_f32_16x16x32_bf16 v[156:159], v[132:135], v[20:23], v[156:159]
    s_waitcnt vmcnt(18)
    v_cvt_pk_bf16_f32 v169, v146, v147
    v_mfma_f32_16x16x32_bf16 v[160:163], v[132:135], v[44:47], v[160:163]
    ds_read_b128 v[96:99], v3 offset:0
    v_accvgpr_write_b32 a12, v168
    v_mfma_f32_16x16x32_bf16 v[164:167], v[132:135], v[76:79], v[164:167]
    ds_read_b128 v[100:103], v4 offset:0
    v_accvgpr_write_b32 a13, v169
    v_mfma_f32_16x16x32_bf16 v[156:159], v[136:139], v[24:27], v[156:159]
    ds_read_b128 v[104:107], v3 offset:1024
    v_cvt_pk_bf16_f32 v170, v148, v149
    v_mfma_f32_16x16x32_bf16 v[160:163], v[136:139], v[48:51], v[160:163]
    ds_read_b128 v[108:111], v4 offset:1024
    v_cvt_pk_bf16_f32 v171, v150, v151
    v_mfma_f32_16x16x32_bf16 v[164:167], v[136:139], v[80:83], v[164:167]
    ds_read_b128 v[112:115], v3 offset:2048
    v_accvgpr_write_b32 a92, v170
    v_mfma_f32_16x16x32_bf16 v[156:159], v[140:143], v[28:31], v[156:159]
    ds_read_b128 v[116:119], v4 offset:2048
    v_accvgpr_write_b32 a93, v171
    v_mfma_f32_16x16x32_bf16 v[160:163], v[140:143], v[52:55], v[160:163]
    v_cvt_pk_bf16_f32 v172, v152, v153
    v_cvt_pk_bf16_f32 v173, v154, v155
    v_mfma_f32_16x16x32_bf16 v[164:167], v[140:143], v[84:87], v[164:167]
    v_accvgpr_write_b32 a172, v172
    v_accvgpr_write_b32 a173, v173
    s_waitcnt lgkmcnt(0)
    v_mfma_f32_16x16x32_bf16 v[144:147], v[96:99], v[8:11], 0
    s_add_u32 s69, s53, 2359296
    s_add_u32 m0, s70, 0
    v_mfma_f32_16x16x32_bf16 v[148:151], v[96:99], v[32:35], 0
    buffer_load_dwordx4 v1, s[44:47], s69 offen offset:0  lds
    s_add_u32 m0, s70, 896
    v_mfma_f32_16x16x32_bf16 v[152:155], v[96:99], v[64:67], 0
    buffer_load_dwordx4 v1, s[44:47], s69 offen offset:128  lds
    s_add_u32 m0, s70, 1792
    v_mfma_f32_16x16x32_bf16 v[144:147], v[100:103], v[12:15], v[144:147]
    buffer_load_dwordx4 v1, s[44:47], s69 offen offset:256  lds
    s_add_u32 m0, s70, 3072
    v_mfma_f32_16x16x32_bf16 v[148:151], v[100:103], v[36:39], v[148:151]
    buffer_load_dwordx4 v2, s[44:47], s69 offen offset:0  lds
    s_add_u32 m0, s70, 3968
    v_mfma_f32_16x16x32_bf16 v[152:155], v[100:103], v[68:71], v[152:155]
    buffer_load_dwordx4 v2, s[44:47], s69 offen offset:128  lds
    s_add_u32 m0, s70, 4864
    v_mfma_f32_16x16x32_bf16 v[144:147], v[104:107], v[16:19], v[144:147]
    buffer_load_dwordx4 v2, s[44:47], s69 offen offset:256  lds
    v_mfma_f32_16x16x32_bf16 v[148:151], v[104:107], v[40:43], v[148:151]
    v_mfma_f32_16x16x32_bf16 v[152:155], v[104:107], v[72:75], v[152:155]
    v_cvt_pk_bf16_f32 v168, v156, v157
    v_mfma_f32_16x16x32_bf16 v[144:147], v[108:111], v[20:23], v[144:147]
    s_waitcnt vmcnt(18)
    v_cvt_pk_bf16_f32 v169, v158, v159
    v_mfma_f32_16x16x32_bf16 v[148:151], v[108:111], v[44:47], v[148:151]
    ds_read_b128 v[120:123], v3 offset:6144
    v_accvgpr_write_b32 a14, v168
    v_mfma_f32_16x16x32_bf16 v[152:155], v[108:111], v[76:79], v[152:155]
    ds_read_b128 v[124:127], v4 offset:6144
    v_accvgpr_write_b32 a15, v169
    v_mfma_f32_16x16x32_bf16 v[144:147], v[112:115], v[24:27], v[144:147]
    ds_read_b128 v[128:131], v3 offset:7168
    v_cvt_pk_bf16_f32 v170, v160, v161
    v_mfma_f32_16x16x32_bf16 v[148:151], v[112:115], v[48:51], v[148:151]
    ds_read_b128 v[132:135], v4 offset:7168
    v_cvt_pk_bf16_f32 v171, v162, v163
    v_mfma_f32_16x16x32_bf16 v[152:155], v[112:115], v[80:83], v[152:155]
    ds_read_b128 v[136:139], v3 offset:8192
    v_accvgpr_write_b32 a94, v170
    v_mfma_f32_16x16x32_bf16 v[144:147], v[116:119], v[28:31], v[144:147]
    ds_read_b128 v[140:143], v4 offset:8192
    v_accvgpr_write_b32 a95, v171
    v_mfma_f32_16x16x32_bf16 v[148:151], v[116:119], v[52:55], v[148:151]
    v_cvt_pk_bf16_f32 v172, v164, v165
    v_cvt_pk_bf16_f32 v173, v166, v167
    v_mfma_f32_16x16x32_bf16 v[152:155], v[116:119], v[84:87], v[152:155]
    v_accvgpr_write_b32 a174, v172
    v_accvgpr_write_b32 a175, v173
    s_waitcnt lgkmcnt(0)
    v_mfma_f32_16x16x32_bf16 v[156:159], v[120:123], v[8:11], 0
    s_add_u32 s69, s53, 2383872
    s_add_u32 m0, s70, 6144
    v_mfma_f32_16x16x32_bf16 v[160:163], v[120:123], v[32:35], 0
    buffer_load_dwordx4 v1, s[44:47], s69 offen offset:0  lds
    s_add_u32 m0, s70, 7040
    v_mfma_f32_16x16x32_bf16 v[164:167], v[120:123], v[64:67], 0
    buffer_load_dwordx4 v1, s[44:47], s69 offen offset:128  lds
    s_add_u32 m0, s70, 7936
    v_mfma_f32_16x16x32_bf16 v[156:159], v[124:127], v[12:15], v[156:159]
    buffer_load_dwordx4 v1, s[44:47], s69 offen offset:256  lds
    s_add_u32 m0, s70, 9216
    v_mfma_f32_16x16x32_bf16 v[160:163], v[124:127], v[36:39], v[160:163]
    buffer_load_dwordx4 v2, s[44:47], s69 offen offset:0  lds
    s_add_u32 m0, s70, 10112
    v_mfma_f32_16x16x32_bf16 v[164:167], v[124:127], v[68:71], v[164:167]
    buffer_load_dwordx4 v2, s[44:47], s69 offen offset:128  lds
    s_add_u32 m0, s70, 11008
    v_mfma_f32_16x16x32_bf16 v[156:159], v[128:131], v[16:19], v[156:159]
    buffer_load_dwordx4 v2, s[44:47], s69 offen offset:256  lds
    v_mfma_f32_16x16x32_bf16 v[160:163], v[128:131], v[40:43], v[160:163]
    v_mfma_f32_16x16x32_bf16 v[164:167], v[128:131], v[72:75], v[164:167]
    v_cvt_pk_bf16_f32 v168, v144, v145
    v_mfma_f32_16x16x32_bf16 v[156:159], v[132:135], v[20:23], v[156:159]
    s_waitcnt vmcnt(18)
    v_cvt_pk_bf16_f32 v169, v146, v147
    v_mfma_f32_16x16x32_bf16 v[160:163], v[132:135], v[44:47], v[160:163]
    ds_read_b128 v[96:99], v3 offset:12288
    v_accvgpr_write_b32 a16, v168
    v_mfma_f32_16x16x32_bf16 v[164:167], v[132:135], v[76:79], v[164:167]
    ds_read_b128 v[100:103], v4 offset:12288
    v_accvgpr_write_b32 a17, v169
    v_mfma_f32_16x16x32_bf16 v[156:159], v[136:139], v[24:27], v[156:159]
    ds_read_b128 v[104:107], v3 offset:13312
    v_cvt_pk_bf16_f32 v170, v148, v149
    v_mfma_f32_16x16x32_bf16 v[160:163], v[136:139], v[48:51], v[160:163]
    ds_read_b128 v[108:111], v4 offset:13312
    v_cvt_pk_bf16_f32 v171, v150, v151
    v_mfma_f32_16x16x32_bf16 v[164:167], v[136:139], v[80:83], v[164:167]
    ds_read_b128 v[112:115], v3 offset:14336
    v_accvgpr_write_b32 a96, v170
    v_mfma_f32_16x16x32_bf16 v[156:159], v[140:143], v[28:31], v[156:159]
    ds_read_b128 v[116:119], v4 offset:14336
    v_accvgpr_write_b32 a97, v171
    v_mfma_f32_16x16x32_bf16 v[160:163], v[140:143], v[52:55], v[160:163]
    v_cvt_pk_bf16_f32 v172, v152, v153
    v_cvt_pk_bf16_f32 v173, v154, v155
    v_mfma_f32_16x16x32_bf16 v[164:167], v[140:143], v[84:87], v[164:167]
    v_accvgpr_write_b32 a176, v172
    v_accvgpr_write_b32 a177, v173
    s_waitcnt lgkmcnt(0)
    v_mfma_f32_16x16x32_bf16 v[144:147], v[96:99], v[8:11], 0
    s_add_u32 s69, s53, 2752512
    s_add_u32 m0, s70, 12288
    v_mfma_f32_16x16x32_bf16 v[148:151], v[96:99], v[32:35], 0
    buffer_load_dwordx4 v1, s[44:47], s69 offen offset:0  lds
    s_add_u32 m0, s70, 13184
    v_mfma_f32_16x16x32_bf16 v[152:155], v[96:99], v[64:67], 0
    buffer_load_dwordx4 v1, s[44:47], s69 offen offset:128  lds
    s_add_u32 m0, s70, 14080
    v_mfma_f32_16x16x32_bf16 v[144:147], v[100:103], v[12:15], v[144:147]
    buffer_load_dwordx4 v1, s[44:47], s69 offen offset:256  lds
    s_add_u32 m0, s70, 15360
    v_mfma_f32_16x16x32_bf16 v[148:151], v[100:103], v[36:39], v[148:151]
    buffer_load_dwordx4 v2, s[44:47], s69 offen offset:0  lds
    s_add_u32 m0, s70, 16256
    v_mfma_f32_16x16x32_bf16 v[152:155], v[100:103], v[68:71], v[152:155]
    buffer_load_dwordx4 v2, s[44:47], s69 offen offset:128  lds
    s_add_u32 m0, s70, 17152
    v_mfma_f32_16x16x32_bf16 v[144:147], v[104:107], v[16:19], v[144:147]
    buffer_load_dwordx4 v2, s[44:47], s69 offen offset:256  lds
    s_add_u32 m0, s52, 0
    v_mfma_f32_16x16x32_bf16 v[148:151], v[104:107], v[40:43], v[148:151]
    s_add_u32 s68, s54, 0
    buffer_load_dwordx4 v5, s[40:43], s68 offen  lds
    v_mfma_f32_16x16x32_bf16 v[152:155], v[104:107], v[72:75], v[152:155]
    v_cvt_pk_bf16_f32 v168, v156, v157
    v_mfma_f32_16x16x32_bf16 v[144:147], v[108:111], v[20:23], v[144:147]
    s_waitcnt vmcnt(19)
    v_cvt_pk_bf16_f32 v169, v158, v159
    v_mfma_f32_16x16x32_bf16 v[148:151], v[108:111], v[44:47], v[148:151]
    ds_read_b128 v[120:123], v3 offset:18432
    v_accvgpr_write_b32 a18, v168
    v_mfma_f32_16x16x32_bf16 v[152:155], v[108:111], v[76:79], v[152:155]
    ds_read_b128 v[124:127], v4 offset:18432
    v_accvgpr_write_b32 a19, v169
    v_mfma_f32_16x16x32_bf16 v[144:147], v[112:115], v[24:27], v[144:147]
    ds_read_b128 v[128:131], v3 offset:19456
    v_cvt_pk_bf16_f32 v170, v160, v161
    v_mfma_f32_16x16x32_bf16 v[148:151], v[112:115], v[48:51], v[148:151]
    ds_read_b128 v[132:135], v4 offset:19456
    v_cvt_pk_bf16_f32 v171, v162, v163
    v_mfma_f32_16x16x32_bf16 v[152:155], v[112:115], v[80:83], v[152:155]
    ds_read_b128 v[136:139], v3 offset:20480
    v_accvgpr_write_b32 a98, v170
    v_mfma_f32_16x16x32_bf16 v[144:147], v[116:119], v[28:31], v[144:147]
    ds_read_b128 v[140:143], v4 offset:20480
    v_accvgpr_write_b32 a99, v171
    v_mfma_f32_16x16x32_bf16 v[148:151], v[116:119], v[52:55], v[148:151]
    v_cvt_pk_bf16_f32 v172, v164, v165
    v_cvt_pk_bf16_f32 v173, v166, v167
    v_mfma_f32_16x16x32_bf16 v[152:155], v[116:119], v[84:87], v[152:155]
    v_accvgpr_write_b32 a178, v172
    v_accvgpr_write_b32 a179, v173
    s_waitcnt lgkmcnt(0)
    v_mfma_f32_16x16x32_bf16 v[156:159], v[120:123], v[8:11], 0
    s_add_u32 s69, s53, 2777088
    s_add_u32 m0, s70, 18432
    v_mfma_f32_16x16x32_bf16 v[160:163], v[120:123], v[32:35], 0
    buffer_load_dwordx4 v1, s[44:47], s69 offen offset:0  lds
    s_add_u32 m0, s70, 19328
    v_mfma_f32_16x16x32_bf16 v[164:167], v[120:123], v[64:67], 0
    buffer_load_dwordx4 v1, s[44:47], s69 offen offset:128  lds
    s_add_u32 m0, s70, 20224
    v_mfma_f32_16x16x32_bf16 v[156:159], v[124:127], v[12:15], v[156:159]
    buffer_load_dwordx4 v1, s[44:47], s69 offen offset:256  lds
    s_add_u32 m0, s70, 21504
    v_mfma_f32_16x16x32_bf16 v[160:163], v[124:127], v[36:39], v[160:163]
    buffer_load_dwordx4 v2, s[44:47], s69 offen offset:0  lds
    s_add_u32 m0, s70, 22400
    v_mfma_f32_16x16x32_bf16 v[164:167], v[124:127], v[68:71], v[164:167]
    buffer_load_dwordx4 v2, s[44:47], s69 offen offset:128  lds
    s_add_u32 m0, s70, 23296
    v_mfma_f32_16x16x32_bf16 v[156:159], v[128:131], v[16:19], v[156:159]
    buffer_load_dwordx4 v2, s[44:47], s69 offen offset:256  lds
    s_add_u32 m0, s52, 1024
    v_mfma_f32_16x16x32_bf16 v[160:163], v[128:131], v[40:43], v[160:163]
    s_add_u32 s68, s54, 0
    buffer_load_dwordx4 v6, s[40:43], s68 offen  lds
    v_mfma_f32_16x16x32_bf16 v[164:167], v[128:131], v[72:75], v[164:167]
    v_cvt_pk_bf16_f32 v168, v144, v145
    v_mfma_f32_16x16x32_bf16 v[156:159], v[132:135], v[20:23], v[156:159]
    s_waitcnt vmcnt(20)
    v_cvt_pk_bf16_f32 v169, v146, v147
    v_mfma_f32_16x16x32_bf16 v[160:163], v[132:135], v[44:47], v[160:163]
    ds_read_b128 v[96:99], v3 offset:0
    v_accvgpr_write_b32 a20, v168
    v_mfma_f32_16x16x32_bf16 v[164:167], v[132:135], v[76:79], v[164:167]
    ds_read_b128 v[100:103], v4 offset:0
    v_accvgpr_write_b32 a21, v169
    v_mfma_f32_16x16x32_bf16 v[156:159], v[136:139], v[24:27], v[156:159]
    ds_read_b128 v[104:107], v3 offset:1024
    v_cvt_pk_bf16_f32 v170, v148, v149
    v_mfma_f32_16x16x32_bf16 v[160:163], v[136:139], v[48:51], v[160:163]
    ds_read_b128 v[108:111], v4 offset:1024
    v_cvt_pk_bf16_f32 v171, v150, v151
    v_mfma_f32_16x16x32_bf16 v[164:167], v[136:139], v[80:83], v[164:167]
    ds_read_b128 v[112:115], v3 offset:2048
    v_accvgpr_write_b32 a100, v170
    v_mfma_f32_16x16x32_bf16 v[156:159], v[140:143], v[28:31], v[156:159]
    ds_read_b128 v[116:119], v4 offset:2048
    v_accvgpr_write_b32 a101, v171
    v_mfma_f32_16x16x32_bf16 v[160:163], v[140:143], v[52:55], v[160:163]
    v_cvt_pk_bf16_f32 v172, v152, v153
    v_cvt_pk_bf16_f32 v173, v154, v155
    v_mfma_f32_16x16x32_bf16 v[164:167], v[140:143], v[84:87], v[164:167]
    v_accvgpr_write_b32 a180, v172
    v_accvgpr_write_b32 a181, v173
    s_waitcnt lgkmcnt(0)
    v_mfma_f32_16x16x32_bf16 v[144:147], v[96:99], v[8:11], 0
    s_add_u32 s69, s53, 3145728
    s_add_u32 m0, s70, 0
    v_mfma_f32_16x16x32_bf16 v[148:151], v[96:99], v[32:35], 0
    buffer_load_dwordx4 v1, s[44:47], s69 offen offset:0  lds
    s_add_u32 m0, s70, 896
    v_mfma_f32_16x16x32_bf16 v[152:155], v[96:99], v[64:67], 0
    buffer_load_dwordx4 v1, s[44:47], s69 offen offset:128  lds
    s_add_u32 m0, s70, 1792
    v_mfma_f32_16x16x32_bf16 v[144:147], v[100:103], v[12:15], v[144:147]
    buffer_load_dwordx4 v1, s[44:47], s69 offen offset:256  lds
    s_add_u32 m0, s70, 3072
    v_mfma_f32_16x16x32_bf16 v[148:151], v[100:103], v[36:39], v[148:151]
    buffer_load_dwordx4 v2, s[44:47], s69 offen offset:0  lds
    s_add_u32 m0, s70, 3968
    v_mfma_f32_16x16x32_bf16 v[152:155], v[100:103], v[68:71], v[152:155]
    buffer_load_dwordx4 v2, s[44:47], s69 offen offset:128  lds
    s_add_u32 m0, s70, 4864
    v_mfma_f32_16x16x32_bf16 v[144:147], v[104:107], v[16:19], v[144:147]
    buffer_load_dwordx4 v2, s[44:47], s69 offen offset:256  lds
    s_add_u32 m0, s52, 2048
    v_mfma_f32_16x16x32_bf16 v[148:151], v[104:107], v[40:43], v[148:151]
    s_add_u32 s68, s54, 0
    buffer_load_dwordx4 v7, s[40:43], s68 offen  lds
    v_mfma_f32_16x16x32_bf16 v[152:155], v[104:107], v[72:75], v[152:155]
    v_cvt_pk_bf16_f32 v168, v156, v157
    v_mfma_f32_16x16x32_bf16 v[144:147], v[108:111], v[20:23], v[144:147]
    s_waitcnt vmcnt(21)
    v_cvt_pk_bf16_f32 v169, v158, v159
    v_mfma_f32_16x16x32_bf16 v[148:151], v[108:111], v[44:47], v[148:151]
    ds_read_b128 v[120:123], v3 offset:6144
    v_accvgpr_write_b32 a22, v168
    v_mfma_f32_16x16x32_bf16 v[152:155], v[108:111], v[76:79], v[152:155]
    ds_read_b128 v[124:127], v4 offset:6144
    v_accvgpr_write_b32 a23, v169
    v_mfma_f32_16x16x32_bf16 v[144:147], v[112:115], v[24:27], v[144:147]
    ds_read_b128 v[128:131], v3 offset:7168
    v_cvt_pk_bf16_f32 v170, v160, v161
    v_mfma_f32_16x16x32_bf16 v[148:151], v[112:115], v[48:51], v[148:151]
    ds_read_b128 v[132:135], v4 offset:7168
    v_cvt_pk_bf16_f32 v171, v162, v163
    v_mfma_f32_16x16x32_bf16 v[152:155], v[112:115], v[80:83], v[152:155]
    ds_read_b128 v[136:139], v3 offset:8192
    v_accvgpr_write_b32 a102, v170
    v_mfma_f32_16x16x32_bf16 v[144:147], v[116:119], v[28:31], v[144:147]
    ds_read_b128 v[140:143], v4 offset:8192
    v_accvgpr_write_b32 a103, v171
    v_mfma_f32_16x16x32_bf16 v[148:151], v[116:119], v[52:55], v[148:151]
    v_cvt_pk_bf16_f32 v172, v164, v165
    v_cvt_pk_bf16_f32 v173, v166, v167
    v_mfma_f32_16x16x32_bf16 v[152:155], v[116:119], v[84:87], v[152:155]
    v_accvgpr_write_b32 a182, v172
    v_accvgpr_write_b32 a183, v173
    s_waitcnt lgkmcnt(0)
    v_mfma_f32_16x16x32_bf16 v[156:159], v[120:123], v[8:11], 0
    s_add_u32 s69, s53, 3170304
    s_add_u32 m0, s70, 6144
    v_mfma_f32_16x16x32_bf16 v[160:163], v[120:123], v[32:35], 0
    buffer_load_dwordx4 v1, s[44:47], s69 offen offset:0  lds
    s_add_u32 m0, s70, 7040
    v_mfma_f32_16x16x32_bf16 v[164:167], v[120:123], v[64:67], 0
    buffer_load_dwordx4 v1, s[44:47], s69 offen offset:128  lds
    s_add_u32 m0, s70, 7936
    v_mfma_f32_16x16x32_bf16 v[156:159], v[124:127], v[12:15], v[156:159]
    buffer_load_dwordx4 v1, s[44:47], s69 offen offset:256  lds
    s_add_u32 m0, s70, 9216
    v_mfma_f32_16x16x32_bf16 v[160:163], v[124:127], v[36:39], v[160:163]
    buffer_load_dwordx4 v2, s[44:47], s69 offen offset:0  lds
    s_add_u32 m0, s70, 10112
    v_mfma_f32_16x16x32_bf16 v[164:167], v[124:127], v[68:71], v[164:167]
    buffer_load_dwordx4 v2, s[44:47], s69 offen offset:128  lds
    s_add_u32 m0, s70, 11008
    v_mfma_f32_16x16x32_bf16 v[156:159], v[128:131], v[16:19], v[156:159]
    buffer_load_dwordx4 v2, s[44:47], s69 offen offset:256  lds
    s_add_u32 m0, s52, 3072
    v_mfma_f32_16x16x32_bf16 v[160:163], v[128:131], v[40:43], v[160:163]
    s_add_u32 s68, s54, 393216
    buffer_load_dwordx4 v5, s[40:43], s68 offen  lds
    v_mfma_f32_16x16x32_bf16 v[164:167], v[128:131], v[72:75], v[164:167]
    v_cvt_pk_bf16_f32 v168, v144, v145
    v_mfma_f32_16x16x32_bf16 v[156:159], v[132:135], v[20:23], v[156:159]
    s_waitcnt vmcnt(22)
    v_cvt_pk_bf16_f32 v169, v146, v147
    v_mfma_f32_16x16x32_bf16 v[160:163], v[132:135], v[44:47], v[160:163]
    ds_read_b128 v[96:99], v3 offset:12288
    v_accvgpr_write_b32 a24, v168
    v_mfma_f32_16x16x32_bf16 v[164:167], v[132:135], v[76:79], v[164:167]
    ds_read_b128 v[100:103], v4 offset:12288
    v_accvgpr_write_b32 a25, v169
    v_mfma_f32_16x16x32_bf16 v[156:159], v[136:139], v[24:27], v[156:159]
    ds_read_b128 v[104:107], v3 offset:13312
    v_cvt_pk_bf16_f32 v170, v148, v149
    v_mfma_f32_16x16x32_bf16 v[160:163], v[136:139], v[48:51], v[160:163]
    ds_read_b128 v[108:111], v4 offset:13312
    v_cvt_pk_bf16_f32 v171, v150, v151
    v_mfma_f32_16x16x32_bf16 v[164:167], v[136:139], v[80:83], v[164:167]
    ds_read_b128 v[112:115], v3 offset:14336
    v_accvgpr_write_b32 a104, v170
    v_mfma_f32_16x16x32_bf16 v[156:159], v[140:143], v[28:31], v[156:159]
    ds_read_b128 v[116:119], v4 offset:14336
    v_accvgpr_write_b32 a105, v171
    v_mfma_f32_16x16x32_bf16 v[160:163], v[140:143], v[52:55], v[160:163]
    v_cvt_pk_bf16_f32 v172, v152, v153
    v_cvt_pk_bf16_f32 v173, v154, v155
    v_mfma_f32_16x16x32_bf16 v[164:167], v[140:143], v[84:87], v[164:167]
    v_accvgpr_write_b32 a184, v172
    v_accvgpr_write_b32 a185, v173
    s_waitcnt lgkmcnt(0)
    v_mfma_f32_16x16x32_bf16 v[144:147], v[96:99], v[8:11], 0
    s_add_u32 s69, s53, 3538944
    s_add_u32 m0, s70, 12288
    v_mfma_f32_16x16x32_bf16 v[148:151], v[96:99], v[32:35], 0
    buffer_load_dwordx4 v1, s[44:47], s69 offen offset:0  lds
    s_add_u32 m0, s70, 13184
    v_mfma_f32_16x16x32_bf16 v[152:155], v[96:99], v[64:67], 0
    buffer_load_dwordx4 v1, s[44:47], s69 offen offset:128  lds
    s_add_u32 m0, s70, 14080
    v_mfma_f32_16x16x32_bf16 v[144:147], v[100:103], v[12:15], v[144:147]
    buffer_load_dwordx4 v1, s[44:47], s69 offen offset:256  lds
    s_add_u32 m0, s70, 15360
    v_mfma_f32_16x16x32_bf16 v[148:151], v[100:103], v[36:39], v[148:151]
    buffer_load_dwordx4 v2, s[44:47], s69 offen offset:0  lds
    s_add_u32 m0, s70, 16256
    v_mfma_f32_16x16x32_bf16 v[152:155], v[100:103], v[68:71], v[152:155]
    buffer_load_dwordx4 v2, s[44:47], s69 offen offset:128  lds
    s_add_u32 m0, s70, 17152
    v_mfma_f32_16x16x32_bf16 v[144:147], v[104:107], v[16:19], v[144:147]
    buffer_load_dwordx4 v2, s[44:47], s69 offen offset:256  lds
    s_add_u32 m0, s52, 4096
    v_mfma_f32_16x16x32_bf16 v[148:151], v[104:107], v[40:43], v[148:151]
    s_add_u32 s68, s54, 393216
    buffer_load_dwordx4 v6, s[40:43], s68 offen  lds
    v_mfma_f32_16x16x32_bf16 v[152:155], v[104:107], v[72:75], v[152:155]
    v_cvt_pk_bf16_f32 v168, v156, v157
    v_mfma_f32_16x16x32_bf16 v[144:147], v[108:111], v[20:23], v[144:147]
    s_waitcnt vmcnt(22)
    v_cvt_pk_bf16_f32 v169, v158, v159
    v_mfma_f32_16x16x32_bf16 v[148:151], v[108:111], v[44:47], v[148:151]
    ds_read_b128 v[120:123], v3 offset:18432
    v_accvgpr_write_b32 a26, v168
    v_mfma_f32_16x16x32_bf16 v[152:155], v[108:111], v[76:79], v[152:155]
    ds_read_b128 v[124:127], v4 offset:18432
    v_accvgpr_write_b32 a27, v169
    v_mfma_f32_16x16x32_bf16 v[144:147], v[112:115], v[24:27], v[144:147]
    ds_read_b128 v[128:131], v3 offset:19456
    v_cvt_pk_bf16_f32 v170, v160, v161
    v_mfma_f32_16x16x32_bf16 v[148:151], v[112:115], v[48:51], v[148:151]
    ds_read_b128 v[132:135], v4 offset:19456
    v_cvt_pk_bf16_f32 v171, v162, v163
    v_mfma_f32_16x16x32_bf16 v[152:155], v[112:115], v[80:83], v[152:155]
    ds_read_b128 v[136:139], v3 offset:20480
    v_accvgpr_write_b32 a106, v170
    v_mfma_f32_16x16x32_bf16 v[144:147], v[116:119], v[28:31], v[144:147]
    ds_read_b128 v[140:143], v4 offset:20480
    v_accvgpr_write_b32 a107, v171
    v_mfma_f32_16x16x32_bf16 v[148:151], v[116:119], v[52:55], v[148:151]
    v_cvt_pk_bf16_f32 v172, v164, v165
    v_cvt_pk_bf16_f32 v173, v166, v167
    v_mfma_f32_16x16x32_bf16 v[152:155], v[116:119], v[84:87], v[152:155]
    v_accvgpr_write_b32 a186, v172
    v_accvgpr_write_b32 a187, v173
    s_waitcnt lgkmcnt(0)
    v_mfma_f32_16x16x32_bf16 v[156:159], v[120:123], v[8:11], 0
    s_add_u32 s69, s53, 3563520
    s_add_u32 m0, s70, 18432
    v_mfma_f32_16x16x32_bf16 v[160:163], v[120:123], v[32:35], 0
    buffer_load_dwordx4 v1, s[44:47], s69 offen offset:0  lds
    s_add_u32 m0, s70, 19328
    v_mfma_f32_16x16x32_bf16 v[164:167], v[120:123], v[64:67], 0
    buffer_load_dwordx4 v1, s[44:47], s69 offen offset:128  lds
    s_add_u32 m0, s70, 20224
    v_mfma_f32_16x16x32_bf16 v[156:159], v[124:127], v[12:15], v[156:159]
    buffer_load_dwordx4 v1, s[44:47], s69 offen offset:256  lds
    s_add_u32 m0, s70, 21504
    v_mfma_f32_16x16x32_bf16 v[160:163], v[124:127], v[36:39], v[160:163]
    buffer_load_dwordx4 v2, s[44:47], s69 offen offset:0  lds
    s_add_u32 m0, s70, 22400
    v_mfma_f32_16x16x32_bf16 v[164:167], v[124:127], v[68:71], v[164:167]
    buffer_load_dwordx4 v2, s[44:47], s69 offen offset:128  lds
    s_add_u32 m0, s70, 23296
    v_mfma_f32_16x16x32_bf16 v[156:159], v[128:131], v[16:19], v[156:159]
    buffer_load_dwordx4 v2, s[44:47], s69 offen offset:256  lds
    s_add_u32 m0, s52, 5120
    v_mfma_f32_16x16x32_bf16 v[160:163], v[128:131], v[40:43], v[160:163]
    s_add_u32 s68, s54, 393216
    buffer_load_dwordx4 v7, s[40:43], s68 offen  lds
    v_mfma_f32_16x16x32_bf16 v[164:167], v[128:131], v[72:75], v[164:167]
    v_cvt_pk_bf16_f32 v168, v144, v145
    v_mfma_f32_16x16x32_bf16 v[156:159], v[132:135], v[20:23], v[156:159]
    s_waitcnt vmcnt(22)
    v_cvt_pk_bf16_f32 v169, v146, v147
    v_mfma_f32_16x16x32_bf16 v[160:163], v[132:135], v[44:47], v[160:163]
    ds_read_b128 v[96:99], v3 offset:0
    v_accvgpr_write_b32 a28, v168
    v_mfma_f32_16x16x32_bf16 v[164:167], v[132:135], v[76:79], v[164:167]
    ds_read_b128 v[100:103], v4 offset:0
    v_accvgpr_write_b32 a29, v169
    v_mfma_f32_16x16x32_bf16 v[156:159], v[136:139], v[24:27], v[156:159]
    ds_read_b128 v[104:107], v3 offset:1024
    v_cvt_pk_bf16_f32 v170, v148, v149
    v_mfma_f32_16x16x32_bf16 v[160:163], v[136:139], v[48:51], v[160:163]
    ds_read_b128 v[108:111], v4 offset:1024
    v_cvt_pk_bf16_f32 v171, v150, v151
    v_mfma_f32_16x16x32_bf16 v[164:167], v[136:139], v[80:83], v[164:167]
    ds_read_b128 v[112:115], v3 offset:2048
    v_accvgpr_write_b32 a108, v170
    v_mfma_f32_16x16x32_bf16 v[156:159], v[140:143], v[28:31], v[156:159]
    ds_read_b128 v[116:119], v4 offset:2048
    v_accvgpr_write_b32 a109, v171
    v_mfma_f32_16x16x32_bf16 v[160:163], v[140:143], v[52:55], v[160:163]
    v_cvt_pk_bf16_f32 v172, v152, v153
    v_cvt_pk_bf16_f32 v173, v154, v155
    v_mfma_f32_16x16x32_bf16 v[164:167], v[140:143], v[84:87], v[164:167]
    v_accvgpr_write_b32 a188, v172
    v_accvgpr_write_b32 a189, v173
    s_waitcnt lgkmcnt(0)
    v_mfma_f32_16x16x32_bf16 v[144:147], v[96:99], v[8:11], 0
    s_add_u32 s69, s53, 3932160
    s_add_u32 m0, s70, 0
    v_mfma_f32_16x16x32_bf16 v[148:151], v[96:99], v[32:35], 0
    buffer_load_dwordx4 v1, s[44:47], s69 offen offset:0  lds
    s_add_u32 m0, s70, 896
    v_mfma_f32_16x16x32_bf16 v[152:155], v[96:99], v[64:67], 0
    buffer_load_dwordx4 v1, s[44:47], s69 offen offset:128  lds
    s_add_u32 m0, s70, 1792
    v_mfma_f32_16x16x32_bf16 v[144:147], v[100:103], v[12:15], v[144:147]
    buffer_load_dwordx4 v1, s[44:47], s69 offen offset:256  lds
    s_add_u32 m0, s70, 3072
    v_mfma_f32_16x16x32_bf16 v[148:151], v[100:103], v[36:39], v[148:151]
    buffer_load_dwordx4 v2, s[44:47], s69 offen offset:0  lds
    s_add_u32 m0, s70, 3968
    v_mfma_f32_16x16x32_bf16 v[152:155], v[100:103], v[68:71], v[152:155]
    buffer_load_dwordx4 v2, s[44:47], s69 offen offset:128  lds
    s_add_u32 m0, s70, 4864
    v_mfma_f32_16x16x32_bf16 v[144:147], v[104:107], v[16:19], v[144:147]
    buffer_load_dwordx4 v2, s[44:47], s69 offen offset:256  lds
    s_add_u32 m0, s52, 6144
    v_mfma_f32_16x16x32_bf16 v[148:151], v[104:107], v[40:43], v[148:151]
    s_add_u32 s68, s54, 786432
    buffer_load_dwordx4 v5, s[40:43], s68 offen  lds
    v_mfma_f32_16x16x32_bf16 v[152:155], v[104:107], v[72:75], v[152:155]
    v_cvt_pk_bf16_f32 v168, v156, v157
    v_mfma_f32_16x16x32_bf16 v[144:147], v[108:111], v[20:23], v[144:147]
    s_waitcnt vmcnt(22)
    v_cvt_pk_bf16_f32 v169, v158, v159
    v_mfma_f32_16x16x32_bf16 v[148:151], v[108:111], v[44:47], v[148:151]
    ds_read_b128 v[120:123], v3 offset:6144
    v_accvgpr_write_b32 a30, v168
    v_mfma_f32_16x16x32_bf16 v[152:155], v[108:111], v[76:79], v[152:155]
    ds_read_b128 v[124:127], v4 offset:6144
    v_accvgpr_write_b32 a31, v169
    v_mfma_f32_16x16x32_bf16 v[144:147], v[112:115], v[24:27], v[144:147]
    ds_read_b128 v[128:131], v3 offset:7168
    v_cvt_pk_bf16_f32 v170, v160, v161
    v_mfma_f32_16x16x32_bf16 v[148:151], v[112:115], v[48:51], v[148:151]
    ds_read_b128 v[132:135], v4 offset:7168
    v_cvt_pk_bf16_f32 v171, v162, v163
    v_mfma_f32_16x16x32_bf16 v[152:155], v[112:115], v[80:83], v[152:155]
    ds_read_b128 v[136:139], v3 offset:8192
    v_accvgpr_write_b32 a110, v170
    v_mfma_f32_16x16x32_bf16 v[144:147], v[116:119], v[28:31], v[144:147]
    ds_read_b128 v[140:143], v4 offset:8192
    v_accvgpr_write_b32 a111, v171
    v_mfma_f32_16x16x32_bf16 v[148:151], v[116:119], v[52:55], v[148:151]
    v_cvt_pk_bf16_f32 v172, v164, v165
    v_cvt_pk_bf16_f32 v173, v166, v167
    v_mfma_f32_16x16x32_bf16 v[152:155], v[116:119], v[84:87], v[152:155]
    v_accvgpr_write_b32 a190, v172
    v_accvgpr_write_b32 a191, v173
    s_waitcnt lgkmcnt(0)
    v_mfma_f32_16x16x32_bf16 v[156:159], v[120:123], v[8:11], 0
    s_add_u32 s69, s53, 3956736
    s_add_u32 m0, s70, 6144
    v_mfma_f32_16x16x32_bf16 v[160:163], v[120:123], v[32:35], 0
    buffer_load_dwordx4 v1, s[44:47], s69 offen offset:0  lds
    s_add_u32 m0, s70, 7040
    v_mfma_f32_16x16x32_bf16 v[164:167], v[120:123], v[64:67], 0
    buffer_load_dwordx4 v1, s[44:47], s69 offen offset:128  lds
    s_add_u32 m0, s70, 7936
    v_mfma_f32_16x16x32_bf16 v[156:159], v[124:127], v[12:15], v[156:159]
    buffer_load_dwordx4 v1, s[44:47], s69 offen offset:256  lds
    s_add_u32 m0, s70, 9216
    v_mfma_f32_16x16x32_bf16 v[160:163], v[124:127], v[36:39], v[160:163]
    buffer_load_dwordx4 v2, s[44:47], s69 offen offset:0  lds
    s_add_u32 m0, s70, 10112
    v_mfma_f32_16x16x32_bf16 v[164:167], v[124:127], v[68:71], v[164:167]
    buffer_load_dwordx4 v2, s[44:47], s69 offen offset:128  lds
    s_add_u32 m0, s70, 11008
    v_mfma_f32_16x16x32_bf16 v[156:159], v[128:131], v[16:19], v[156:159]
    buffer_load_dwordx4 v2, s[44:47], s69 offen offset:256  lds
    s_add_u32 m0, s52, 7168
    v_mfma_f32_16x16x32_bf16 v[160:163], v[128:131], v[40:43], v[160:163]
    s_add_u32 s68, s54, 786432
    buffer_load_dwordx4 v6, s[40:43], s68 offen  lds
    v_mfma_f32_16x16x32_bf16 v[164:167], v[128:131], v[72:75], v[164:167]
    v_cvt_pk_bf16_f32 v168, v144, v145
    v_mfma_f32_16x16x32_bf16 v[156:159], v[132:135], v[20:23], v[156:159]
    s_waitcnt vmcnt(22)
    v_cvt_pk_bf16_f32 v169, v146, v147
    v_mfma_f32_16x16x32_bf16 v[160:163], v[132:135], v[44:47], v[160:163]
    ds_read_b128 v[96:99], v3 offset:12288
    v_accvgpr_write_b32 a32, v168
    v_mfma_f32_16x16x32_bf16 v[164:167], v[132:135], v[76:79], v[164:167]
    ds_read_b128 v[100:103], v4 offset:12288
    v_accvgpr_write_b32 a33, v169
    v_mfma_f32_16x16x32_bf16 v[156:159], v[136:139], v[24:27], v[156:159]
    ds_read_b128 v[104:107], v3 offset:13312
    v_cvt_pk_bf16_f32 v170, v148, v149
    v_mfma_f32_16x16x32_bf16 v[160:163], v[136:139], v[48:51], v[160:163]
    ds_read_b128 v[108:111], v4 offset:13312
    v_cvt_pk_bf16_f32 v171, v150, v151
    v_mfma_f32_16x16x32_bf16 v[164:167], v[136:139], v[80:83], v[164:167]
    ds_read_b128 v[112:115], v3 offset:14336
    v_accvgpr_write_b32 a112, v170
    v_mfma_f32_16x16x32_bf16 v[156:159], v[140:143], v[28:31], v[156:159]
    ds_read_b128 v[116:119], v4 offset:14336
    v_accvgpr_write_b32 a113, v171
    v_mfma_f32_16x16x32_bf16 v[160:163], v[140:143], v[52:55], v[160:163]
    v_cvt_pk_bf16_f32 v172, v152, v153
    v_cvt_pk_bf16_f32 v173, v154, v155
    v_mfma_f32_16x16x32_bf16 v[164:167], v[140:143], v[84:87], v[164:167]
    v_accvgpr_write_b32 a192, v172
    v_accvgpr_write_b32 a193, v173
    s_waitcnt lgkmcnt(0)
    v_mfma_f32_16x16x32_bf16 v[144:147], v[96:99], v[8:11], 0
    s_add_u32 s69, s53, 4325376
    s_add_u32 m0, s70, 12288
    v_mfma_f32_16x16x32_bf16 v[148:151], v[96:99], v[32:35], 0
    buffer_load_dwordx4 v1, s[44:47], s69 offen offset:0  lds
    s_add_u32 m0, s70, 13184
    v_mfma_f32_16x16x32_bf16 v[152:155], v[96:99], v[64:67], 0
    buffer_load_dwordx4 v1, s[44:47], s69 offen offset:128  lds
    s_add_u32 m0, s70, 14080
    v_mfma_f32_16x16x32_bf16 v[144:147], v[100:103], v[12:15], v[144:147]
    buffer_load_dwordx4 v1, s[44:47], s69 offen offset:256  lds
    s_add_u32 m0, s70, 15360
    v_mfma_f32_16x16x32_bf16 v[148:151], v[100:103], v[36:39], v[148:151]
    buffer_load_dwordx4 v2, s[44:47], s69 offen offset:0  lds
    s_add_u32 m0, s70, 16256
    v_mfma_f32_16x16x32_bf16 v[152:155], v[100:103], v[68:71], v[152:155]
    buffer_load_dwordx4 v2, s[44:47], s69 offen offset:128  lds
    s_add_u32 m0, s70, 17152
    v_mfma_f32_16x16x32_bf16 v[144:147], v[104:107], v[16:19], v[144:147]
    buffer_load_dwordx4 v2, s[44:47], s69 offen offset:256  lds
    s_add_u32 m0, s52, 8192
    v_mfma_f32_16x16x32_bf16 v[148:151], v[104:107], v[40:43], v[148:151]
    s_add_u32 s68, s54, 786432
    buffer_load_dwordx4 v7, s[40:43], s68 offen  lds
    v_mfma_f32_16x16x32_bf16 v[152:155], v[104:107], v[72:75], v[152:155]
    v_cvt_pk_bf16_f32 v168, v156, v157
    v_mfma_f32_16x16x32_bf16 v[144:147], v[108:111], v[20:23], v[144:147]
    s_waitcnt vmcnt(22)
    v_cvt_pk_bf16_f32 v169, v158, v159
    v_mfma_f32_16x16x32_bf16 v[148:151], v[108:111], v[44:47], v[148:151]
    ds_read_b128 v[120:123], v3 offset:18432
    v_accvgpr_write_b32 a34, v168
    v_mfma_f32_16x16x32_bf16 v[152:155], v[108:111], v[76:79], v[152:155]
    ds_read_b128 v[124:127], v4 offset:18432
    v_accvgpr_write_b32 a35, v169
    v_mfma_f32_16x16x32_bf16 v[144:147], v[112:115], v[24:27], v[144:147]
    ds_read_b128 v[128:131], v3 offset:19456
    v_cvt_pk_bf16_f32 v170, v160, v161
    v_mfma_f32_16x16x32_bf16 v[148:151], v[112:115], v[48:51], v[148:151]
    ds_read_b128 v[132:135], v4 offset:19456
    v_cvt_pk_bf16_f32 v171, v162, v163
    v_mfma_f32_16x16x32_bf16 v[152:155], v[112:115], v[80:83], v[152:155]
    ds_read_b128 v[136:139], v3 offset:20480
    v_accvgpr_write_b32 a114, v170
    v_mfma_f32_16x16x32_bf16 v[144:147], v[116:119], v[28:31], v[144:147]
    ds_read_b128 v[140:143], v4 offset:20480
    v_accvgpr_write_b32 a115, v171
    v_mfma_f32_16x16x32_bf16 v[148:151], v[116:119], v[52:55], v[148:151]
    v_cvt_pk_bf16_f32 v172, v164, v165
    v_cvt_pk_bf16_f32 v173, v166, v167
    v_mfma_f32_16x16x32_bf16 v[152:155], v[116:119], v[84:87], v[152:155]
    v_accvgpr_write_b32 a194, v172
    v_accvgpr_write_b32 a195, v173
    s_waitcnt lgkmcnt(0)
    v_mfma_f32_16x16x32_bf16 v[156:159], v[120:123], v[8:11], 0
    s_add_u32 s69, s53, 4349952
    s_add_u32 m0, s70, 18432
    v_mfma_f32_16x16x32_bf16 v[160:163], v[120:123], v[32:35], 0
    buffer_load_dwordx4 v1, s[44:47], s69 offen offset:0  lds
    s_add_u32 m0, s70, 19328
    v_mfma_f32_16x16x32_bf16 v[164:167], v[120:123], v[64:67], 0
    buffer_load_dwordx4 v1, s[44:47], s69 offen offset:128  lds
    s_add_u32 m0, s70, 20224
    v_mfma_f32_16x16x32_bf16 v[156:159], v[124:127], v[12:15], v[156:159]
    buffer_load_dwordx4 v1, s[44:47], s69 offen offset:256  lds
    s_add_u32 m0, s70, 21504
    v_mfma_f32_16x16x32_bf16 v[160:163], v[124:127], v[36:39], v[160:163]
    buffer_load_dwordx4 v2, s[44:47], s69 offen offset:0  lds
    s_add_u32 m0, s70, 22400
    v_mfma_f32_16x16x32_bf16 v[164:167], v[124:127], v[68:71], v[164:167]
    buffer_load_dwordx4 v2, s[44:47], s69 offen offset:128  lds
    s_add_u32 m0, s70, 23296
    v_mfma_f32_16x16x32_bf16 v[156:159], v[128:131], v[16:19], v[156:159]
    buffer_load_dwordx4 v2, s[44:47], s69 offen offset:256  lds
    s_add_u32 m0, s52, 9216
    v_mfma_f32_16x16x32_bf16 v[160:163], v[128:131], v[40:43], v[160:163]
    s_add_u32 s68, s54, 1179648
    buffer_load_dwordx4 v5, s[40:43], s68 offen  lds
    v_mfma_f32_16x16x32_bf16 v[164:167], v[128:131], v[72:75], v[164:167]
    v_cvt_pk_bf16_f32 v168, v144, v145
    v_mfma_f32_16x16x32_bf16 v[156:159], v[132:135], v[20:23], v[156:159]
    s_waitcnt vmcnt(22)
    v_cvt_pk_bf16_f32 v169, v146, v147
    v_mfma_f32_16x16x32_bf16 v[160:163], v[132:135], v[44:47], v[160:163]
    ds_read_b128 v[96:99], v3 offset:0
    v_accvgpr_write_b32 a36, v168
    v_mfma_f32_16x16x32_bf16 v[164:167], v[132:135], v[76:79], v[164:167]
    ds_read_b128 v[100:103], v4 offset:0
    v_accvgpr_write_b32 a37, v169
    v_mfma_f32_16x16x32_bf16 v[156:159], v[136:139], v[24:27], v[156:159]
    ds_read_b128 v[104:107], v3 offset:1024
    v_cvt_pk_bf16_f32 v170, v148, v149
    v_mfma_f32_16x16x32_bf16 v[160:163], v[136:139], v[48:51], v[160:163]
    ds_read_b128 v[108:111], v4 offset:1024
    v_cvt_pk_bf16_f32 v171, v150, v151
    v_mfma_f32_16x16x32_bf16 v[164:167], v[136:139], v[80:83], v[164:167]
    ds_read_b128 v[112:115], v3 offset:2048
    v_accvgpr_write_b32 a116, v170
    v_mfma_f32_16x16x32_bf16 v[156:159], v[140:143], v[28:31], v[156:159]
    ds_read_b128 v[116:119], v4 offset:2048
    v_accvgpr_write_b32 a117, v171
    v_mfma_f32_16x16x32_bf16 v[160:163], v[140:143], v[52:55], v[160:163]
    v_cvt_pk_bf16_f32 v172, v152, v153
    v_cvt_pk_bf16_f32 v173, v154, v155
    v_mfma_f32_16x16x32_bf16 v[164:167], v[140:143], v[84:87], v[164:167]
    v_accvgpr_write_b32 a196, v172
    v_accvgpr_write_b32 a197, v173
    s_waitcnt lgkmcnt(0)
    v_mfma_f32_16x16x32_bf16 v[144:147], v[96:99], v[8:11], 0
    s_add_u32 s69, s53, 4718592
    s_add_u32 m0, s70, 0
    v_mfma_f32_16x16x32_bf16 v[148:151], v[96:99], v[32:35], 0
    buffer_load_dwordx4 v1, s[44:47], s69 offen offset:0  lds
    s_add_u32 m0, s70, 896
    v_mfma_f32_16x16x32_bf16 v[152:155], v[96:99], v[64:67], 0
    buffer_load_dwordx4 v1, s[44:47], s69 offen offset:128  lds
    s_add_u32 m0, s70, 1792
    v_mfma_f32_16x16x32_bf16 v[144:147], v[100:103], v[12:15], v[144:147]
    buffer_load_dwordx4 v1, s[44:47], s69 offen offset:256  lds
    s_add_u32 m0, s70, 3072
    v_mfma_f32_16x16x32_bf16 v[148:151], v[100:103], v[36:39], v[148:151]
    buffer_load_dwordx4 v2, s[44:47], s69 offen offset:0  lds
    s_add_u32 m0, s70, 3968
    v_mfma_f32_16x16x32_bf16 v[152:155], v[100:103], v[68:71], v[152:155]
    buffer_load_dwordx4 v2, s[44:47], s69 offen offset:128  lds
    s_add_u32 m0, s70, 4864
    v_mfma_f32_16x16x32_bf16 v[144:147], v[104:107], v[16:19], v[144:147]
    buffer_load_dwordx4 v2, s[44:47], s69 offen offset:256  lds
    s_add_u32 m0, s52, 10240
    v_mfma_f32_16x16x32_bf16 v[148:151], v[104:107], v[40:43], v[148:151]
    s_add_u32 s68, s54, 1179648
    buffer_load_dwordx4 v6, s[40:43], s68 offen  lds
    v_mfma_f32_16x16x32_bf16 v[152:155], v[104:107], v[72:75], v[152:155]
    v_cvt_pk_bf16_f32 v168, v156, v157
    v_mfma_f32_16x16x32_bf16 v[144:147], v[108:111], v[20:23], v[144:147]
    s_waitcnt vmcnt(22)
    v_cvt_pk_bf16_f32 v169, v158, v159
    v_mfma_f32_16x16x32_bf16 v[148:151], v[108:111], v[44:47], v[148:151]
    ds_read_b128 v[120:123], v3 offset:6144
    v_accvgpr_write_b32 a38, v168
    v_mfma_f32_16x16x32_bf16 v[152:155], v[108:111], v[76:79], v[152:155]
    ds_read_b128 v[124:127], v4 offset:6144
    v_accvgpr_write_b32 a39, v169
    v_mfma_f32_16x16x32_bf16 v[144:147], v[112:115], v[24:27], v[144:147]
    ds_read_b128 v[128:131], v3 offset:7168
    v_cvt_pk_bf16_f32 v170, v160, v161
    v_mfma_f32_16x16x32_bf16 v[148:151], v[112:115], v[48:51], v[148:151]
    ds_read_b128 v[132:135], v4 offset:7168
    v_cvt_pk_bf16_f32 v171, v162, v163
    v_mfma_f32_16x16x32_bf16 v[152:155], v[112:115], v[80:83], v[152:155]
    ds_read_b128 v[136:139], v3 offset:8192
    v_accvgpr_write_b32 a118, v170
    v_mfma_f32_16x16x32_bf16 v[144:147], v[116:119], v[28:31], v[144:147]
    ds_read_b128 v[140:143], v4 offset:8192
    v_accvgpr_write_b32 a119, v171
    v_mfma_f32_16x16x32_bf16 v[148:151], v[116:119], v[52:55], v[148:151]
    v_cvt_pk_bf16_f32 v172, v164, v165
    v_cvt_pk_bf16_f32 v173, v166, v167
    v_mfma_f32_16x16x32_bf16 v[152:155], v[116:119], v[84:87], v[152:155]
    v_accvgpr_write_b32 a198, v172
    v_accvgpr_write_b32 a199, v173
    s_waitcnt lgkmcnt(0)
    v_mfma_f32_16x16x32_bf16 v[156:159], v[120:123], v[8:11], 0
    s_add_u32 s69, s53, 4743168
    s_add_u32 m0, s70, 6144
    v_mfma_f32_16x16x32_bf16 v[160:163], v[120:123], v[32:35], 0
    buffer_load_dwordx4 v1, s[44:47], s69 offen offset:0  lds
    s_add_u32 m0, s70, 7040
    v_mfma_f32_16x16x32_bf16 v[164:167], v[120:123], v[64:67], 0
    buffer_load_dwordx4 v1, s[44:47], s69 offen offset:128  lds
    s_add_u32 m0, s70, 7936
    v_mfma_f32_16x16x32_bf16 v[156:159], v[124:127], v[12:15], v[156:159]
    buffer_load_dwordx4 v1, s[44:47], s69 offen offset:256  lds
    s_add_u32 m0, s70, 9216
    v_mfma_f32_16x16x32_bf16 v[160:163], v[124:127], v[36:39], v[160:163]
    buffer_load_dwordx4 v2, s[44:47], s69 offen offset:0  lds
    s_add_u32 m0, s70, 10112
    v_mfma_f32_16x16x32_bf16 v[164:167], v[124:127], v[68:71], v[164:167]
    buffer_load_dwordx4 v2, s[44:47], s69 offen offset:128  lds
    s_add_u32 m0, s70, 11008
    v_mfma_f32_16x16x32_bf16 v[156:159], v[128:131], v[16:19], v[156:159]
    buffer_load_dwordx4 v2, s[44:47], s69 offen offset:256  lds
    s_add_u32 m0, s52, 11264
    v_mfma_f32_16x16x32_bf16 v[160:163], v[128:131], v[40:43], v[160:163]
    s_add_u32 s68, s54, 1179648
    buffer_load_dwordx4 v7, s[40:43], s68 offen  lds
    v_mfma_f32_16x16x32_bf16 v[164:167], v[128:131], v[72:75], v[164:167]
    v_cvt_pk_bf16_f32 v168, v144, v145
    v_mfma_f32_16x16x32_bf16 v[156:159], v[132:135], v[20:23], v[156:159]
    s_waitcnt vmcnt(22)
    v_cvt_pk_bf16_f32 v169, v146, v147
    v_mfma_f32_16x16x32_bf16 v[160:163], v[132:135], v[44:47], v[160:163]
    ds_read_b128 v[96:99], v3 offset:12288
    v_accvgpr_write_b32 a40, v168
    v_mfma_f32_16x16x32_bf16 v[164:167], v[132:135], v[76:79], v[164:167]
    ds_read_b128 v[100:103], v4 offset:12288
    v_accvgpr_write_b32 a41, v169
    v_mfma_f32_16x16x32_bf16 v[156:159], v[136:139], v[24:27], v[156:159]
    ds_read_b128 v[104:107], v3 offset:13312
    v_cvt_pk_bf16_f32 v170, v148, v149
    v_mfma_f32_16x16x32_bf16 v[160:163], v[136:139], v[48:51], v[160:163]
    ds_read_b128 v[108:111], v4 offset:13312
    v_cvt_pk_bf16_f32 v171, v150, v151
    v_mfma_f32_16x16x32_bf16 v[164:167], v[136:139], v[80:83], v[164:167]
    ds_read_b128 v[112:115], v3 offset:14336
    v_accvgpr_write_b32 a120, v170
    v_mfma_f32_16x16x32_bf16 v[156:159], v[140:143], v[28:31], v[156:159]
    ds_read_b128 v[116:119], v4 offset:14336
    v_accvgpr_write_b32 a121, v171
    v_mfma_f32_16x16x32_bf16 v[160:163], v[140:143], v[52:55], v[160:163]
    v_cvt_pk_bf16_f32 v172, v152, v153
    v_cvt_pk_bf16_f32 v173, v154, v155
    v_mfma_f32_16x16x32_bf16 v[164:167], v[140:143], v[84:87], v[164:167]
    v_accvgpr_write_b32 a200, v172
    v_accvgpr_write_b32 a201, v173
    s_waitcnt lgkmcnt(0)
    v_mfma_f32_16x16x32_bf16 v[144:147], v[96:99], v[8:11], 0
    s_add_u32 s69, s53, 5111808
    s_add_u32 m0, s70, 12288
    v_mfma_f32_16x16x32_bf16 v[148:151], v[96:99], v[32:35], 0
    buffer_load_dwordx4 v1, s[44:47], s69 offen offset:0  lds
    s_add_u32 m0, s70, 13184
    v_mfma_f32_16x16x32_bf16 v[152:155], v[96:99], v[64:67], 0
    buffer_load_dwordx4 v1, s[44:47], s69 offen offset:128  lds
    s_add_u32 m0, s70, 14080
    v_mfma_f32_16x16x32_bf16 v[144:147], v[100:103], v[12:15], v[144:147]
    buffer_load_dwordx4 v1, s[44:47], s69 offen offset:256  lds
    s_add_u32 m0, s70, 15360
    v_mfma_f32_16x16x32_bf16 v[148:151], v[100:103], v[36:39], v[148:151]
    buffer_load_dwordx4 v2, s[44:47], s69 offen offset:0  lds
    s_add_u32 m0, s70, 16256
    v_mfma_f32_16x16x32_bf16 v[152:155], v[100:103], v[68:71], v[152:155]
    buffer_load_dwordx4 v2, s[44:47], s69 offen offset:128  lds
    s_add_u32 m0, s70, 17152
    v_mfma_f32_16x16x32_bf16 v[144:147], v[104:107], v[16:19], v[144:147]
    buffer_load_dwordx4 v2, s[44:47], s69 offen offset:256  lds
    s_add_u32 m0, s52, 12288
    v_mfma_f32_16x16x32_bf16 v[148:151], v[104:107], v[40:43], v[148:151]
    s_add_u32 s68, s54, 1572864
    buffer_load_dwordx4 v5, s[40:43], s68 offen  lds
    v_mfma_f32_16x16x32_bf16 v[152:155], v[104:107], v[72:75], v[152:155]
    v_cvt_pk_bf16_f32 v168, v156, v157
    v_mfma_f32_16x16x32_bf16 v[144:147], v[108:111], v[20:23], v[144:147]
    s_waitcnt vmcnt(22)
    v_cvt_pk_bf16_f32 v169, v158, v159
    v_mfma_f32_16x16x32_bf16 v[148:151], v[108:111], v[44:47], v[148:151]
    ds_read_b128 v[120:123], v3 offset:18432
    v_accvgpr_write_b32 a42, v168
    v_mfma_f32_16x16x32_bf16 v[152:155], v[108:111], v[76:79], v[152:155]
    ds_read_b128 v[124:127], v4 offset:18432
    v_accvgpr_write_b32 a43, v169
    v_mfma_f32_16x16x32_bf16 v[144:147], v[112:115], v[24:27], v[144:147]
    ds_read_b128 v[128:131], v3 offset:19456
    v_cvt_pk_bf16_f32 v170, v160, v161
    v_mfma_f32_16x16x32_bf16 v[148:151], v[112:115], v[48:51], v[148:151]
    ds_read_b128 v[132:135], v4 offset:19456
    v_cvt_pk_bf16_f32 v171, v162, v163
    v_mfma_f32_16x16x32_bf16 v[152:155], v[112:115], v[80:83], v[152:155]
    ds_read_b128 v[136:139], v3 offset:20480
    v_accvgpr_write_b32 a122, v170
    v_mfma_f32_16x16x32_bf16 v[144:147], v[116:119], v[28:31], v[144:147]
    ds_read_b128 v[140:143], v4 offset:20480
    v_accvgpr_write_b32 a123, v171
    v_mfma_f32_16x16x32_bf16 v[148:151], v[116:119], v[52:55], v[148:151]
    v_cvt_pk_bf16_f32 v172, v164, v165
    v_cvt_pk_bf16_f32 v173, v166, v167
    v_mfma_f32_16x16x32_bf16 v[152:155], v[116:119], v[84:87], v[152:155]
    v_accvgpr_write_b32 a202, v172
    v_accvgpr_write_b32 a203, v173
    s_waitcnt lgkmcnt(0)
    v_mfma_f32_16x16x32_bf16 v[156:159], v[120:123], v[8:11], 0
    s_add_u32 s69, s53, 5136384
    s_add_u32 m0, s70, 18432
    v_mfma_f32_16x16x32_bf16 v[160:163], v[120:123], v[32:35], 0
    buffer_load_dwordx4 v1, s[44:47], s69 offen offset:0  lds
    s_add_u32 m0, s70, 19328
    v_mfma_f32_16x16x32_bf16 v[164:167], v[120:123], v[64:67], 0
    buffer_load_dwordx4 v1, s[44:47], s69 offen offset:128  lds
    s_add_u32 m0, s70, 20224
    v_mfma_f32_16x16x32_bf16 v[156:159], v[124:127], v[12:15], v[156:159]
    buffer_load_dwordx4 v1, s[44:47], s69 offen offset:256  lds
    s_add_u32 m0, s70, 21504
    v_mfma_f32_16x16x32_bf16 v[160:163], v[124:127], v[36:39], v[160:163]
    buffer_load_dwordx4 v2, s[44:47], s69 offen offset:0  lds
    s_add_u32 m0, s70, 22400
    v_mfma_f32_16x16x32_bf16 v[164:167], v[124:127], v[68:71], v[164:167]
    buffer_load_dwordx4 v2, s[44:47], s69 offen offset:128  lds
    s_add_u32 m0, s70, 23296
    v_mfma_f32_16x16x32_bf16 v[156:159], v[128:131], v[16:19], v[156:159]
    buffer_load_dwordx4 v2, s[44:47], s69 offen offset:256  lds
    s_add_u32 m0, s52, 13312
    v_mfma_f32_16x16x32_bf16 v[160:163], v[128:131], v[40:43], v[160:163]
    s_add_u32 s68, s54, 1572864
    buffer_load_dwordx4 v6, s[40:43], s68 offen  lds
    v_mfma_f32_16x16x32_bf16 v[164:167], v[128:131], v[72:75], v[164:167]
    v_cvt_pk_bf16_f32 v168, v144, v145
    v_mfma_f32_16x16x32_bf16 v[156:159], v[132:135], v[20:23], v[156:159]
    s_waitcnt vmcnt(22)
    v_cvt_pk_bf16_f32 v169, v146, v147
    v_mfma_f32_16x16x32_bf16 v[160:163], v[132:135], v[44:47], v[160:163]
    ds_read_b128 v[96:99], v3 offset:0
    v_accvgpr_write_b32 a44, v168
    v_mfma_f32_16x16x32_bf16 v[164:167], v[132:135], v[76:79], v[164:167]
    ds_read_b128 v[100:103], v4 offset:0
    v_accvgpr_write_b32 a45, v169
    v_mfma_f32_16x16x32_bf16 v[156:159], v[136:139], v[24:27], v[156:159]
    ds_read_b128 v[104:107], v3 offset:1024
    v_cvt_pk_bf16_f32 v170, v148, v149
    v_mfma_f32_16x16x32_bf16 v[160:163], v[136:139], v[48:51], v[160:163]
    ds_read_b128 v[108:111], v4 offset:1024
    v_cvt_pk_bf16_f32 v171, v150, v151
    v_mfma_f32_16x16x32_bf16 v[164:167], v[136:139], v[80:83], v[164:167]
    ds_read_b128 v[112:115], v3 offset:2048
    v_accvgpr_write_b32 a124, v170
    v_mfma_f32_16x16x32_bf16 v[156:159], v[140:143], v[28:31], v[156:159]
    ds_read_b128 v[116:119], v4 offset:2048
    v_accvgpr_write_b32 a125, v171
    v_mfma_f32_16x16x32_bf16 v[160:163], v[140:143], v[52:55], v[160:163]
    v_cvt_pk_bf16_f32 v172, v152, v153
    v_cvt_pk_bf16_f32 v173, v154, v155
    v_mfma_f32_16x16x32_bf16 v[164:167], v[140:143], v[84:87], v[164:167]
    v_accvgpr_write_b32 a204, v172
    v_accvgpr_write_b32 a205, v173
    s_waitcnt lgkmcnt(0)
    v_mfma_f32_16x16x32_bf16 v[144:147], v[96:99], v[8:11], 0
    s_add_u32 s69, s53, 5505024
    s_add_u32 m0, s70, 0
    v_mfma_f32_16x16x32_bf16 v[148:151], v[96:99], v[32:35], 0
    buffer_load_dwordx4 v1, s[44:47], s69 offen offset:0  lds
    s_add_u32 m0, s70, 896
    v_mfma_f32_16x16x32_bf16 v[152:155], v[96:99], v[64:67], 0
    buffer_load_dwordx4 v1, s[44:47], s69 offen offset:128  lds
    s_add_u32 m0, s70, 1792
    v_mfma_f32_16x16x32_bf16 v[144:147], v[100:103], v[12:15], v[144:147]
    buffer_load_dwordx4 v1, s[44:47], s69 offen offset:256  lds
    s_add_u32 m0, s70, 3072
    v_mfma_f32_16x16x32_bf16 v[148:151], v[100:103], v[36:39], v[148:151]
    buffer_load_dwordx4 v2, s[44:47], s69 offen offset:0  lds
    s_add_u32 m0, s70, 3968
    v_mfma_f32_16x16x32_bf16 v[152:155], v[100:103], v[68:71], v[152:155]
    buffer_load_dwordx4 v2, s[44:47], s69 offen offset:128  lds
    s_add_u32 m0, s70, 4864
    v_mfma_f32_16x16x32_bf16 v[144:147], v[104:107], v[16:19], v[144:147]
    buffer_load_dwordx4 v2, s[44:47], s69 offen offset:256  lds
    s_add_u32 m0, s52, 14336
    v_mfma_f32_16x16x32_bf16 v[148:151], v[104:107], v[40:43], v[148:151]
    s_add_u32 s68, s54, 1572864
    buffer_load_dwordx4 v7, s[40:43], s68 offen  lds
    v_mfma_f32_16x16x32_bf16 v[152:155], v[104:107], v[72:75], v[152:155]
    v_cvt_pk_bf16_f32 v168, v156, v157
    v_mfma_f32_16x16x32_bf16 v[144:147], v[108:111], v[20:23], v[144:147]
    s_waitcnt vmcnt(22)
    v_cvt_pk_bf16_f32 v169, v158, v159
    v_mfma_f32_16x16x32_bf16 v[148:151], v[108:111], v[44:47], v[148:151]
    ds_read_b128 v[120:123], v3 offset:6144
    v_accvgpr_write_b32 a46, v168
    v_mfma_f32_16x16x32_bf16 v[152:155], v[108:111], v[76:79], v[152:155]
    ds_read_b128 v[124:127], v4 offset:6144
    v_accvgpr_write_b32 a47, v169
    v_mfma_f32_16x16x32_bf16 v[144:147], v[112:115], v[24:27], v[144:147]
    ds_read_b128 v[128:131], v3 offset:7168
    v_cvt_pk_bf16_f32 v170, v160, v161
    v_mfma_f32_16x16x32_bf16 v[148:151], v[112:115], v[48:51], v[148:151]
    ds_read_b128 v[132:135], v4 offset:7168
    v_cvt_pk_bf16_f32 v171, v162, v163
    v_mfma_f32_16x16x32_bf16 v[152:155], v[112:115], v[80:83], v[152:155]
    ds_read_b128 v[136:139], v3 offset:8192
    v_accvgpr_write_b32 a126, v170
    v_mfma_f32_16x16x32_bf16 v[144:147], v[116:119], v[28:31], v[144:147]
    ds_read_b128 v[140:143], v4 offset:8192
    v_accvgpr_write_b32 a127, v171
    v_mfma_f32_16x16x32_bf16 v[148:151], v[116:119], v[52:55], v[148:151]
    v_cvt_pk_bf16_f32 v172, v164, v165
    v_cvt_pk_bf16_f32 v173, v166, v167
    v_mfma_f32_16x16x32_bf16 v[152:155], v[116:119], v[84:87], v[152:155]
    v_accvgpr_write_b32 a206, v172
    v_accvgpr_write_b32 a207, v173
    s_waitcnt lgkmcnt(0)
    v_mfma_f32_16x16x32_bf16 v[156:159], v[120:123], v[8:11], 0
    s_add_u32 s69, s53, 5529600
    s_add_u32 m0, s70, 6144
    v_mfma_f32_16x16x32_bf16 v[160:163], v[120:123], v[32:35], 0
    buffer_load_dwordx4 v1, s[44:47], s69 offen offset:0  lds
    s_add_u32 m0, s70, 7040
    v_mfma_f32_16x16x32_bf16 v[164:167], v[120:123], v[64:67], 0
    buffer_load_dwordx4 v1, s[44:47], s69 offen offset:128  lds
    s_add_u32 m0, s70, 7936
    v_mfma_f32_16x16x32_bf16 v[156:159], v[124:127], v[12:15], v[156:159]
    buffer_load_dwordx4 v1, s[44:47], s69 offen offset:256  lds
    s_add_u32 m0, s70, 9216
    v_mfma_f32_16x16x32_bf16 v[160:163], v[124:127], v[36:39], v[160:163]
    buffer_load_dwordx4 v2, s[44:47], s69 offen offset:0  lds
    s_add_u32 m0, s70, 10112
    v_mfma_f32_16x16x32_bf16 v[164:167], v[124:127], v[68:71], v[164:167]
    buffer_load_dwordx4 v2, s[44:47], s69 offen offset:128  lds
    s_add_u32 m0, s70, 11008
    v_mfma_f32_16x16x32_bf16 v[156:159], v[128:131], v[16:19], v[156:159]
    buffer_load_dwordx4 v2, s[44:47], s69 offen offset:256  lds
    v_mfma_f32_16x16x32_bf16 v[160:163], v[128:131], v[40:43], v[160:163]
    v_mfma_f32_16x16x32_bf16 v[164:167], v[128:131], v[72:75], v[164:167]
    v_cvt_pk_bf16_f32 v168, v144, v145
    v_mfma_f32_16x16x32_bf16 v[156:159], v[132:135], v[20:23], v[156:159]
    s_waitcnt vmcnt(21)
    v_cvt_pk_bf16_f32 v169, v146, v147
    v_mfma_f32_16x16x32_bf16 v[160:163], v[132:135], v[44:47], v[160:163]
    ds_read_b128 v[96:99], v3 offset:12288
    v_accvgpr_write_b32 a48, v168
    v_mfma_f32_16x16x32_bf16 v[164:167], v[132:135], v[76:79], v[164:167]
    ds_read_b128 v[100:103], v4 offset:12288
    v_accvgpr_write_b32 a49, v169
    v_mfma_f32_16x16x32_bf16 v[156:159], v[136:139], v[24:27], v[156:159]
    ds_read_b128 v[104:107], v3 offset:13312
    v_cvt_pk_bf16_f32 v170, v148, v149
    v_mfma_f32_16x16x32_bf16 v[160:163], v[136:139], v[48:51], v[160:163]
    ds_read_b128 v[108:111], v4 offset:13312
    v_cvt_pk_bf16_f32 v171, v150, v151
    v_mfma_f32_16x16x32_bf16 v[164:167], v[136:139], v[80:83], v[164:167]
    ds_read_b128 v[112:115], v3 offset:14336
    v_accvgpr_write_b32 a128, v170
    v_mfma_f32_16x16x32_bf16 v[156:159], v[140:143], v[28:31], v[156:159]
    ds_read_b128 v[116:119], v4 offset:14336
    v_accvgpr_write_b32 a129, v171
    v_mfma_f32_16x16x32_bf16 v[160:163], v[140:143], v[52:55], v[160:163]
    v_cvt_pk_bf16_f32 v172, v152, v153
    v_cvt_pk_bf16_f32 v173, v154, v155
    v_mfma_f32_16x16x32_bf16 v[164:167], v[140:143], v[84:87], v[164:167]
    v_accvgpr_write_b32 a208, v172
    v_accvgpr_write_b32 a209, v173
    s_waitcnt lgkmcnt(0)
    v_mfma_f32_16x16x32_bf16 v[144:147], v[96:99], v[8:11], 0
    s_add_u32 s69, s53, 5898240
    s_add_u32 m0, s70, 12288
    v_mfma_f32_16x16x32_bf16 v[148:151], v[96:99], v[32:35], 0
    buffer_load_dwordx4 v1, s[44:47], s69 offen offset:0  lds
    s_add_u32 m0, s70, 13184
    v_mfma_f32_16x16x32_bf16 v[152:155], v[96:99], v[64:67], 0
    buffer_load_dwordx4 v1, s[44:47], s69 offen offset:128  lds
    s_add_u32 m0, s70, 14080
    v_mfma_f32_16x16x32_bf16 v[144:147], v[100:103], v[12:15], v[144:147]
    buffer_load_dwordx4 v1, s[44:47], s69 offen offset:256  lds
    s_add_u32 m0, s70, 15360
    v_mfma_f32_16x16x32_bf16 v[148:151], v[100:103], v[36:39], v[148:151]
    buffer_load_dwordx4 v2, s[44:47], s69 offen offset:0  lds
    s_add_u32 m0, s70, 16256
    v_mfma_f32_16x16x32_bf16 v[152:155], v[100:103], v[68:71], v[152:155]
    buffer_load_dwordx4 v2, s[44:47], s69 offen offset:128  lds
    s_add_u32 m0, s70, 17152
    v_mfma_f32_16x16x32_bf16 v[144:147], v[104:107], v[16:19], v[144:147]
    buffer_load_dwordx4 v2, s[44:47], s69 offen offset:256  lds
    v_mfma_f32_16x16x32_bf16 v[148:151], v[104:107], v[40:43], v[148:151]
    v_mfma_f32_16x16x32_bf16 v[152:155], v[104:107], v[72:75], v[152:155]
    v_cvt_pk_bf16_f32 v168, v156, v157
    v_mfma_f32_16x16x32_bf16 v[144:147], v[108:111], v[20:23], v[144:147]
    s_waitcnt vmcnt(20)
    v_cvt_pk_bf16_f32 v169, v158, v159
    v_mfma_f32_16x16x32_bf16 v[148:151], v[108:111], v[44:47], v[148:151]
    ds_read_b128 v[120:123], v3 offset:18432
    v_accvgpr_write_b32 a50, v168
    v_mfma_f32_16x16x32_bf16 v[152:155], v[108:111], v[76:79], v[152:155]
    ds_read_b128 v[124:127], v4 offset:18432
    v_accvgpr_write_b32 a51, v169
    v_mfma_f32_16x16x32_bf16 v[144:147], v[112:115], v[24:27], v[144:147]
    ds_read_b128 v[128:131], v3 offset:19456
    v_cvt_pk_bf16_f32 v170, v160, v161
    v_mfma_f32_16x16x32_bf16 v[148:151], v[112:115], v[48:51], v[148:151]
    ds_read_b128 v[132:135], v4 offset:19456
    v_cvt_pk_bf16_f32 v171, v162, v163
    v_mfma_f32_16x16x32_bf16 v[152:155], v[112:115], v[80:83], v[152:155]
    ds_read_b128 v[136:139], v3 offset:20480
    v_accvgpr_write_b32 a130, v170
    v_mfma_f32_16x16x32_bf16 v[144:147], v[116:119], v[28:31], v[144:147]
    ds_read_b128 v[140:143], v4 offset:20480
    v_accvgpr_write_b32 a131, v171
    v_mfma_f32_16x16x32_bf16 v[148:151], v[116:119], v[52:55], v[148:151]
    v_cvt_pk_bf16_f32 v172, v164, v165
    v_cvt_pk_bf16_f32 v173, v166, v167
    v_mfma_f32_16x16x32_bf16 v[152:155], v[116:119], v[84:87], v[152:155]
    v_accvgpr_write_b32 a210, v172
    v_accvgpr_write_b32 a211, v173
    s_waitcnt lgkmcnt(0)
    v_mfma_f32_16x16x32_bf16 v[156:159], v[120:123], v[8:11], 0
    s_add_u32 s69, s53, 5922816
    s_add_u32 m0, s70, 18432
    v_mfma_f32_16x16x32_bf16 v[160:163], v[120:123], v[32:35], 0
    buffer_load_dwordx4 v1, s[44:47], s69 offen offset:0  lds
    s_add_u32 m0, s70, 19328
    v_mfma_f32_16x16x32_bf16 v[164:167], v[120:123], v[64:67], 0
    buffer_load_dwordx4 v1, s[44:47], s69 offen offset:128  lds
    s_add_u32 m0, s70, 20224
    v_mfma_f32_16x16x32_bf16 v[156:159], v[124:127], v[12:15], v[156:159]
    buffer_load_dwordx4 v1, s[44:47], s69 offen offset:256  lds
    s_add_u32 m0, s70, 21504
    v_mfma_f32_16x16x32_bf16 v[160:163], v[124:127], v[36:39], v[160:163]
    buffer_load_dwordx4 v2, s[44:47], s69 offen offset:0  lds
    s_add_u32 m0, s70, 22400
    v_mfma_f32_16x16x32_bf16 v[164:167], v[124:127], v[68:71], v[164:167]
    buffer_load_dwordx4 v2, s[44:47], s69 offen offset:128  lds
    s_add_u32 m0, s70, 23296
    v_mfma_f32_16x16x32_bf16 v[156:159], v[128:131], v[16:19], v[156:159]
    buffer_load_dwordx4 v2, s[44:47], s69 offen offset:256  lds
    v_mfma_f32_16x16x32_bf16 v[160:163], v[128:131], v[40:43], v[160:163]
    v_mfma_f32_16x16x32_bf16 v[164:167], v[128:131], v[72:75], v[164:167]
    v_cvt_pk_bf16_f32 v168, v144, v145
    v_mfma_f32_16x16x32_bf16 v[156:159], v[132:135], v[20:23], v[156:159]
    s_waitcnt vmcnt(19)
    v_cvt_pk_bf16_f32 v169, v146, v147
    v_mfma_f32_16x16x32_bf16 v[160:163], v[132:135], v[44:47], v[160:163]
    ds_read_b128 v[96:99], v3 offset:0
    v_accvgpr_write_b32 a52, v168
    v_mfma_f32_16x16x32_bf16 v[164:167], v[132:135], v[76:79], v[164:167]
    ds_read_b128 v[100:103], v4 offset:0
    v_accvgpr_write_b32 a53, v169
    v_mfma_f32_16x16x32_bf16 v[156:159], v[136:139], v[24:27], v[156:159]
    ds_read_b128 v[104:107], v3 offset:1024
    v_cvt_pk_bf16_f32 v170, v148, v149
    v_mfma_f32_16x16x32_bf16 v[160:163], v[136:139], v[48:51], v[160:163]
    ds_read_b128 v[108:111], v4 offset:1024
    v_cvt_pk_bf16_f32 v171, v150, v151
    v_mfma_f32_16x16x32_bf16 v[164:167], v[136:139], v[80:83], v[164:167]
    ds_read_b128 v[112:115], v3 offset:2048
    v_accvgpr_write_b32 a132, v170
    v_mfma_f32_16x16x32_bf16 v[156:159], v[140:143], v[28:31], v[156:159]
    ds_read_b128 v[116:119], v4 offset:2048
    v_accvgpr_write_b32 a133, v171
    v_mfma_f32_16x16x32_bf16 v[160:163], v[140:143], v[52:55], v[160:163]
    v_cvt_pk_bf16_f32 v172, v152, v153
    v_cvt_pk_bf16_f32 v173, v154, v155
    v_mfma_f32_16x16x32_bf16 v[164:167], v[140:143], v[84:87], v[164:167]
    v_accvgpr_write_b32 a212, v172
    v_accvgpr_write_b32 a213, v173
    s_waitcnt lgkmcnt(0)
    s_waitcnt vmcnt(18)
    s_barrier
    v_mfma_f32_16x16x32_bf16 v[144:147], v[96:99], v[8:11], 0
    s_add_u32 s69, s53, 6291456
    s_add_u32 m0, s70, 0
    ds_read_b64_tr_b16 v[176:177], v88 offset:0
    ds_read_b64_tr_b16 v[178:179], v88 offset:192
    v_mfma_f32_16x16x32_bf16 v[148:151], v[96:99], v[32:35], 0
    buffer_load_dwordx4 v1, s[44:47], s69 offen offset:0  lds
    s_add_u32 m0, s70, 896
    ds_read_b64_tr_b16 v[180:181], v88 offset:3072
    ds_read_b64_tr_b16 v[182:183], v88 offset:3264
    v_mfma_f32_16x16x32_bf16 v[152:155], v[96:99], v[64:67], 0
    buffer_load_dwordx4 v1, s[44:47], s69 offen offset:128  lds
    s_add_u32 m0, s70, 1792
    ds_read_b64_tr_b16 v[184:185], v88 offset:6144
    ds_read_b64_tr_b16 v[186:187], v88 offset:6336
    v_mfma_f32_16x16x32_bf16 v[144:147], v[100:103], v[12:15], v[144:147]
    buffer_load_dwordx4 v1, s[44:47], s69 offen offset:256  lds
    s_add_u32 m0, s70, 3072
    ds_read_b64_tr_b16 v[188:189], v88 offset:9216
    ds_read_b64_tr_b16 v[190:191], v88 offset:9408
    v_mfma_f32_16x16x32_bf16 v[148:151], v[100:103], v[36:39], v[148:151]
    buffer_load_dwordx4 v2, s[44:47], s69 offen offset:0  lds
    s_add_u32 m0, s70, 3968
    ds_read_b64_tr_b16 v[192:193], v88 offset:12288
    ds_read_b64_tr_b16 v[194:195], v88 offset:12480
    v_mfma_f32_16x16x32_bf16 v[152:155], v[100:103], v[68:71], v[152:155]
    buffer_load_dwordx4 v2, s[44:47], s69 offen offset:128  lds
    s_add_u32 m0, s70, 4864
    ds_read_b64_tr_b16 v[196:197], v88 offset:15360
    ds_read_b64_tr_b16 v[198:199], v88 offset:15552
    v_mfma_f32_16x16x32_bf16 v[144:147], v[104:107], v[16:19], v[144:147]
    buffer_load_dwordx4 v2, s[44:47], s69 offen offset:256  lds
    ds_read_b64_tr_b16 v[200:201], v88 offset:18432
    ds_read_b64_tr_b16 v[202:203], v88 offset:18624
    v_mfma_f32_16x16x32_bf16 v[148:151], v[104:107], v[40:43], v[148:151]
    v_mfma_f32_16x16x32_bf16 v[152:155], v[104:107], v[72:75], v[152:155]
    v_cvt_pk_bf16_f32 v168, v156, v157
    v_mfma_f32_16x16x32_bf16 v[144:147], v[108:111], v[20:23], v[144:147]
    s_waitcnt vmcnt(18) lgkmcnt(6)
    v_cvt_pk_bf16_f32 v169, v158, v159
    v_mfma_f32_16x16x32_bf16 v[148:151], v[108:111], v[44:47], v[148:151]
    ds_read_b128 v[120:123], v3 offset:6144
    v_accvgpr_write_b32 a54, v168
    v_mfma_f32_16x16x32_bf16 v[152:155], v[108:111], v[76:79], v[152:155]
    ds_read_b128 v[124:127], v4 offset:6144
    v_accvgpr_write_b32 a55, v169
    v_mfma_f32_16x16x32_bf16 v[144:147], v[112:115], v[24:27], v[144:147]
    ds_read_b128 v[128:131], v3 offset:7168
    v_cvt_pk_bf16_f32 v170, v160, v161
    v_mfma_f32_16x16x32_bf16 v[148:151], v[112:115], v[48:51], v[148:151]
    ds_read_b128 v[132:135], v4 offset:7168
    v_cvt_pk_bf16_f32 v171, v162, v163
    v_mfma_f32_16x16x32_bf16 v[152:155], v[112:115], v[80:83], v[152:155]
    ds_read_b128 v[136:139], v3 offset:8192
    v_accvgpr_write_b32 a134, v170
    v_mfma_f32_16x16x32_bf16 v[144:147], v[116:119], v[28:31], v[144:147]
    ds_read_b128 v[140:143], v4 offset:8192
    v_accvgpr_write_b32 a135, v171
    v_mfma_f32_16x16x32_bf16 v[148:151], v[116:119], v[52:55], v[148:151]
    v_cvt_pk_bf16_f32 v172, v164, v165
    v_cvt_pk_bf16_f32 v173, v166, v167
    v_mfma_f32_16x16x32_bf16 v[152:155], v[116:119], v[84:87], v[152:155]
    v_accvgpr_write_b32 a214, v172
    v_accvgpr_write_b32 a215, v173
    s_waitcnt lgkmcnt(0)
    v_mfma_f32_16x16x32_bf16 v[156:159], v[120:123], v[8:11], 0
    s_add_u32 s69, s53, 6316032
    s_add_u32 m0, s70, 6144
    ds_read_b64_tr_b16 v[204:205], v88 offset:21504
    ds_read_b64_tr_b16 v[206:207], v88 offset:21696
    v_mfma_f32_16x16x32_bf16 v[160:163], v[120:123], v[32:35], 0
    buffer_load_dwordx4 v1, s[44:47], s69 offen offset:0  lds
    s_add_u32 m0, s70, 7040
    ds_read_b64_tr_b16 v[208:209], v88 offset:24576
    ds_read_b64_tr_b16 v[210:211], v88 offset:24768
    v_mfma_f32_16x16x32_bf16 v[164:167], v[120:123], v[64:67], 0
    buffer_load_dwordx4 v1, s[44:47], s69 offen offset:128  lds
    s_add_u32 m0, s70, 7936
    ds_read_b64_tr_b16 v[212:213], v88 offset:27648
    ds_read_b64_tr_b16 v[214:215], v88 offset:27840
    v_mfma_f32_16x16x32_bf16 v[156:159], v[124:127], v[12:15], v[156:159]
    buffer_load_dwordx4 v1, s[44:47], s69 offen offset:256  lds
    s_add_u32 m0, s70, 9216
    ds_read_b64_tr_b16 v[216:217], v88 offset:30720
    ds_read_b64_tr_b16 v[218:219], v88 offset:30912
    v_mfma_f32_16x16x32_bf16 v[160:163], v[124:127], v[36:39], v[160:163]
    buffer_load_dwordx4 v2, s[44:47], s69 offen offset:0  lds
    s_add_u32 m0, s70, 10112
    ds_read_b64_tr_b16 v[220:221], v88 offset:33792
    ds_read_b64_tr_b16 v[222:223], v88 offset:33984
    v_mfma_f32_16x16x32_bf16 v[164:167], v[124:127], v[68:71], v[164:167]
    buffer_load_dwordx4 v2, s[44:47], s69 offen offset:128  lds
    s_add_u32 m0, s70, 11008
    ds_read_b64_tr_b16 v[224:225], v88 offset:36864
    ds_read_b64_tr_b16 v[226:227], v88 offset:37056
    v_mfma_f32_16x16x32_bf16 v[156:159], v[128:131], v[16:19], v[156:159]
    buffer_load_dwordx4 v2, s[44:47], s69 offen offset:256  lds
    ds_read_b64_tr_b16 v[228:229], v88 offset:39936
    ds_read_b64_tr_b16 v[230:231], v88 offset:40128
    v_mfma_f32_16x16x32_bf16 v[160:163], v[128:131], v[40:43], v[160:163]
    v_mfma_f32_16x16x32_bf16 v[164:167], v[128:131], v[72:75], v[164:167]
    v_cvt_pk_bf16_f32 v168, v144, v145
    v_mfma_f32_16x16x32_bf16 v[156:159], v[132:135], v[20:23], v[156:159]
    s_waitcnt vmcnt(18) lgkmcnt(6)
    v_cvt_pk_bf16_f32 v169, v146, v147
    v_mfma_f32_16x16x32_bf16 v[160:163], v[132:135], v[44:47], v[160:163]
    ds_read_b128 v[96:99], v3 offset:12288
    v_accvgpr_write_b32 a56, v168
    v_mfma_f32_16x16x32_bf16 v[164:167], v[132:135], v[76:79], v[164:167]
    ds_read_b128 v[100:103], v4 offset:12288
    v_accvgpr_write_b32 a57, v169
    v_mfma_f32_16x16x32_bf16 v[156:159], v[136:139], v[24:27], v[156:159]
    ds_read_b128 v[104:107], v3 offset:13312
    v_cvt_pk_bf16_f32 v170, v148, v149
    v_mfma_f32_16x16x32_bf16 v[160:163], v[136:139], v[48:51], v[160:163]
    ds_read_b128 v[108:111], v4 offset:13312
    v_cvt_pk_bf16_f32 v171, v150, v151
    v_mfma_f32_16x16x32_bf16 v[164:167], v[136:139], v[80:83], v[164:167]
    ds_read_b128 v[112:115], v3 offset:14336
    v_accvgpr_write_b32 a136, v170
    v_mfma_f32_16x16x32_bf16 v[156:159], v[140:143], v[28:31], v[156:159]
    ds_read_b128 v[116:119], v4 offset:14336
    v_accvgpr_write_b32 a137, v171
    v_mfma_f32_16x16x32_bf16 v[160:163], v[140:143], v[52:55], v[160:163]
    v_cvt_pk_bf16_f32 v172, v152, v153
    v_cvt_pk_bf16_f32 v173, v154, v155
    v_mfma_f32_16x16x32_bf16 v[164:167], v[140:143], v[84:87], v[164:167]
    v_accvgpr_write_b32 a216, v172
    v_accvgpr_write_b32 a217, v173
    s_waitcnt lgkmcnt(0)
    v_mfma_f32_16x16x32_bf16 v[144:147], v[96:99], v[8:11], 0
    s_add_u32 s69, s53, 6684672
    s_add_u32 m0, s70, 12288
    ds_read_b64_tr_b16 v[232:233], v88 offset:43008
    ds_read_b64_tr_b16 v[234:235], v88 offset:43200
    v_mfma_f32_16x16x32_bf16 v[148:151], v[96:99], v[32:35], 0
    buffer_load_dwordx4 v1, s[44:47], s69 offen offset:0  lds
    s_add_u32 m0, s70, 13184
    ds_read_b64_tr_b16 v[236:237], v88 offset:46080
    ds_read_b64_tr_b16 v[238:239], v88 offset:46272
    v_mfma_f32_16x16x32_bf16 v[152:155], v[96:99], v[64:67], 0
    buffer_load_dwordx4 v1, s[44:47], s69 offen offset:128  lds
    s_add_u32 m0, s70, 14080
    ds_read_b64_tr_b16 v[240:241], v88 offset:49152
    ds_read_b64_tr_b16 v[242:243], v88 offset:49344
    v_mfma_f32_16x16x32_bf16 v[144:147], v[100:103], v[12:15], v[144:147]
    buffer_load_dwordx4 v1, s[44:47], s69 offen offset:256  lds
    s_add_u32 m0, s70, 15360
    ds_read_b64_tr_b16 v[244:245], v88 offset:52224
    ds_read_b64_tr_b16 v[246:247], v88 offset:52416
    v_mfma_f32_16x16x32_bf16 v[148:151], v[100:103], v[36:39], v[148:151]
    buffer_load_dwordx4 v2, s[44:47], s69 offen offset:0  lds
    s_add_u32 m0, s70, 16256
    ds_read_b64_tr_b16 v[248:249], v88 offset:55296
    ds_read_b64_tr_b16 v[250:251], v88 offset:55488
    v_mfma_f32_16x16x32_bf16 v[152:155], v[100:103], v[68:71], v[152:155]
    buffer_load_dwordx4 v2, s[44:47], s69 offen offset:128  lds
    s_add_u32 m0, s70, 17152
    ds_read_b64_tr_b16 v[252:253], v88 offset:58368
    ds_read_b64_tr_b16 v[254:255], v88 offset:58560
    v_mfma_f32_16x16x32_bf16 v[144:147], v[104:107], v[16:19], v[144:147]
    buffer_load_dwordx4 v2, s[44:47], s69 offen offset:256  lds
    v_mfma_f32_16x16x32_bf16 v[148:151], v[104:107], v[40:43], v[148:151]
    v_mfma_f32_16x16x32_bf16 v[152:155], v[104:107], v[72:75], v[152:155]
    v_cvt_pk_bf16_f32 v168, v156, v157
    v_mfma_f32_16x16x32_bf16 v[144:147], v[108:111], v[20:23], v[144:147]
    s_waitcnt vmcnt(18) lgkmcnt(6)
    v_cvt_pk_bf16_f32 v169, v158, v159
    v_mfma_f32_16x16x32_bf16 v[148:151], v[108:111], v[44:47], v[148:151]
    ds_read_b128 v[120:123], v3 offset:18432
    v_accvgpr_write_b32 a58, v168
    v_mfma_f32_16x16x32_bf16 v[152:155], v[108:111], v[76:79], v[152:155]
    ds_read_b128 v[124:127], v4 offset:18432
    v_accvgpr_write_b32 a59, v169
    v_mfma_f32_16x16x32_bf16 v[144:147], v[112:115], v[24:27], v[144:147]
    ds_read_b128 v[128:131], v3 offset:19456
    v_cvt_pk_bf16_f32 v170, v160, v161
    v_mfma_f32_16x16x32_bf16 v[148:151], v[112:115], v[48:51], v[148:151]
    ds_read_b128 v[132:135], v4 offset:19456
    v_cvt_pk_bf16_f32 v171, v162, v163
    v_mfma_f32_16x16x32_bf16 v[152:155], v[112:115], v[80:83], v[152:155]
    ds_read_b128 v[136:139], v3 offset:20480
    v_accvgpr_write_b32 a138, v170
    v_mfma_f32_16x16x32_bf16 v[144:147], v[116:119], v[28:31], v[144:147]
    ds_read_b128 v[140:143], v4 offset:20480
    v_accvgpr_write_b32 a139, v171
    v_mfma_f32_16x16x32_bf16 v[148:151], v[116:119], v[52:55], v[148:151]
    v_cvt_pk_bf16_f32 v172, v164, v165
    v_cvt_pk_bf16_f32 v173, v166, v167
    v_mfma_f32_16x16x32_bf16 v[152:155], v[116:119], v[84:87], v[152:155]
    v_accvgpr_write_b32 a218, v172
    v_accvgpr_write_b32 a219, v173
    s_waitcnt lgkmcnt(0)
    s_barrier
    s_mov_b32 s40, s18
    s_and_b32 s41, s19, 0xffff
    s_mov_b32 s42, 7864320
    s_mov_b32 s43, 0x20000
    v_mfma_f32_16x16x32_bf16 v[156:159], v[120:123], v[8:11], 0
    s_add_u32 s69, s53, 6709248
    s_add_u32 m0, s70, 18432
    v_mfma_f32_16x16x32_bf16 v[160:163], v[120:123], v[32:35], 0
    buffer_load_dwordx4 v1, s[44:47], s69 offen offset:0  lds
    s_add_u32 m0, s70, 19328
    v_mfma_f32_16x16x32_bf16 v[164:167], v[120:123], v[64:67], 0
    buffer_load_dwordx4 v1, s[44:47], s69 offen offset:128  lds
    s_add_u32 m0, s70, 20224
    v_mfma_f32_16x16x32_bf16 v[156:159], v[124:127], v[12:15], v[156:159]
    buffer_load_dwordx4 v1, s[44:47], s69 offen offset:256  lds
    s_add_u32 m0, s70, 21504
    v_mfma_f32_16x16x32_bf16 v[160:163], v[124:127], v[36:39], v[160:163]
    buffer_load_dwordx4 v2, s[44:47], s69 offen offset:0  lds
    s_add_u32 m0, s70, 22400
    v_mfma_f32_16x16x32_bf16 v[164:167], v[124:127], v[68:71], v[164:167]
    buffer_load_dwordx4 v2, s[44:47], s69 offen offset:128  lds
    s_add_u32 m0, s70, 23296
    v_mfma_f32_16x16x32_bf16 v[156:159], v[128:131], v[16:19], v[156:159]
    buffer_load_dwordx4 v2, s[44:47], s69 offen offset:256  lds
    s_add_u32 m0, s52, 0
    v_mfma_f32_16x16x32_bf16 v[160:163], v[128:131], v[40:43], v[160:163]
    s_add_u32 s68, s54, 0
    buffer_load_dwordx4 v5, s[40:43], s68 offen  lds
    v_mfma_f32_16x16x32_bf16 v[164:167], v[128:131], v[72:75], v[164:167]
    s_add_u32 m0, s52, 1024
    s_add_u32 s68, s54, 0
    v_cvt_pk_bf16_f32 v168, v144, v145
    v_mfma_f32_16x16x32_bf16 v[156:159], v[132:135], v[20:23], v[156:159]
    buffer_load_dwordx4 v6, s[40:43], s68 offen  lds
    s_waitcnt vmcnt(20)
    v_cvt_pk_bf16_f32 v169, v146, v147
    v_mfma_f32_16x16x32_bf16 v[160:163], v[132:135], v[44:47], v[160:163]
    ds_read_b128 v[96:99], v3 offset:0
    v_accvgpr_write_b32 a60, v168
    v_mfma_f32_16x16x32_bf16 v[164:167], v[132:135], v[76:79], v[164:167]
    ds_read_b128 v[100:103], v4 offset:0
    v_accvgpr_write_b32 a61, v169
    v_mfma_f32_16x16x32_bf16 v[156:159], v[136:139], v[24:27], v[156:159]
    ds_read_b128 v[104:107], v3 offset:1024
    v_cvt_pk_bf16_f32 v170, v148, v149
    v_mfma_f32_16x16x32_bf16 v[160:163], v[136:139], v[48:51], v[160:163]
    ds_read_b128 v[108:111], v4 offset:1024
    v_cvt_pk_bf16_f32 v171, v150, v151
    v_mfma_f32_16x16x32_bf16 v[164:167], v[136:139], v[80:83], v[164:167]
    ds_read_b128 v[112:115], v3 offset:2048
    v_accvgpr_write_b32 a140, v170
    v_mfma_f32_16x16x32_bf16 v[156:159], v[140:143], v[28:31], v[156:159]
    ds_read_b128 v[116:119], v4 offset:2048
    v_accvgpr_write_b32 a141, v171
    v_mfma_f32_16x16x32_bf16 v[160:163], v[140:143], v[52:55], v[160:163]
    v_cvt_pk_bf16_f32 v172, v152, v153
    v_cvt_pk_bf16_f32 v173, v154, v155
    v_mfma_f32_16x16x32_bf16 v[164:167], v[140:143], v[84:87], v[164:167]
    v_accvgpr_write_b32 a220, v172
    v_accvgpr_write_b32 a221, v173
    s_waitcnt lgkmcnt(0)
    v_mfma_f32_16x16x32_bf16 v[144:147], v[96:99], v[8:11], 0
    s_add_u32 s69, s53, 7077888
    s_add_u32 m0, s70, 0
    v_mfma_f32_16x16x32_bf16 v[148:151], v[96:99], v[32:35], 0
    buffer_load_dwordx4 v1, s[44:47], s69 offen offset:0  lds
    s_add_u32 m0, s70, 896
    v_mfma_f32_16x16x32_bf16 v[152:155], v[96:99], v[64:67], 0
    buffer_load_dwordx4 v1, s[44:47], s69 offen offset:128  lds
    s_add_u32 m0, s70, 1792
    v_mfma_f32_16x16x32_bf16 v[144:147], v[100:103], v[12:15], v[144:147]
    buffer_load_dwordx4 v1, s[44:47], s69 offen offset:256  lds
    s_add_u32 m0, s70, 3072
    v_mfma_f32_16x16x32_bf16 v[148:151], v[100:103], v[36:39], v[148:151]
    buffer_load_dwordx4 v2, s[44:47], s69 offen offset:0  lds
    s_add_u32 m0, s70, 3968
    v_mfma_f32_16x16x32_bf16 v[152:155], v[100:103], v[68:71], v[152:155]
    buffer_load_dwordx4 v2, s[44:47], s69 offen offset:128  lds
    s_add_u32 m0, s70, 4864
    v_mfma_f32_16x16x32_bf16 v[144:147], v[104:107], v[16:19], v[144:147]
    buffer_load_dwordx4 v2, s[44:47], s69 offen offset:256  lds
    s_add_u32 m0, s52, 2048
    v_mfma_f32_16x16x32_bf16 v[148:151], v[104:107], v[40:43], v[148:151]
    s_add_u32 s68, s54, 0
    buffer_load_dwordx4 v7, s[40:43], s68 offen  lds
    v_mfma_f32_16x16x32_bf16 v[152:155], v[104:107], v[72:75], v[152:155]
    s_add_u32 m0, s52, 3072
    s_add_u32 s68, s54, 393216
    v_cvt_pk_bf16_f32 v168, v156, v157
    v_mfma_f32_16x16x32_bf16 v[144:147], v[108:111], v[20:23], v[144:147]
    buffer_load_dwordx4 v5, s[40:43], s68 offen  lds
    s_waitcnt vmcnt(22)
    v_cvt_pk_bf16_f32 v169, v158, v159
    v_mfma_f32_16x16x32_bf16 v[148:151], v[108:111], v[44:47], v[148:151]
    ds_read_b128 v[120:123], v3 offset:6144
    v_accvgpr_write_b32 a62, v168
    v_mfma_f32_16x16x32_bf16 v[152:155], v[108:111], v[76:79], v[152:155]
    ds_read_b128 v[124:127], v4 offset:6144
    v_accvgpr_write_b32 a63, v169
    v_mfma_f32_16x16x32_bf16 v[144:147], v[112:115], v[24:27], v[144:147]
    ds_read_b128 v[128:131], v3 offset:7168
    v_cvt_pk_bf16_f32 v170, v160, v161
    v_mfma_f32_16x16x32_bf16 v[148:151], v[112:115], v[48:51], v[148:151]
    ds_read_b128 v[132:135], v4 offset:7168
    v_cvt_pk_bf16_f32 v171, v162, v163
    v_mfma_f32_16x16x32_bf16 v[152:155], v[112:115], v[80:83], v[152:155]
    ds_read_b128 v[136:139], v3 offset:8192
    v_accvgpr_write_b32 a142, v170
    v_mfma_f32_16x16x32_bf16 v[144:147], v[116:119], v[28:31], v[144:147]
    ds_read_b128 v[140:143], v4 offset:8192
    v_accvgpr_write_b32 a143, v171
    v_mfma_f32_16x16x32_bf16 v[148:151], v[116:119], v[52:55], v[148:151]
    v_cvt_pk_bf16_f32 v172, v164, v165
    v_cvt_pk_bf16_f32 v173, v166, v167
    v_mfma_f32_16x16x32_bf16 v[152:155], v[116:119], v[84:87], v[152:155]
    v_accvgpr_write_b32 a222, v172
    v_accvgpr_write_b32 a223, v173
    s_waitcnt lgkmcnt(0)
    v_mfma_f32_16x16x32_bf16 v[156:159], v[120:123], v[8:11], 0
    s_add_u32 s69, s53, 7102464
    s_add_u32 m0, s70, 6144
    v_mfma_f32_16x16x32_bf16 v[160:163], v[120:123], v[32:35], 0
    buffer_load_dwordx4 v1, s[44:47], s69 offen offset:0  lds
    s_add_u32 m0, s70, 7040
    v_mfma_f32_16x16x32_bf16 v[164:167], v[120:123], v[64:67], 0
    buffer_load_dwordx4 v1, s[44:47], s69 offen offset:128  lds
    s_add_u32 m0, s70, 7936
    v_mfma_f32_16x16x32_bf16 v[156:159], v[124:127], v[12:15], v[156:159]
    buffer_load_dwordx4 v1, s[44:47], s69 offen offset:256  lds
    s_add_u32 m0, s70, 9216
    v_mfma_f32_16x16x32_bf16 v[160:163], v[124:127], v[36:39], v[160:163]
    buffer_load_dwordx4 v2, s[44:47], s69 offen offset:0  lds
    s_add_u32 m0, s70, 10112
    v_mfma_f32_16x16x32_bf16 v[164:167], v[124:127], v[68:71], v[164:167]
    buffer_load_dwordx4 v2, s[44:47], s69 offen offset:128  lds
    s_add_u32 m0, s70, 11008
    v_mfma_f32_16x16x32_bf16 v[156:159], v[128:131], v[16:19], v[156:159]
    buffer_load_dwordx4 v2, s[44:47], s69 offen offset:256  lds
    s_add_u32 m0, s52, 4096
    v_mfma_f32_16x16x32_bf16 v[160:163], v[128:131], v[40:43], v[160:163]
    s_add_u32 s68, s54, 393216
    buffer_load_dwordx4 v6, s[40:43], s68 offen  lds
    v_mfma_f32_16x16x32_bf16 v[164:167], v[128:131], v[72:75], v[164:167]
    s_add_u32 m0, s52, 5120
    s_add_u32 s68, s54, 393216
    v_cvt_pk_bf16_f32 v168, v144, v145
    v_mfma_f32_16x16x32_bf16 v[156:159], v[132:135], v[20:23], v[156:159]
    buffer_load_dwordx4 v7, s[40:43], s68 offen  lds
    s_waitcnt vmcnt(24)
    v_cvt_pk_bf16_f32 v169, v146, v147
    v_mfma_f32_16x16x32_bf16 v[160:163], v[132:135], v[44:47], v[160:163]
    ds_read_b128 v[96:99], v3 offset:12288
    v_accvgpr_write_b32 a64, v168
    v_mfma_f32_16x16x32_bf16 v[164:167], v[132:135], v[76:79], v[164:167]
    ds_read_b128 v[100:103], v4 offset:12288
    v_accvgpr_write_b32 a65, v169
    v_mfma_f32_16x16x32_bf16 v[156:159], v[136:139], v[24:27], v[156:159]
    ds_read_b128 v[104:107], v3 offset:13312
    v_cvt_pk_bf16_f32 v170, v148, v149
    v_mfma_f32_16x16x32_bf16 v[160:163], v[136:139], v[48:51], v[160:163]
    ds_read_b128 v[108:111], v4 offset:13312
    v_cvt_pk_bf16_f32 v171, v150, v151
    v_mfma_f32_16x16x32_bf16 v[164:167], v[136:139], v[80:83], v[164:167]
    ds_read_b128 v[112:115], v3 offset:14336
    v_accvgpr_write_b32 a144, v170
    v_mfma_f32_16x16x32_bf16 v[156:159], v[140:143], v[28:31], v[156:159]
    ds_read_b128 v[116:119], v4 offset:14336
    v_accvgpr_write_b32 a145, v171
    v_mfma_f32_16x16x32_bf16 v[160:163], v[140:143], v[52:55], v[160:163]
    v_cvt_pk_bf16_f32 v172, v152, v153
    v_cvt_pk_bf16_f32 v173, v154, v155
    v_mfma_f32_16x16x32_bf16 v[164:167], v[140:143], v[84:87], v[164:167]
    v_accvgpr_write_b32 a224, v172
    v_accvgpr_write_b32 a225, v173
    s_waitcnt lgkmcnt(0)
    v_mfma_f32_16x16x32_bf16 v[144:147], v[96:99], v[8:11], 0
    s_add_u32 s69, s53, 7471104
    s_add_u32 m0, s70, 12288
    v_mfma_f32_16x16x32_bf16 v[148:151], v[96:99], v[32:35], 0
    buffer_load_dwordx4 v1, s[44:47], s69 offen offset:0  lds
    s_add_u32 m0, s70, 13184
    v_mfma_f32_16x16x32_bf16 v[152:155], v[96:99], v[64:67], 0
    buffer_load_dwordx4 v1, s[44:47], s69 offen offset:128  lds
    s_add_u32 m0, s70, 14080
    v_mfma_f32_16x16x32_bf16 v[144:147], v[100:103], v[12:15], v[144:147]
    buffer_load_dwordx4 v1, s[44:47], s69 offen offset:256  lds
    s_add_u32 m0, s70, 15360
    v_mfma_f32_16x16x32_bf16 v[148:151], v[100:103], v[36:39], v[148:151]
    buffer_load_dwordx4 v2, s[44:47], s69 offen offset:0  lds
    s_add_u32 m0, s70, 16256
    v_mfma_f32_16x16x32_bf16 v[152:155], v[100:103], v[68:71], v[152:155]
    buffer_load_dwordx4 v2, s[44:47], s69 offen offset:128  lds
    s_add_u32 m0, s70, 17152
    v_mfma_f32_16x16x32_bf16 v[144:147], v[104:107], v[16:19], v[144:147]
    buffer_load_dwordx4 v2, s[44:47], s69 offen offset:256  lds
    s_add_u32 m0, s52, 6144
    v_mfma_f32_16x16x32_bf16 v[148:151], v[104:107], v[40:43], v[148:151]
    s_add_u32 s68, s54, 786432
    buffer_load_dwordx4 v5, s[40:43], s68 offen  lds
    v_mfma_f32_16x16x32_bf16 v[152:155], v[104:107], v[72:75], v[152:155]
    s_add_u32 m0, s52, 7168
    s_add_u32 s68, s54, 786432
    v_cvt_pk_bf16_f32 v168, v156, v157
    v_mfma_f32_16x16x32_bf16 v[144:147], v[108:111], v[20:23], v[144:147]
    buffer_load_dwordx4 v6, s[40:43], s68 offen  lds
    s_waitcnt vmcnt(26)
    v_cvt_pk_bf16_f32 v169, v158, v159
    v_mfma_f32_16x16x32_bf16 v[148:151], v[108:111], v[44:47], v[148:151]
    ds_read_b128 v[120:123], v3 offset:18432
    v_accvgpr_write_b32 a66, v168
    v_mfma_f32_16x16x32_bf16 v[152:155], v[108:111], v[76:79], v[152:155]
    ds_read_b128 v[124:127], v4 offset:18432
    v_accvgpr_write_b32 a67, v169
    v_mfma_f32_16x16x32_bf16 v[144:147], v[112:115], v[24:27], v[144:147]
    ds_read_b128 v[128:131], v3 offset:19456
    v_cvt_pk_bf16_f32 v170, v160, v161
    v_mfma_f32_16x16x32_bf16 v[148:151], v[112:115], v[48:51], v[148:151]
    ds_read_b128 v[132:135], v4 offset:19456
    v_cvt_pk_bf16_f32 v171, v162, v163
    v_mfma_f32_16x16x32_bf16 v[152:155], v[112:115], v[80:83], v[152:155]
    ds_read_b128 v[136:139], v3 offset:20480
    v_accvgpr_write_b32 a146, v170
    v_mfma_f32_16x16x32_bf16 v[144:147], v[116:119], v[28:31], v[144:147]
    ds_read_b128 v[140:143], v4 offset:20480
    v_accvgpr_write_b32 a147, v171
    v_mfma_f32_16x16x32_bf16 v[148:151], v[116:119], v[52:55], v[148:151]
    v_cvt_pk_bf16_f32 v172, v164, v165
    v_cvt_pk_bf16_f32 v173, v166, v167
    v_mfma_f32_16x16x32_bf16 v[152:155], v[116:119], v[84:87], v[152:155]
    v_accvgpr_write_b32 a226, v172
    v_accvgpr_write_b32 a227, v173
    s_waitcnt lgkmcnt(0)
    v_mfma_f32_16x16x32_bf16 v[156:159], v[120:123], v[8:11], 0
    s_add_u32 s69, s53, 7495680
    s_add_u32 m0, s70, 18432
    v_mfma_f32_16x16x32_bf16 v[160:163], v[120:123], v[32:35], 0
    buffer_load_dwordx4 v1, s[44:47], s69 offen offset:0  lds
    s_add_u32 m0, s70, 19328
    v_mfma_f32_16x16x32_bf16 v[164:167], v[120:123], v[64:67], 0
    buffer_load_dwordx4 v1, s[44:47], s69 offen offset:128  lds
    s_add_u32 m0, s70, 20224
    v_mfma_f32_16x16x32_bf16 v[156:159], v[124:127], v[12:15], v[156:159]
    buffer_load_dwordx4 v1, s[44:47], s69 offen offset:256  lds
    s_add_u32 m0, s70, 21504
    v_mfma_f32_16x16x32_bf16 v[160:163], v[124:127], v[36:39], v[160:163]
    buffer_load_dwordx4 v2, s[44:47], s69 offen offset:0  lds
    s_add_u32 m0, s70, 22400
    v_mfma_f32_16x16x32_bf16 v[164:167], v[124:127], v[68:71], v[164:167]
    buffer_load_dwordx4 v2, s[44:47], s69 offen offset:128  lds
    s_add_u32 m0, s70, 23296
    v_mfma_f32_16x16x32_bf16 v[156:159], v[128:131], v[16:19], v[156:159]
    buffer_load_dwordx4 v2, s[44:47], s69 offen offset:256  lds
    s_add_u32 m0, s52, 8192
    v_mfma_f32_16x16x32_bf16 v[160:163], v[128:131], v[40:43], v[160:163]
    s_add_u32 s68, s54, 786432
    buffer_load_dwordx4 v7, s[40:43], s68 offen  lds
    v_mfma_f32_16x16x32_bf16 v[164:167], v[128:131], v[72:75], v[164:167]
    s_add_u32 m0, s52, 9216
    s_add_u32 s68, s54, 1179648
    v_cvt_pk_bf16_f32 v168, v144, v145
    v_mfma_f32_16x16x32_bf16 v[156:159], v[132:135], v[20:23], v[156:159]
    buffer_load_dwordx4 v5, s[40:43], s68 offen  lds
    s_waitcnt vmcnt(26)
    v_cvt_pk_bf16_f32 v169, v146, v147
    v_mfma_f32_16x16x32_bf16 v[160:163], v[132:135], v[44:47], v[160:163]
    ds_read_b128 v[96:99], v3 offset:0
    v_accvgpr_write_b32 a68, v168
    v_mfma_f32_16x16x32_bf16 v[164:167], v[132:135], v[76:79], v[164:167]
    ds_read_b128 v[100:103], v4 offset:0
    v_accvgpr_write_b32 a69, v169
    v_mfma_f32_16x16x32_bf16 v[156:159], v[136:139], v[24:27], v[156:159]
    ds_read_b128 v[104:107], v3 offset:1024
    v_cvt_pk_bf16_f32 v170, v148, v149
    v_mfma_f32_16x16x32_bf16 v[160:163], v[136:139], v[48:51], v[160:163]
    ds_read_b128 v[108:111], v4 offset:1024
    v_cvt_pk_bf16_f32 v171, v150, v151
    v_mfma_f32_16x16x32_bf16 v[164:167], v[136:139], v[80:83], v[164:167]
    ds_read_b128 v[112:115], v3 offset:2048
    v_accvgpr_write_b32 a148, v170
    v_mfma_f32_16x16x32_bf16 v[156:159], v[140:143], v[28:31], v[156:159]
    ds_read_b128 v[116:119], v4 offset:2048
    v_accvgpr_write_b32 a149, v171
    v_mfma_f32_16x16x32_bf16 v[160:163], v[140:143], v[52:55], v[160:163]
    v_cvt_pk_bf16_f32 v172, v152, v153
    v_cvt_pk_bf16_f32 v173, v154, v155
    v_mfma_f32_16x16x32_bf16 v[164:167], v[140:143], v[84:87], v[164:167]
    v_accvgpr_write_b32 a228, v172
    v_accvgpr_write_b32 a229, v173
    s_waitcnt lgkmcnt(0)
    v_mfma_f32_16x16x32_bf16 v[144:147], v[96:99], v[8:11], 0
    s_add_u32 m0, s52, 10240
    s_add_u32 s68, s54, 1179648
    v_mfma_f32_16x16x32_bf16 v[148:151], v[96:99], v[32:35], 0
    buffer_load_dwordx4 v6, s[40:43], s68 offen  lds
    s_add_u32 m0, s52, 11264
    v_mfma_f32_16x16x32_bf16 v[152:155], v[96:99], v[64:67], 0
    s_add_u32 s68, s54, 1179648
    buffer_load_dwordx4 v7, s[40:43], s68 offen  lds
    v_mfma_f32_16x16x32_bf16 v[144:147], v[100:103], v[12:15], v[144:147]
    v_mfma_f32_16x16x32_bf16 v[148:151], v[100:103], v[36:39], v[148:151]
    v_mfma_f32_16x16x32_bf16 v[152:155], v[100:103], v[68:71], v[152:155]
    v_mfma_f32_16x16x32_bf16 v[144:147], v[104:107], v[16:19], v[144:147]
    v_mfma_f32_16x16x32_bf16 v[148:151], v[104:107], v[40:43], v[148:151]
    v_mfma_f32_16x16x32_bf16 v[152:155], v[104:107], v[72:75], v[152:155]
    v_cvt_pk_bf16_f32 v168, v156, v157
    v_mfma_f32_16x16x32_bf16 v[144:147], v[108:111], v[20:23], v[144:147]
    s_waitcnt vmcnt(20)
    v_cvt_pk_bf16_f32 v169, v158, v159
    v_mfma_f32_16x16x32_bf16 v[148:151], v[108:111], v[44:47], v[148:151]
    ds_read_b128 v[120:123], v3 offset:6144
    v_accvgpr_write_b32 a70, v168
    v_mfma_f32_16x16x32_bf16 v[152:155], v[108:111], v[76:79], v[152:155]
    ds_read_b128 v[124:127], v4 offset:6144
    v_accvgpr_write_b32 a71, v169
    v_mfma_f32_16x16x32_bf16 v[144:147], v[112:115], v[24:27], v[144:147]
    ds_read_b128 v[128:131], v3 offset:7168
    v_cvt_pk_bf16_f32 v170, v160, v161
    v_mfma_f32_16x16x32_bf16 v[148:151], v[112:115], v[48:51], v[148:151]
    ds_read_b128 v[132:135], v4 offset:7168
    v_cvt_pk_bf16_f32 v171, v162, v163
    v_mfma_f32_16x16x32_bf16 v[152:155], v[112:115], v[80:83], v[152:155]
    ds_read_b128 v[136:139], v3 offset:8192
    v_accvgpr_write_b32 a150, v170
    v_mfma_f32_16x16x32_bf16 v[144:147], v[116:119], v[28:31], v[144:147]
    ds_read_b128 v[140:143], v4 offset:8192
    v_accvgpr_write_b32 a151, v171
    v_mfma_f32_16x16x32_bf16 v[148:151], v[116:119], v[52:55], v[148:151]
    v_cvt_pk_bf16_f32 v172, v164, v165
    v_cvt_pk_bf16_f32 v173, v166, v167
    v_mfma_f32_16x16x32_bf16 v[152:155], v[116:119], v[84:87], v[152:155]
    v_accvgpr_write_b32 a230, v172
    v_accvgpr_write_b32 a231, v173
    s_waitcnt lgkmcnt(0)
    v_mfma_f32_16x16x32_bf16 v[156:159], v[120:123], v[8:11], 0
    s_add_u32 m0, s52, 12288
    s_add_u32 s68, s54, 1572864
    v_mfma_f32_16x16x32_bf16 v[160:163], v[120:123], v[32:35], 0
    buffer_load_dwordx4 v5, s[40:43], s68 offen  lds
    s_add_u32 m0, s52, 13312
    v_mfma_f32_16x16x32_bf16 v[164:167], v[120:123], v[64:67], 0
    s_add_u32 s68, s54, 1572864
    buffer_load_dwordx4 v6, s[40:43], s68 offen  lds
    v_mfma_f32_16x16x32_bf16 v[156:159], v[124:127], v[12:15], v[156:159]
    v_mfma_f32_16x16x32_bf16 v[160:163], v[124:127], v[36:39], v[160:163]
    v_mfma_f32_16x16x32_bf16 v[164:167], v[124:127], v[68:71], v[164:167]
    v_mfma_f32_16x16x32_bf16 v[156:159], v[128:131], v[16:19], v[156:159]
    v_mfma_f32_16x16x32_bf16 v[160:163], v[128:131], v[40:43], v[160:163]
    v_mfma_f32_16x16x32_bf16 v[164:167], v[128:131], v[72:75], v[164:167]
    v_cvt_pk_bf16_f32 v168, v144, v145
    v_mfma_f32_16x16x32_bf16 v[156:159], v[132:135], v[20:23], v[156:159]
    s_waitcnt vmcnt(14)
    v_cvt_pk_bf16_f32 v169, v146, v147
    v_mfma_f32_16x16x32_bf16 v[160:163], v[132:135], v[44:47], v[160:163]
    ds_read_b128 v[96:99], v3 offset:12288
    v_accvgpr_write_b32 a72, v168
    v_mfma_f32_16x16x32_bf16 v[164:167], v[132:135], v[76:79], v[164:167]
    ds_read_b128 v[100:103], v4 offset:12288
    v_accvgpr_write_b32 a73, v169
    v_mfma_f32_16x16x32_bf16 v[156:159], v[136:139], v[24:27], v[156:159]
    ds_read_b128 v[104:107], v3 offset:13312
    v_cvt_pk_bf16_f32 v170, v148, v149
    v_mfma_f32_16x16x32_bf16 v[160:163], v[136:139], v[48:51], v[160:163]
    ds_read_b128 v[108:111], v4 offset:13312
    v_cvt_pk_bf16_f32 v171, v150, v151
    v_mfma_f32_16x16x32_bf16 v[164:167], v[136:139], v[80:83], v[164:167]
    ds_read_b128 v[112:115], v3 offset:14336
    v_accvgpr_write_b32 a152, v170
    v_mfma_f32_16x16x32_bf16 v[156:159], v[140:143], v[28:31], v[156:159]
    ds_read_b128 v[116:119], v4 offset:14336
    v_accvgpr_write_b32 a153, v171
    v_mfma_f32_16x16x32_bf16 v[160:163], v[140:143], v[52:55], v[160:163]
    v_cvt_pk_bf16_f32 v172, v152, v153
    v_cvt_pk_bf16_f32 v173, v154, v155
    v_mfma_f32_16x16x32_bf16 v[164:167], v[140:143], v[84:87], v[164:167]
    v_accvgpr_write_b32 a232, v172
    v_accvgpr_write_b32 a233, v173
    s_waitcnt lgkmcnt(0)
    v_mfma_f32_16x16x32_bf16 v[144:147], v[96:99], v[8:11], 0
    s_add_u32 m0, s52, 14336
    s_add_u32 s68, s54, 1572864
    v_mfma_f32_16x16x32_bf16 v[148:151], v[96:99], v[32:35], 0
    buffer_load_dwordx4 v7, s[40:43], s68 offen  lds
    v_mfma_f32_16x16x32_bf16 v[152:155], v[96:99], v[64:67], 0
    v_mfma_f32_16x16x32_bf16 v[144:147], v[100:103], v[12:15], v[144:147]
    v_mfma_f32_16x16x32_bf16 v[148:151], v[100:103], v[36:39], v[148:151]
    v_mfma_f32_16x16x32_bf16 v[152:155], v[100:103], v[68:71], v[152:155]
    v_mfma_f32_16x16x32_bf16 v[144:147], v[104:107], v[16:19], v[144:147]
    v_mfma_f32_16x16x32_bf16 v[148:151], v[104:107], v[40:43], v[148:151]
    v_mfma_f32_16x16x32_bf16 v[152:155], v[104:107], v[72:75], v[152:155]
    v_cvt_pk_bf16_f32 v168, v156, v157
    v_mfma_f32_16x16x32_bf16 v[144:147], v[108:111], v[20:23], v[144:147]
    s_waitcnt vmcnt(7)
    v_cvt_pk_bf16_f32 v169, v158, v159
    v_mfma_f32_16x16x32_bf16 v[148:151], v[108:111], v[44:47], v[148:151]
    ds_read_b128 v[120:123], v3 offset:18432
    v_accvgpr_write_b32 a74, v168
    v_mfma_f32_16x16x32_bf16 v[152:155], v[108:111], v[76:79], v[152:155]
    ds_read_b128 v[124:127], v4 offset:18432
    v_accvgpr_write_b32 a75, v169
    v_mfma_f32_16x16x32_bf16 v[144:147], v[112:115], v[24:27], v[144:147]
    ds_read_b128 v[128:131], v3 offset:19456
    v_cvt_pk_bf16_f32 v170, v160, v161
    v_mfma_f32_16x16x32_bf16 v[148:151], v[112:115], v[48:51], v[148:151]
    ds_read_b128 v[132:135], v4 offset:19456
    v_cvt_pk_bf16_f32 v171, v162, v163
    v_mfma_f32_16x16x32_bf16 v[152:155], v[112:115], v[80:83], v[152:155]
    ds_read_b128 v[136:139], v3 offset:20480
    v_accvgpr_write_b32 a154, v170
    v_mfma_f32_16x16x32_bf16 v[144:147], v[116:119], v[28:31], v[144:147]
    ds_read_b128 v[140:143], v4 offset:20480
    v_accvgpr_write_b32 a155, v171
    v_mfma_f32_16x16x32_bf16 v[148:151], v[116:119], v[52:55], v[148:151]
    v_cvt_pk_bf16_f32 v172, v164, v165
    v_cvt_pk_bf16_f32 v173, v166, v167
    v_mfma_f32_16x16x32_bf16 v[152:155], v[116:119], v[84:87], v[152:155]
    v_accvgpr_write_b32 a234, v172
    v_accvgpr_write_b32 a235, v173
    s_waitcnt lgkmcnt(0)
    v_mfma_f32_16x16x32_bf16 v[156:159], v[120:123], v[8:11], 0
    v_mfma_f32_16x16x32_bf16 v[160:163], v[120:123], v[32:35], 0
    v_mfma_f32_16x16x32_bf16 v[164:167], v[120:123], v[64:67], 0
    v_mfma_f32_16x16x32_bf16 v[156:159], v[124:127], v[12:15], v[156:159]
    v_mfma_f32_16x16x32_bf16 v[160:163], v[124:127], v[36:39], v[160:163]
    v_mfma_f32_16x16x32_bf16 v[164:167], v[124:127], v[68:71], v[164:167]
    v_mfma_f32_16x16x32_bf16 v[156:159], v[128:131], v[16:19], v[156:159]
    v_mfma_f32_16x16x32_bf16 v[160:163], v[128:131], v[40:43], v[160:163]
    v_mfma_f32_16x16x32_bf16 v[164:167], v[128:131], v[72:75], v[164:167]
    v_cvt_pk_bf16_f32 v168, v144, v145
    v_mfma_f32_16x16x32_bf16 v[156:159], v[132:135], v[20:23], v[156:159]
    v_cvt_pk_bf16_f32 v169, v146, v147
    v_mfma_f32_16x16x32_bf16 v[160:163], v[132:135], v[44:47], v[160:163]
    v_accvgpr_write_b32 a76, v168
    v_mfma_f32_16x16x32_bf16 v[164:167], v[132:135], v[76:79], v[164:167]
    v_accvgpr_write_b32 a77, v169
    v_mfma_f32_16x16x32_bf16 v[156:159], v[136:139], v[24:27], v[156:159]
    v_cvt_pk_bf16_f32 v170, v148, v149
    v_mfma_f32_16x16x32_bf16 v[160:163], v[136:139], v[48:51], v[160:163]
    v_cvt_pk_bf16_f32 v171, v150, v151
    v_mfma_f32_16x16x32_bf16 v[164:167], v[136:139], v[80:83], v[164:167]
    v_accvgpr_write_b32 a156, v170
    v_mfma_f32_16x16x32_bf16 v[156:159], v[140:143], v[28:31], v[156:159]
    v_accvgpr_write_b32 a157, v171
    v_mfma_f32_16x16x32_bf16 v[160:163], v[140:143], v[52:55], v[160:163]
    v_cvt_pk_bf16_f32 v172, v152, v153
    v_cvt_pk_bf16_f32 v173, v154, v155
    v_mfma_f32_16x16x32_bf16 v[164:167], v[140:143], v[84:87], v[164:167]
    v_accvgpr_write_b32 a236, v172
    v_accvgpr_write_b32 a237, v173
    s_nop 7
    v_cvt_pk_bf16_f32 v168, v156, v157
    v_cvt_pk_bf16_f32 v169, v158, v159
    v_accvgpr_write_b32 a78, v168
    v_accvgpr_write_b32 a79, v169
    v_cvt_pk_bf16_f32 v170, v160, v161
    v_cvt_pk_bf16_f32 v171, v162, v163
    v_accvgpr_write_b32 a158, v170
    v_accvgpr_write_b32 a159, v171
    v_cvt_pk_bf16_f32 v172, v164, v165
    v_cvt_pk_bf16_f32 v173, v166, v167
    v_accvgpr_write_b32 a238, v172
    v_accvgpr_write_b32 a239, v173
    v_mov_b32 v64, 4
    v_mov_b32 v65, 144
L_wini_42:
    buffer_load_dword v66, v64, s[48:51], 0 offen sc1
    buffer_load_dwordx4 v[68:71], v65, s[48:51], 0 offen sc1
    s_add_u32 s7, s7, 1
    s_cmp_gt_u32 s7, 400000
    s_cbranch_scc1 L_exit
    s_waitcnt vmcnt(0)
    v_readfirstlane_b32 s68, v66
    v_readfirstlane_b32 s71, v68
    v_readfirstlane_b32 s69, v69
    v_readfirstlane_b32 s70, v70
    s_cmp_lt_u32 s68, 128
    s_cbranch_scc1 L_wini_42
    s_cmp_lt_u32 s71, 32
    s_cbranch_scc1 L_wini_42
    s_cmp_gt_u32 s69, s70
    s_cselect_b32 s71, 8192, 0
    s_barrier
    ds_read_b64_tr_b16 v[96:97], v88 offset:0
    ds_read_b64_tr_b16 v[98:99], v88 offset:192
    ds_read_b64_tr_b16 v[100:101], v88 offset:3072
    ds_read_b64_tr_b16 v[102:103], v88 offset:3264
    ds_read_b64_tr_b16 v[104:105], v88 offset:6144
    ds_read_b64_tr_b16 v[106:107], v88 offset:6336
    ds_read_b64_tr_b16 v[108:109], v88 offset:9216
    ds_read_b64_tr_b16 v[110:111], v88 offset:9408
    s_waitcnt lgkmcnt(6)
    ds_read_b64_tr_b16 v[112:113], v88 offset:12288
    ds_read_b64_tr_b16 v[114:115], v88 offset:12480
    ds_read_b64_tr_b16 v[116:117], v88 offset:15360
    ds_read_b64_tr_b16 v[118:119], v88 offset:15552
    ds_read_b64_tr_b16 v[120:121], v88 offset:18432
    ds_read_b64_tr_b16 v[122:123], v88 offset:18624
    ds_read_b64_tr_b16 v[124:125], v88 offset:21504
    ds_read_b64_tr_b16 v[126:127], v88 offset:21696
    s_waitcnt lgkmcnt(6)
    ds_read_b64_tr_b16 v[128:129], v88 offset:24576
    ds_read_b64_tr_b16 v[130:131], v88 offset:24768
    ds_read_b64_tr_b16 v[132:133], v88 offset:27648
    ds_read_b64_tr_b16 v[134:135], v88 offset:27840
    ds_read_b64_tr_b16 v[136:137], v88 offset:30720
    ds_read_b64_tr_b16 v[138:139], v88 offset:30912
    ds_read_b64_tr_b16 v[140:141], v88 offset:33792
    ds_read_b64_tr_b16 v[142:143], v88 offset:33984
    s_waitcnt lgkmcnt(6)
    ds_read_b64_tr_b16 v[144:145], v88 offset:36864
    ds_read_b64_tr_b16 v[146:147], v88 offset:37056
    ds_read_b64_tr_b16 v[148:149], v88 offset:39936
    ds_read_b64_tr_b16 v[150:151], v88 offset:40128
    ds_read_b64_tr_b16 v[152:153], v88 offset:43008
    ds_read_b64_tr_b16 v[154:155], v88 offset:43200
    ds_read_b64_tr_b16 v[156:157], v88 offset:46080
    ds_read_b64_tr_b16 v[158:159], v88 offset:46272
    s_waitcnt lgkmcnt(6)
    ds_read_b64_tr_b16 v[160:161], v88 offset:49152
    ds_read_b64_tr_b16 v[162:163], v88 offset:49344
    ds_read_b64_tr_b16 v[164:165], v88 offset:52224
    ds_read_b64_tr_b16 v[166:167], v88 offset:52416
    ds_read_b64_tr_b16 v[168:169], v88 offset:55296
    ds_read_b64_tr_b16 v[170:171], v88 offset:55488
    ds_read_b64_tr_b16 v[172:173], v88 offset:58368
    ds_read_b64_tr_b16 v[174:175], v88 offset:58560
    s_waitcnt lgkmcnt(6)
    s_waitcnt lgkmcnt(0)
    s_barrier
    v_mov_b32 v64, 0x4444
    v_mov_b32 v65, 0xeeee
    v_cndmask_b32 v1, v64, v65, s[76:77]
    s_lshl_b32 s68, s3, 4
    v_add_u32 v64, s68, v60
    v_lshlrev_b32 v64, 4, v64
    v_and_b32 v65, 1, v61
    v_lshl_add_u32 v64, v65, 3, v64
    v_lshrrev_b32 v65, 1, v61
    v_lshl_add_u32 v2, v65, 2, v64
    v_lshlrev_b32 v4, 1, v2
    v_lshrrev_b32 v64, 3, v60
    v_lshlrev_b32 v64, 9, v64
    v_lshl_add_u32 v64, v61, 7, v64
    v_and_b32 v65, 7, v60
    v_lshl_add_u32 v3, v65, 4, v64
    v_mov_b32 v8, 0
    v_mov_b32 v9, 0
    v_mov_b32 v10, 0
    v_mov_b32 v11, 0
    v_mov_b32 v12, 0
    v_mov_b32 v13, 0
    v_mov_b32 v14, 0
    v_mov_b32 v15, 0
    v_accvgpr_write_b32 a244, 0
    v_accvgpr_write_b32 a245, 0
    v_accvgpr_write_b32 a246, 0
    v_accvgpr_write_b32 a247, 0
    v_accvgpr_write_b32 a248, 0
    v_accvgpr_write_b32 a249, 0
    v_accvgpr_write_b32 a250, 0
    v_accvgpr_write_b32 a251, 0
    v_accvgpr_write_b32 a252, 0
    v_accvgpr_write_b32 a253, 0
    v_accvgpr_write_b32 a254, 0
    v_accvgpr_write_b32 a255, 0
    v_and_b32 v64, 0x1ff, v3
    v_lshrrev_b32 v65, 3, v60
    v_lshl_add_u32 v5, v65, 3, v64
    s_mov_b32 s6, 0
    s_mul_i32 s61, s82, 40960
    s_mul_i32 s68, s83, 2560
    s_add_u32 s61, s61, s68
    s_add_u32 s61, s61, 98566144
    s_lshr_b32 s63, s82, 2
    s_mul_i32 s63, s63, 40960
    s_add_u32 s63, s63, s68
    s_add_u32 s67, s63, 21954560
    s_add_u32 s63, s63, 26542080
    s_and_b32 s44, s82, 28
    s_lshl_b32 s44, s44, 11
    s_add_u32 s44, s44, 8060928
    s_mov_b32 s46, 23040
    s_mov_b32 s47, 53760
    s_mov_b32 s32, 0xffff
    s_mov_b32 s33, 0
    s_mul_i32 s62, s84, 12288
    s_mul_i32 s68, s85, 3072
    s_add_u32 s62, s62, s68
    s_add_u32 s62, s62, 48234496
    s_xor_b32 s82, s71, 0
    s_mul_i32 s64, s84, 3072
    s_mul_i32 s68, s85, 768
    s_add_u32 s64, s64, s68
    s_add_u32 s64, s64, 2129920
    s_mov_b32 s40, s16
    s_and_b32 s41, s17, 0xffff
    s_mov_b32 s42, 10240
    s_mov_b32 s43, 0x20000
    v_and_b32 v63, 7, v60
    v_mul_u32_u24 v63, 1280, v63
    v_lshl_add_u32 v63, v61, 5, v63
    v_lshrrev_b32 v64, 3, v60
    v_lshl_add_u32 v40, v64, 4, v63
    v_mov_b32 v41, v60
    v_mov_b32 v42, v61
    v_mov_b32 v43, v62
    s_cmp_eq_u32 s3, 0
    s_cbranch_scc1 L_rec_0
    s_cmp_eq_u32 s3, 1
    s_cbranch_scc1 L_rec_1
    s_cmp_eq_u32 s3, 2
    s_cbranch_scc1 L_rec_2
    s_branch L_rec_3
L_rec_0:
    v_min_u32 v64, 9, v41
    v_add_u32 v65, 0, v64
    v_lshlrev_b32 v65, 4, v65
    s_and_b32 s68, s5, 1
    s_mul_i32 s69, s68, 384
    s_mul_i32 s70, s83, 1536
    s_add_u32 s69, s69, s70
    v_add_u32 v65, s69, v65
    v_and_b32 v66, 1, v42
    v_mul_u32_u24 v66, 768, v66
    v_add_u32 v65, v65, v66
    v_lshrrev_b32 v66, 1, v42
    v_add_u32 v66, 0, v66
    v_mul_u32_u24 v67, 24576, v66
    v_add_u32 v6, v65, v67
    v_lshrrev_b32 v67, 13, v6
    v_lshl_add_u32 v6, v67, 13, v6
    v_add_u32 v6, s71, v6
    v_xor_b32 v67, 8192, v6
    s_lshl_b32 s70, s4, 0
    v_cmp_eq_u32 vcc, s70, v66
    s_nop 1
    v_cndmask_b32 v6, v6, v67, vcc
    v_lshrrev_b32 v66, 1, v42
    v_add_u32 v66, 2, v66
    v_mul_u32_u24 v67, 24576, v66
    v_add_u32 v7, v65, v67
    v_lshrrev_b32 v67, 13, v7
    v_lshl_add_u32 v7, v67, 13, v7
    v_add_u32 v7, s71, v7
    v_xor_b32 v67, 8192, v7
    s_lshl_b32 s70, s4, 0
    v_cmp_eq_u32 vcc, s70, v66
    s_nop 1
    v_cndmask_b32 v7, v7, v67, vcc
    v_lshrrev_b32 v66, 1, v64
    v_lshlrev_b32 v66, 7, v66
    v_and_b32 v67, 1, v64
    v_lshl_add_u32 v66, v67, 4, v66
    v_lshl_add_u32 v66, v42, 3, v66
    s_mul_i32 s69, s83, 640
    s_lshl_b32 s68, s68, 6
    s_add_u32 s69, s69, s68
    s_add_u32 s69, s69, 0
    v_add_u32 v8, s69, v66
    s_mov_b32 s78, 0x03ff03ff
    s_mov_b32 s79, 0
    v_mov_b32 v68, 0
    v_and_b32 v64, 1, v41
    v_lshlrev_b32 v64, 4, v64
    v_mov_b32 v65, 0x3f80
    v_lshlrev_b32 v64, v64, v65
    v_lshrrev_b32 v65, 1, v41
    v_add_u32 v65, 0, v65
    v_lshlrev_b32 v66, 2, v68
    v_sub_u32 v65, v65, v66
    v_cmp_eq_u32 vcc, 0, v65
    s_nop 1
    v_cndmask_b32 v72, 0, v64, vcc
    v_cmp_eq_u32 vcc, 1, v65
    s_nop 1
    v_cndmask_b32 v73, 0, v64, vcc
    v_cmp_eq_u32 vcc, 2, v65
    s_nop 1
    v_cndmask_b32 v74, 0, v64, vcc
    v_cmp_eq_u32 vcc, 3, v65
    s_nop 1
    v_cndmask_b32 v75, 0, v64, vcc
    v_accvgpr_write_b32 a240, v72
    v_accvgpr_write_b32 a241, v73
    v_accvgpr_write_b32 a242, v74
    v_accvgpr_write_b32 a243, v75
    s_barrier
    s_add_u32 m0, s46, 0
    v_and_b32 v44, 0x1ff, v0
    buffer_load_dwordx4 v0, s[36:39], s61 offen offset:0 sc1 lds
    buffer_load_dwordx4 v0, s[36:39], s61 offen offset:1024 sc1 lds
    buffer_load_dwordx4 v44, s[36:39], s61 offen offset:2048 sc1 lds
    s_add_u32 s61, s61, 1310720
    s_and_b32 s68, s6, 3
    s_mul_i32 s52, s68, 40960
    s_add_u32 s52, s52, s87
    s_add_u32 s52, s52, 0
    s_mul_i32 s57, s68, 196608
    s_add_u32 s65, s6, 1
    s_mul_i32 s66, s65, 0x01010101
    s_mov_b32 s45, s46
    s_add_u32 s46, s46, 15360
    s_cmp_ge_u32 s46, 161280
    s_cselect_b32 s46, 23040, s46
    buffer_load_dwordx4 v[56:59], v40, s[40:43], 0 offen offset:0
    buffer_load_dwordx4 v[60:63], v40, s[40:43], 0 offen offset:128
    buffer_load_dwordx4 v[64:67], v40, s[40:43], 0 offen offset:256
    v_mov_b32 v16, 0
    v_mov_b32 v17, 0
    v_mov_b32 v18, 0
    v_mov_b32 v19, 0
    v_mov_b32 v20, 0
    v_mov_b32 v21, 0
    v_mov_b32 v22, 0
    v_mov_b32 v23, 0
    v_mov_b32 v24, 0
    v_mov_b32 v25, 0
    v_mov_b32 v26, 0
    v_mov_b32 v27, 0
    v_mov_b32 v28, 0
    v_mov_b32 v29, 0
    v_mov_b32 v30, 0
    v_mov_b32 v31, 0
    v_mov_b32 v32, 0
    v_mov_b32 v33, 0
    v_mov_b32 v34, 0
    v_mov_b32 v35, 0
    s_waitcnt vmcnt(0)
    ds_write_b128 v0, v[56:59] offset:0
    ds_write_b128 v0, v[60:63] offset:1024
    ds_write_b128 v0, v[64:67] offset:2048
    s_waitcnt lgkmcnt(0)
    s_branch L_rec_0_m
    .p2align 6
L_rec_0_top0:
    buffer_load_dwordx4 v0, s[36:39], s52 offen offset:0 sc1 lds
    buffer_load_dwordx4 v0, s[36:39], s52 offen offset:1024 sc1 lds
    buffer_load_dwordx4 v0, s[36:39], s52 offen offset:2048 sc1 lds
    s_nop 11
L_rec_0_top:
    buffer_load_dwordx4 v0, s[36:39], s52 offen offset:0 sc1 lds
    buffer_load_dwordx4 v0, s[36:39], s52 offen offset:1024 sc1 lds
    buffer_load_dwordx4 v0, s[36:39], s52 offen offset:2048 sc1 lds
    s_waitcnt vmcnt(5)
    ds_read_b128 v[56:59], v0 offset:0
    s_waitcnt vmcnt(4)
    ds_read_b128 v[60:63], v0 offset:1024
    s_waitcnt vmcnt(3)
    ds_read_b128 v[64:67], v0 offset:2048
    s_waitcnt lgkmcnt(2)
    v_max3_u32 v40, v56, v57, v58
    s_waitcnt lgkmcnt(1)
    v_max3_u32 v41, v59, v60, v61
    v_max3_u32 v40, v40, v62, v63
    s_waitcnt lgkmcnt(0)
    v_max3_u32 v41, v41, v64, v65
    v_max3_u32 v40, v40, v66, v67
    v_max_u32 v40, v40, v41
    v_cmp_eq_u32 vcc, -1, v40
    s_cbranch_vccnz L_rm_43
L_rec_0_m:
    s_barrier
    ds_read_b128 v[68:71], v0 offset:3072
    v_smfmac_f32_16x16x64_bf16 v[16:19], v[56:59], v[96:103], v1
    ds_read_b128 v[72:75], v0 offset:4096
    ds_read_b128 v[76:79], v0 offset:5120
    ds_read_b128 v[80:83], v0 offset:6144
    v_smfmac_f32_16x16x64_bf16 v[16:19], v[60:63], v[104:111], v1
    ds_read_b128 v[84:87], v0 offset:7168
    ds_read_b128 v[88:91], v0 offset:8192
    ds_read_b128 v[92:95], v0 offset:9216
    v_smfmac_f32_16x16x64_bf16 v[16:19], v[64:67], v[112:119], v1
    s_waitcnt lgkmcnt(6)
    v_smfmac_f32_16x16x64_bf16 v[16:19], v[68:71], v[120:127], v1
    s_waitcnt lgkmcnt(5)
    v_smfmac_f32_16x16x64_bf16 v[16:19], v[72:75], v[128:135], v1
    s_waitcnt lgkmcnt(4)
    v_smfmac_f32_16x16x64_bf16 v[16:19], v[76:79], v[136:143], v1
    s_waitcnt lgkmcnt(3)
    v_smfmac_f32_16x16x64_bf16 v[16:19], v[80:83], v[144:151], v1
    s_waitcnt lgkmcnt(2)
    v_smfmac_f32_16x16x64_bf16 v[16:19], v[84:87], v[152:159], v1
    s_waitcnt lgkmcnt(1)
    v_smfmac_f32_16x16x64_bf16 v[16:19], v[88:91], v[160:167], v1
    s_waitcnt lgkmcnt(0)
    v_smfmac_f32_16x16x64_bf16 v[16:19], v[92:95], v[168:175], v1
    v_smfmac_f32_16x16x64_bf16 v[20:23], v[56:59], v[176:183], v1
    s_nop 2
    v_smfmac_f32_16x16x64_bf16 v[20:23], v[60:63], v[184:191], v1
    s_nop 2
    v_smfmac_f32_16x16x64_bf16 v[20:23], v[64:67], v[192:199], v1
    v_permlane32_swap_b32 v16, v18
    v_smfmac_f32_16x16x64_bf16 v[20:23], v[68:71], v[200:207], v1
    v_permlane32_swap_b32 v17, v19
    v_smfmac_f32_16x16x64_bf16 v[20:23], v[72:75], v[208:215], v1
    v_add_f32 v16, v16, v18
    v_add_f32 v17, v17, v19
    v_smfmac_f32_16x16x64_bf16 v[20:23], v[76:79], v[216:223], v1
    v_cvt_pk_bf16_f32 v40, v16, v17
    ds_write_b32 v2, v40 offset:10240
    v_smfmac_f32_16x16x64_bf16 v[20:23], v[80:83], v[224:231], v1
    v_smfmac_f32_16x16x64_bf16 v[20:23], v[84:87], v[232:239], v1
    v_smfmac_f32_16x16x64_bf16 v[20:23], v[88:91], v[240:247], v1
    v_smfmac_f32_16x16x64_bf16 v[20:23], v[92:95], v[248:255], v1
    s_waitcnt lgkmcnt(0)
    s_barrier
    s_nop 5
    v_permlane32_swap_b32 v20, v22
    v_permlane32_swap_b32 v21, v23
    v_pk_add_f32 v[20:21], v[20:21], v[22:23]
    v_cvt_pk_bf16_f32 v41, v20, v21
    ds_write_b32 v4, v41 offset:11264
    v_smfmac_f32_16x16x64_bf16 v[24:27], v[56:59], a[0:7], v1
    v_smfmac_f32_16x16x64_bf16 v[24:27], v[60:63], a[8:15], v1
    s_waitcnt lgkmcnt(0)
    s_barrier
    v_smfmac_f32_16x16x64_bf16 v[24:27], v[64:67], a[16:23], v1
    v_add_u32 v11, s45, v3
    ds_read_b128 v[44:47], v11 offset:0
    v_smfmac_f32_16x16x64_bf16 v[24:27], v[68:71], a[24:31], v1
    ds_read_b128 v[48:51], v11 offset:1024
    ds_read_b128 v[52:55], v11 offset:2048
    v_smfmac_f32_16x16x64_bf16 v[24:27], v[72:75], a[32:39], v1
    v_smfmac_f32_16x16x64_bf16 v[24:27], v[76:79], a[40:47], v1
    v_smfmac_f32_16x16x64_bf16 v[24:27], v[80:83], a[48:55], v1
    v_smfmac_f32_16x16x64_bf16 v[24:27], v[84:87], a[56:63], v1
    v_smfmac_f32_16x16x64_bf16 v[24:27], v[88:91], a[64:71], v1
    v_smfmac_f32_16x16x64_bf16 v[24:27], v[92:95], a[72:79], v1
    v_smfmac_f32_16x16x64_bf16 v[28:31], v[56:59], a[80:87], v1
    v_smfmac_f32_16x16x64_bf16 v[28:31], v[60:63], a[88:95], v1
    v_smfmac_f32_16x16x64_bf16 v[28:31], v[64:67], a[96:103], v1
    v_smfmac_f32_16x16x64_bf16 v[28:31], v[68:71], a[104:111], v1
    v_smfmac_f32_16x16x64_bf16 v[28:31], v[72:75], a[112:119], v1
    v_smfmac_f32_16x16x64_bf16 v[28:31], v[76:79], a[120:127], v1
    v_smfmac_f32_16x16x64_bf16 v[28:31], v[80:83], a[128:135], v1
    v_smfmac_f32_16x16x64_bf16 v[28:31], v[84:87], a[136:143], v1
    v_permlane32_swap_b32 v24, v26
    v_smfmac_f32_16x16x64_bf16 v[28:31], v[88:91], a[144:151], v1
    v_permlane32_swap_b32 v25, v27
    v_smfmac_f32_16x16x64_bf16 v[28:31], v[92:95], a[152:159], v1
    v_add_f32 v24, v24, v26
    v_add_f32 v25, v25, v27
    v_smfmac_f32_16x16x64_bf16 v[32:35], v[56:59], a[160:167], v1
    v_cvt_pk_bf16_f32 v10, v24, v25
    ds_write_b32 v0, v10 offset:19968
    v_smfmac_f32_16x16x64_bf16 v[32:35], v[60:63], a[168:175], v1
    v_accvgpr_write_b32 a244, v10
    v_smfmac_f32_16x16x64_bf16 v[32:35], v[64:67], a[176:183], v1
    buffer_load_dwordx4 v[16:19], v0, s[36:39], s56 offen offset:0 sc1
    buffer_load_dwordx4 v[20:23], v0, s[36:39], s56 offen offset:1024 sc1
    v_smfmac_f32_16x16x64_bf16 v[32:35], v[68:71], a[184:191], v1
    buffer_load_dwordx4 v[36:39], v0, s[36:39], s56 offen offset:2048 sc1
    buffer_load_dwordx4 v[40:43], v0, s[36:39], s56 offen offset:3072 sc1
    v_smfmac_f32_16x16x64_bf16 v[32:35], v[72:75], a[192:199], v1
    v_smfmac_f32_16x16x64_bf16 v[32:35], v[76:79], a[200:207], v1
    s_nop 1
    v_smfmac_f32_16x16x64_bf16 v[32:35], v[80:83], a[208:215], v1
    v_permlane32_swap_b32 v28, v30
    v_smfmac_f32_16x16x64_bf16 v[32:35], v[84:87], a[216:223], v1
    v_permlane32_swap_b32 v29, v31
    v_smfmac_f32_16x16x64_bf16 v[32:35], v[88:91], a[224:231], v1
    v_add_f32 v28, v28, v30
    v_add_f32 v29, v29, v31
    v_smfmac_f32_16x16x64_bf16 v[32:35], v[92:95], a[232:239], v1
    v_cvt_pk_bf16_f32 v11, v28, v29
    ds_write_b32 v0, v11 offset:20992
    v_accvgpr_write_b32 a248, v11
    s_nop 6
    v_permlane32_swap_b32 v32, v34
    v_permlane32_swap_b32 v33, v35
    v_pk_add_f32 v[32:33], v[32:33], v[34:35]
    v_cvt_pk_bf16_f32 v10, v32, v33
    ds_write_b32 v0, v10 offset:22016
    v_accvgpr_write_b32 a252, v10
    s_cmp_eq_u32 s6, 63
    s_cbranch_scc1 L_rec_0_fin
    s_add_u32 m0, s46, 0
    v_and_b32 v25, 0x1ff, v0
    v_and_b32 v26, 0x1ff, v3
    v_mov_b32 v27, 40.0
L_ps_44_a:
    s_waitcnt vmcnt(3) lgkmcnt(0)
    v_perm_b32 v72, v18, v17, s74
    v_perm_b32 v72, v19, v72, s75
    s_waitcnt vmcnt(2)
    v_perm_b32 v73, v22, v21, s74
    v_pk_add_f32 v[68:69], v[16:17], v[20:21]
    v_perm_b32 v73, v23, v73, s75
    v_pk_add_f32 v[70:71], v[18:19], v[22:23]
    v_add_f32 v72, v72, v73
    v_perm_b32 v74, v16, v20, s72
    s_waitcnt vmcnt(1)
    v_perm_b32 v73, v38, v37, s74
    v_pk_add_f32 v[68:69], v[68:69], v[36:37]
    v_perm_b32 v73, v39, v73, s75
    v_pk_add_f32 v[70:71], v[70:71], v[38:39]
    v_add_f32 v72, v72, v73
    v_perm_b32 v74, v36, v74, s73
    s_waitcnt vmcnt(0)
    v_perm_b32 v74, v40, v74, s89
    v_perm_b32 v73, v42, v41, s74
    v_cmp_ne_u32 vcc, s66, v74
    v_perm_b32 v73, v43, v73, s75
    v_pk_add_f32 v[68:69], v[68:69], v[40:41]
    v_pk_add_f32 v[70:71], v[70:71], v[42:43]
    v_add_f32 v72, v72, v73
    v_max3_f32 v73, |v68|, |v69|, |v70|
    v_max3_f32 v73, v73, |v71|, |v72|
    s_cbranch_vccnz L_ps_44_r
L_ps_44_j:
    v_cmp_nle_f32 vcc, v73, v27
    s_barrier
L_ps_44_x:
    v_exp_f32 v32, v72
    v_exp_f32 v28, v68
    v_exp_f32 v29, v69
    s_cbranch_vccnz L_ps_44_m
    v_mov_b32_dpp v74, v32 row_ror:8 row_mask:0xf bank_mask:0xf
    v_cvt_pk_bf16_f32 v12, v32, v74
    v_exp_f32 v30, v70
    v_cvt_pk_bf16_f32 v76, v28, v29
    v_mfma_f32_16x16x32_bf16 v[60:63], a[248:251], v[12:15], 0
    buffer_load_dwordx4 v0, s[36:39], s61 offen offset:0 sc1 lds
    v_exp_f32 v31, v71
    v_mfma_f32_16x16x32_bf16 v[56:59], a[244:247], v[12:15], 0
    buffer_load_dwordx4 v0, s[36:39], s61 offen offset:1024 sc1 lds
    v_cvt_pk_bf16_f32 v77, v30, v31
    v_mov_b32_dpp v78, v76 row_ror:8 row_mask:0xf bank_mask:0xf
    v_mfma_f32_16x16x32_bf16 v[64:67], a[252:255], v[12:15], 0
    v_mov_b32_dpp v79, v77 row_ror:8 row_mask:0xf bank_mask:0xf
    v_add_f32 v73, v28, v29
    v_add_f32 v75, v30, v31
    v_mfma_f32_16x16x32_bf16 v[60:63], v[48:51], v[76:79], v[60:63]
    v_add_f32 v73, v73, v32
    v_add_f32 v73, v73, v75
    v_mfma_f32_16x16x32_bf16 v[56:59], v[44:47], v[76:79], v[56:59]
    s_nop 0
    v_add_f32_dpp v74, v73, v73 row_ror:8 row_mask:0xf bank_mask:0xf
    v_mfma_f32_16x16x32_bf16 v[64:67], v[52:55], v[76:79], v[64:67]
    v_add_f32_dpp v75, v73, v73 row_ror:8 row_mask:0xf bank_mask:0xf
    s_nop 1
    v_permlane16_swap_b32 v74, v75
    v_add_f32 v73, v74, v75
    v_add_f32 v74, v74, v75
    v_mov_b32_dpp v56, v60 row_ror:8 row_mask:0xf bank_mask:0xc
    v_mov_b32_dpp v57, v61 row_ror:8 row_mask:0xf bank_mask:0xc
    v_permlane32_swap_b32 v73, v74
    v_mov_b32_dpp v58, v62 row_ror:8 row_mask:0xf bank_mask:0xc
    v_mov_b32_dpp v59, v63 row_ror:8 row_mask:0xf bank_mask:0xc
    ds_write_b128 v0, v[56:59] offset:13312
    v_add_f32 v73, v73, v74
    v_rcp_f32 v73, v73
    v_mov_b32_dpp v64, v66 row_ror:8 row_mask:0xf bank_mask:0xc
    v_mov_b32_dpp v65, v67 row_ror:8 row_mask:0xf bank_mask:0xc
    ds_write_b32 v26, v73 offset:19456
    ds_write_b64 v5, v[64:65] offset:14336
    s_waitcnt lgkmcnt(0)
    s_barrier
    s_waitcnt vmcnt(2) lgkmcnt(0)
    v_mov_b32 v43, v25
    v_mov_b32 v16, 0
    v_mov_b32 v17, 0
    v_mov_b32 v18, 0
    v_mov_b32 v19, 0
    v_mov_b32 v20, 0
    v_mov_b32 v21, 0
    v_mov_b32 v22, 0
    v_mov_b32 v23, 0
    v_mov_b32 v24, 0
    v_mov_b32 v25, 0
    v_mov_b32 v26, 0
    v_mov_b32 v27, 0
    v_mov_b32 v28, 0
    v_mov_b32 v29, 0
    v_mov_b32 v30, 0
    v_mov_b32 v31, 0
    v_mov_b32 v32, 0
    v_mov_b32 v33, 0
    v_mov_b32 v34, 0
    v_mov_b32 v35, 0
    s_and_b32 s68, s65, 3
    s_mul_i32 s53, s68, 40960
    s_add_u32 s53, s53, s87
    s_mov_b32 s59, s57
    s_add_u32 s6, s6, 1
    s_and_b32 s68, s6, 3
    s_mul_i32 s52, s68, 40960
    s_add_u32 s52, s52, s87
    s_add_u32 s52, s52, 0
    s_mul_i32 s57, s68, 196608
    s_add_u32 s65, s6, 1
    s_mul_i32 s66, s65, 0x01010101
    s_mov_b32 s45, s46
    s_add_u32 s46, s46, 15360
    s_cmp_ge_u32 s46, 161280
    s_cselect_b32 s46, 23040, s46
    s_sleep 1
    buffer_load_dwordx4 v43, s[36:39], s61 offen offset:2048 sc1 lds
    s_add_u32 s61, s61, 1310720
    s_sleep 6
    s_nop 3
    buffer_load_dwordx4 v[60:63], v6, s[36:39], s59 offen offset:0 sc1
    buffer_load_dwordx4 v[64:67], v7, s[36:39], s59 offen offset:0 sc1
    s_nop 15
    s_nop 15
    s_nop 15
    buffer_load_dwordx4 v[68:71], v6, s[36:39], s59 offen offset:0 sc1
    buffer_load_dwordx4 v[72:75], v7, s[36:39], s59 offen offset:0 sc1
    s_nop 15
    s_nop 15
    s_nop 15
L_pg_45:
    buffer_load_dwordx4 v[76:79], v6, s[36:39], s59 offen offset:0 sc1
    buffer_load_dwordx4 v[80:83], v7, s[36:39], s59 offen offset:0 sc1
    s_waitcnt vmcnt(4)
    v_mfma_f32_16x16x32_bf16 v[56:59], a[240:243], v[60:63], 0
    v_max3_u32 v40, v60, v62, v64
    v_max_u32 v40, v40, v66
    v_mfma_f32_16x16x32_bf16 v[56:59], a[240:243], v[64:67], v[56:59]
    v_cmp_eq_u32 vcc, -1, v40
    s_nop 4
    s_cbranch_vccz L_pg_45_ok
    buffer_load_dwordx4 v[60:63], v6, s[36:39], s59 offen offset:0 sc1
    buffer_load_dwordx4 v[64:67], v7, s[36:39], s59 offen offset:0 sc1
    s_waitcnt vmcnt(4)
    v_mfma_f32_16x16x32_bf16 v[56:59], a[240:243], v[68:71], 0
    v_max3_u32 v40, v68, v70, v72
    v_max_u32 v40, v40, v74
    v_mfma_f32_16x16x32_bf16 v[56:59], a[240:243], v[72:75], v[56:59]
    v_cmp_eq_u32 vcc, -1, v40
    s_nop 4
    s_cbranch_vccz L_pg_45_ok
    buffer_load_dwordx4 v[68:71], v6, s[36:39], s59 offen offset:0 sc1
    buffer_load_dwordx4 v[72:75], v7, s[36:39], s59 offen offset:0 sc1
    s_waitcnt vmcnt(4)
    v_mfma_f32_16x16x32_bf16 v[56:59], a[240:243], v[76:79], 0
    v_max3_u32 v40, v76, v78, v80
    v_max_u32 v40, v40, v82
    v_mfma_f32_16x16x32_bf16 v[56:59], a[240:243], v[80:83], v[56:59]
    v_cmp_eq_u32 vcc, -1, v40
    s_nop 4
    s_cbranch_vccz L_pg_45_ok
    s_add_u32 s7, s7, 1
    s_cmp_gt_u32 s7, 400000
    s_cbranch_scc1 L_exit
    s_branch L_pg_45
L_pg_45_ok:
    s_mov_b64 exec, s[78:79]
    v_cvt_pk_bf16_f32 v40, v56, v57
    v_cvt_pk_bf16_f32 v41, v58, v59
    v_min_u32 v40, -2, v40
    v_min_u32 v41, -2, v41
    buffer_store_dwordx2 v[40:41], v8, s[36:39], s53 offen offset:0
    s_mov_b64 exec, -1
    s_barrier
    s_mov_b32 m0, 0
    s_nop 15
    s_nop 15
    s_branch L_rec_0_top0
L_rec_0_fin:
    s_waitcnt lgkmcnt(0)
    s_barrier
    s_branch L_rec_done
L_rec_1:
    v_min_u32 v64, 9, v41
    v_add_u32 v65, 10, v64
    v_lshlrev_b32 v65, 4, v65
    s_and_b32 s68, s5, 1
    s_mul_i32 s69, s68, 384
    s_mul_i32 s70, s83, 1536
    s_add_u32 s69, s69, s70
    v_add_u32 v65, s69, v65
    v_and_b32 v66, 1, v42
    v_mul_u32_u24 v66, 768, v66
    v_add_u32 v65, v65, v66
    v_lshrrev_b32 v66, 1, v42
    v_add_u32 v66, 0, v66
    v_mul_u32_u24 v67, 24576, v66
    v_add_u32 v6, v65, v67
    v_lshrrev_b32 v67, 13, v6
    v_lshl_add_u32 v6, v67, 13, v6
    v_add_u32 v6, s71, v6
    v_xor_b32 v67, 8192, v6
    s_lshl_b32 s70, s4, 0
    v_cmp_eq_u32 vcc, s70, v66
    s_nop 1
    v_cndmask_b32 v6, v6, v67, vcc
    v_lshrrev_b32 v66, 1, v42
    v_add_u32 v66, 2, v66
    v_mul_u32_u24 v67, 24576, v66
    v_add_u32 v7, v65, v67
    v_lshrrev_b32 v67, 13, v7
    v_lshl_add_u32 v7, v67, 13, v7
    v_add_u32 v7, s71, v7
    v_xor_b32 v67, 8192, v7
    s_lshl_b32 s70, s4, 0
    v_cmp_eq_u32 vcc, s70, v66
    s_nop 1
    v_cndmask_b32 v7, v7, v67, vcc
    v_lshrrev_b32 v66, 1, v64
    v_lshlrev_b32 v66, 7, v66
    v_and_b32 v67, 1, v64
    v_lshl_add_u32 v66, v67, 4, v66
    v_lshl_add_u32 v66, v42, 3, v66
    s_mul_i32 s69, s83, 640
    s_lshl_b32 s68, s68, 6
    s_add_u32 s69, s69, s68
    s_add_u32 s69, s69, 32
    v_add_u32 v8, s69, v66
    s_mov_b32 s78, 0x03ff03ff
    s_mov_b32 s79, 0
    v_mov_b32 v68, 0
    v_and_b32 v64, 1, v41
    v_lshlrev_b32 v64, 4, v64
    v_mov_b32 v65, 0x3f80
    v_lshlrev_b32 v64, v64, v65
    v_lshrrev_b32 v65, 1, v41
    v_add_u32 v65, 0, v65
    v_lshlrev_b32 v66, 2, v68
    v_sub_u32 v65, v65, v66
    v_cmp_eq_u32 vcc, 0, v65
    s_nop 1
    v_cndmask_b32 v72, 0, v64, vcc
    v_cmp_eq_u32 vcc, 1, v65
    s_nop 1
    v_cndmask_b32 v73, 0, v64, vcc
    v_cmp_eq_u32 vcc, 2, v65
    s_nop 1
    v_cndmask_b32 v74, 0, v64, vcc
    v_cmp_eq_u32 vcc, 3, v65
    s_nop 1
    v_cndmask_b32 v75, 0, v64, vcc
    v_accvgpr_write_b32 a240, v72
    v_accvgpr_write_b32 a241, v73
    v_accvgpr_write_b32 a242, v74
    v_accvgpr_write_b32 a243, v75
    s_barrier
    s_add_u32 m0, s46, 3072
    v_and_b32 v44, 0x1ff, v0
    buffer_load_dwordx4 v0, s[36:39], s61 offen offset:0 sc1 lds
    buffer_load_dwordx4 v0, s[36:39], s61 offen offset:1024 sc1 lds
    buffer_load_dwordx4 v44, s[36:39], s61 offen offset:2048 sc1 lds
    s_add_u32 s61, s61, 1310720
    s_and_b32 s68, s6, 3
    s_mul_i32 s52, s68, 40960
    s_add_u32 s52, s52, s87
    s_add_u32 s52, s52, 3072
    s_mul_i32 s57, s68, 196608
    s_add_u32 s65, s6, 1
    s_mul_i32 s66, s65, 0x01010101
    s_mov_b32 s45, s46
    s_add_u32 s46, s46, 15360
    s_cmp_ge_u32 s46, 161280
    s_cselect_b32 s46, 23040, s46
    buffer_load_dwordx4 v[68:71], v40, s[40:43], 0 offen offset:384
    buffer_load_dwordx4 v[72:75], v40, s[40:43], 0 offen offset:512
    buffer_load_dwordx4 v[76:79], v40, s[40:43], 0 offen offset:640
    v_mov_b32 v16, 0
    v_mov_b32 v17, 0
    v_mov_b32 v18, 0
    v_mov_b32 v19, 0
    v_mov_b32 v20, 0
    v_mov_b32 v21, 0
    v_mov_b32 v22, 0
    v_mov_b32 v23, 0
    v_mov_b32 v24, 0
    v_mov_b32 v25, 0
    v_mov_b32 v26, 0
    v_mov_b32 v27, 0
    v_mov_b32 v28, 0
    v_mov_b32 v29, 0
    v_mov_b32 v30, 0
    v_mov_b32 v31, 0
    v_mov_b32 v32, 0
    v_mov_b32 v33, 0
    v_mov_b32 v34, 0
    v_mov_b32 v35, 0
    s_waitcnt vmcnt(0)
    ds_write_b128 v0, v[68:71] offset:3072
    ds_write_b128 v0, v[72:75] offset:4096
    ds_write_b128 v0, v[76:79] offset:5120
    s_waitcnt lgkmcnt(0)
    s_branch L_rec_1_m
    .p2align 6
L_rec_1_top0:
    buffer_load_dwordx4 v0, s[36:39], s52 offen offset:0 sc1 lds
    buffer_load_dwordx4 v0, s[36:39], s52 offen offset:1024 sc1 lds
    buffer_load_dwordx4 v0, s[36:39], s52 offen offset:2048 sc1 lds
    s_nop 11
L_rec_1_top:
    buffer_load_dwordx4 v0, s[36:39], s52 offen offset:0 sc1 lds
    buffer_load_dwordx4 v0, s[36:39], s52 offen offset:1024 sc1 lds
    buffer_load_dwordx4 v0, s[36:39], s52 offen offset:2048 sc1 lds
    s_waitcnt vmcnt(5)
    ds_read_b128 v[68:71], v0 offset:3072
    s_waitcnt vmcnt(4)
    ds_read_b128 v[72:75], v0 offset:4096
    s_waitcnt vmcnt(3)
    ds_read_b128 v[76:79], v0 offset:5120
    s_waitcnt lgkmcnt(2)
    v_max3_u32 v40, v68, v69, v70
    s_waitcnt lgkmcnt(1)
    v_max3_u32 v41, v71, v72, v73
    v_max3_u32 v40, v40, v74, v75
    s_waitcnt lgkmcnt(0)
    v_max3_u32 v41, v41, v76, v77
    v_max3_u32 v40, v40, v78, v79
    v_max_u32 v40, v40, v41
    v_cmp_eq_u32 vcc, -1, v40
    s_cbranch_vccnz L_rm_46
L_rec_1_m:
    s_barrier
    ds_read_b128 v[56:59], v0 offset:0
    v_smfmac_f32_16x16x64_bf16 v[16:19], v[68:71], v[120:127], v1
    ds_read_b128 v[60:63], v0 offset:1024
    ds_read_b128 v[64:67], v0 offset:2048
    ds_read_b128 v[80:83], v0 offset:6144
    v_smfmac_f32_16x16x64_bf16 v[16:19], v[72:75], v[128:135], v1
    ds_read_b128 v[84:87], v0 offset:7168
    ds_read_b128 v[88:91], v0 offset:8192
    ds_read_b128 v[92:95], v0 offset:9216
    v_smfmac_f32_16x16x64_bf16 v[16:19], v[76:79], v[136:143], v1
    s_waitcnt lgkmcnt(6)
    v_smfmac_f32_16x16x64_bf16 v[16:19], v[56:59], v[96:103], v1
    s_waitcnt lgkmcnt(5)
    v_smfmac_f32_16x16x64_bf16 v[16:19], v[60:63], v[104:111], v1
    s_waitcnt lgkmcnt(4)
    v_smfmac_f32_16x16x64_bf16 v[16:19], v[64:67], v[112:119], v1
    s_waitcnt lgkmcnt(3)
    v_smfmac_f32_16x16x64_bf16 v[16:19], v[80:83], v[144:151], v1
    s_waitcnt lgkmcnt(2)
    v_smfmac_f32_16x16x64_bf16 v[16:19], v[84:87], v[152:159], v1
    s_waitcnt lgkmcnt(1)
    v_smfmac_f32_16x16x64_bf16 v[16:19], v[88:91], v[160:167], v1
    s_waitcnt lgkmcnt(0)
    v_smfmac_f32_16x16x64_bf16 v[16:19], v[92:95], v[168:175], v1
    v_smfmac_f32_16x16x64_bf16 v[20:23], v[68:71], v[200:207], v1
    s_nop 2
    v_smfmac_f32_16x16x64_bf16 v[20:23], v[72:75], v[208:215], v1
    s_nop 2
    v_smfmac_f32_16x16x64_bf16 v[20:23], v[76:79], v[216:223], v1
    v_permlane32_swap_b32 v16, v18
    v_smfmac_f32_16x16x64_bf16 v[20:23], v[56:59], v[176:183], v1
    v_permlane32_swap_b32 v17, v19
    v_smfmac_f32_16x16x64_bf16 v[20:23], v[60:63], v[184:191], v1
    v_add_f32 v16, v16, v18
    v_add_f32 v17, v17, v19
    v_smfmac_f32_16x16x64_bf16 v[20:23], v[64:67], v[192:199], v1
    v_cvt_pk_bf16_f32 v40, v16, v17
    ds_write_b32 v2, v40 offset:10240
    v_smfmac_f32_16x16x64_bf16 v[20:23], v[80:83], v[224:231], v1
    v_smfmac_f32_16x16x64_bf16 v[20:23], v[84:87], v[232:239], v1
    v_smfmac_f32_16x16x64_bf16 v[20:23], v[88:91], v[240:247], v1
    v_smfmac_f32_16x16x64_bf16 v[20:23], v[92:95], v[248:255], v1
    s_waitcnt lgkmcnt(0)
    s_barrier
    s_nop 5
    v_permlane32_swap_b32 v20, v22
    v_permlane32_swap_b32 v21, v23
    v_pk_add_f32 v[20:21], v[20:21], v[22:23]
    v_cvt_pk_bf16_f32 v41, v20, v21
    ds_write_b32 v4, v41 offset:11264
    v_smfmac_f32_16x16x64_bf16 v[24:27], v[56:59], a[0:7], v1
    v_smfmac_f32_16x16x64_bf16 v[24:27], v[60:63], a[8:15], v1
    s_waitcnt lgkmcnt(0)
    s_barrier
    v_smfmac_f32_16x16x64_bf16 v[24:27], v[64:67], a[16:23], v1
    v_add_u32 v11, s45, v3
    ds_read_b128 v[44:47], v11 offset:3072
    v_smfmac_f32_16x16x64_bf16 v[24:27], v[68:71], a[24:31], v1
    ds_read_b128 v[48:51], v11 offset:4096
    ds_read_b128 v[52:55], v11 offset:5120
    v_smfmac_f32_16x16x64_bf16 v[24:27], v[72:75], a[32:39], v1
    v_smfmac_f32_16x16x64_bf16 v[24:27], v[76:79], a[40:47], v1
    v_smfmac_f32_16x16x64_bf16 v[24:27], v[80:83], a[48:55], v1
    v_smfmac_f32_16x16x64_bf16 v[24:27], v[84:87], a[56:63], v1
    v_smfmac_f32_16x16x64_bf16 v[24:27], v[88:91], a[64:71], v1
    v_smfmac_f32_16x16x64_bf16 v[24:27], v[92:95], a[72:79], v1
    v_smfmac_f32_16x16x64_bf16 v[28:31], v[56:59], a[80:87], v1
    v_smfmac_f32_16x16x64_bf16 v[28:31], v[60:63], a[88:95], v1
    v_smfmac_f32_16x16x64_bf16 v[28:31], v[64:67], a[96:103], v1
    v_smfmac_f32_16x16x64_bf16 v[28:31], v[68:71], a[104:111], v1
    v_smfmac_f32_16x16x64_bf16 v[28:31], v[72:75], a[112:119], v1
    v_smfmac_f32_16x16x64_bf16 v[28:31], v[76:79], a[120:127], v1
    v_smfmac_f32_16x16x64_bf16 v[28:31], v[80:83], a[128:135], v1
    v_smfmac_f32_16x16x64_bf16 v[28:31], v[84:87], a[136:143], v1
    v_permlane32_swap_b32 v24, v26
    v_smfmac_f32_16x16x64_bf16 v[28:31], v[88:91], a[144:151], v1
    v_permlane32_swap_b32 v25, v27
    v_smfmac_f32_16x16x64_bf16 v[28:31], v[92:95], a[152:159], v1
    v_add_f32 v24, v24, v26
    v_add_f32 v25, v25, v27
    v_smfmac_f32_16x16x64_bf16 v[32:35], v[56:59], a[160:167], v1
    v_cvt_pk_bf16_f32 v10, v24, v25
    ds_write_b32 v0, v10 offset:19972
    v_smfmac_f32_16x16x64_bf16 v[32:35], v[60:63], a[168:175], v1
    v_accvgpr_write_b32 a244, v10
    v_smfmac_f32_16x16x64_bf16 v[32:35], v[64:67], a[176:183], v1
    buffer_load_dwordx4 v[16:19], v0, s[36:39], s56 offen offset:0 sc1
    buffer_load_dwordx4 v[20:23], v0, s[36:39], s56 offen offset:1024 sc1
    v_smfmac_f32_16x16x64_bf16 v[32:35], v[68:71], a[184:191], v1
    buffer_load_dwordx4 v[36:39], v0, s[36:39], s56 offen offset:2048 sc1
    buffer_load_dwordx4 v[40:43], v0, s[36:39], s56 offen offset:3072 sc1
    v_smfmac_f32_16x16x64_bf16 v[32:35], v[72:75], a[192:199], v1
    v_smfmac_f32_16x16x64_bf16 v[32:35], v[76:79], a[200:207], v1
    s_nop 1
    v_smfmac_f32_16x16x64_bf16 v[32:35], v[80:83], a[208:215], v1
    v_permlane32_swap_b32 v28, v30
    v_smfmac_f32_16x16x64_bf16 v[32:35], v[84:87], a[216:223], v1
    v_permlane32_swap_b32 v29, v31
    v_smfmac_f32_16x16x64_bf16 v[32:35], v[88:91], a[224:231], v1
    v_add_f32 v28, v28, v30
    v_add_f32 v29, v29, v31
    v_smfmac_f32_16x16x64_bf16 v[32:35], v[92:95], a[232:239], v1
    v_cvt_pk_bf16_f32 v11, v28, v29
    ds_write_b32 v0, v11 offset:20996
    v_accvgpr_write_b32 a248, v11
    s_nop 6
    v_permlane32_swap_b32 v32, v34
    v_permlane32_swap_b32 v33, v35
    v_pk_add_f32 v[32:33], v[32:33], v[34:35]
    v_cvt_pk_bf16_f32 v10, v32, v33
    ds_write_b32 v0, v10 offset:22020
    v_accvgpr_write_b32 a252, v10
    s_cmp_eq_u32 s6, 63
    s_cbranch_scc1 L_rec_1_fin
    s_add_u32 m0, s46, 3072
    v_and_b32 v25, 0x1ff, v0
    v_and_b32 v26, 0x1ff, v3
    v_mov_b32 v27, 40.0
L_ps_47_a:
    s_waitcnt vmcnt(3) lgkmcnt(0)
    v_perm_b32 v72, v18, v17, s74
    v_perm_b32 v72, v19, v72, s75
    s_waitcnt vmcnt(2)
    v_perm_b32 v73, v22, v21, s74
    v_pk_add_f32 v[68:69], v[16:17], v[20:21]
    v_perm_b32 v73, v23, v73, s75
    v_pk_add_f32 v[70:71], v[18:19], v[22:23]
    v_add_f32 v72, v72, v73
    v_perm_b32 v74, v16, v20, s72
    s_waitcnt vmcnt(1)
    v_perm_b32 v73, v38, v37, s74
    v_pk_add_f32 v[68:69], v[68:69], v[36:37]
    v_perm_b32 v73, v39, v73, s75
    v_pk_add_f32 v[70:71], v[70:71], v[38:39]
    v_add_f32 v72, v72, v73
    v_perm_b32 v74, v36, v74, s73
    s_waitcnt vmcnt(0)
    v_perm_b32 v74, v40, v74, s89
    v_perm_b32 v73, v42, v41, s74
    v_cmp_ne_u32 vcc, s66, v74
    v_perm_b32 v73, v43, v73, s75
    v_pk_add_f32 v[68:69], v[68:69], v[40:41]
    v_pk_add_f32 v[70:71], v[70:71], v[42:43]
    v_add_f32 v72, v72, v73
    v_max3_f32 v73, |v68|, |v69|, |v70|
    v_max3_f32 v73, v73, |v71|, |v72|
    s_cbranch_vccnz L_ps_47_r
L_ps_47_j:
    v_cmp_nle_f32 vcc, v73, v27
    s_barrier
L_ps_47_x:
    v_exp_f32 v32, v72
    v_exp_f32 v28, v68
    v_exp_f32 v29, v69
    s_cbranch_vccnz L_ps_47_m
    v_mov_b32_dpp v74, v32 row_ror:8 row_mask:0xf bank_mask:0xf
    v_cvt_pk_bf16_f32 v12, v32, v74
    v_exp_f32 v30, v70
    v_cvt_pk_bf16_f32 v76, v28, v29
    v_mfma_f32_16x16x32_bf16 v[60:63], a[248:251], v[12:15], 0
    buffer_load_dwordx4 v0, s[36:39], s61 offen offset:0 sc1 lds
    v_exp_f32 v31, v71
    v_mfma_f32_16x16x32_bf16 v[56:59], a[244:247], v[12:15], 0
    buffer_load_dwordx4 v0, s[36:39], s61 offen offset:1024 sc1 lds
    v_cvt_pk_bf16_f32 v77, v30, v31
    v_mov_b32_dpp v78, v76 row_ror:8 row_mask:0xf bank_mask:0xf
    v_mfma_f32_16x16x32_bf16 v[64:67], a[252:255], v[12:15], 0
    v_mov_b32_dpp v79, v77 row_ror:8 row_mask:0xf bank_mask:0xf
    v_add_f32 v73, v28, v29
    v_add_f32 v75, v30, v31
    v_mfma_f32_16x16x32_bf16 v[60:63], v[48:51], v[76:79], v[60:63]
    v_add_f32 v73, v73, v32
    v_add_f32 v73, v73, v75
    v_mfma_f32_16x16x32_bf16 v[56:59], v[44:47], v[76:79], v[56:59]
    s_nop 0
    v_add_f32_dpp v74, v73, v73 row_ror:8 row_mask:0xf bank_mask:0xf
    v_mfma_f32_16x16x32_bf16 v[64:67], v[52:55], v[76:79], v[64:67]
    v_add_f32_dpp v75, v73, v73 row_ror:8 row_mask:0xf bank_mask:0xf
    s_nop 1
    v_permlane16_swap_b32 v74, v75
    v_add_f32 v73, v74, v75
    v_add_f32 v74, v74, v75
    v_mov_b32_dpp v56, v60 row_ror:8 row_mask:0xf bank_mask:0xc
    v_mov_b32_dpp v57, v61 row_ror:8 row_mask:0xf bank_mask:0xc
    v_permlane32_swap_b32 v73, v74
    v_mov_b32_dpp v58, v62 row_ror:8 row_mask:0xf bank_mask:0xc
    v_mov_b32_dpp v59, v63 row_ror:8 row_mask:0xf bank_mask:0xc
    ds_write_b128 v0, v[56:59] offset:14848
    v_add_f32 v73, v73, v74
    v_rcp_f32 v73, v73
    v_mov_b32_dpp v64, v66 row_ror:8 row_mask:0xf bank_mask:0xc
    v_mov_b32_dpp v65, v67 row_ror:8 row_mask:0xf bank_mask:0xc
    ds_write_b32 v26, v73 offset:19460
    ds_write_b64 v5, v[64:65] offset:15872
    s_waitcnt lgkmcnt(0)
    s_barrier
    s_waitcnt vmcnt(2) lgkmcnt(0)
    v_mov_b32 v43, v25
    v_mov_b32 v16, 0
    v_mov_b32 v17, 0
    v_mov_b32 v18, 0
    v_mov_b32 v19, 0
    v_mov_b32 v20, 0
    v_mov_b32 v21, 0
    v_mov_b32 v22, 0
    v_mov_b32 v23, 0
    v_mov_b32 v24, 0
    v_mov_b32 v25, 0
    v_mov_b32 v26, 0
    v_mov_b32 v27, 0
    v_mov_b32 v28, 0
    v_mov_b32 v29, 0
    v_mov_b32 v30, 0
    v_mov_b32 v31, 0
    v_mov_b32 v32, 0
    v_mov_b32 v33, 0
    v_mov_b32 v34, 0
    v_mov_b32 v35, 0
    s_and_b32 s68, s65, 3
    s_mul_i32 s53, s68, 40960
    s_add_u32 s53, s53, s87
    s_mov_b32 s59, s57
    s_add_u32 s6, s6, 1
    s_and_b32 s68, s6, 3
    s_mul_i32 s52, s68, 40960
    s_add_u32 s52, s52, s87
    s_add_u32 s52, s52, 3072
    s_mul_i32 s57, s68, 196608
    s_add_u32 s65, s6, 1
    s_mul_i32 s66, s65, 0x01010101
    s_mov_b32 s45, s46
    s_add_u32 s46, s46, 15360
    s_cmp_ge_u32 s46, 161280
    s_cselect_b32 s46, 23040, s46
    s_sleep 1
    buffer_load_dwordx4 v43, s[36:39], s61 offen offset:2048 sc1 lds
    s_add_u32 s61, s61, 1310720
    s_sleep 6
    s_nop 3
    buffer_load_dwordx4 v[60:63], v6, s[36:39], s59 offen offset:0 sc1
    buffer_load_dwordx4 v[64:67], v7, s[36:39], s59 offen offset:0 sc1
    s_nop 15
    s_nop 15
    s_nop 15
    buffer_load_dwordx4 v[68:71], v6, s[36:39], s59 offen offset:0 sc1
    buffer_load_dwordx4 v[72:75], v7, s[36:39], s59 offen offset:0 sc1
    s_nop 15
    s_nop 15
    s_nop 15
L_pg_48:
    buffer_load_dwordx4 v[76:79], v6, s[36:39], s59 offen offset:0 sc1
    buffer_load_dwordx4 v[80:83], v7, s[36:39], s59 offen offset:0 sc1
    s_waitcnt vmcnt(4)
    v_mfma_f32_16x16x32_bf16 v[56:59], a[240:243], v[60:63], 0
    v_max3_u32 v40, v60, v62, v64
    v_max_u32 v40, v40, v66
    v_mfma_f32_16x16x32_bf16 v[56:59], a[240:243], v[64:67], v[56:59]
    v_cmp_eq_u32 vcc, -1, v40
    s_nop 4
    s_cbranch_vccz L_pg_48_ok
    buffer_load_dwordx4 v[60:63], v6, s[36:39], s59 offen offset:0 sc1
    buffer_load_dwordx4 v[64:67], v7, s[36:39], s59 offen offset:0 sc1
    s_waitcnt vmcnt(4)
    v_mfma_f32_16x16x32_bf16 v[56:59], a[240:243], v[68:71], 0
    v_max3_u32 v40, v68, v70, v72
    v_max_u32 v40, v40, v74
    v_mfma_f32_16x16x32_bf16 v[56:59], a[240:243], v[72:75], v[56:59]
    v_cmp_eq_u32 vcc, -1, v40
    s_nop 4
    s_cbranch_vccz L_pg_48_ok
    buffer_load_dwordx4 v[68:71], v6, s[36:39], s59 offen offset:0 sc1
    buffer_load_dwordx4 v[72:75], v7, s[36:39], s59 offen offset:0 sc1
    s_waitcnt vmcnt(4)
    v_mfma_f32_16x16x32_bf16 v[56:59], a[240:243], v[76:79], 0
    v_max3_u32 v40, v76, v78, v80
    v_max_u32 v40, v40, v82
    v_mfma_f32_16x16x32_bf16 v[56:59], a[240:243], v[80:83], v[56:59]
    v_cmp_eq_u32 vcc, -1, v40
    s_nop 4
    s_cbranch_vccz L_pg_48_ok
    s_add_u32 s7, s7, 1
    s_cmp_gt_u32 s7, 400000
    s_cbranch_scc1 L_exit
    s_branch L_pg_48
L_pg_48_ok:
    s_mov_b64 exec, s[78:79]
    v_cvt_pk_bf16_f32 v40, v56, v57
    v_cvt_pk_bf16_f32 v41, v58, v59
    v_min_u32 v40, -2, v40
    v_min_u32 v41, -2, v41
    buffer_store_dwordx2 v[40:41], v8, s[36:39], s53 offen offset:0
    s_mov_b64 exec, -1
    s_barrier
    s_mov_b32 m0, 3072
    s_nop 15
    s_nop 15
    s_branch L_rec_1_top0
L_rec_1_fin:
    s_waitcnt lgkmcnt(0)
    s_barrier
    s_branch L_rec_done
L_rec_2:
    v_min_u32 v64, 39, v43
    v_lshlrev_b32 v7, 3, v64
    v_add_u32 v7, s86, v7
    v_add_u32 v7, 0, v7
    v_lshrrev_b32 v65, 13, v7
    v_lshl_add_u32 v7, v65, 13, v7
    v_lshrrev_b32 v65, 1, v64
    v_cmp_le_u32 vcc, 10, v65
    s_nop 1
    v_cndmask_b32 v66, 0, 1, vcc
    v_mul_u32_u24 v67, 10, v66
    v_sub_u32 v65, v65, v67
    v_and_b32 v67, 1, v65
    v_lshl_add_u32 v67, v66, 1, v67
    v_add_u32 v67, 0, v67
    v_lshlrev_b32 v67, 4, v67
    v_lshrrev_b32 v65, 1, v65
    v_and_b32 v64, 1, v64
    v_and_b32 v66, 1, v65
    v_lshl_add_u32 v66, v66, 1, v64
    v_lshlrev_b32 v66, 8, v66
    v_bfe_u32 v68, v65, 1, 1
    v_lshl_add_u32 v66, v68, 7, v66
    v_lshlrev_b32 v64, 7, v64
    v_add_u32 v64, 1024, v64
    v_cmp_eq_u32 vcc, 4, v65
    s_nop 1
    v_cndmask_b32 v66, v66, v64, vcc
    v_add_u32 v6, v66, v67
    s_mov_b32 s78, -1
    s_mov_b32 s79, 0xff
    s_barrier
    s_add_u32 m0, s46, 6144
    v_and_b32 v44, 0x1ff, v0
    buffer_load_dwordx4 v0, s[36:39], s61 offen offset:0 sc1 lds
    buffer_load_dwordx4 v0, s[36:39], s61 offen offset:1024 sc1 lds
    buffer_load_dwordx4 v44, s[36:39], s61 offen offset:2048 sc1 lds
    s_add_u32 s61, s61, 1310720
    s_and_b32 s68, s6, 3
    s_mul_i32 s52, s68, 40960
    s_add_u32 s52, s52, s87
    s_add_u32 s52, s52, 6144
    s_mul_i32 s57, s68, 196608
    s_add_u32 s65, s6, 1
    s_mul_i32 s66, s65, 0x01010101
    s_mov_b32 s45, s46
    s_add_u32 s46, s46, 15360
    s_cmp_ge_u32 s46, 161280
    s_cselect_b32 s46, 23040, s46
    s_add_u32 s57, s57, s71
    s_xor_b32 s58, s57, 8192
    buffer_load_dwordx4 v[80:83], v40, s[40:43], 0 offen offset:768
    buffer_load_dwordx4 v[84:87], v40, s[40:43], 0 offen offset:896
    buffer_load_dwordx4 v[88:91], v40, s[40:43], 0 offen offset:1024
    v_mov_b32 v16, 0
    v_mov_b32 v17, 0
    v_mov_b32 v18, 0
    v_mov_b32 v19, 0
    v_mov_b32 v20, 0
    v_mov_b32 v21, 0
    v_mov_b32 v22, 0
    v_mov_b32 v23, 0
    v_mov_b32 v24, 0
    v_mov_b32 v25, 0
    v_mov_b32 v26, 0
    v_mov_b32 v27, 0
    v_mov_b32 v28, 0
    v_mov_b32 v29, 0
    v_mov_b32 v30, 0
    v_mov_b32 v31, 0
    v_mov_b32 v32, 0
    v_mov_b32 v33, 0
    v_mov_b32 v34, 0
    v_mov_b32 v35, 0
    s_waitcnt vmcnt(0)
    ds_write_b128 v0, v[80:83] offset:6144
    ds_write_b128 v0, v[84:87] offset:7168
    ds_write_b128 v0, v[88:91] offset:8192
    s_waitcnt lgkmcnt(0)
    s_branch L_rec_2_m
    .p2align 6
L_rec_2_top0:
    buffer_load_dwordx4 v0, s[36:39], s52 offen offset:0 sc1 lds
    buffer_load_dwordx4 v0, s[36:39], s52 offen offset:1024 sc1 lds
    buffer_load_dwordx4 v0, s[36:39], s52 offen offset:2048 sc1 lds
    s_nop 11
L_rec_2_top:
    buffer_load_dwordx4 v0, s[36:39], s52 offen offset:0 sc1 lds
    buffer_load_dwordx4 v0, s[36:39], s52 offen offset:1024 sc1 lds
    buffer_load_dwordx4 v0, s[36:39], s52 offen offset:2048 sc1 lds
    s_waitcnt vmcnt(5)
    ds_read_b128 v[80:83], v0 offset:6144
    s_waitcnt vmcnt(4)
    ds_read_b128 v[84:87], v0 offset:7168
    s_waitcnt vmcnt(3)
    ds_read_b128 v[88:91], v0 offset:8192
    s_waitcnt lgkmcnt(2)
    v_max3_u32 v40, v80, v81, v82
    s_waitcnt lgkmcnt(1)
    v_max3_u32 v41, v83, v84, v85
    v_max3_u32 v40, v40, v86, v87
    s_waitcnt lgkmcnt(0)
    v_max3_u32 v41, v41, v88, v89
    v_max3_u32 v40, v40, v90, v91
    v_max_u32 v40, v40, v41
    v_cmp_eq_u32 vcc, -1, v40
    s_cbranch_vccnz L_rm_49
L_rec_2_m:
    s_barrier
    ds_read_b128 v[56:59], v0 offset:0
    v_smfmac_f32_16x16x64_bf16 v[16:19], v[80:83], v[144:151], v1
    ds_read_b128 v[60:63], v0 offset:1024
    ds_read_b128 v[64:67], v0 offset:2048
    ds_read_b128 v[68:71], v0 offset:3072
    v_smfmac_f32_16x16x64_bf16 v[16:19], v[84:87], v[152:159], v1
    ds_read_b128 v[72:75], v0 offset:4096
    ds_read_b128 v[76:79], v0 offset:5120
    ds_read_b128 v[92:95], v0 offset:9216
    v_smfmac_f32_16x16x64_bf16 v[16:19], v[88:91], v[160:167], v1
    s_waitcnt lgkmcnt(6)
    v_smfmac_f32_16x16x64_bf16 v[16:19], v[56:59], v[96:103], v1
    s_waitcnt lgkmcnt(5)
    v_smfmac_f32_16x16x64_bf16 v[16:19], v[60:63], v[104:111], v1
    s_waitcnt lgkmcnt(4)
    v_smfmac_f32_16x16x64_bf16 v[16:19], v[64:67], v[112:119], v1
    s_waitcnt lgkmcnt(3)
    v_smfmac_f32_16x16x64_bf16 v[16:19], v[68:71], v[120:127], v1
    s_waitcnt lgkmcnt(2)
    v_smfmac_f32_16x16x64_bf16 v[16:19], v[72:75], v[128:135], v1
    s_waitcnt lgkmcnt(1)
    v_smfmac_f32_16x16x64_bf16 v[16:19], v[76:79], v[136:143], v1
    s_waitcnt lgkmcnt(0)
    v_smfmac_f32_16x16x64_bf16 v[16:19], v[92:95], v[168:175], v1
    v_smfmac_f32_16x16x64_bf16 v[20:23], v[80:83], v[224:231], v1
    s_nop 2
    v_smfmac_f32_16x16x64_bf16 v[20:23], v[84:87], v[232:239], v1
    s_nop 2
    v_smfmac_f32_16x16x64_bf16 v[20:23], v[88:91], v[240:247], v1
    v_permlane32_swap_b32 v16, v18
    v_smfmac_f32_16x16x64_bf16 v[20:23], v[56:59], v[176:183], v1
    v_permlane32_swap_b32 v17, v19
    v_smfmac_f32_16x16x64_bf16 v[20:23], v[60:63], v[184:191], v1
    v_add_f32 v16, v16, v18
    v_add_f32 v17, v17, v19
    v_smfmac_f32_16x16x64_bf16 v[20:23], v[64:67], v[192:199], v1
    v_cvt_pk_bf16_f32 v40, v16, v17
    ds_write_b32 v2, v40 offset:10240
    v_smfmac_f32_16x16x64_bf16 v[20:23], v[68:71], v[200:207], v1
    v_smfmac_f32_16x16x64_bf16 v[20:23], v[72:75], v[208:215], v1
    v_smfmac_f32_16x16x64_bf16 v[20:23], v[76:79], v[216:223], v1
    v_smfmac_f32_16x16x64_bf16 v[20:23], v[92:95], v[248:255], v1
    s_waitcnt lgkmcnt(0)
    s_barrier
    s_nop 5
    v_permlane32_swap_b32 v20, v22
    v_permlane32_swap_b32 v21, v23
    v_pk_add_f32 v[20:21], v[20:21], v[22:23]
    v_cvt_pk_bf16_f32 v41, v20, v21
    ds_write_b32 v4, v41 offset:11264
    v_smfmac_f32_16x16x64_bf16 v[24:27], v[56:59], a[0:7], v1
    v_smfmac_f32_16x16x64_bf16 v[24:27], v[60:63], a[8:15], v1
    s_waitcnt lgkmcnt(0)
    s_barrier
    v_smfmac_f32_16x16x64_bf16 v[24:27], v[64:67], a[16:23], v1
    v_add_u32 v11, s45, v3
    ds_read_b128 v[44:47], v11 offset:6144
    v_smfmac_f32_16x16x64_bf16 v[24:27], v[68:71], a[24:31], v1
    ds_read_b128 v[48:51], v11 offset:7168
    ds_read_b128 v[52:55], v11 offset:8192
    v_smfmac_f32_16x16x64_bf16 v[24:27], v[72:75], a[32:39], v1
    v_smfmac_f32_16x16x64_bf16 v[24:27], v[76:79], a[40:47], v1
    v_smfmac_f32_16x16x64_bf16 v[24:27], v[80:83], a[48:55], v1
    v_smfmac_f32_16x16x64_bf16 v[24:27], v[84:87], a[56:63], v1
    v_smfmac_f32_16x16x64_bf16 v[24:27], v[88:91], a[64:71], v1
    v_smfmac_f32_16x16x64_bf16 v[24:27], v[92:95], a[72:79], v1
    v_smfmac_f32_16x16x64_bf16 v[28:31], v[56:59], a[80:87], v1
    v_smfmac_f32_16x16x64_bf16 v[28:31], v[60:63], a[88:95], v1
    v_smfmac_f32_16x16x64_bf16 v[28:31], v[64:67], a[96:103], v1
    v_smfmac_f32_16x16x64_bf16 v[28:31], v[68:71], a[104:111], v1
    v_smfmac_f32_16x16x64_bf16 v[28:31], v[72:75], a[112:119], v1
    v_smfmac_f32_16x16x64_bf16 v[28:31], v[76:79], a[120:127], v1
    v_smfmac_f32_16x16x64_bf16 v[28:31], v[80:83], a[128:135], v1
    v_smfmac_f32_16x16x64_bf16 v[28:31], v[84:87], a[136:143], v1
    v_permlane32_swap_b32 v24, v26
    v_smfmac_f32_16x16x64_bf16 v[28:31], v[88:91], a[144:151], v1
    v_permlane32_swap_b32 v25, v27
    v_smfmac_f32_16x16x64_bf16 v[28:31], v[92:95], a[152:159], v1
    v_add_f32 v24, v24, v26
    v_add_f32 v25, v25, v27
    v_smfmac_f32_16x16x64_bf16 v[32:35], v[56:59], a[160:167], v1
    v_cvt_pk_bf16_f32 v10, v24, v25
    ds_write_b32 v0, v10 offset:19976
    v_smfmac_f32_16x16x64_bf16 v[32:35], v[60:63], a[168:175], v1
    v_accvgpr_write_b32 a244, v10
    v_smfmac_f32_16x16x64_bf16 v[32:35], v[64:67], a[176:183], v1
    buffer_load_dwordx4 v[16:19], v0, s[36:39], s56 offen offset:0 sc1
    buffer_load_dwordx4 v[20:23], v0, s[36:39], s56 offen offset:1024 sc1
    v_smfmac_f32_16x16x64_bf16 v[32:35], v[68:71], a[184:191], v1
    buffer_load_dwordx4 v[36:39], v0, s[36:39], s56 offen offset:2048 sc1
    buffer_load_dwordx4 v[40:43], v0, s[36:39], s56 offen offset:3072 sc1
    v_smfmac_f32_16x16x64_bf16 v[32:35], v[72:75], a[192:199], v1
    v_smfmac_f32_16x16x64_bf16 v[32:35], v[76:79], a[200:207], v1
    s_nop 1
    v_smfmac_f32_16x16x64_bf16 v[32:35], v[80:83], a[208:215], v1
    v_permlane32_swap_b32 v28, v30
    v_smfmac_f32_16x16x64_bf16 v[32:35], v[84:87], a[216:223], v1
    v_permlane32_swap_b32 v29, v31
    v_smfmac_f32_16x16x64_bf16 v[32:35], v[88:91], a[224:231], v1
    v_add_f32 v28, v28, v30
    v_add_f32 v29, v29, v31
    v_smfmac_f32_16x16x64_bf16 v[32:35], v[92:95], a[232:239], v1
    v_cvt_pk_bf16_f32 v11, v28, v29
    ds_write_b32 v0, v11 offset:21000
    v_accvgpr_write_b32 a248, v11
    s_nop 6
    v_permlane32_swap_b32 v32, v34
    v_permlane32_swap_b32 v33, v35
    v_pk_add_f32 v[32:33], v[32:33], v[34:35]
    v_cvt_pk_bf16_f32 v10, v32, v33
    ds_write_b32 v0, v10 offset:22024
    v_accvgpr_write_b32 a252, v10
    s_cmp_eq_u32 s6, 63
    s_cbranch_scc1 L_rec_2_fin
    s_add_u32 m0, s46, 6144
    v_and_b32 v25, 0x1ff, v0
    v_and_b32 v26, 0x1ff, v3
    v_mov_b32 v27, 40.0
    v_and_b32 v24, 0x70, v6
L_ps_50_a:
    s_waitcnt vmcnt(3) lgkmcnt(0)
    v_perm_b32 v72, v18, v17, s74
    v_perm_b32 v72, v19, v72, s75
    s_waitcnt vmcnt(2)
    v_perm_b32 v73, v22, v21, s74
    v_pk_add_f32 v[68:69], v[16:17], v[20:21]
    v_perm_b32 v73, v23, v73, s75
    v_pk_add_f32 v[70:71], v[18:19], v[22:23]
    v_add_f32 v72, v72, v73
    v_perm_b32 v74, v16, v20, s72
    s_waitcnt vmcnt(1)
    v_perm_b32 v73, v38, v37, s74
    v_pk_add_f32 v[68:69], v[68:69], v[36:37]
    v_perm_b32 v73, v39, v73, s75
    v_pk_add_f32 v[70:71], v[70:71], v[38:39]
    v_add_f32 v72, v72, v73
    v_perm_b32 v74, v36, v74, s73
    s_waitcnt vmcnt(0)
    v_perm_b32 v74, v40, v74, s89
    v_perm_b32 v73, v42, v41, s74
    v_cmp_ne_u32 vcc, s66, v74
    v_perm_b32 v73, v43, v73, s75
    v_pk_add_f32 v[68:69], v[68:69], v[40:41]
    v_pk_add_f32 v[70:71], v[70:71], v[42:43]
    v_add_f32 v72, v72, v73
    v_max3_f32 v73, |v68|, |v69|, |v70|
    v_max3_f32 v73, v73, |v71|, |v72|
    s_cbranch_vccnz L_ps_50_r
L_ps_50_j:
    v_cmp_nle_f32 vcc, v73, v27
    s_barrier
L_ps_50_x:
    v_exp_f32 v32, v72
    v_exp_f32 v28, v68
    v_exp_f32 v29, v69
    s_cbranch_vccnz L_ps_50_m
    v_mov_b32_dpp v74, v32 row_ror:8 row_mask:0xf bank_mask:0xf
    v_cvt_pk_bf16_f32 v12, v32, v74
    v_exp_f32 v30, v70
    v_cvt_pk_bf16_f32 v76, v28, v29
    v_mfma_f32_16x16x32_bf16 v[60:63], a[248:251], v[12:15], 0
    buffer_load_dwordx4 v0, s[36:39], s61 offen offset:0 sc1 lds
    v_exp_f32 v31, v71
    v_mfma_f32_16x16x32_bf16 v[56:59], a[244:247], v[12:15], 0
    buffer_load_dwordx4 v0, s[36:39], s61 offen offset:1024 sc1 lds
    v_cvt_pk_bf16_f32 v77, v30, v31
    v_mov_b32_dpp v78, v76 row_ror:8 row_mask:0xf bank_mask:0xf
    v_mfma_f32_16x16x32_bf16 v[64:67], a[252:255], v[12:15], 0
    v_mov_b32_dpp v79, v77 row_ror:8 row_mask:0xf bank_mask:0xf
    v_add_f32 v73, v28, v29
    v_add_f32 v75, v30, v31
    v_mfma_f32_16x16x32_bf16 v[60:63], v[48:51], v[76:79], v[60:63]
    v_add_f32 v73, v73, v32
    v_add_f32 v73, v73, v75
    v_mfma_f32_16x16x32_bf16 v[56:59], v[44:47], v[76:79], v[56:59]
    s_nop 0
    v_add_f32_dpp v74, v73, v73 row_ror:8 row_mask:0xf bank_mask:0xf
    v_mfma_f32_16x16x32_bf16 v[64:67], v[52:55], v[76:79], v[64:67]
    v_add_f32_dpp v75, v73, v73 row_ror:8 row_mask:0xf bank_mask:0xf
    s_nop 1
    v_permlane16_swap_b32 v74, v75
    v_add_f32 v73, v74, v75
    v_add_f32 v74, v74, v75
    v_mov_b32_dpp v56, v60 row_ror:8 row_mask:0xf bank_mask:0xc
    v_mov_b32_dpp v57, v61 row_ror:8 row_mask:0xf bank_mask:0xc
    v_permlane32_swap_b32 v73, v74
    v_mov_b32_dpp v58, v62 row_ror:8 row_mask:0xf bank_mask:0xc
    v_mov_b32_dpp v59, v63 row_ror:8 row_mask:0xf bank_mask:0xc
    ds_write_b128 v0, v[56:59] offset:16384
    v_add_f32 v73, v73, v74
    v_rcp_f32 v73, v73
    v_mov_b32_dpp v64, v66 row_ror:8 row_mask:0xf bank_mask:0xc
    v_mov_b32_dpp v65, v67 row_ror:8 row_mask:0xf bank_mask:0xc
    ds_write_b32 v26, v73 offset:19464
    ds_write_b64 v5, v[64:65] offset:17408
    s_mov_b64 exec, s[78:79]
    s_waitcnt lgkmcnt(0)
    s_barrier
    ds_read_b128 v[72:75], v24 offset:19456
    ds_read_b128 v[56:59], v6 offset:13312
    ds_read_b128 v[60:63], v6 offset:14848
    ds_read_b128 v[64:67], v6 offset:16384
    ds_read_b128 v[68:71], v6 offset:17920
    s_waitcnt lgkmcnt(3)
    v_pk_mul_f32 v[76:77], v[56:57], v[72:73] op_sel_hi:[1,0]
    v_pk_mul_f32 v[78:79], v[58:59], v[72:73] op_sel_hi:[1,0]
    s_waitcnt lgkmcnt(2)
    v_pk_fma_f32 v[76:77], v[60:61], v[72:73], v[76:77] op_sel:[0,1,0] op_sel_hi:[1,1,1]
    v_pk_fma_f32 v[78:79], v[62:63], v[72:73], v[78:79] op_sel:[0,1,0] op_sel_hi:[1,1,1]
    s_waitcnt lgkmcnt(1)
    v_pk_fma_f32 v[76:77], v[64:65], v[74:75], v[76:77] op_sel_hi:[1,0,1]
    v_pk_fma_f32 v[78:79], v[66:67], v[74:75], v[78:79] op_sel_hi:[1,0,1]
    s_waitcnt lgkmcnt(0)
    v_pk_fma_f32 v[76:77], v[68:69], v[74:75], v[76:77] op_sel:[0,1,0] op_sel_hi:[1,1,1]
    v_pk_fma_f32 v[78:79], v[70:71], v[74:75], v[78:79] op_sel:[0,1,0] op_sel_hi:[1,1,1]
    v_cvt_pk_bf16_f32 v76, v76, v77
    v_cvt_pk_bf16_f32 v77, v78, v79
    v_min_u32 v76, -2, v76
    buffer_store_dwordx2 v[76:77], v7, s[36:39], s57 offen offset:0 sc1
    buffer_store_dwordx2 v[76:77], v7, s[36:39], s58 offen offset:0
    s_mov_b64 exec, -1
    buffer_load_dwordx4 v25, s[36:39], s61 offen offset:2048 sc1 lds
    s_add_u32 s61, s61, 1310720
    s_waitcnt vmcnt(5)
    s_add_u32 s6, s6, 1
    s_and_b32 s68, s6, 3
    s_mul_i32 s52, s68, 40960
    s_add_u32 s52, s52, s87
    s_add_u32 s52, s52, 6144
    s_mul_i32 s57, s68, 196608
    s_add_u32 s65, s6, 1
    s_mul_i32 s66, s65, 0x01010101
    s_mov_b32 s45, s46
    s_add_u32 s46, s46, 15360
    s_cmp_ge_u32 s46, 161280
    s_cselect_b32 s46, 23040, s46
    s_add_u32 s57, s57, s71
    s_xor_b32 s58, s57, 8192
    v_mov_b32 v16, 0
    v_mov_b32 v17, 0
    v_mov_b32 v18, 0
    v_mov_b32 v19, 0
    v_mov_b32 v20, 0
    v_mov_b32 v21, 0
    v_mov_b32 v22, 0
    v_mov_b32 v23, 0
    v_mov_b32 v24, 0
    v_mov_b32 v25, 0
    v_mov_b32 v26, 0
    v_mov_b32 v27, 0
    v_mov_b32 v28, 0
    v_mov_b32 v29, 0
    v_mov_b32 v30, 0
    v_mov_b32 v31, 0
    v_mov_b32 v32, 0
    v_mov_b32 v33, 0
    v_mov_b32 v34, 0
    v_mov_b32 v35, 0
    s_waitcnt lgkmcnt(0)
    s_barrier
    s_mov_b32 m0, 6144
    s_nop 15
    s_nop 15
    s_branch L_rec_2_top0
L_rec_2_fin:
    s_waitcnt lgkmcnt(0)
    s_barrier
    s_branch L_rec_done
L_rec_3:
    v_min_u32 v64, 39, v43
    v_lshlrev_b32 v7, 3, v64
    v_add_u32 v7, s86, v7
    v_add_u32 v7, 384, v7
    v_lshrrev_b32 v65, 13, v7
    v_lshl_add_u32 v7, v65, 13, v7
    v_lshrrev_b32 v65, 1, v64
    v_cmp_le_u32 vcc, 10, v65
    s_nop 1
    v_cndmask_b32 v66, 0, 1, vcc
    v_mul_u32_u24 v67, 10, v66
    v_sub_u32 v65, v65, v67
    v_and_b32 v67, 1, v65
    v_lshl_add_u32 v67, v66, 1, v67
    v_add_u32 v67, 4, v67
    v_lshlrev_b32 v67, 4, v67
    v_lshrrev_b32 v65, 1, v65
    v_and_b32 v64, 1, v64
    v_and_b32 v66, 1, v65
    v_lshl_add_u32 v66, v66, 1, v64
    v_lshlrev_b32 v66, 8, v66
    v_bfe_u32 v68, v65, 1, 1
    v_lshl_add_u32 v66, v68, 7, v66
    v_lshlrev_b32 v64, 7, v64
    v_add_u32 v64, 1024, v64
    v_cmp_eq_u32 vcc, 4, v65
    s_nop 1
    v_cndmask_b32 v66, v66, v64, vcc
    v_add_u32 v6, v66, v67
    s_mov_b32 s78, -1
    s_mov_b32 s79, 0xff
    v_lshrrev_b32 v64, 2, v41
    v_lshl_add_u32 v64, v42, 2, v64
    v_lshlrev_b32 v64, 4, v64
    v_and_b32 v65, 1, v41
    v_lshl_add_u32 v96, v65, 3, v64
    v_bfe_u32 v65, v41, 1, 1
    v_lshlrev_b32 v65, 3, v65
    v_lshl_add_u32 v97, v96, 1, v65
    v_min_u32 v64, 47, v43
    v_lshlrev_b32 v64, 4, v64
    v_add_u32 v98, s86, v64
    v_lshrrev_b32 v65, 13, v98
    v_lshl_add_u32 v98, v65, 13, v98
    v_min_u32 v64, 19, v43
    v_lshrrev_b32 v65, 2, v64
    v_lshlrev_b32 v65, 7, v65
    v_and_b32 v64, 3, v64
    v_lshl_add_u32 v65, v64, 4, v65
    s_and_b32 s68, s5, 1
    s_lshl_b32 s68, s68, 6
    s_mul_i32 s69, s83, 640
    s_add_u32 s69, s69, s68
    v_add_u32 v99, s69, v65
    v_mov_b32 v104, -1
    v_mov_b32 v105, -1
    v_mov_b32 v106, -1
    v_mov_b32 v107, -1
    v_mov_b32 v114, 0
    v_mov_b32 v115, 0
    v_mov_b32 v122, 0
    v_mov_b32 v123, 0
    v_mov_b32 v142, 0
    v_mov_b32 v143, 0
    v_mov_b32 v150, 0
    v_mov_b32 v151, 0
    v_mov_b32 v64, 0xf0000000
    v_cmp_eq_u32 vcc, 0, v43
    s_nop 1
    v_cndmask_b32 v103, v64, 0, vcc
    v_and_b32 v64, 3, v43
    v_lshlrev_b32 v64, 9, v64
    s_sub_u32 s68, s92, 1536
    v_add_u32 v64, s68, v64
    v_mov_b32 v65, s93
    v_cmp_gt_u32 vcc, 4, v43
    s_nop 1
    v_cndmask_b32 v184, v65, v64, vcc
    v_bfe_u32 v64, v43, 2, 2
    v_lshlrev_b32 v64, 9, v64
    v_and_b32 v65, 3, v43
    v_lshl_add_u32 v64, v65, 2, v64
    s_add_u32 s68, s68, 128
    v_add_u32 v64, s68, v64
    v_cndmask_b32 v184, v64, v184, s[32:33]
    v_cndmask_b32 v187, 0, 1, s[32:33]
L_k0_51:
    s_add_u32 s7, s7, 1
    s_cmp_gt_u32 s7, 400000
    s_cbranch_scc1 L_exit
    buffer_load_dword v101, v184, s[36:39], 0 offen offset:0 sc1
    s_waitcnt vmcnt(0)
    v_cmp_gt_u32 vcc, v187, v101
    s_cbranch_vccnz L_k0_51
    v_lshrrev_b32 v64, 2, v43
    v_and_b32 v65, 1, v43
    v_lshl_add_u32 v64, v64, 1, v65
    v_lshlrev_b32 v185, 4, v64
    v_lshlrev_b32 v186, 3, v64
    v_add_u32 v183, 4096, v0
    v_and_b32 v255, 0x1ff, v0
    v_and_b32 v64, 3, v43
    s_lshl_b32 s68, s83, 2
    v_add_u32 v64, s68, v64
    v_lshlrev_b32 v100, 7, v64
    buffer_load_dwordx4 v[124:127], v0, s[36:39], s62 offen offset:0 sc1
    buffer_load_dwordx4 v[128:131], v0, s[36:39], s62 offen offset:1024 sc1
    buffer_load_dwordx4 v[132:135], v0, s[36:39], s62 offen offset:2048 sc1
    s_add_u32 s62, s62, 393216
    s_barrier
    s_add_u32 m0, s46, 9216
    v_and_b32 v44, 0x1ff, v0
    buffer_load_dwordx4 v0, s[36:39], s61 offen offset:0 sc1 lds
    buffer_load_dwordx4 v0, s[36:39], s61 offen offset:1024 sc1 lds
    buffer_load_dwordx4 v44, s[36:39], s61 offen offset:2048 sc1 lds
    s_add_u32 s61, s61, 1310720
    s_and_b32 s68, s6, 3
    s_mul_i32 s52, s68, 40960
    s_add_u32 s52, s52, s87
    s_add_u32 s52, s52, 9216
    s_mul_i32 s57, s68, 196608
    s_add_u32 s65, s6, 1
    s_mul_i32 s66, s65, 0x01010101
    s_mov_b32 s45, s46
    s_add_u32 s46, s46, 15360
    s_cmp_ge_u32 s46, 161280
    s_cselect_b32 s46, 23040, s46
    s_add_u32 s57, s57, s71
    s_xor_b32 s58, s57, 8192
    s_xor_b32 s68, s68, 2
    s_mul_i32 s59, s68, 196608
    s_add_u32 s59, s59, s71
    s_xor_b32 s60, s59, 8192
    s_add_u32 s68, s6, 3
    s_and_b32 s68, s68, 3
    s_mul_i32 s54, s68, 40960
    s_add_u32 s54, s54, s87
    v_mov_b32 v102, s6
    s_add_u32 s47, s47, 15360
    s_cmp_ge_u32 s47, 161280
    s_cselect_b32 s47, 23040, s47
    s_add_u32 s44, s44, 65536
    s_cmp_lt_u32 s6, 6
    s_cselect_b32 s95, 0xf0000000, s44
    s_add_u32 s68, s6, 2
    s_min_u32 s68, s68, 64
    s_sub_u32 s69, s6, 5
    s_max_i32 s69, s69, 0
    s_cmp_ge_u32 s6, 63
    s_cselect_b32 s69, 0, s69
    v_mov_b32 v252, s68
    v_mov_b32 v253, s69
    v_cndmask_b32 v187, v253, v252, s[32:33]
    v_cmp_gt_u32 s[90:91], v187, v101
    buffer_load_dwordx4 v[92:95], v40, s[40:43], 0 offen offset:1152
    v_mov_b32 v24, 0
    v_mov_b32 v25, 0
    v_mov_b32 v26, 0
    v_mov_b32 v27, 0
    v_mov_b32 v28, 0
    v_mov_b32 v29, 0
    v_mov_b32 v30, 0
    v_mov_b32 v31, 0
    v_mov_b32 v32, 0
    v_mov_b32 v33, 0
    v_mov_b32 v34, 0
    v_mov_b32 v35, 0
    s_waitcnt vmcnt(0)
    v_mov_b32 v108, v124
    v_mov_b32 v109, v125
    v_mov_b32 v116, v126
    v_mov_b32 v117, v127
    v_mov_b32 v110, v128
    v_mov_b32 v111, v129
    v_mov_b32 v118, v130
    v_mov_b32 v119, v131
    v_mov_b32 v112, v132
    v_mov_b32 v113, v133
    v_mov_b32 v120, v134
    v_mov_b32 v121, v135
    ds_write_b128 v0, v[92:95] offset:9216
    s_waitcnt lgkmcnt(0)
    s_branch L_rec_3_m
    .p2align 6
L_rec_3_top0:
    buffer_load_dwordx4 v0, s[36:39], s52 offen offset:0 sc1 lds
    s_nop 11
L_rec_3_top:
    buffer_load_dwordx4 v0, s[36:39], s52 offen offset:0 sc1 lds
    s_waitcnt vmcnt(1)
    ds_read_b128 v[92:95], v0 offset:9216
    s_waitcnt lgkmcnt(0)
    v_max3_u32 v40, v92, v93, v94
    v_max_u32 v40, v40, v95
    v_cmp_eq_u32 vcc, -1, v40
    s_cbranch_vccnz L_rm_52
L_rec_3_m:
    s_barrier
    s_cmp_lg_u64 s[90:91], 0
    s_cbranch_scc1 L_wk_54
L_wk_54_b:
    buffer_load_dword v101, v184, s[36:39], 0 offen offset:0 sc1
    buffer_load_dwordx4 v[124:127], v0, s[36:39], s62 offen offset:0 sc1
    ds_read_b128 v[56:59], v0 offset:0
    buffer_load_dwordx4 v[128:131], v0, s[36:39], s62 offen offset:1024 sc1
    ds_read_b128 v[60:63], v0 offset:1024
    buffer_load_dwordx4 v[132:135], v0, s[36:39], s62 offen offset:2048 sc1
    ds_read_b128 v[64:67], v0 offset:2048
    s_mov_b64 exec, s[34:35]
    buffer_store_dwordx4 v[144:147], v185, s[36:39], s64 offen offset:0 sc1
    buffer_store_dwordx2 v[148:149], v186, s[36:39], s64 offen offset:512 sc1
    s_mov_b64 exec, -1
    s_cmp_lt_u32 s6, 6
    s_cbranch_scc1 L_np_53_p
    buffer_load_dwordx4 v[188:191], v0, s[36:39], s95 offen offset:0 sc1
    ds_read_b128 v[68:71], v0 offset:3072
    buffer_load_dwordx4 v[192:195], v0, s[36:39], s95 offen offset:1024 sc1
    ds_read_b128 v[72:75], v0 offset:4096
    buffer_load_dwordx4 v[196:199], v0, s[36:39], s95 offen offset:2048 sc1
    ds_read_b128 v[76:79], v0 offset:5120
    buffer_load_dwordx4 v[200:203], v0, s[36:39], s95 offen offset:3072 sc1
    ds_read_b128 v[80:83], v0 offset:6144
    buffer_load_dwordx4 v[204:207], v183, s[36:39], s95 offen offset:0 sc1
    ds_read_b128 v[84:87], v0 offset:7168
    buffer_load_dwordx4 v[208:211], v183, s[36:39], s95 offen offset:1024 sc1
    ds_read_b128 v[88:91], v0 offset:8192
    buffer_load_dwordx4 v[212:215], v183, s[36:39], s95 offen offset:2048 sc1
    buffer_load_dwordx4 v[216:219], v183, s[36:39], s95 offen offset:3072 sc1
L_np_53_q:
L_np_53_a:
    s_cmp_ge_u32 s6, 58
    s_cbranch_scc1 L_np_53_u
L_np_53_b:
    buffer_store_dwordx4 v[104:107], v98, s[36:39], s59 offen offset:0 sc1
    s_waitcnt lgkmcnt(0)
    v_smfmac_f32_16x16x64_bf16 v[24:27], v[56:59], a[0:7], v1
    v_smfmac_f32_16x16x64_bf16 v[24:27], v[60:63], a[8:15], v1
    v_smfmac_f32_16x16x64_bf16 v[24:27], v[64:67], a[16:23], v1
    v_smfmac_f32_16x16x64_bf16 v[24:27], v[68:71], a[24:31], v1
    v_smfmac_f32_16x16x64_bf16 v[24:27], v[72:75], a[32:39], v1
    v_smfmac_f32_16x16x64_bf16 v[24:27], v[76:79], a[40:47], v1
    s_barrier
    ds_read_b64_tr_b16 v[136:137], v96 offset:10240
    ds_read_b64_tr_b16 v[138:139], v96 offset:10496
    ds_read_b64_tr_b16 v[140:141], v96 offset:10752
    s_waitcnt lgkmcnt(0)
    v_mfma_f32_16x16x32_bf16 v[152:155], v[108:111], v[136:139], 0
    v_mfma_f32_16x16x32_bf16 v[156:159], v[116:119], v[136:139], 0
    v_mfma_f32_16x16x32_bf16 v[152:155], v[112:115], v[140:143], v[152:155]
    v_mfma_f32_16x16x32_bf16 v[156:159], v[120:123], v[140:143], v[156:159]
    s_barrier
    ds_read_b64_tr_b16 v[144:145], v97 offset:11264
    ds_read_b64_tr_b16 v[146:147], v97 offset:11776
    ds_read_b64_tr_b16 v[148:149], v97 offset:12288
    s_nop 3
    v_cndmask_b32 v164, v152, v156, s[76:77]
    v_cndmask_b32 v165, v153, v157, s[76:77]
    v_cndmask_b32 v166, v154, v158, s[76:77]
    v_cndmask_b32 v167, v155, v159, s[76:77]
    s_waitcnt lgkmcnt(0)
    v_mfma_f32_16x16x32_bf16 v[160:163], v[144:147], v[136:139], 0
    v_mfma_f32_16x16x32_bf16 v[160:163], v[148:151], v[140:143], v[160:163]
    v_mul_f32 v164, s88, v164
    v_mul_f32 v165, s88, v165
    v_mul_f32 v166, s88, v166
    v_mul_f32 v167, s88, v167
    v_mov_b32_sdwa v164, s65 dst_sel:BYTE_0 dst_unused:UNUSED_PRESERVE src0_sel:BYTE_0
    s_nop 2
    v_cndmask_b32 v160, v160, v161, s[76:77]
    v_mul_f32 v160, s88, v160
    v_mov_b32_sdwa v165, v160 dst_sel:BYTE_0 dst_unused:UNUSED_PRESERVE src0_sel:BYTE_1
    v_mov_b32_sdwa v166, v160 dst_sel:BYTE_0 dst_unused:UNUSED_PRESERVE src0_sel:BYTE_2
    v_mov_b32_sdwa v167, v160 dst_sel:BYTE_0 dst_unused:UNUSED_PRESERVE src0_sel:BYTE_3
    s_nop 0
    buffer_store_dwordx4 v[164:167], v0, s[36:39], s55 offen offset:0
    v_smfmac_f32_16x16x64_bf16 v[24:27], v[80:83], a[48:55], v1
    v_add_u32 v11, s45, v3
    ds_read_b128 v[44:47], v11 offset:9216
    v_smfmac_f32_16x16x64_bf16 v[24:27], v[84:87], a[56:63], v1
    ds_read_b128 v[48:51], v11 offset:10240
    ds_read_b128 v[52:55], v11 offset:11264
    v_smfmac_f32_16x16x64_bf16 v[24:27], v[88:91], a[64:71], v1
    buffer_store_dwordx4 v[104:107], v98, s[36:39], s60 offen offset:0
    buffer_store_dwordx4 v[104:107], v99, s[36:39], s54 offen offset:0
    v_smfmac_f32_16x16x64_bf16 v[24:27], v[92:95], a[72:79], v1
    s_add_u32 s63, s63, 327680
    s_add_u32 s64, s64, 98304
    v_smfmac_f32_16x16x64_bf16 v[28:31], v[56:59], a[80:87], v1
    s_add_u32 s62, s62, 393216
    s_cmp_le_u32 s6, 6
    s_cselect_b32 s53, 0xf0000000, s67
    v_smfmac_f32_16x16x64_bf16 v[28:31], v[60:63], a[88:95], v1
    s_add_u32 s67, s67, 327680
    v_smfmac_f32_16x16x64_bf16 v[28:31], v[64:67], a[96:103], v1
    v_smfmac_f32_16x16x64_bf16 v[28:31], v[68:71], a[104:111], v1
    v_smfmac_f32_16x16x64_bf16 v[28:31], v[72:75], a[112:119], v1
    v_smfmac_f32_16x16x64_bf16 v[28:31], v[76:79], a[120:127], v1
    v_smfmac_f32_16x16x64_bf16 v[28:31], v[80:83], a[128:135], v1
    v_smfmac_f32_16x16x64_bf16 v[28:31], v[84:87], a[136:143], v1
    v_permlane32_swap_b32 v24, v26
    v_smfmac_f32_16x16x64_bf16 v[28:31], v[88:91], a[144:151], v1
    v_permlane32_swap_b32 v25, v27
    v_smfmac_f32_16x16x64_bf16 v[28:31], v[92:95], a[152:159], v1
    v_add_f32 v24, v24, v26
    v_add_f32 v25, v25, v27
    v_smfmac_f32_16x16x64_bf16 v[32:35], v[56:59], a[160:167], v1
    v_cvt_pk_bf16_f32 v10, v24, v25
    ds_write_b32 v0, v10 offset:19980
    v_smfmac_f32_16x16x64_bf16 v[32:35], v[60:63], a[168:175], v1
    v_accvgpr_write_b32 a244, v10
    v_smfmac_f32_16x16x64_bf16 v[32:35], v[64:67], a[176:183], v1
    buffer_load_dwordx4 v[16:19], v0, s[36:39], s56 offen offset:0 sc1
    buffer_load_dwordx4 v[20:23], v0, s[36:39], s56 offen offset:1024 sc1
    v_smfmac_f32_16x16x64_bf16 v[32:35], v[68:71], a[184:191], v1
    buffer_load_dwordx4 v[36:39], v0, s[36:39], s56 offen offset:2048 sc1
    buffer_load_dwordx4 v[40:43], v0, s[36:39], s56 offen offset:3072 sc1
    v_smfmac_f32_16x16x64_bf16 v[32:35], v[72:75], a[192:199], v1
    v_smfmac_f32_16x16x64_bf16 v[32:35], v[76:79], a[200:207], v1
    s_nop 1
    v_smfmac_f32_16x16x64_bf16 v[32:35], v[80:83], a[208:215], v1
    v_permlane32_swap_b32 v28, v30
    v_smfmac_f32_16x16x64_bf16 v[32:35], v[84:87], a[216:223], v1
    v_permlane32_swap_b32 v29, v31
    v_smfmac_f32_16x16x64_bf16 v[32:35], v[88:91], a[224:231], v1
    v_add_f32 v28, v28, v30
    v_add_f32 v29, v29, v31
    v_smfmac_f32_16x16x64_bf16 v[32:35], v[92:95], a[232:239], v1
    v_cvt_pk_bf16_f32 v11, v28, v29
    ds_write_b32 v0, v11 offset:21004
    v_accvgpr_write_b32 a248, v11
    s_nop 6
    v_permlane32_swap_b32 v32, v34
    v_permlane32_swap_b32 v33, v35
    v_pk_add_f32 v[32:33], v[32:33], v[34:35]
    v_cvt_pk_bf16_f32 v10, v32, v33
    ds_write_b32 v0, v10 offset:22028
    v_accvgpr_write_b32 a252, v10
    s_cmp_eq_u32 s6, 63
    s_cbranch_scc1 L_rec_3_fin
    s_add_u32 m0, s46, 9216
    v_and_b32 v25, 0x1ff, v0
    v_and_b32 v26, 0x1ff, v3
    v_mov_b32 v27, 40.0
    v_and_b32 v24, 0x70, v6
L_ps_55_a:
    s_waitcnt vmcnt(3) lgkmcnt(0)
    v_perm_b32 v72, v18, v17, s74
    v_perm_b32 v72, v19, v72, s75
    s_waitcnt vmcnt(2)
    v_perm_b32 v73, v22, v21, s74
    v_pk_add_f32 v[68:69], v[16:17], v[20:21]
    v_perm_b32 v73, v23, v73, s75
    v_pk_add_f32 v[70:71], v[18:19], v[22:23]
    v_add_f32 v72, v72, v73
    v_perm_b32 v74, v16, v20, s72
    s_waitcnt vmcnt(1)
    v_perm_b32 v73, v38, v37, s74
    v_pk_add_f32 v[68:69], v[68:69], v[36:37]
    v_perm_b32 v73, v39, v73, s75
    v_pk_add_f32 v[70:71], v[70:71], v[38:39]
    v_add_f32 v72, v72, v73
    v_perm_b32 v74, v36, v74, s73
    s_waitcnt vmcnt(0)
    v_perm_b32 v74, v40, v74, s89
    v_perm_b32 v73, v42, v41, s74
    v_cmp_ne_u32 vcc, s66, v74
    v_perm_b32 v73, v43, v73, s75
    v_pk_add_f32 v[68:69], v[68:69], v[40:41]
    v_pk_add_f32 v[70:71], v[70:71], v[42:43]
    v_add_f32 v72, v72, v73
    v_max3_f32 v73, |v68|, |v69|, |v70|
    v_max3_f32 v73, v73, |v71|, |v72|
    s_cbranch_vccnz L_ps_55_r
L_ps_55_j:
    v_cmp_nle_f32 vcc, v73, v27
    s_barrier
L_ps_55_x:
    v_exp_f32 v32, v72
    v_exp_f32 v28, v68
    v_exp_f32 v29, v69
    s_cbranch_vccnz L_ps_55_m
    v_mov_b32_dpp v74, v32 row_ror:8 row_mask:0xf bank_mask:0xf
    v_cvt_pk_bf16_f32 v12, v32, v74
    v_exp_f32 v30, v70
    v_cvt_pk_bf16_f32 v76, v28, v29
    v_mfma_f32_16x16x32_bf16 v[60:63], a[248:251], v[12:15], 0
    buffer_load_dwordx4 v0, s[36:39], s61 offen offset:0 sc1 lds
    v_exp_f32 v31, v71
    v_mfma_f32_16x16x32_bf16 v[56:59], a[244:247], v[12:15], 0
    buffer_store_dword v102, v103, s[36:39], s94 offen offset:0 sc1
    v_cvt_pk_bf16_f32 v77, v30, v31
    v_mov_b32_dpp v78, v76 row_ror:8 row_mask:0xf bank_mask:0xf
    v_mfma_f32_16x16x32_bf16 v[64:67], a[252:255], v[12:15], 0
    buffer_load_dwordx4 v0, s[36:39], s61 offen offset:1024 sc1 lds
    v_mov_b32_dpp v79, v77 row_ror:8 row_mask:0xf bank_mask:0xf
    v_add_f32 v73, v28, v29
    v_add_f32 v75, v30, v31
    v_mfma_f32_16x16x32_bf16 v[60:63], v[48:51], v[76:79], v[60:63]
    v_add_f32 v73, v73, v32
    v_add_f32 v73, v73, v75
    v_mfma_f32_16x16x32_bf16 v[56:59], v[44:47], v[76:79], v[56:59]
    s_nop 0
    v_add_f32_dpp v74, v73, v73 row_ror:8 row_mask:0xf bank_mask:0xf
    v_mfma_f32_16x16x32_bf16 v[64:67], v[52:55], v[76:79], v[64:67]
    v_add_f32_dpp v75, v73, v73 row_ror:8 row_mask:0xf bank_mask:0xf
    s_nop 1
    v_permlane16_swap_b32 v74, v75
    v_add_f32 v73, v74, v75
    v_add_f32 v74, v74, v75
    v_mov_b32_dpp v56, v60 row_ror:8 row_mask:0xf bank_mask:0xc
    v_mov_b32_dpp v57, v61 row_ror:8 row_mask:0xf bank_mask:0xc
    v_permlane32_swap_b32 v73, v74
    v_mov_b32_dpp v58, v62 row_ror:8 row_mask:0xf bank_mask:0xc
    v_mov_b32_dpp v59, v63 row_ror:8 row_mask:0xf bank_mask:0xc
    ds_write_b128 v0, v[56:59] offset:17920
    v_add_f32 v73, v73, v74
    v_rcp_f32 v73, v73
    v_mov_b32_dpp v64, v66 row_ror:8 row_mask:0xf bank_mask:0xc
    v_mov_b32_dpp v65, v67 row_ror:8 row_mask:0xf bank_mask:0xc
    ds_write_b32 v26, v73 offset:19468
    ds_write_b64 v5, v[64:65] offset:18944
    s_mov_b64 exec, s[78:79]
    s_waitcnt lgkmcnt(0)
    s_barrier
    ds_read_b128 v[72:75], v24 offset:19456
    ds_read_b128 v[56:59], v6 offset:13312
    ds_read_b128 v[60:63], v6 offset:14848
    ds_read_b128 v[64:67], v6 offset:16384
    ds_read_b128 v[68:71], v6 offset:17920
    s_waitcnt lgkmcnt(3)
    v_pk_mul_f32 v[76:77], v[56:57], v[72:73] op_sel_hi:[1,0]
    v_pk_mul_f32 v[78:79], v[58:59], v[72:73] op_sel_hi:[1,0]
    s_waitcnt lgkmcnt(2)
    v_pk_fma_f32 v[76:77], v[60:61], v[72:73], v[76:77] op_sel:[0,1,0] op_sel_hi:[1,1,1]
    v_pk_fma_f32 v[78:79], v[62:63], v[72:73], v[78:79] op_sel:[0,1,0] op_sel_hi:[1,1,1]
    s_waitcnt lgkmcnt(1)
    v_pk_fma_f32 v[76:77], v[64:65], v[74:75], v[76:77] op_sel_hi:[1,0,1]
    v_pk_fma_f32 v[78:79], v[66:67], v[74:75], v[78:79] op_sel_hi:[1,0,1]
    s_waitcnt lgkmcnt(0)
    v_pk_fma_f32 v[76:77], v[68:69], v[74:75], v[76:77] op_sel:[0,1,0] op_sel_hi:[1,1,1]
    v_pk_fma_f32 v[78:79], v[70:71], v[74:75], v[78:79] op_sel:[0,1,0] op_sel_hi:[1,1,1]
    v_cvt_pk_bf16_f32 v76, v76, v77
    v_cvt_pk_bf16_f32 v77, v78, v79
    v_min_u32 v76, -2, v76
    buffer_store_dwordx2 v[76:77], v7, s[36:39], s57 offen offset:0 sc1
    buffer_store_dwordx2 v[76:77], v7, s[36:39], s58 offen offset:0
    s_mov_b64 exec, -1
    buffer_load_dwordx4 v25, s[36:39], s61 offen offset:2048 sc1 lds
    s_add_u32 s61, s61, 1310720
    s_cmp_le_u32 s6, 6
    s_cbranch_scc1 L_bq_56_s
    buffer_store_dwordx4 v[228:231], v0, s[36:39], s53 offen offset:0 sc1
    buffer_store_dwordx4 v[232:235], v0, s[36:39], s53 offen offset:1024 sc1
    s_mov_b32 exec_hi, 0
    buffer_store_dwordx4 v[236:239], v0, s[36:39], s53 offen offset:2048 sc1
    s_mov_b32 exec_hi, -1
L_bq_56:
    s_waitcnt vmcnt(9)
    ds_read_b128 v[168:171], v0 offset:19968
    ds_read_b128 v[172:175], v0 offset:20992
    ds_read_b128 v[176:179], v0 offset:22016
    v_add_u32 v180, s45, v0
    v_add_u32 v181, s47, v3
    v_add_u32 v182, s47, v0
    ds_read_b128 v[56:59], v181 offset:0
    ds_read_b128 v[60:63], v181 offset:1024
    ds_read_b128 v[64:67], v181 offset:2048
    ds_read_b128 v[68:71], v181 offset:3072
    ds_read_b128 v[72:75], v181 offset:4096
    ds_read_b128 v[76:79], v181 offset:5120
    ds_read_b128 v[80:83], v181 offset:6144
    ds_read_b128 v[84:87], v181 offset:7168
    ds_read_b128 v[88:91], v181 offset:8192
    ds_read_b128 v[92:95], v181 offset:9216
    ds_read_b128 v[16:19], v181 offset:10240
    ds_read_b128 v[20:23], v181 offset:11264
    s_mov_b32 s41, s95
    v_mov_b32 v220, v190
    v_mov_b32 v224, v191
    v_mov_b32 v190, 0
    v_mov_b32 v191, 0
    v_mov_b32 v221, v198
    v_mov_b32 v225, v199
    v_mov_b32 v198, 0
    v_mov_b32 v199, 0
    s_waitcnt lgkmcnt(9)
    ds_read_b128 v[44:47], v182 offset:12288
    ds_read_b128 v[48:51], v182 offset:13312
    ds_read_b128 v[52:55], v182 offset:14336
    v_mfma_f32_16x16x32_bf16 v[228:231], v[56:59], v[188:191], 0
    v_mov_b32 v222, v206
    v_mov_b32 v226, v207
    v_mfma_f32_16x16x32_bf16 v[232:235], v[56:59], v[192:195], 0
    v_mov_b32 v206, 0
    v_mov_b32 v207, 0
    v_mfma_f32_16x16x32_bf16 v[236:239], v[60:63], v[188:191], 0
    v_mov_b32 v223, v214
    v_mov_b32 v227, v215
    v_mfma_f32_16x16x32_bf16 v[240:243], v[60:63], v[192:195], 0
    v_mov_b32 v214, 0
    v_mov_b32 v215, 0
    v_mfma_f32_16x16x32_bf16 v[244:247], v[64:67], v[188:191], 0
    v_mov_b32 v108, v124
    v_mov_b32 v109, v125
    v_mfma_f32_16x16x32_bf16 v[248:251], v[64:67], v[192:195], 0
    v_mov_b32 v116, v126
    v_mov_b32 v117, v127
    s_waitcnt lgkmcnt(9)
    v_mfma_f32_16x16x32_bf16 v[228:231], v[68:71], v[196:199], v[228:231]
    v_mov_b32 v110, v128
    v_mov_b32 v111, v129
    v_mfma_f32_16x16x32_bf16 v[232:235], v[68:71], v[200:203], v[232:235]
    v_mov_b32 v118, v130
    v_mov_b32 v119, v131
    v_mfma_f32_16x16x32_bf16 v[236:239], v[72:75], v[196:199], v[236:239]
    v_mov_b32 v112, v132
    v_mov_b32 v113, v133
    v_mfma_f32_16x16x32_bf16 v[240:243], v[72:75], v[200:203], v[240:243]
    v_mov_b32 v120, v134
    v_mov_b32 v121, v135
    v_mfma_f32_16x16x32_bf16 v[244:247], v[76:79], v[196:199], v[244:247]
    v_mov_b32 v24, 0
    v_mov_b32 v25, 0
    v_mfma_f32_16x16x32_bf16 v[248:251], v[76:79], v[200:203], v[248:251]
    v_mov_b32 v26, 0
    v_mov_b32 v27, 0
    s_waitcnt lgkmcnt(6)
    v_mfma_f32_16x16x32_bf16 v[228:231], v[80:83], v[204:207], v[228:231]
    v_mov_b32 v28, 0
    v_mov_b32 v29, 0
    v_mfma_f32_16x16x32_bf16 v[232:235], v[80:83], v[208:211], v[232:235]
    v_mov_b32 v30, 0
    v_mov_b32 v31, 0
    v_mfma_f32_16x16x32_bf16 v[236:239], v[84:87], v[204:207], v[236:239]
    v_mov_b32 v32, 0
    v_mov_b32 v33, 0
    v_mfma_f32_16x16x32_bf16 v[240:243], v[84:87], v[208:211], v[240:243]
    v_mov_b32 v34, 0
    v_mov_b32 v35, 0
    v_mfma_f32_16x16x32_bf16 v[244:247], v[88:91], v[204:207], v[244:247]
    s_add_u32 s6, s6, 1
    s_and_b32 s68, s6, 3
    s_mul_i32 s52, s68, 40960
    v_mfma_f32_16x16x32_bf16 v[248:251], v[88:91], v[208:211], v[248:251]
    s_add_u32 s52, s52, s87
    s_add_u32 s52, s52, 9216
    s_mul_i32 s57, s68, 196608
    s_waitcnt lgkmcnt(3)
    v_mfma_f32_16x16x32_bf16 v[228:231], v[92:95], v[212:215], v[228:231]
    s_add_u32 s65, s6, 1
    s_mul_i32 s66, s65, 0x01010101
    s_mov_b32 s45, s46
    v_mfma_f32_16x16x32_bf16 v[232:235], v[92:95], v[216:219], v[232:235]
    s_add_u32 s46, s46, 15360
    s_cmp_ge_u32 s46, 161280
    s_cselect_b32 s46, 23040, s46
    v_mfma_f32_16x16x32_bf16 v[236:239], v[16:19], v[212:215], v[236:239]
    s_add_u32 s57, s57, s71
    s_xor_b32 s58, s57, 8192
    s_xor_b32 s68, s68, 2
    v_mfma_f32_16x16x32_bf16 v[240:243], v[16:19], v[216:219], v[240:243]
    s_mul_i32 s59, s68, 196608
    s_add_u32 s59, s59, s71
    s_xor_b32 s60, s59, 8192
    v_mfma_f32_16x16x32_bf16 v[244:247], v[20:23], v[212:215], v[244:247]
    s_add_u32 s68, s6, 3
    s_and_b32 s68, s68, 3
    s_mul_i32 s54, s68, 40960
    v_mfma_f32_16x16x32_bf16 v[248:251], v[20:23], v[216:219], v[248:251]
    s_add_u32 s54, s54, s87
    v_mov_b32 v102, s6
    s_add_u32 s47, s47, 15360
    s_waitcnt lgkmcnt(0)
    v_mfma_f32_16x16x32_bf16 v[228:231], v[44:47], v[220:223], v[228:231]
    s_cmp_ge_u32 s47, 161280
    s_cselect_b32 s47, 23040, s47
    s_add_u32 s44, s44, 65536
    v_mfma_f32_16x16x32_bf16 v[232:235], v[44:47], v[224:227], v[232:235]
    s_cmp_lt_u32 s6, 6
    s_cselect_b32 s95, 0xf0000000, s44
    s_add_u32 s68, s6, 2
    v_mfma_f32_16x16x32_bf16 v[236:239], v[48:51], v[220:223], v[236:239]
    s_min_u32 s68, s68, 64
    s_sub_u32 s69, s6, 5
    s_max_i32 s69, s69, 0
    v_mfma_f32_16x16x32_bf16 v[240:243], v[48:51], v[224:227], v[240:243]
    s_cmp_ge_u32 s6, 63
    s_cselect_b32 s69, 0, s69
    v_mov_b32 v252, s68
    v_mfma_f32_16x16x32_bf16 v[244:247], v[52:55], v[220:223], v[244:247]
    v_mov_b32 v253, s69
    v_cndmask_b32 v187, v253, v252, s[32:33]
    v_mfma_f32_16x16x32_bf16 v[248:251], v[52:55], v[224:227], v[248:251]
    v_cmp_gt_u32 s[90:91], v187, v101
    ds_write_b128 v180, v[168:171] offset:12288
    ds_write_b128 v180, v[172:175] offset:13312
    ds_write_b128 v180, v[176:179] offset:14336
    v_cvt_pk_bf16_f32 v228, v228, v229
    v_cvt_pk_bf16_f32 v229, v230, v231
    v_cvt_pk_bf16_f32 v230, v232, v233
    v_cvt_pk_bf16_f32 v231, v234, v235
    v_cvt_pk_bf16_f32 v232, v236, v237
    v_cvt_pk_bf16_f32 v233, v238, v239
    v_cvt_pk_bf16_f32 v234, v240, v241
    v_cvt_pk_bf16_f32 v235, v242, v243
    v_cvt_pk_bf16_f32 v236, v244, v245
    v_cvt_pk_bf16_f32 v237, v246, v247
    v_cvt_pk_bf16_f32 v238, v248, v249
    v_cvt_pk_bf16_f32 v239, v250, v251
    s_waitcnt lgkmcnt(0)
    s_barrier
    s_mov_b32 m0, 9216
    s_nop 15
    s_nop 15
    s_branch L_rec_3_top0
L_rec_3_fin:
    s_waitcnt lgkmcnt(0)
    s_barrier
    ds_read_b128 v[168:171], v0 offset:19968
    ds_read_b128 v[172:175], v0 offset:20992
    ds_read_b128 v[176:179], v0 offset:22016
    s_mov_b64 exec, s[34:35]
    buffer_store_dwordx4 v[144:147], v185, s[36:39], s64 offen offset:0 sc1
    buffer_store_dwordx2 v[148:149], v186, s[36:39], s64 offen offset:512 sc1
    s_mov_b64 exec, -1
    buffer_store_dwordx4 v[228:231], v0, s[36:39], s53 offen offset:0 sc1
    buffer_store_dwordx4 v[232:235], v0, s[36:39], s53 offen offset:1024 sc1
    s_mov_b32 exec_hi, 0
    buffer_store_dwordx4 v[236:239], v0, s[36:39], s53 offen offset:2048 sc1
    s_mov_b32 exec_hi, -1
    s_waitcnt lgkmcnt(0)
    buffer_store_dwordx4 v[168:171], v3, s[36:39], s63 offen offset:0 sc1
    buffer_store_dwordx4 v[172:175], v3, s[36:39], s63 offen offset:1024 sc1
    s_mov_b64 exec, s[80:81]
    buffer_store_dwordx4 v[176:179], v3, s[36:39], s63 offen offset:2048 sc1
    s_mov_b64 exec, -1
    v_mov_b32 v102, 64
    s_waitcnt vmcnt(0)
    buffer_store_dword v102, v103, s[36:39], s94 offen offset:0 sc1
    s_branch L_rec_done
L_rm_43:
    s_add_u32 s7, s7, 1
    s_cmp_gt_u32 s7, 400000
    s_cbranch_scc0 L_rec_0_top
    s_branch L_exit
L_ps_44_b:
    buffer_load_dwordx4 v[16:19], v0, s[36:39], s56 offen offset:0 sc1
    buffer_load_dwordx4 v[20:23], v0, s[36:39], s56 offen offset:1024 sc1
    buffer_load_dwordx4 v[36:39], v0, s[36:39], s56 offen offset:2048 sc1
    buffer_load_dwordx4 v[40:43], v0, s[36:39], s56 offen offset:3072 sc1
    s_branch L_ps_44_a
L_ps_44_r:
    s_add_u32 s7, s7, 1
    s_cmp_gt_u32 s7, 400000
    s_cbranch_scc0 L_ps_44_b
    s_branch L_exit
L_ps_44_m:
    v_max3_f32 v73, v68, v69, v70
    v_max3_f32 v73, v73, v71, v72
    s_nop 1
    v_max_f32_dpp v74, v73, v73 row_ror:8 row_mask:0xf bank_mask:0xf
    v_max_f32_dpp v75, v73, v73 row_ror:8 row_mask:0xf bank_mask:0xf
    s_nop 0
    s_nop 0
    v_permlane16_swap_b32 v74, v75
    v_max_f32 v73, v74, v75
    v_max_f32 v74, v74, v75
    s_nop 0
    s_nop 0
    v_permlane32_swap_b32 v73, v74
    v_max_f32 v74, v73, v74
    v_sub_f32 v72, v72, v74
    v_pk_add_f32 v[68:69], v[68:69], v[74:75] op_sel_hi:[1,0] neg_lo:[0,1] neg_hi:[0,1]
    v_pk_add_f32 v[70:71], v[70:71], v[74:75] op_sel_hi:[1,0] neg_lo:[0,1] neg_hi:[0,1]
    s_mov_b64 vcc, 0
    s_branch L_ps_44_x
L_rm_46:
    s_add_u32 s7, s7, 1
    s_cmp_gt_u32 s7, 400000
    s_cbranch_scc0 L_rec_1_top
    s_branch L_exit
L_ps_47_b:
    buffer_load_dwordx4 v[16:19], v0, s[36:39], s56 offen offset:0 sc1
    buffer_load_dwordx4 v[20:23], v0, s[36:39], s56 offen offset:1024 sc1
    buffer_load_dwordx4 v[36:39], v0, s[36:39], s56 offen offset:2048 sc1
    buffer_load_dwordx4 v[40:43], v0, s[36:39], s56 offen offset:3072 sc1
    s_branch L_ps_47_a
L_ps_47_r:
    s_add_u32 s7, s7, 1
    s_cmp_gt_u32 s7, 400000
    s_cbranch_scc0 L_ps_47_b
    s_branch L_exit
L_ps_47_m:
    v_max3_f32 v73, v68, v69, v70
    v_max3_f32 v73, v73, v71, v72
    s_nop 1
    v_max_f32_dpp v74, v73, v73 row_ror:8 row_mask:0xf bank_mask:0xf
    v_max_f32_dpp v75, v73, v73 row_ror:8 row_mask:0xf bank_mask:0xf
    s_nop 0
    s_nop 0
    v_permlane16_swap_b32 v74, v75
    v_max_f32 v73, v74, v75
    v_max_f32 v74, v74, v75
    s_nop 0
    s_nop 0
    v_permlane32_swap_b32 v73, v74
    v_max_f32 v74, v73, v74
    v_sub_f32 v72, v72, v74
    v_pk_add_f32 v[68:69], v[68:69], v[74:75] op_sel_hi:[1,0] neg_lo:[0,1] neg_hi:[0,1]
    v_pk_add_f32 v[70:71], v[70:71], v[74:75] op_sel_hi:[1,0] neg_lo:[0,1] neg_hi:[0,1]
    s_mov_b64 vcc, 0
    s_branch L_ps_47_x
L_rm_49:
    s_add_u32 s7, s7, 1
    s_cmp_gt_u32 s7, 400000
    s_cbranch_scc0 L_rec_2_top
    s_branch L_exit
L_ps_50_b:
    buffer_load_dwordx4 v[16:19], v0, s[36:39], s56 offen offset:0 sc1
    buffer_load_dwordx4 v[20:23], v0, s[36:39], s56 offen offset:1024 sc1
    buffer_load_dwordx4 v[36:39], v0, s[36:39], s56 offen offset:2048 sc1
    buffer_load_dwordx4 v[40:43], v0, s[36:39], s56 offen offset:3072 sc1
    s_branch L_ps_50_a
L_ps_50_r:
    s_add_u32 s7, s7, 1
    s_cmp_gt_u32 s7, 400000
    s_cbranch_scc0 L_ps_50_b
    s_branch L_exit
L_ps_50_m:
    v_max3_f32 v73, v68, v69, v70
    v_max3_f32 v73, v73, v71, v72
    s_nop 1
    v_max_f32_dpp v74, v73, v73 row_ror:8 row_mask:0xf bank_mask:0xf
    v_max_f32_dpp v75, v73, v73 row_ror:8 row_mask:0xf bank_mask:0xf
    s_nop 0
    s_nop 0
    v_permlane16_swap_b32 v74, v75
    v_max_f32 v73, v74, v75
    v_max_f32 v74, v74, v75
    s_nop 0
    s_nop 0
    v_permlane32_swap_b32 v73, v74
    v_max_f32 v74, v73, v74
    v_sub_f32 v72, v72, v74
    v_pk_add_f32 v[68:69], v[68:69], v[74:75] op_sel_hi:[1,0] neg_lo:[0,1] neg_hi:[0,1]
    v_pk_add_f32 v[70:71], v[70:71], v[74:75] op_sel_hi:[1,0] neg_lo:[0,1] neg_hi:[0,1]
    s_mov_b64 vcc, 0
    s_branch L_ps_50_x
L_rm_52:
    s_add_u32 s7, s7, 1
    s_cmp_gt_u32 s7, 400000
    s_cbranch_scc0 L_rec_3_top
    s_branch L_exit
L_wk_54:
    s_add_u32 s7, s7, 1
    s_cmp_gt_u32 s7, 400000
    s_cbranch_scc1 L_exit
    buffer_load_dword v101, v184, s[36:39], 0 offen offset:0 sc1
    s_waitcnt vmcnt(0)
    v_cmp_gt_u32 vcc, v187, v101
    s_cbranch_vccnz L_wk_54
    s_branch L_wk_54_b
L_np_53_p:
    ds_read_b128 v[68:71], v0 offset:3072
    ds_read_b128 v[72:75], v0 offset:4096
    ds_read_b128 v[76:79], v0 offset:5120
    ds_read_b128 v[80:83], v0 offset:6144
    ds_read_b128 v[84:87], v0 offset:7168
    ds_read_b128 v[88:91], v0 offset:8192
    s_branch L_np_53_q
L_np_53_u:
    buffer_store_dwordx4 v[168:171], v3, s[36:39], s63 offen offset:0 sc1
    buffer_store_dwordx4 v[172:175], v3, s[36:39], s63 offen offset:1024 sc1
    s_mov_b64 exec, s[80:81]
    buffer_store_dwordx4 v[176:179], v3, s[36:39], s63 offen offset:2048 sc1
    s_mov_b64 exec, -1
    s_branch L_np_53_b
L_ps_55_b:
    buffer_load_dwordx4 v[16:19], v0, s[36:39], s56 offen offset:0 sc1
    buffer_load_dwordx4 v[20:23], v0, s[36:39], s56 offen offset:1024 sc1
    buffer_load_dwordx4 v[36:39], v0, s[36:39], s56 offen offset:2048 sc1
    buffer_load_dwordx4 v[40:43], v0, s[36:39], s56 offen offset:3072 sc1
    s_branch L_ps_55_a
L_ps_55_r:
    s_add_u32 s7, s7, 1
    s_cmp_gt_u32 s7, 400000
    s_cbranch_scc0 L_ps_55_b
    s_branch L_exit
L_ps_55_m:
    v_max3_f32 v73, v68, v69, v70
    v_max3_f32 v73, v73, v71, v72
    s_nop 1
    v_max_f32_dpp v74, v73, v73 row_ror:8 row_mask:0xf bank_mask:0xf
    v_max_f32_dpp v75, v73, v73 row_ror:8 row_mask:0xf bank_mask:0xf
    s_nop 0
    s_nop 0
    v_permlane16_swap_b32 v74, v75
    v_max_f32 v73, v74, v75
    v_max_f32 v74, v74, v75
    s_nop 0
    s_nop 0
    v_permlane32_swap_b32 v73, v74
    v_max_f32 v74, v73, v74
    v_sub_f32 v72, v72, v74
    v_pk_add_f32 v[68:69], v[68:69], v[74:75] op_sel_hi:[1,0] neg_lo:[0,1] neg_hi:[0,1]
    v_pk_add_f32 v[70:71], v[70:71], v[74:75] op_sel_hi:[1,0] neg_lo:[0,1] neg_hi:[0,1]
    s_mov_b64 vcc, 0
    s_branch L_ps_55_x
L_bq_56_s:
    s_waitcnt vmcnt(6)
    s_branch L_bq_56
L_rec_done:
    s_waitcnt vmcnt(0)
    s_barrier
    s_branch L_exit
L_code_end:

.section .rodata,"a"
.p2align 6
.amdhsa_kernel gated_mix__linear_attn_block__memory_aug_recurrent_mem_tr__prompt_kernel
  .amdhsa_next_free_vgpr 512
  .amdhsa_next_free_sgpr 102
  .amdhsa_accum_offset 256
  .amdhsa_group_segment_fixed_size 0
  .amdhsa_kernarg_size 112
  .amdhsa_user_sgpr_count 2
  .amdhsa_user_sgpr_kernarg_segment_ptr 1
  .amdhsa_system_sgpr_workgroup_id_x 1
.end_amdhsa_kernel
```
